```python
import torch

def _softmax(x, axis=-1):
    return torch.softmax(x, dim=axis)
def _gelu(x):
    return torch.nn.functional.gelu(x, approximate="tanh")
def _silu(x):
    return torch.nn.functional.silu(x)
def _sigmoid(x):
    return torch.sigmoid(x)
def _layernorm(x, axis=-1, eps=1e-5):
    m = x.mean(dim=axis, keepdim=True)
    v = x.var(dim=axis, keepdim=True, unbiased=False)
    return (x - m) / torch.sqrt(v + eps)
def _scatter_add(tgt, idx, src, axis=0):
    return tgt.clone().index_add_(axis, idx, src)
def _segment_sum(src, seg, n):
    out = torch.zeros((n,) + src.shape[1:], dtype=src.dtype)
    return out.index_add_(0, seg, src)
def _pad(x, pw):
    flat = tuple(v for pair in reversed(pw) for v in pair)
    return torch.nn.functional.pad(x, flat)

kernel_name = 'standalone__mha_softmax__near_ridge'

def setup_inputs():

    _w = (lambda a: (lambda t: t.to(torch.bfloat16) if t.is_floating_point() else t)(torch.as_tensor(a)))
    B, H, Sq, Sk, D = 32, 32, 384, 384, 192
    return {
        "q": _w((lambda *s: torch.randn(*s, dtype=torch.bfloat16) * 0.8)(B, H, Sq, D)),
        "k": _w((lambda *s: torch.randn(*s, dtype=torch.bfloat16) * 0.8)(B, H, Sk, D)),
        "v": _w((lambda *s: torch.randn(*s, dtype=torch.bfloat16) * 0.05)(B, H, Sk, D)),
    }

def reference(q, k, v):
    scale = q.shape[-1] ** -0.5
    scores = torch.einsum("bhqd,bhkd->bhqk", q, k) * scale
    p = _softmax(scores, axis=-1)
    return torch.einsum("bhqk,bhkd->bhqd", p, v)
```

```asm
; @launch grid=(256,1,1) block=(256,1,1) lds=159744
.amdgcn_target "amdgcn-amd-amdhsa--gfx950"
.text
.globl standalone__mha_softmax__near_ridge_kernel
.p2align 8
.type standalone__mha_softmax__near_ridge_kernel,@function
standalone__mha_softmax__near_ridge_kernel:
    s_cmp_ge_u32 s2, 256
    s_cbranch_scc1 L_end
    s_load_dwordx4 s[40:43], s[0:1], 0
    s_load_dwordx4 s[44:47], s[0:1], 16
    v_lshrrev_b32 v1, 6, v0
    v_and_b32 v5, 63, v0
    v_readfirstlane_b32 s24, v1
    s_mov_b32 s29, 0x3dd53b95
    s_mov_b32 s31, 0x41000000
    s_mov_b32 s25, 0
    s_mov_b32 s84, s29
    s_mov_b32 s85, s29
    s_mov_b32 s86, 0x3f803f80
    v_bfe_u32 v1, v5, 3, 2
    v_mul_u32_u24 v1, 3072, v1
    v_and_b32 v2, 7, v5
    v_lshl_add_u32 v1, v2, 7, v1
    v_bfe_u32 v2, v5, 1, 3
    v_lshrrev_b32 v3, 5, v5
    v_xor_b32 v2, v2, v3
    v_xor_b32 v4, 0, v2
    v_lshl_add_u32 v240, v4, 4, v1
    v_xor_b32 v4, 2, v2
    v_lshl_add_u32 v241, v4, 4, v1
    v_xor_b32 v4, 4, v2
    v_lshl_add_u32 v242, v4, 4, v1
    v_xor_b32 v4, 6, v2
    v_lshl_add_u32 v243, v4, 4, v1
    v_bfe_u32 v1, v5, 2, 2
    v_lshl_add_u32 v1, v3, 2, v1
    v_lshlrev_b32 v1, 7, v1
    v_and_b32 v2, 1, v5
    v_lshl_add_u32 v1, v2, 3, v1
    v_bfe_u32 v2, v5, 1, 1
    v_bfe_u32 v4, v5, 4, 1
    v_lshl_add_u32 v2, v4, 1, v2
    v_bfe_u32 v4, v5, 3, 1
    v_lshl_add_u32 v2, v4, 2, v2
    v_xor_b32 v4, 0, v2
    v_lshl_add_u32 v244, v4, 4, v1
    v_xor_b32 v4, 4, v2
    v_lshl_add_u32 v245, v4, 4, v1
    s_mul_i32 s30, s24, 3072
    s_lshl_b32 s32, s24, 2
    v_lshrrev_b32 v1, 3, v5
    v_mul_u32_u24 v1, 384, v1
    v_add_u32 v1, s30, v1
    v_and_b32 v2, 7, v5
    v_lshrrev_b32 v3, 4, v5
    v_add_u32 v4, s32, v3
    v_and_b32 v4, 7, v4
    v_xor_b32 v4, v4, v2
    v_lshl_add_u32 v246, v4, 4, v1
    v_and_b32 v4, 1, v3
    v_lshlrev_b32 v4, 2, v4
    v_xor_b32 v4, v4, v2
    v_lshl_add_u32 v247, v4, 4, v1
    s_mul_i32 s36, s24, 12288
    s_and_b32 s32, s24, 1
    s_lshl_b32 s32, s32, 6
    s_add_u32 s38, s36, s32
    s_xor_b32 s39, s38, 64
    s_mul_i32 s35, s24, 33792
    s_mul_i32 s27, s2, 147456
    s_mov_b32 s26, s27
    s_add_u32 s28, s27, s35
    s_waitcnt lgkmcnt(0)
    s_mov_b32 s8, s40
    s_and_b32 s9, s41, 0xffff
    s_mov_b32 s10, 0
    s_mov_b32 s11, 0x20000
    s_mov_b32 s12, s42
    s_and_b32 s13, s43, 0xffff
    s_mov_b32 s14, 0
    s_mov_b32 s15, 0x20000
    s_mov_b32 s16, s44
    s_and_b32 s17, s45, 0xffff
    s_mov_b32 s18, 0
    s_mov_b32 s19, 0x20000
    s_mov_b32 s64, s40
    s_and_b32 s65, s41, 0xffff
    s_mov_b32 s66, 150994944
    s_mov_b32 s67, 0x20000
    s_mov_b32 s68, s42
    s_and_b32 s69, s43, 0xffff
    s_mov_b32 s70, 150994944
    s_mov_b32 s71, 0x20000
    s_mov_b32 s72, s44
    s_and_b32 s73, s45, 0xffff
    s_mov_b32 s74, 150994944
    s_mov_b32 s75, 0x20000
    s_mov_b32 s20, s46
    s_and_b32 s21, s47, 0xffff
    s_mov_b32 s22, 0
    s_mov_b32 s23, 0x20000
    s_add_u32 m0, s30, 0
    s_add_u32 s33, s27, 0
    buffer_load_dwordx4 v246, s[64:67], s33 offen offset:0 nt lds
    s_add_u32 m0, s30, 896
    s_nop 0
    buffer_load_dwordx4 v246, s[64:67], s33 offen offset:128 nt lds
    s_add_u32 m0, s30, 1792
    s_nop 0
    buffer_load_dwordx4 v246, s[64:67], s33 offen offset:256 nt lds
    s_add_u32 m0, s30, 12288
    s_add_u32 s33, s27, 36864
    buffer_load_dwordx4 v246, s[64:67], s33 offen offset:0 nt lds
    s_add_u32 m0, s30, 13184
    s_nop 0
    buffer_load_dwordx4 v246, s[64:67], s33 offen offset:128 nt lds
    s_add_u32 m0, s30, 14080
    s_nop 0
    buffer_load_dwordx4 v246, s[64:67], s33 offen offset:256 nt lds
    s_add_u32 m0, s30, 24576
    s_add_u32 s33, s27, 73728
    buffer_load_dwordx4 v246, s[64:67], s33 offen offset:0 nt lds
    s_add_u32 m0, s30, 25472
    s_nop 0
    buffer_load_dwordx4 v246, s[64:67], s33 offen offset:128 nt lds
    s_add_u32 m0, s30, 26368
    s_nop 0
    buffer_load_dwordx4 v246, s[64:67], s33 offen offset:256 nt lds
    s_add_u32 m0, s30, 36864
    s_add_u32 s33, s27, 110592
    buffer_load_dwordx4 v246, s[64:67], s33 offen offset:0 nt lds
    s_add_u32 m0, s30, 37760
    s_nop 0
    buffer_load_dwordx4 v246, s[64:67], s33 offen offset:128 nt lds
    s_add_u32 m0, s30, 38656
    s_nop 0
    buffer_load_dwordx4 v246, s[64:67], s33 offen offset:256 nt lds
    s_add_u32 m0, s30, 147456
    s_add_u32 s33, s27, 0
    buffer_load_dwordx4 v246, s[68:71], s33 offen offset:0 nt lds
    s_add_u32 m0, s30, 148352
    s_nop 0
    buffer_load_dwordx4 v246, s[68:71], s33 offen offset:128 nt lds
    s_add_u32 m0, s30, 149248
    s_nop 0
    buffer_load_dwordx4 v246, s[68:71], s33 offen offset:256 nt lds
    s_add_u32 m0, s30, 49152
    s_add_u32 s33, s27, 12288
    buffer_load_dwordx4 v246, s[64:67], s33 offen offset:0 nt lds
    s_add_u32 m0, s30, 50048
    s_nop 0
    buffer_load_dwordx4 v246, s[64:67], s33 offen offset:128 nt lds
    s_add_u32 m0, s30, 50944
    s_nop 0
    buffer_load_dwordx4 v246, s[64:67], s33 offen offset:256 nt lds
    s_add_u32 m0, s30, 61440
    s_add_u32 s33, s27, 49152
    buffer_load_dwordx4 v246, s[64:67], s33 offen offset:0 nt lds
    s_add_u32 m0, s30, 62336
    s_nop 0
    buffer_load_dwordx4 v246, s[64:67], s33 offen offset:128 nt lds
    s_add_u32 m0, s30, 63232
    s_nop 0
    buffer_load_dwordx4 v246, s[64:67], s33 offen offset:256 nt lds
    s_add_u32 m0, s30, 73728
    s_add_u32 s33, s27, 86016
    buffer_load_dwordx4 v246, s[64:67], s33 offen offset:0 nt lds
    s_add_u32 m0, s30, 74624
    s_nop 0
    buffer_load_dwordx4 v246, s[64:67], s33 offen offset:128 nt lds
    s_add_u32 m0, s30, 75520
    s_nop 0
    buffer_load_dwordx4 v246, s[64:67], s33 offen offset:256 nt lds
    s_add_u32 m0, s30, 86016
    s_add_u32 s33, s27, 122880
    buffer_load_dwordx4 v246, s[64:67], s33 offen offset:0 nt lds
    s_add_u32 m0, s30, 86912
    s_nop 0
    buffer_load_dwordx4 v246, s[64:67], s33 offen offset:128 nt lds
    s_add_u32 m0, s30, 87808
    s_nop 0
    buffer_load_dwordx4 v246, s[64:67], s33 offen offset:256 nt lds
    s_waitcnt vmcnt(12)
    s_barrier
    s_add_u32 s37, s36, 0x0
    v_add_u32 v176, s37, v240
    ds_read_b128 a[0:3], v176 offset:0
    v_add_u32 v177, s37, v241
    ds_read_b128 a[4:7], v177 offset:0
    v_add_u32 v176, s37, v242
    ds_read_b128 a[8:11], v176 offset:0
    v_add_u32 v177, s37, v243
    ds_read_b128 a[12:15], v177 offset:0
    v_add_u32 v176, s37, v240
    ds_read_b128 a[16:19], v176 offset:1024
    v_add_u32 v177, s37, v241
    ds_read_b128 a[20:23], v177 offset:1024
    v_add_u32 v176, s37, v242
    ds_read_b128 a[24:27], v176 offset:1024
    v_add_u32 v177, s37, v243
    ds_read_b128 a[28:31], v177 offset:1024
    v_add_u32 v176, s37, v240
    ds_read_b128 a[32:35], v176 offset:2048
    v_add_u32 v177, s37, v241
    ds_read_b128 a[36:39], v177 offset:2048
    v_add_u32 v176, s37, v242
    ds_read_b128 a[40:43], v176 offset:2048
    v_add_u32 v177, s37, v243
    ds_read_b128 a[44:47], v177 offset:2048
    v_add_u32 v240, 0x24000, v240
    v_add_u32 v241, 0x24000, v241
    v_add_u32 v242, 0x24000, v242
    v_add_u32 v243, 0x24000, v243
    v_add_u32 v244, 0x21000, v244
    v_add_u32 v245, 0x21000, v245
    ds_read_b128 v[224:227], v240 offset:0
    ds_read_b128 v[228:231], v241 offset:0
    ds_read_b128 v[232:235], v242 offset:0
    ds_read_b128 v[236:239], v243 offset:0
    s_waitcnt lgkmcnt(0)
    s_barrier
    s_add_u32 m0, s30, 0
    s_add_u32 s33, s27, 24576
    buffer_load_dwordx4 v246, s[64:67], s33 offen offset:0 nt lds
    s_add_u32 m0, s30, 896
    s_nop 0
    buffer_load_dwordx4 v246, s[64:67], s33 offen offset:128 nt lds
    s_add_u32 m0, s30, 1792
    s_nop 0
    buffer_load_dwordx4 v246, s[64:67], s33 offen offset:256 nt lds
    s_add_u32 m0, s30, 12288
    s_add_u32 s33, s27, 61440
    buffer_load_dwordx4 v246, s[64:67], s33 offen offset:0 nt lds
    s_add_u32 m0, s30, 13184
    s_nop 0
    buffer_load_dwordx4 v246, s[64:67], s33 offen offset:128 nt lds
    s_add_u32 m0, s30, 98304
    s_add_u32 s33, s27, 0
    buffer_load_dwordx4 v247, s[72:75], s33 offen offset:0 nt lds
    s_add_u32 m0, s30, 99200
    s_nop 0
    buffer_load_dwordx4 v247, s[72:75], s33 offen offset:128 nt lds
    s_add_u32 m0, s30, 100096
    s_nop 0
    buffer_load_dwordx4 v247, s[72:75], s33 offen offset:256 nt lds
    s_add_u32 m0, s30, 110592
    s_add_u32 s33, s27, 12288
    buffer_load_dwordx4 v246, s[68:71], s33 offen offset:0 nt lds
    s_add_u32 m0, s30, 111488
    s_nop 0
    buffer_load_dwordx4 v246, s[68:71], s33 offen offset:128 nt lds
    s_add_u32 m0, s30, 112384
    s_nop 0
    buffer_load_dwordx4 v246, s[68:71], s33 offen offset:256 nt lds
    s_mov_b32 s26, s27
    s_mov_b32 s10, s66
    s_mov_b32 s14, s66
    s_mov_b32 s18, s66
    s_add_u32 s27, s27, 37748736
    s_cmp_lt_u32 s25, 3
    s_cselect_b32 s32, 150994944, 0
    s_cselect_b32 s27, s27, s26
    s_mov_b32 s66, s32
    s_mov_b32 s70, s32
    s_mov_b32 s74, s32
    s_nop 3
    s_waitcnt lgkmcnt(2)
    v_mfma_f32_32x32x16_bf16 v[176:191], v[224:227], a[0:3], 0
    s_add_u32 m0, s30, 14080
    s_add_u32 s33, s26, 61440
    ds_read_b128 v[224:227], v240 offset:1024
    buffer_load_dwordx4 v246, s[8:11], s33 offen offset:256 nt lds
    v_mfma_f32_32x32x16_bf16 v[176:191], v[228:231], a[4:7], v[176:191]
    s_add_u32 m0, s30, 122880
    s_add_u32 s33, s26, 12288
    ds_read_b128 v[228:231], v241 offset:1024
    buffer_load_dwordx4 v247, s[16:19], s33 offen offset:0 nt lds
    s_add_u32 m0, s30, 24576
    s_add_u32 s33, s26, 98304
    buffer_load_dwordx4 v246, s[8:11], s33 offen offset:0 nt lds
    s_waitcnt lgkmcnt(2)
    v_mfma_f32_32x32x16_bf16 v[176:191], v[232:235], a[8:11], v[176:191]
    s_add_u32 m0, s30, 25472
    ds_read_b128 v[232:235], v242 offset:1024
    buffer_load_dwordx4 v246, s[8:11], s33 offen offset:128 nt lds
    v_mfma_f32_32x32x16_bf16 v[176:191], v[236:239], a[12:15], v[176:191]
    s_add_u32 m0, s30, 123776
    s_add_u32 s33, s26, 12288
    ds_read_b128 v[236:239], v243 offset:1024
    buffer_load_dwordx4 v247, s[16:19], s33 offen offset:128 nt lds
    s_add_u32 m0, s30, 26368
    s_add_u32 s33, s26, 98304
    buffer_load_dwordx4 v246, s[8:11], s33 offen offset:256 nt lds
    s_waitcnt lgkmcnt(2)
    v_mfma_f32_32x32x16_bf16 v[176:191], v[224:227], a[16:19], v[176:191]
    s_add_u32 m0, s30, 36864
    s_add_u32 s33, s26, 135168
    ds_read_b128 v[224:227], v240 offset:2048
    buffer_load_dwordx4 v246, s[8:11], s33 offen offset:0 nt lds
    v_mfma_f32_32x32x16_bf16 v[176:191], v[228:231], a[20:23], v[176:191]
    s_add_u32 m0, s30, 124672
    s_add_u32 s33, s26, 12288
    ds_read_b128 v[228:231], v241 offset:2048
    buffer_load_dwordx4 v247, s[16:19], s33 offen offset:256 nt lds
    s_add_u32 m0, s30, 37760
    s_add_u32 s33, s26, 135168
    buffer_load_dwordx4 v246, s[8:11], s33 offen offset:128 nt lds
    s_waitcnt lgkmcnt(2)
    v_mfma_f32_32x32x16_bf16 v[176:191], v[232:235], a[24:27], v[176:191]
    s_add_u32 m0, s30, 38656
    ds_read_b128 v[232:235], v242 offset:2048
    buffer_load_dwordx4 v246, s[8:11], s33 offen offset:256 nt lds
    v_mfma_f32_32x32x16_bf16 v[176:191], v[236:239], a[28:31], v[176:191]
    ds_read_b128 v[236:239], v243 offset:2048
    s_waitcnt lgkmcnt(2)
    v_mfma_f32_32x32x16_bf16 v[176:191], v[224:227], a[32:35], v[176:191]
    ds_read_b128 v[224:227], v240 offset:0
    v_mfma_f32_32x32x16_bf16 v[176:191], v[228:231], a[36:39], v[176:191]
    ds_read_b128 v[228:231], v241 offset:0
    s_waitcnt lgkmcnt(2)
    v_mfma_f32_32x32x16_bf16 v[176:191], v[232:235], a[40:43], v[176:191]
    ds_read_b128 v[232:235], v242 offset:0
    v_mfma_f32_32x32x16_bf16 v[176:191], v[236:239], a[44:47], v[176:191]
    ds_read_b128 v[236:239], v243 offset:0
    s_waitcnt vmcnt(21)
    s_barrier
    s_add_u32 s37, s36, 0xfffe8000
    v_add_u32 v206, s37, v240
    ds_read_b128 a[48:51], v206 offset:0
    v_add_u32 v207, s37, v241
    ds_read_b128 a[52:55], v207 offset:0
    s_nop 3
    v_max3_f32 v254, v176, v177, v178
    v_max3_f32 v254, v254, v179, v180
    v_max3_f32 v254, v254, v181, v182
    v_add_u32 v206, s37, v242
    ds_read_b128 a[56:59], v206 offset:0
    v_max3_f32 v254, v254, v183, v184
    v_max3_f32 v254, v254, v185, v186
    v_max3_f32 v254, v254, v187, v188
    v_add_u32 v207, s37, v243
    ds_read_b128 a[60:63], v207 offset:0
    v_max3_f32 v254, v254, v189, v190
    v_max_f32 v254, v254, v191
    v_mov_b32 v255, v254
    v_add_u32 v206, s37, v240
    ds_read_b128 a[64:67], v206 offset:1024
    v_permlane32_swap_b32 v254, v255
    v_max_f32 v254, v254, v255
    v_mul_f32 v248, s29, v254
    v_add_u32 v207, s37, v241
    ds_read_b128 a[68:71], v207 offset:1024
    v_fma_f32 v176, v176, s29, -v248
    v_fma_f32 v177, v177, s29, -v248
    v_exp_f32 v176, v176
    v_add_u32 v206, s37, v242
    ds_read_b128 a[72:75], v206 offset:1024
    v_exp_f32 v177, v177
    v_fma_f32 v178, v178, s29, -v248
    v_add_u32 v207, s37, v243
    ds_read_b128 a[76:79], v207 offset:1024
    v_fma_f32 v179, v179, s29, -v248
    v_exp_f32 v178, v178
    v_add_u32 v206, s37, v240
    ds_read_b128 a[80:83], v206 offset:2048
    v_exp_f32 v179, v179
    v_add_f32 v251, v176, v177
    v_add_u32 v207, s37, v241
    ds_read_b128 a[84:87], v207 offset:2048
    v_cvt_pk_bf16_f32 v176, v176, v177
    v_fma_f32 v180, v180, s29, -v248
    v_fma_f32 v181, v181, s29, -v248
    v_add_u32 v206, s37, v242
    ds_read_b128 a[88:91], v206 offset:2048
    v_exp_f32 v180, v180
    v_add_u32 v207, s37, v243
    ds_read_b128 a[92:95], v207 offset:2048
    s_waitcnt lgkmcnt(0)
    v_mfma_f32_32x32x16_bf16 v[192:207], v[224:227], a[48:51], 0
    ds_read_b128 v[224:227], v240 offset:1024
    v_exp_f32 v181, v181
    v_add_f32 v251, v251, v178
    v_add_f32 v251, v251, v179
    v_cvt_pk_bf16_f32 v177, v178, v179
    v_mfma_f32_32x32x16_bf16 v[192:207], v[228:231], a[52:55], v[192:207]
    ds_read_b128 v[228:231], v241 offset:1024
    v_fma_f32 v182, v182, s29, -v248
    v_fma_f32 v183, v183, s29, -v248
    v_exp_f32 v182, v182
    v_mfma_f32_32x32x16_bf16 v[192:207], v[232:235], a[56:59], v[192:207]
    ds_read_b128 v[232:235], v242 offset:1024
    v_exp_f32 v183, v183
    v_add_f32 v251, v251, v180
    v_add_f32 v251, v251, v181
    v_mfma_f32_32x32x16_bf16 v[192:207], v[236:239], a[60:63], v[192:207]
    ds_read_b128 v[236:239], v243 offset:1024
    v_cvt_pk_bf16_f32 v178, v180, v181
    v_fma_f32 v184, v184, s29, -v248
    v_fma_f32 v185, v185, s29, -v248
    v_exp_f32 v184, v184
    s_waitcnt lgkmcnt(2)
    v_mfma_f32_32x32x16_bf16 v[192:207], v[224:227], a[64:67], v[192:207]
    ds_read_b128 v[224:227], v240 offset:2048
    v_exp_f32 v185, v185
    v_add_f32 v251, v251, v182
    v_mfma_f32_32x32x16_bf16 v[192:207], v[228:231], a[68:71], v[192:207]
    ds_read_b128 v[228:231], v241 offset:2048
    v_add_f32 v251, v251, v183
    v_cvt_pk_bf16_f32 v179, v182, v183
    v_fma_f32 v186, v186, s29, -v248
    v_fma_f32 v187, v187, s29, -v248
    s_waitcnt lgkmcnt(2)
    v_mfma_f32_32x32x16_bf16 v[192:207], v[232:235], a[72:75], v[192:207]
    ds_read_b128 v[232:235], v242 offset:2048
    v_exp_f32 v186, v186
    v_exp_f32 v187, v187
    v_mfma_f32_32x32x16_bf16 v[192:207], v[236:239], a[76:79], v[192:207]
    s_waitcnt vmcnt(0)
    s_barrier
    ds_read_b128 v[236:239], v243 offset:2048
    v_add_f32 v251, v251, v184
    v_add_f32 v251, v251, v185
    s_waitcnt lgkmcnt(2)
    v_mfma_f32_32x32x16_bf16 v[192:207], v[224:227], a[80:83], v[192:207]
    ds_read_b128 v[224:227], v240 offset:0
    v_cvt_pk_bf16_f32 v180, v184, v185
    v_fma_f32 v188, v188, s29, -v248
    v_fma_f32 v189, v189, s29, -v248
    v_mfma_f32_32x32x16_bf16 v[192:207], v[228:231], a[84:87], v[192:207]
    ds_read_b128 v[228:231], v241 offset:0
    v_exp_f32 v188, v188
    v_exp_f32 v189, v189
    v_add_f32 v251, v251, v186
    s_waitcnt lgkmcnt(2)
    v_mfma_f32_32x32x16_bf16 v[192:207], v[232:235], a[88:91], v[192:207]
    ds_read_b128 v[232:235], v242 offset:0
    v_add_f32 v251, v251, v187
    v_cvt_pk_bf16_f32 v181, v186, v187
    v_fma_f32 v190, v190, s29, -v248
    v_fma_f32 v191, v191, s29, -v248
    v_mfma_f32_32x32x16_bf16 v[192:207], v[236:239], a[92:95], v[192:207]
    ds_read_b128 v[236:239], v243 offset:0
    v_exp_f32 v190, v190
    v_exp_f32 v191, v191
    v_add_f32 v251, v251, v188
    v_add_f32 v251, v251, v189
    v_cvt_pk_bf16_f32 v182, v188, v189
    s_add_u32 s37, s36, 0xfffdc000
    v_add_u32 v222, s37, v240
    ds_read_b128 a[96:99], v222 offset:0
    v_add_f32 v251, v251, v190
    v_add_f32 v251, v251, v191
    v_cvt_pk_bf16_f32 v183, v190, v191
    v_add_u32 v223, s37, v241
    ds_read_b128 a[100:103], v223 offset:0
    v_add_u32 v222, s37, v242
    ds_read_b128 a[104:107], v222 offset:0
    v_max3_f32 v254, v192, v193, v194
    v_max3_f32 v254, v254, v195, v196
    v_max3_f32 v254, v254, v197, v198
    v_max3_f32 v254, v254, v199, v200
    v_max3_f32 v254, v254, v201, v202
    v_add_u32 v223, s37, v243
    ds_read_b128 a[108:111], v223 offset:0
    v_max3_f32 v254, v254, v203, v204
    v_max3_f32 v254, v254, v205, v206
    v_max_f32 v254, v254, v207
    v_mov_b32 v255, v254
    v_add_u32 v222, s37, v240
    ds_read_b128 a[112:115], v222 offset:1024
    v_permlane32_swap_b32 v254, v255
    buffer_store_dwordx4 v[0:3], v246, s[20:23], 0 offen
    v_add_u32 v223, s37, v241
    ds_read_b128 a[116:119], v223 offset:1024
    buffer_store_dwordx4 v[0:3], v246, s[20:23], 0 offen
    v_add_u32 v222, s37, v242
    ds_read_b128 a[120:123], v222 offset:1024
    v_max_f32 v254, v254, v255
    v_mul_f32 v249, s29, v254
    v_fma_f32 v192, v192, s29, -v249
    v_fma_f32 v193, v193, s29, -v249
    v_exp_f32 v192, v192
    v_add_u32 v223, s37, v243
    ds_read_b128 a[124:127], v223 offset:1024
    v_exp_f32 v193, v193
    v_fma_f32 v194, v194, s29, -v249
    v_fma_f32 v195, v195, s29, -v249
    v_add_u32 v222, s37, v240
    ds_read_b128 a[128:131], v222 offset:2048
    v_exp_f32 v194, v194
    v_exp_f32 v195, v195
    v_add_u32 v223, s37, v241
    ds_read_b128 a[132:135], v223 offset:2048
    v_add_f32 v252, v192, v193
    v_cvt_pk_bf16_f32 v192, v192, v193
    v_fma_f32 v196, v196, s29, -v249
    v_fma_f32 v197, v197, s29, -v249
    v_add_u32 v222, s37, v242
    ds_read_b128 a[136:139], v222 offset:2048
    v_exp_f32 v196, v196
    v_exp_f32 v197, v197
    v_add_f32 v252, v252, v194
    v_add_f32 v252, v252, v195
    v_add_u32 v223, s37, v243
    ds_read_b128 a[140:143], v223 offset:2048
    s_waitcnt lgkmcnt(0)
    v_mfma_f32_32x32x16_bf16 v[208:223], v[224:227], a[96:99], 0
    ds_read_b128 v[224:227], v240 offset:1024
    v_mfma_f32_32x32x16_bf16 v[208:223], v[228:231], a[100:103], v[208:223]
    ds_read_b128 v[228:231], v241 offset:1024
    v_cvt_pk_bf16_f32 v193, v194, v195
    v_fma_f32 v198, v198, s29, -v249
    v_fma_f32 v199, v199, s29, -v249
    v_exp_f32 v198, v198
    v_mfma_f32_32x32x16_bf16 v[208:223], v[232:235], a[104:107], v[208:223]
    ds_read_b128 v[232:235], v242 offset:1024
    v_exp_f32 v199, v199
    v_add_f32 v252, v252, v196
    v_add_f32 v252, v252, v197
    v_cvt_pk_bf16_f32 v194, v196, v197
    v_fma_f32 v200, v200, s29, -v249
    v_mfma_f32_32x32x16_bf16 v[208:223], v[236:239], a[108:111], v[208:223]
    ds_read_b128 v[236:239], v243 offset:1024
    v_fma_f32 v201, v201, s29, -v249
    buffer_store_dwordx4 v[0:3], v246, s[20:23], 0 offen
    s_waitcnt lgkmcnt(2)
    v_mfma_f32_32x32x16_bf16 v[208:223], v[224:227], a[112:115], v[208:223]
    ds_read_b128 v[224:227], v240 offset:2048
    v_exp_f32 v200, v200
    buffer_store_dwordx4 v[0:3], v246, s[20:23], 0 offen
    v_mfma_f32_32x32x16_bf16 v[208:223], v[228:231], a[116:119], v[208:223]
    ds_read_b128 v[228:231], v241 offset:2048
    v_exp_f32 v201, v201
    v_add_f32 v252, v252, v198
    v_add_f32 v252, v252, v199
    v_cvt_pk_bf16_f32 v195, v198, v199
    v_fma_f32 v202, v202, s29, -v249
    s_waitcnt lgkmcnt(2)
    v_mfma_f32_32x32x16_bf16 v[208:223], v[232:235], a[120:123], v[208:223]
    ds_read_b128 v[232:235], v242 offset:2048
    v_fma_f32 v203, v203, s29, -v249
    v_exp_f32 v202, v202
    v_exp_f32 v203, v203
    v_mfma_f32_32x32x16_bf16 v[208:223], v[236:239], a[124:127], v[208:223]
    ds_read_b128 v[236:239], v243 offset:2048
    s_waitcnt lgkmcnt(2)
    v_mfma_f32_32x32x16_bf16 v[208:223], v[224:227], a[128:131], v[208:223]
    v_add_u32 v244, 0xffff7000, v244
    v_add_u32 v245, 0xffff7000, v245
    ds_read_b64_tr_b16 v[224:225], v244 offset:0
    ds_read_b64_tr_b16 v[226:227], v244 offset:3072
    v_add_f32 v252, v252, v200
    v_add_f32 v252, v252, v201
    v_cvt_pk_bf16_f32 v196, v200, v201
    v_fma_f32 v204, v204, s29, -v249
    v_fma_f32 v205, v205, s29, -v249
    v_mfma_f32_32x32x16_bf16 v[208:223], v[228:231], a[132:135], v[208:223]
    ds_read_b64_tr_b16 v[228:229], v245 offset:0
    ds_read_b64_tr_b16 v[230:231], v245 offset:3072
    v_exp_f32 v204, v204
    v_exp_f32 v205, v205
    v_add_f32 v252, v252, v202
    v_add_f32 v252, v252, v203
    v_cvt_pk_bf16_f32 v197, v202, v203
    s_waitcnt lgkmcnt(4)
    v_mfma_f32_32x32x16_bf16 v[208:223], v[232:235], a[136:139], v[208:223]
    ds_read_b64_tr_b16 v[232:233], v244 offset:1024
    ds_read_b64_tr_b16 v[234:235], v244 offset:4096
    v_fma_f32 v206, v206, s29, -v249
    buffer_store_dwordx4 v[0:3], v246, s[20:23], 0 offen
    v_mfma_f32_32x32x16_bf16 v[208:223], v[236:239], a[140:143], v[208:223]
    ds_read_b64_tr_b16 v[236:237], v245 offset:1024
    ds_read_b64_tr_b16 v[238:239], v245 offset:4096
    v_fma_f32 v207, v207, s29, -v249
    buffer_store_dwordx4 v[0:3], v246, s[20:23], 0 offen
    s_waitcnt lgkmcnt(4)
    v_mfma_f32_32x32x16_bf16 v[0:15], v[224:227], v[176:179], 0
    ds_read_b64_tr_b16 v[224:225], v244 offset:2048
    ds_read_b64_tr_b16 v[226:227], v244 offset:5120
    v_exp_f32 v206, v206
    v_exp_f32 v207, v207
    v_add_f32 v252, v252, v204
    v_mfma_f32_32x32x16_bf16 v[16:31], v[228:231], v[176:179], 0
    ds_read_b64_tr_b16 v[228:229], v245 offset:2048
    ds_read_b64_tr_b16 v[230:231], v245 offset:5120
    v_add_f32 v252, v252, v205
    v_cvt_pk_bf16_f32 v198, v204, v205
    v_add_f32 v252, v252, v206
    v_add_f32 v252, v252, v207
    v_cvt_pk_bf16_f32 v199, v206, v207
    s_waitcnt lgkmcnt(4)
    v_mfma_f32_32x32x16_bf16 v[32:47], v[232:235], v[176:179], 0
    ds_read_b64_tr_b16 v[232:233], v244 offset:6144
    ds_read_b64_tr_b16 v[234:235], v244 offset:9216
    v_max3_f32 v254, v208, v209, v210
    v_max3_f32 v254, v254, v211, v212
    v_max3_f32 v254, v254, v213, v214
    v_max3_f32 v254, v254, v215, v216
    v_max3_f32 v254, v254, v217, v218
    v_mfma_f32_32x32x16_bf16 a[144:159], v[236:239], v[176:179], 0
    ds_read_b64_tr_b16 v[236:237], v245 offset:6144
    ds_read_b64_tr_b16 v[238:239], v245 offset:9216
    s_waitcnt lgkmcnt(4)
    v_mfma_f32_32x32x16_bf16 v[48:63], v[224:227], v[176:179], 0
    ds_read_b64_tr_b16 v[224:225], v244 offset:7168
    ds_read_b64_tr_b16 v[226:227], v244 offset:10240
    v_max3_f32 v254, v254, v219, v220
    v_max3_f32 v254, v254, v221, v222
    v_max_f32 v254, v254, v223
    v_mov_b32 v255, v254
    v_mfma_f32_32x32x16_bf16 a[160:175], v[228:231], v[176:179], 0
    ds_read_b64_tr_b16 v[228:229], v245 offset:7168
    ds_read_b64_tr_b16 v[230:231], v245 offset:10240
    v_permlane32_swap_b32 v254, v255
    v_max_f32 v254, v254, v255
    v_mul_f32 v250, s29, v254
    v_fma_f32 v208, v208, s29, -v250
    v_fma_f32 v209, v209, s29, -v250
    s_waitcnt lgkmcnt(4)
    v_mfma_f32_32x32x16_bf16 v[0:15], v[232:235], v[180:183], v[0:15]
    ds_read_b64_tr_b16 v[232:233], v244 offset:8192
    ds_read_b64_tr_b16 v[234:235], v244 offset:11264
    s_nop 9
    buffer_store_dwordx4 v[0:3], v246, s[20:23], 0 offen
    v_mfma_f32_32x32x16_bf16 v[16:31], v[236:239], v[180:183], v[16:31]
    s_waitcnt vmcnt(9)
    s_barrier
    s_add_u32 m0, s30, 135168
    s_add_u32 s33, s26, 24576
    ds_read_b64_tr_b16 v[236:237], v245 offset:8192
    ds_read_b64_tr_b16 v[238:239], v245 offset:11264
    buffer_store_dwordx4 v[0:3], v246, s[20:23], 0 offen
    buffer_load_dwordx4 v246, s[12:15], s33 offen offset:0 nt lds
    s_waitcnt lgkmcnt(4)
    v_mfma_f32_32x32x16_bf16 v[32:47], v[224:227], v[180:183], v[32:47]
    v_add_u32 v240, 0xffff7000, v240
    v_add_u32 v241, 0xffff7000, v241
    v_add_u32 v242, 0xffff7000, v242
    v_add_u32 v243, 0xffff7000, v243
    ds_read_b128 v[224:227], v240 offset:0
    v_exp_f32 v208, v208
    v_exp_f32 v209, v209
    v_fma_f32 v210, v210, s29, -v250
    v_mfma_f32_32x32x16_bf16 a[144:159], v[228:231], v[180:183], a[144:159]
    s_add_u32 m0, s30, 136064
    ds_read_b128 v[228:231], v241 offset:0
    v_fma_f32 v211, v211, s29, -v250
    buffer_load_dwordx4 v246, s[12:15], s33 offen offset:128 nt lds
    s_waitcnt lgkmcnt(2)
    v_mfma_f32_32x32x16_bf16 v[48:63], v[232:235], v[180:183], v[48:63]
    ds_read_b128 v[232:235], v242 offset:0
    v_exp_f32 v210, v210
    v_exp_f32 v211, v211
    v_add_f32 v253, v208, v209
    v_cvt_pk_bf16_f32 v208, v208, v209
    v_mfma_f32_32x32x16_bf16 a[160:175], v[236:239], v[180:183], a[160:175]
    s_add_u32 m0, s30, 136960
    ds_read_b128 v[236:239], v243 offset:0
    v_fma_f32 v212, v212, s29, -v250
    buffer_load_dwordx4 v246, s[12:15], s33 offen offset:256 nt lds
    s_waitcnt lgkmcnt(2)
    v_mfma_f32_32x32x16_bf16 v[176:191], v[224:227], a[0:3], 0
    ds_read_b128 v[224:227], v240 offset:1024
    v_fma_f32 v213, v213, s29, -v250
    v_exp_f32 v212, v212
    v_exp_f32 v213, v213
    v_add_f32 v253, v253, v210
    v_mfma_f32_32x32x16_bf16 v[176:191], v[228:231], a[4:7], v[176:191]
    s_add_u32 m0, s30, 147456
    s_add_u32 s33, s26, 24576
    ds_read_b128 v[228:231], v241 offset:1024
    v_add_f32 v253, v253, v211
    v_cvt_pk_bf16_f32 v209, v210, v211
    v_fma_f32 v214, v214, s29, -v250
    buffer_load_dwordx4 v247, s[16:19], s33 offen offset:0 nt lds
    s_waitcnt lgkmcnt(2)
    v_mfma_f32_32x32x16_bf16 v[176:191], v[232:235], a[8:11], v[176:191]
    ds_read_b128 v[232:235], v242 offset:1024
    v_mfma_f32_32x32x16_bf16 v[176:191], v[236:239], a[12:15], v[176:191]
    s_add_u32 m0, s30, 148352
    ds_read_b128 v[236:239], v243 offset:1024
    v_fma_f32 v215, v215, s29, -v250
    v_exp_f32 v214, v214
    buffer_load_dwordx4 v247, s[16:19], s33 offen offset:128 nt lds
    s_waitcnt lgkmcnt(2)
    v_mfma_f32_32x32x16_bf16 v[176:191], v[224:227], a[16:19], v[176:191]
    ds_read_b128 v[224:227], v240 offset:2048
    v_exp_f32 v215, v215
    v_add_f32 v253, v253, v212
    v_add_f32 v253, v253, v213
    v_cvt_pk_bf16_f32 v210, v212, v213
    v_mfma_f32_32x32x16_bf16 v[176:191], v[228:231], a[20:23], v[176:191]
    s_add_u32 m0, s30, 149248
    ds_read_b128 v[228:231], v241 offset:2048
    buffer_store_dwordx4 v[0:3], v246, s[20:23], 0 offen
    buffer_load_dwordx4 v247, s[16:19], s33 offen offset:256 nt lds
    s_waitcnt lgkmcnt(2)
    v_mfma_f32_32x32x16_bf16 v[176:191], v[232:235], a[24:27], v[176:191]
    ds_read_b128 v[232:235], v242 offset:2048
    v_fma_f32 v216, v216, s29, -v250
    buffer_store_dwordx4 v[0:3], v246, s[20:23], 0 offen
    v_mfma_f32_32x32x16_bf16 v[176:191], v[236:239], a[28:31], v[176:191]
    ds_read_b128 v[236:239], v243 offset:2048
    v_fma_f32 v217, v217, s29, -v250
    v_exp_f32 v216, v216
    v_exp_f32 v217, v217
    v_add_f32 v253, v253, v214
    s_waitcnt lgkmcnt(2)
    v_mfma_f32_32x32x16_bf16 v[176:191], v[224:227], a[32:35], v[176:191]
    ds_read_b64_tr_b16 v[224:225], v244 offset:0
    ds_read_b64_tr_b16 v[226:227], v244 offset:3072
    v_add_f32 v253, v253, v215
    v_cvt_pk_bf16_f32 v211, v214, v215
    v_fma_f32 v218, v218, s29, -v250
    v_fma_f32 v219, v219, s29, -v250
    v_exp_f32 v218, v218
    v_mfma_f32_32x32x16_bf16 v[176:191], v[228:231], a[36:39], v[176:191]
    ds_read_b64_tr_b16 v[228:229], v245 offset:0
    ds_read_b64_tr_b16 v[230:231], v245 offset:3072
    v_exp_f32 v219, v219
    v_add_f32 v253, v253, v216
    v_add_f32 v253, v253, v217
    v_cvt_pk_bf16_f32 v212, v216, v217
    s_waitcnt lgkmcnt(4)
    v_mfma_f32_32x32x16_bf16 v[176:191], v[232:235], a[40:43], v[176:191]
    ds_read_b64_tr_b16 v[232:233], v244 offset:1024
    ds_read_b64_tr_b16 v[234:235], v244 offset:4096
    v_fma_f32 v220, v220, s29, -v250
    v_fma_f32 v221, v221, s29, -v250
    v_exp_f32 v220, v220
    v_exp_f32 v221, v221
    v_mfma_f32_32x32x16_bf16 v[176:191], v[236:239], a[44:47], v[176:191]
    ds_read_b64_tr_b16 v[236:237], v245 offset:1024
    ds_read_b64_tr_b16 v[238:239], v245 offset:4096
    v_add_f32 v253, v253, v218
    v_add_f32 v253, v253, v219
    v_cvt_pk_bf16_f32 v213, v218, v219
    v_fma_f32 v222, v222, s29, -v250
    v_fma_f32 v223, v223, s29, -v250
    s_waitcnt lgkmcnt(4)
    v_mfma_f32_32x32x16_bf16 v[64:79], v[224:227], v[192:195], 0
    ds_read_b64_tr_b16 v[224:225], v244 offset:2048
    ds_read_b64_tr_b16 v[226:227], v244 offset:5120
    v_exp_f32 v222, v222
    v_exp_f32 v223, v223
    v_add_f32 v253, v253, v220
    v_mfma_f32_32x32x16_bf16 v[80:95], v[228:231], v[192:195], 0
    ds_read_b64_tr_b16 v[228:229], v245 offset:2048
    ds_read_b64_tr_b16 v[230:231], v245 offset:5120
    v_add_f32 v253, v253, v221
    v_cvt_pk_bf16_f32 v214, v220, v221
    v_add_f32 v253, v253, v222
    v_add_f32 v253, v253, v223
    v_cvt_pk_bf16_f32 v215, v222, v223
    s_waitcnt lgkmcnt(4)
    v_mfma_f32_32x32x16_bf16 v[96:111], v[232:235], v[192:195], 0
    ds_read_b64_tr_b16 v[232:233], v244 offset:6144
    ds_read_b64_tr_b16 v[234:235], v244 offset:9216
    v_mfma_f32_32x32x16_bf16 a[176:191], v[236:239], v[192:195], 0
    ds_read_b64_tr_b16 v[236:237], v245 offset:6144
    ds_read_b64_tr_b16 v[238:239], v245 offset:9216
    v_max3_f32 v254, v176, v177, v178
    v_max3_f32 v254, v254, v179, v180
    v_max3_f32 v254, v254, v181, v182
    v_max3_f32 v254, v254, v183, v184
    s_waitcnt lgkmcnt(4)
    v_mfma_f32_32x32x16_bf16 v[112:127], v[224:227], v[192:195], 0
    ds_read_b64_tr_b16 v[224:225], v244 offset:7168
    ds_read_b64_tr_b16 v[226:227], v244 offset:10240
    v_max3_f32 v254, v254, v185, v186
    v_max3_f32 v254, v254, v187, v188
    v_max3_f32 v254, v254, v189, v190
    v_max_f32 v254, v254, v191
    v_mfma_f32_32x32x16_bf16 a[192:207], v[228:231], v[192:195], 0
    ds_read_b64_tr_b16 v[228:229], v245 offset:7168
    ds_read_b64_tr_b16 v[230:231], v245 offset:10240
    buffer_store_dwordx4 v[0:3], v246, s[20:23], 0 offen
    s_waitcnt lgkmcnt(4)
    v_mfma_f32_32x32x16_bf16 v[64:79], v[232:235], v[196:199], v[64:79]
    ds_read_b64_tr_b16 v[232:233], v244 offset:8192
    ds_read_b64_tr_b16 v[234:235], v244 offset:11264
    buffer_store_dwordx4 v[0:3], v246, s[20:23], 0 offen
    v_mfma_f32_32x32x16_bf16 v[80:95], v[236:239], v[196:199], v[80:95]
    ds_read_b64_tr_b16 v[236:237], v245 offset:8192
    ds_read_b64_tr_b16 v[238:239], v245 offset:11264
    v_fma_f32 v255, v254, s29, -v248
    v_cmp_lt_f32 vcc, s31, v255
    s_cbranch_vccnz L_slow6first
L_ret6first:
    v_fma_f32 v176, v176, s29, -v248
    s_waitcnt lgkmcnt(4)
    v_mfma_f32_32x32x16_bf16 v[96:111], v[224:227], v[196:199], v[96:111]
    ds_read_b128 v[224:227], v240 offset:0
    v_fma_f32 v177, v177, s29, -v248
    v_exp_f32 v176, v176
    v_exp_f32 v177, v177
    v_mfma_f32_32x32x16_bf16 a[176:191], v[228:231], v[196:199], a[176:191]
    ds_read_b128 v[228:231], v241 offset:0
    v_fma_f32 v178, v178, s29, -v248
    v_fma_f32 v179, v179, s29, -v248
    v_exp_f32 v178, v178
    s_waitcnt lgkmcnt(2)
    v_mfma_f32_32x32x16_bf16 v[112:127], v[232:235], v[196:199], v[112:127]
    ds_read_b128 v[232:235], v242 offset:0
    v_exp_f32 v179, v179
    v_add_f32 v251, v251, v176
    v_mfma_f32_32x32x16_bf16 a[192:207], v[236:239], v[196:199], a[192:207]
    ds_read_b128 v[236:239], v243 offset:0
    v_add_f32 v251, v251, v177
    v_cvt_pk_bf16_f32 v176, v176, v177
    v_fma_f32 v180, v180, s29, -v248
    v_fma_f32 v181, v181, s29, -v248
    s_waitcnt lgkmcnt(2)
    v_mfma_f32_32x32x16_bf16 v[192:207], v[224:227], a[48:51], 0
    ds_read_b128 v[224:227], v240 offset:1024
    v_exp_f32 v180, v180
    v_exp_f32 v181, v181
    v_add_f32 v251, v251, v178
    v_mfma_f32_32x32x16_bf16 v[192:207], v[228:231], a[52:55], v[192:207]
    ds_read_b128 v[228:231], v241 offset:1024
    v_add_f32 v251, v251, v179
    v_cvt_pk_bf16_f32 v177, v178, v179
    v_fma_f32 v182, v182, s29, -v248
    v_fma_f32 v183, v183, s29, -v248
    v_exp_f32 v182, v182
    s_waitcnt lgkmcnt(2)
    v_mfma_f32_32x32x16_bf16 v[192:207], v[232:235], a[56:59], v[192:207]
    ds_read_b128 v[232:235], v242 offset:1024
    v_exp_f32 v183, v183
    v_add_f32 v251, v251, v180
    v_add_f32 v251, v251, v181
    v_mfma_f32_32x32x16_bf16 v[192:207], v[236:239], a[60:63], v[192:207]
    ds_read_b128 v[236:239], v243 offset:1024
    s_waitcnt lgkmcnt(2)
    v_mfma_f32_32x32x16_bf16 v[192:207], v[224:227], a[64:67], v[192:207]
    ds_read_b128 v[224:227], v240 offset:2048
    v_cvt_pk_bf16_f32 v178, v180, v181
    v_fma_f32 v184, v184, s29, -v248
    v_fma_f32 v185, v185, s29, -v248
    v_exp_f32 v184, v184
    v_mfma_f32_32x32x16_bf16 v[192:207], v[228:231], a[68:71], v[192:207]
    ds_read_b128 v[228:231], v241 offset:2048
    v_exp_f32 v185, v185
    v_add_f32 v251, v251, v182
    v_add_f32 v251, v251, v183
    v_cvt_pk_bf16_f32 v179, v182, v183
    s_waitcnt lgkmcnt(2)
    v_mfma_f32_32x32x16_bf16 v[192:207], v[232:235], a[72:75], v[192:207]
    ds_read_b128 v[232:235], v242 offset:2048
    v_fma_f32 v186, v186, s29, -v248
    buffer_store_dwordx4 v[0:3], v246, s[20:23], 0 offen
    v_mfma_f32_32x32x16_bf16 v[192:207], v[236:239], a[76:79], v[192:207]
    ds_read_b128 v[236:239], v243 offset:2048
    v_fma_f32 v187, v187, s29, -v248
    buffer_store_dwordx4 v[0:3], v246, s[20:23], 0 offen
    s_waitcnt lgkmcnt(2)
    v_mfma_f32_32x32x16_bf16 v[192:207], v[224:227], a[80:83], v[192:207]
    ds_read_b64_tr_b16 v[224:225], v244 offset:0
    ds_read_b64_tr_b16 v[226:227], v244 offset:3072
    v_exp_f32 v186, v186
    v_exp_f32 v187, v187
    v_add_f32 v251, v251, v184
    v_mfma_f32_32x32x16_bf16 v[192:207], v[228:231], a[84:87], v[192:207]
    ds_read_b64_tr_b16 v[228:229], v245 offset:0
    ds_read_b64_tr_b16 v[230:231], v245 offset:3072
    v_add_f32 v251, v251, v185
    v_cvt_pk_bf16_f32 v180, v184, v185
    v_fma_f32 v188, v188, s29, -v248
    v_fma_f32 v189, v189, s29, -v248
    v_exp_f32 v188, v188
    s_waitcnt lgkmcnt(4)
    v_mfma_f32_32x32x16_bf16 v[192:207], v[232:235], a[88:91], v[192:207]
    ds_read_b64_tr_b16 v[232:233], v244 offset:1024
    ds_read_b64_tr_b16 v[234:235], v244 offset:4096
    v_exp_f32 v189, v189
    v_add_f32 v251, v251, v186
    v_add_f32 v251, v251, v187
    v_mfma_f32_32x32x16_bf16 v[192:207], v[236:239], a[92:95], v[192:207]
    ds_read_b64_tr_b16 v[236:237], v245 offset:1024
    ds_read_b64_tr_b16 v[238:239], v245 offset:4096
    v_cvt_pk_bf16_f32 v181, v186, v187
    v_fma_f32 v190, v190, s29, -v248
    v_fma_f32 v191, v191, s29, -v248
    v_exp_f32 v190, v190
    s_waitcnt vmcnt(29)
    s_waitcnt lgkmcnt(0)
    s_branch L_join
L_loop:
    s_mov_b32 s26, s27
    s_mov_b32 s10, s66
    s_mov_b32 s14, s66
    s_mov_b32 s18, s66
    s_add_u32 s27, s27, 37748736
    s_cmp_lt_u32 s25, 3
    s_cselect_b32 s32, 150994944, 0
    s_cselect_b32 s27, s27, s26
    s_mov_b32 s66, s32
    s_mov_b32 s70, s32
    s_mov_b32 s74, s32
    s_nop 3
    s_waitcnt lgkmcnt(2)
    v_mfma_f32_32x32x16_bf16 v[176:191], v[224:227], a[0:3], 0
    s_add_u32 m0, s30, 14080
    s_add_u32 s33, s26, 61440
    ds_read_b128 v[224:227], v240 offset:1024
    v_exp_f32 v213, v213
    v_add_f32 v253, v253, v210
    buffer_load_dwordx4 v246, s[8:11], s33 offen offset:256 nt lds
    v_mfma_f32_32x32x16_bf16 v[176:191], v[228:231], a[4:7], v[176:191]
    s_add_u32 m0, s30, 122880
    s_add_u32 s33, s26, 12288
    ds_read_b128 v[228:231], v241 offset:1024
    v_mov_b32 v248, v251
    s_nop 1
    v_permlane32_swap_b32 v251, v248
    v_add_f32 v251, v251, v248
    buffer_load_dwordx4 v247, s[16:19], s33 offen offset:0 nt lds
    s_add_u32 m0, s30, 24576
    s_add_u32 s33, s26, 98304
    buffer_load_dwordx4 v246, s[8:11], s33 offen offset:0 nt lds
    s_waitcnt lgkmcnt(2)
    v_mfma_f32_32x32x16_bf16 v[176:191], v[232:235], a[8:11], v[176:191]
    s_add_u32 m0, s30, 25472
    ds_read_b128 v[232:235], v242 offset:1024
    v_add_f32 v253, v253, v211
    v_cvt_pk_bf16_f32 v209, v210, v211
    v_fma_f32 v214, v214, s29, -v250
    v_rcp_f32 v251, v251
    s_nop 0
    v_mul_f32 v0, v0, v251
    v_mul_f32 v1, v1, v251
    buffer_load_dwordx4 v246, s[8:11], s33 offen offset:128 nt lds
    v_mfma_f32_32x32x16_bf16 v[176:191], v[236:239], a[12:15], v[176:191]
    s_add_u32 m0, s30, 123776
    s_add_u32 s33, s26, 12288
    ds_read_b128 v[236:239], v243 offset:1024
    v_mul_f32 v2, v2, v251
    v_mul_f32 v3, v3, v251
    v_mul_f32 v4, v4, v251
    buffer_load_dwordx4 v247, s[16:19], s33 offen offset:128 nt lds
    s_add_u32 m0, s30, 26368
    s_add_u32 s33, s26, 98304
    buffer_load_dwordx4 v246, s[8:11], s33 offen offset:256 nt lds
    s_waitcnt lgkmcnt(2)
    v_mfma_f32_32x32x16_bf16 v[176:191], v[224:227], a[16:19], v[176:191]
    s_add_u32 m0, s30, 36864
    s_add_u32 s33, s26, 135168
    ds_read_b128 v[224:227], v240 offset:2048
    v_fma_f32 v215, v215, s29, -v250
    v_exp_f32 v214, v214
    v_mul_f32 v5, v5, v251
    v_mul_f32 v6, v6, v251
    v_mul_f32 v7, v7, v251
    buffer_load_dwordx4 v246, s[8:11], s33 offen offset:0 nt lds
    v_mfma_f32_32x32x16_bf16 v[176:191], v[228:231], a[20:23], v[176:191]
    s_add_u32 m0, s30, 124672
    s_add_u32 s33, s26, 12288
    ds_read_b128 v[228:231], v241 offset:2048
    v_mul_f32 v8, v8, v251
    v_mul_f32 v9, v9, v251
    v_mul_f32 v10, v10, v251
    buffer_load_dwordx4 v247, s[16:19], s33 offen offset:256 nt lds
    s_add_u32 m0, s30, 37760
    s_add_u32 s33, s26, 135168
    buffer_load_dwordx4 v246, s[8:11], s33 offen offset:128 nt lds
    s_waitcnt lgkmcnt(2)
    v_mfma_f32_32x32x16_bf16 v[176:191], v[232:235], a[24:27], v[176:191]
    s_add_u32 m0, s30, 38656
    ds_read_b128 v[232:235], v242 offset:2048
    v_exp_f32 v215, v215
    v_add_f32 v253, v253, v212
    v_mul_f32 v11, v11, v251
    v_mul_f32 v12, v12, v251
    v_mul_f32 v13, v13, v251
    v_mul_f32 v14, v14, v251
    buffer_load_dwordx4 v246, s[8:11], s33 offen offset:256 nt lds
    v_mfma_f32_32x32x16_bf16 v[176:191], v[236:239], a[28:31], v[176:191]
    ds_read_b128 v[236:239], v243 offset:2048
    v_add_f32 v253, v253, v213
    v_cvt_pk_bf16_f32 v210, v212, v213
    v_fma_f32 v216, v216, s29, -v250
    v_fma_f32 v217, v217, s29, -v250
    v_exp_f32 v216, v216
    v_mul_f32 v15, v15, v251
    v_cvt_pk_bf16_f32 v0, v0, v1
    v_cvt_pk_bf16_f32 v1, v2, v3
    s_waitcnt lgkmcnt(2)
    v_mfma_f32_32x32x16_bf16 v[176:191], v[224:227], a[32:35], v[176:191]
    ds_read_b64_tr_b16 v[224:225], v244 offset:0
    ds_read_b64_tr_b16 v[226:227], v244 offset:3072
    v_exp_f32 v217, v217
    v_add_f32 v253, v253, v214
    v_add_f32 v253, v253, v215
    v_cvt_pk_bf16_f32 v211, v214, v215
    v_fma_f32 v218, v218, s29, -v250
    v_fma_f32 v219, v219, s29, -v250
    v_cvt_pk_bf16_f32 v2, v4, v5
    v_cvt_pk_bf16_f32 v3, v6, v7
    v_mfma_f32_32x32x16_bf16 v[176:191], v[228:231], a[36:39], v[176:191]
    ds_read_b64_tr_b16 v[228:229], v245 offset:0
    ds_read_b64_tr_b16 v[230:231], v245 offset:3072
    v_exp_f32 v218, v218
    v_exp_f32 v219, v219
    v_add_f32 v253, v253, v216
    v_add_f32 v253, v253, v217
    v_cvt_pk_bf16_f32 v4, v8, v9
    v_cvt_pk_bf16_f32 v5, v10, v11
    v_cvt_pk_bf16_f32 v6, v12, v13
    s_waitcnt lgkmcnt(4)
    v_mfma_f32_32x32x16_bf16 v[176:191], v[232:235], a[40:43], v[176:191]
    ds_read_b64_tr_b16 v[232:233], v244 offset:1024
    ds_read_b64_tr_b16 v[234:235], v244 offset:4096
    v_cvt_pk_bf16_f32 v212, v216, v217
    v_fma_f32 v220, v220, s29, -v250
    v_fma_f32 v221, v221, s29, -v250
    v_exp_f32 v220, v220
    v_cvt_pk_bf16_f32 v7, v14, v15
    v_permlane32_swap_b32 v0, v2
    v_permlane32_swap_b32 v1, v3
    v_permlane32_swap_b32 v4, v6
    v_mfma_f32_32x32x16_bf16 v[176:191], v[236:239], a[44:47], v[176:191]
    ds_read_b64_tr_b16 v[236:237], v245 offset:1024
    ds_read_b64_tr_b16 v[238:239], v245 offset:4096
    v_exp_f32 v221, v221
    v_add_f32 v253, v253, v218
    v_add_f32 v253, v253, v219
    v_cvt_pk_bf16_f32 v213, v218, v219
    v_fma_f32 v222, v222, s29, -v250
    v_fma_f32 v223, v223, s29, -v250
    v_permlane32_swap_b32 v5, v7
    v_mov_b32 v8, v251
    s_waitcnt lgkmcnt(4)
    v_mfma_f32_32x32x16_bf16 v[64:79], v[224:227], v[192:195], v[64:79]
    ds_read_b64_tr_b16 v[224:225], v244 offset:2048
    ds_read_b64_tr_b16 v[226:227], v244 offset:5120
    v_exp_f32 v222, v222
    v_exp_f32 v223, v223
    v_add_f32 v253, v253, v220
    s_add_u32 s32, s36, 0xfffe8000
    v_add_u32 v9, s32, v240
    v_add_u32 v10, s32, v241
    v_add_u32 v11, s32, v242
    v_add_u32 v12, s32, v243
    s_add_u32 s37, s36, 0xfffe8000
    v_add_u32 v206, s37, v240
    ds_read_b128 a[48:51], v206 offset:0
    v_mfma_f32_32x32x16_bf16 v[80:95], v[228:231], v[192:195], v[80:95]
    ds_read_b64_tr_b16 v[228:229], v245 offset:2048
    ds_read_b64_tr_b16 v[230:231], v245 offset:5120
    v_add_f32 v253, v253, v221
    v_cvt_pk_bf16_f32 v214, v220, v221
    v_add_f32 v253, v253, v222
    v_add_f32 v253, v253, v223
    v_cvt_pk_bf16_f32 v215, v222, v223
    v_mul_f32 v16, v16, v8
    v_add_u32 v207, s37, v241
    ds_read_b128 a[52:55], v207 offset:0
    s_waitcnt lgkmcnt(6)
    v_mfma_f32_32x32x16_bf16 v[96:111], v[232:235], v[192:195], v[96:111]
    ds_read_b64_tr_b16 v[232:233], v244 offset:6144
    ds_read_b64_tr_b16 v[234:235], v244 offset:9216
    v_max3_f32 v254, v176, v177, v178
    v_max3_f32 v254, v254, v179, v180
    v_max3_f32 v254, v254, v181, v182
    v_mul_f32 v17, v17, v8
    v_mul_f32 v18, v18, v8
    v_add_u32 v206, s37, v242
    ds_read_b128 a[56:59], v206 offset:0
    v_mfma_f32_32x32x16_bf16 a[176:191], v[236:239], v[192:195], a[176:191]
    ds_read_b64_tr_b16 v[236:237], v245 offset:6144
    ds_read_b64_tr_b16 v[238:239], v245 offset:9216
    v_max3_f32 v254, v254, v183, v184
    v_max3_f32 v254, v254, v185, v186
    v_max3_f32 v254, v254, v187, v188
    v_mul_f32 v19, v19, v8
    v_mul_f32 v20, v20, v8
    v_mul_f32 v21, v21, v8
    v_add_u32 v207, s37, v243
    ds_read_b128 a[60:63], v207 offset:0
    s_waitcnt lgkmcnt(7)
    v_mfma_f32_32x32x16_bf16 v[112:127], v[224:227], v[192:195], v[112:127]
    ds_read_b64_tr_b16 v[224:225], v244 offset:7168
    ds_read_b64_tr_b16 v[226:227], v244 offset:10240
    v_max3_f32 v254, v254, v189, v190
    v_max_f32 v254, v254, v191
    v_mov_b32 v255, v254
    v_mul_f32 v22, v22, v8
    v_mul_f32 v23, v23, v8
    v_mul_f32 v24, v24, v8
    v_add_u32 v206, s37, v240
    ds_read_b128 a[64:67], v206 offset:1024
    v_mfma_f32_32x32x16_bf16 a[192:207], v[228:231], v[192:195], a[192:207]
    ds_read_b64_tr_b16 v[228:229], v245 offset:7168
    ds_read_b64_tr_b16 v[230:231], v245 offset:10240
    v_permlane32_swap_b32 v254, v255
    v_max_f32 v254, v254, v255
    v_mul_f32 v248, s29, v254
    v_mul_f32 v25, v25, v8
    v_mul_f32 v26, v26, v8
    v_mul_f32 v27, v27, v8
    v_add_u32 v207, s37, v241
    ds_read_b128 a[68:71], v207 offset:1024
    s_waitcnt lgkmcnt(7)
    v_mfma_f32_32x32x16_bf16 v[64:79], v[232:235], v[196:199], v[64:79]
    ds_read_b64_tr_b16 v[232:233], v244 offset:8192
    ds_read_b64_tr_b16 v[234:235], v244 offset:11264
    v_fma_f32 v176, v176, s29, -v248
    v_fma_f32 v177, v177, s29, -v248
    v_exp_f32 v176, v176
    v_mul_f32 v28, v28, v8
    v_add_u32 v206, s37, v242
    ds_read_b128 a[72:75], v206 offset:1024
    v_mfma_f32_32x32x16_bf16 v[80:95], v[236:239], v[196:199], v[80:95]
    ds_read_b64_tr_b16 v[236:237], v245 offset:8192
    ds_read_b64_tr_b16 v[238:239], v245 offset:11264
    v_exp_f32 v177, v177
    v_fma_f32 v178, v178, s29, -v248
    v_mul_f32 v29, v29, v8
    v_mul_f32 v30, v30, v8
    v_mul_f32 v31, v31, v8
    v_add_u32 v207, s37, v243
    ds_read_b128 a[76:79], v207 offset:1024
    s_waitcnt lgkmcnt(7)
    v_mfma_f32_32x32x16_bf16 v[96:111], v[224:227], v[196:199], v[96:111]
    ds_read_b128 v[224:227], v240 offset:0
    v_fma_f32 v179, v179, s29, -v248
    v_exp_f32 v178, v178
    v_cvt_pk_bf16_f32 v16, v16, v17
    v_cvt_pk_bf16_f32 v17, v18, v19
    v_cvt_pk_bf16_f32 v18, v20, v21
    v_add_u32 v206, s37, v240
    ds_read_b128 a[80:83], v206 offset:2048
    v_mfma_f32_32x32x16_bf16 a[176:191], v[228:231], v[196:199], a[176:191]
    ds_read_b128 v[228:231], v241 offset:0
    v_exp_f32 v179, v179
    v_add_f32 v251, v176, v177
    v_cvt_pk_bf16_f32 v19, v22, v23
    v_cvt_pk_bf16_f32 v20, v24, v25
    v_cvt_pk_bf16_f32 v21, v26, v27
    v_add_u32 v207, s37, v241
    ds_read_b128 a[84:87], v207 offset:2048
    s_waitcnt lgkmcnt(5)
    v_mfma_f32_32x32x16_bf16 v[112:127], v[232:235], v[196:199], v[112:127]
    ds_read_b128 v[232:235], v242 offset:0
    v_cvt_pk_bf16_f32 v176, v176, v177
    v_fma_f32 v180, v180, s29, -v248
    v_fma_f32 v181, v181, s29, -v248
    v_cvt_pk_bf16_f32 v22, v28, v29
    v_cvt_pk_bf16_f32 v23, v30, v31
    v_add_u32 v206, s37, v242
    ds_read_b128 a[88:91], v206 offset:2048
    v_mfma_f32_32x32x16_bf16 a[192:207], v[236:239], v[196:199], a[192:207]
    ds_read_b128 v[236:239], v243 offset:0
    v_exp_f32 v180, v180
    v_permlane32_swap_b32 v16, v18
    v_permlane32_swap_b32 v17, v19
    v_permlane32_swap_b32 v20, v22
    v_permlane32_swap_b32 v21, v23
    v_add_u32 v207, s37, v243
    ds_read_b128 a[92:95], v207 offset:2048
    s_waitcnt lgkmcnt(0)
    v_mfma_f32_32x32x16_bf16 v[192:207], v[224:227], a[48:51], 0
    ds_read_b128 v[224:227], v240 offset:1024
    v_exp_f32 v181, v181
    v_add_f32 v251, v251, v178
    v_add_f32 v251, v251, v179
    v_cvt_pk_bf16_f32 v177, v178, v179
    ds_write_b128 v9, v[0:3] offset:0
    ds_write_b128 v10, v[4:7] offset:0
    ds_write_b128 v11, v[16:19] offset:0
    v_mfma_f32_32x32x16_bf16 v[192:207], v[228:231], a[52:55], v[192:207]
    ds_read_b128 v[228:231], v241 offset:1024
    v_fma_f32 v182, v182, s29, -v248
    v_fma_f32 v183, v183, s29, -v248
    v_exp_f32 v182, v182
    ds_write_b128 v12, v[20:23] offset:0
    v_mul_f32 v32, v32, v8
    v_mul_f32 v33, v33, v8
    v_mul_f32 v34, v34, v8
    v_mov_b32 v249, v252
    s_nop 1
    v_permlane32_swap_b32 v252, v249
    v_add_f32 v252, v252, v249
    v_rcp_f32 v252, v252
    v_mfma_f32_32x32x16_bf16 v[192:207], v[232:235], a[56:59], v[192:207]
    ds_read_b128 v[232:235], v242 offset:1024
    v_exp_f32 v183, v183
    v_add_f32 v251, v251, v180
    v_add_f32 v251, v251, v181
    v_mul_f32 v35, v35, v8
    v_mul_f32 v36, v36, v8
    v_mul_f32 v37, v37, v8
    v_mul_f32 v38, v38, v8
    v_mul_f32 v39, v39, v8
    v_mul_f32 v40, v40, v8
    v_mul_f32 v64, v64, v252
    v_mul_f32 v65, v65, v252
    v_mul_f32 v66, v66, v252
    v_mfma_f32_32x32x16_bf16 v[192:207], v[236:239], a[60:63], v[192:207]
    ds_read_b128 v[236:239], v243 offset:1024
    v_cvt_pk_bf16_f32 v178, v180, v181
    v_fma_f32 v184, v184, s29, -v248
    v_fma_f32 v185, v185, s29, -v248
    v_exp_f32 v184, v184
    v_mul_f32 v41, v41, v8
    v_mul_f32 v42, v42, v8
    v_mul_f32 v43, v43, v8
    v_mul_f32 v44, v44, v8
    v_mul_f32 v45, v45, v8
    v_mul_f32 v67, v67, v252
    v_mul_f32 v68, v68, v252
    v_mul_f32 v69, v69, v252
    s_waitcnt lgkmcnt(3)
    v_mfma_f32_32x32x16_bf16 v[192:207], v[224:227], a[64:67], v[192:207]
    ds_read_b128 v[224:227], v240 offset:2048
    v_exp_f32 v185, v185
    v_add_f32 v251, v251, v182
    v_mul_f32 v46, v46, v8
    v_mul_f32 v47, v47, v8
    v_cvt_pk_bf16_f32 v32, v32, v33
    v_cvt_pk_bf16_f32 v33, v34, v35
    v_cvt_pk_bf16_f32 v34, v36, v37
    v_cvt_pk_bf16_f32 v35, v38, v39
    v_cvt_pk_bf16_f32 v36, v40, v41
    v_cvt_pk_bf16_f32 v37, v42, v43
    v_mul_f32 v70, v70, v252
    v_mul_f32 v71, v71, v252
    v_mfma_f32_32x32x16_bf16 v[192:207], v[228:231], a[68:71], v[192:207]
    ds_read_b128 v[228:231], v241 offset:2048
    v_add_f32 v251, v251, v183
    v_cvt_pk_bf16_f32 v179, v182, v183
    v_fma_f32 v186, v186, s29, -v248
    v_fma_f32 v187, v187, s29, -v248
    v_cvt_pk_bf16_f32 v38, v44, v45
    v_cvt_pk_bf16_f32 v39, v46, v47
    v_permlane32_swap_b32 v32, v34
    v_permlane32_swap_b32 v33, v35
    v_permlane32_swap_b32 v36, v38
    v_permlane32_swap_b32 v37, v39
    v_mul_f32 v72, v72, v252
    v_mul_f32 v73, v73, v252
    v_mul_f32 v74, v74, v252
    s_waitcnt lgkmcnt(2)
    v_mfma_f32_32x32x16_bf16 v[192:207], v[232:235], a[72:75], v[192:207]
    ds_read_b128 v[232:235], v242 offset:2048
    v_exp_f32 v186, v186
    v_exp_f32 v187, v187
    ds_write_b128 v9, v[32:35] offset:1024
    ds_write_b128 v10, v[36:39] offset:1024
    v_accvgpr_read_b32 v16, a144
    v_accvgpr_read_b32 v17, a145
    v_mul_f32 v75, v75, v252
    v_mul_f32 v76, v76, v252
    v_mul_f32 v77, v77, v252
    v_mfma_f32_32x32x16_bf16 v[192:207], v[236:239], a[76:79], v[192:207]
    s_waitcnt vmcnt(0)
    s_barrier
    ds_read_b128 v[236:239], v243 offset:2048
    v_add_f32 v251, v251, v184
    v_add_f32 v251, v251, v185
    v_accvgpr_read_b32 v18, a146
    v_accvgpr_read_b32 v19, a147
    v_accvgpr_read_b32 v20, a148
    v_accvgpr_read_b32 v21, a149
    v_accvgpr_read_b32 v22, a150
    v_mul_f32 v78, v78, v252
    v_mul_f32 v79, v79, v252
    v_cvt_pk_bf16_f32 v64, v64, v65
    s_waitcnt lgkmcnt(4)
    v_mfma_f32_32x32x16_bf16 v[192:207], v[224:227], a[80:83], v[192:207]
    ds_read_b64_tr_b16 v[224:225], v244 offset:0
    ds_read_b64_tr_b16 v[226:227], v244 offset:3072
    v_cvt_pk_bf16_f32 v180, v184, v185
    v_fma_f32 v188, v188, s29, -v248
    v_fma_f32 v189, v189, s29, -v248
    v_accvgpr_read_b32 v23, a151
    v_accvgpr_read_b32 v24, a152
    v_accvgpr_read_b32 v25, a153
    v_accvgpr_read_b32 v26, a154
    v_accvgpr_read_b32 v27, a155
    v_accvgpr_read_b32 v28, a156
    v_accvgpr_read_b32 v29, a157
    v_cvt_pk_bf16_f32 v65, v66, v67
    v_cvt_pk_bf16_f32 v66, v68, v69
    v_cvt_pk_bf16_f32 v67, v70, v71
    v_mfma_f32_32x32x16_bf16 v[192:207], v[228:231], a[84:87], v[192:207]
    ds_read_b64_tr_b16 v[228:229], v245 offset:0
    ds_read_b64_tr_b16 v[230:231], v245 offset:3072
    v_exp_f32 v188, v188
    v_exp_f32 v189, v189
    v_add_f32 v251, v251, v186
    v_accvgpr_read_b32 v30, a158
    v_accvgpr_read_b32 v31, a159
    v_mul_f32 v16, v16, v8
    v_mul_f32 v17, v17, v8
    v_mul_f32 v18, v18, v8
    v_cvt_pk_bf16_f32 v68, v72, v73
    v_cvt_pk_bf16_f32 v69, v74, v75
    v_cvt_pk_bf16_f32 v70, v76, v77
    s_waitcnt lgkmcnt(4)
    v_mfma_f32_32x32x16_bf16 v[192:207], v[232:235], a[88:91], v[192:207]
    ds_read_b64_tr_b16 v[232:233], v244 offset:1024
    ds_read_b64_tr_b16 v[234:235], v244 offset:4096
    v_add_f32 v251, v251, v187
    v_cvt_pk_bf16_f32 v181, v186, v187
    v_fma_f32 v190, v190, s29, -v248
    v_fma_f32 v191, v191, s29, -v248
    v_mul_f32 v19, v19, v8
    v_mul_f32 v20, v20, v8
    v_mul_f32 v21, v21, v8
    v_mul_f32 v22, v22, v8
    v_mul_f32 v23, v23, v8
    v_mul_f32 v24, v24, v8
    v_cvt_pk_bf16_f32 v71, v78, v79
    v_permlane32_swap_b32 v64, v66
    v_permlane32_swap_b32 v65, v67
    v_mfma_f32_32x32x16_bf16 v[192:207], v[236:239], a[92:95], v[192:207]
    ds_read_b64_tr_b16 v[236:237], v245 offset:1024
    ds_read_b64_tr_b16 v[238:239], v245 offset:4096
    v_exp_f32 v190, v190
    v_exp_f32 v191, v191
    v_mul_f32 v25, v25, v8
    v_mul_f32 v26, v26, v8
    v_mul_f32 v27, v27, v8
    v_mul_f32 v28, v28, v8
    v_mul_f32 v29, v29, v8
    v_mul_f32 v30, v30, v8
    v_permlane32_swap_b32 v68, v70
    v_permlane32_swap_b32 v69, v71
    v_mov_b32 v72, v252
    s_waitcnt lgkmcnt(4)
    v_mfma_f32_32x32x16_bf16 v[128:143], v[224:227], v[208:211], v[128:143]
    ds_read_b64_tr_b16 v[224:225], v244 offset:2048
    ds_read_b64_tr_b16 v[226:227], v244 offset:5120
    v_add_f32 v251, v251, v188
    v_add_f32 v251, v251, v189
    v_cvt_pk_bf16_f32 v182, v188, v189
    v_mul_f32 v31, v31, v8
    v_cvt_pk_bf16_f32 v16, v16, v17
    v_cvt_pk_bf16_f32 v17, v18, v19
    v_cvt_pk_bf16_f32 v18, v20, v21
    v_cvt_pk_bf16_f32 v19, v22, v23
    v_cvt_pk_bf16_f32 v20, v24, v25
    v_cvt_pk_bf16_f32 v21, v26, v27
    s_add_u32 s32, s36, 0xfffdc000
    v_add_u32 v73, s32, v240
    v_add_u32 v74, s32, v241
    v_add_u32 v75, s32, v242
    v_add_u32 v76, s32, v243
    v_mul_f32 v80, v80, v72
    s_add_u32 s37, s36, 0xfffdc000
    v_add_u32 v222, s37, v240
    ds_read_b128 a[96:99], v222 offset:0
    v_mfma_f32_32x32x16_bf16 v[144:159], v[228:231], v[208:211], v[144:159]
    ds_read_b64_tr_b16 v[228:229], v245 offset:2048
    ds_read_b64_tr_b16 v[230:231], v245 offset:5120
    v_add_f32 v251, v251, v190
    v_add_f32 v251, v251, v191
    v_cvt_pk_bf16_f32 v183, v190, v191
    v_cvt_pk_bf16_f32 v22, v28, v29
    v_cvt_pk_bf16_f32 v23, v30, v31
    v_permlane32_swap_b32 v16, v18
    v_permlane32_swap_b32 v17, v19
    v_permlane32_swap_b32 v20, v22
    v_permlane32_swap_b32 v21, v23
    v_mul_f32 v81, v81, v72
    v_mul_f32 v82, v82, v72
    v_add_u32 v223, s37, v241
    ds_read_b128 a[100:103], v223 offset:0
    s_waitcnt lgkmcnt(6)
    v_mfma_f32_32x32x16_bf16 v[160:175], v[232:235], v[208:211], v[160:175]
    ds_read_b64_tr_b16 v[232:233], v244 offset:6144
    ds_read_b64_tr_b16 v[234:235], v244 offset:9216
    ds_write_b128 v11, v[16:19] offset:1024
    v_mul_f32 v83, v83, v72
    v_mul_f32 v84, v84, v72
    v_mul_f32 v85, v85, v72
    v_mbcnt_lo_u32_b32 v184, -1, 0
    s_add_u32 s32, s38, 49152
    v_mbcnt_hi_u32_b32 v184, -1, v184
    v_lshlrev_b32 v184, 4, v184
    v_xor_b32 v184, s32, v184
    ds_read_b128 v[188:191], v184 offset:6144
    ds_read_b128 v[184:187], v184 offset:0
    v_add_u32 v222, s37, v242
    ds_read_b128 a[104:107], v222 offset:0
    v_mfma_f32_32x32x16_bf16 a[208:223], v[236:239], v[208:211], a[208:223]
    ds_read_b64_tr_b16 v[236:237], v245 offset:6144
    ds_read_b64_tr_b16 v[238:239], v245 offset:9216
    v_max3_f32 v254, v192, v193, v194
    v_max3_f32 v254, v254, v195, v196
    v_max3_f32 v254, v254, v197, v198
    v_max3_f32 v254, v254, v199, v200
    v_max3_f32 v254, v254, v201, v202
    ds_write_b128 v12, v[20:23] offset:1024
    v_mul_f32 v48, v48, v8
    v_mul_f32 v49, v49, v8
    v_mul_f32 v86, v86, v72
    v_mul_f32 v87, v87, v72
    v_add_u32 v223, s37, v243
    ds_read_b128 a[108:111], v223 offset:0
    s_waitcnt lgkmcnt(11)
    v_mfma_f32_32x32x16_bf16 a[240:255], v[224:227], v[208:211], a[240:255]
    ds_read_b64_tr_b16 v[224:225], v244 offset:7168
    ds_read_b64_tr_b16 v[226:227], v244 offset:10240
    v_max3_f32 v254, v254, v203, v204
    v_max3_f32 v254, v254, v205, v206
    v_max_f32 v254, v254, v207
    v_mov_b32 v255, v254
    v_mul_f32 v50, v50, v8
    v_mul_f32 v51, v51, v8
    v_mul_f32 v52, v52, v8
    v_mul_f32 v53, v53, v8
    v_mul_f32 v54, v54, v8
    v_mul_f32 v88, v88, v72
    v_mul_f32 v89, v89, v72
    v_mul_f32 v90, v90, v72
    v_add_u32 v222, s37, v240
    ds_read_b128 a[112:115], v222 offset:1024
    v_mfma_f32_32x32x16_bf16 a[224:239], v[228:231], v[208:211], a[224:239]
    ds_read_b64_tr_b16 v[228:229], v245 offset:7168
    ds_read_b64_tr_b16 v[230:231], v245 offset:10240
    v_permlane32_swap_b32 v254, v255
    v_mul_f32 v55, v55, v8
    v_mul_f32 v56, v56, v8
    v_mul_f32 v57, v57, v8
    v_mul_f32 v58, v58, v8
    v_mul_f32 v91, v91, v72
    v_mul_f32 v92, v92, v72
    v_mul_f32 v93, v93, v72
    s_add_u32 s32, s28, 0
    s_waitcnt lgkmcnt(10)
    buffer_store_dwordx4 v[184:187], v246, s[20:23], s32 offen offset:0 nt
    v_add_u32 v223, s37, v241
    ds_read_b128 a[116:119], v223 offset:1024
    s_waitcnt lgkmcnt(8)
    v_mfma_f32_32x32x16_bf16 v[128:143], v[232:235], v[212:215], v[128:143]
    ds_read_b64_tr_b16 v[232:233], v244 offset:8192
    ds_read_b64_tr_b16 v[234:235], v244 offset:11264
    v_mul_f32 v59, v59, v8
    v_mul_f32 v60, v60, v8
    v_mul_f32 v61, v61, v8
    v_mul_f32 v62, v62, v8
    v_mul_f32 v63, v63, v8
    v_mul_f32 v94, v94, v72
    v_mul_f32 v95, v95, v72
    s_add_u32 s32, s28, 6144
    buffer_store_dwordx4 v[188:191], v246, s[20:23], s32 offen offset:0 nt
    v_add_u32 v222, s37, v242
    ds_read_b128 a[120:123], v222 offset:1024
    v_mfma_f32_32x32x16_bf16 v[144:159], v[236:239], v[212:215], v[144:159]
    ds_read_b64_tr_b16 v[236:237], v245 offset:8192
    ds_read_b64_tr_b16 v[238:239], v245 offset:11264
    v_max_f32 v254, v254, v255
    v_mul_f32 v249, s29, v254
    v_fma_f32 v192, v192, s29, -v249
    v_fma_f32 v193, v193, s29, -v249
    v_exp_f32 v192, v192
    v_cvt_pk_bf16_f32 v48, v48, v49
    v_cvt_pk_bf16_f32 v49, v50, v51
    v_cvt_pk_bf16_f32 v50, v52, v53
    v_cvt_pk_bf16_f32 v80, v80, v81
    v_cvt_pk_bf16_f32 v81, v82, v83
    v_cvt_pk_bf16_f32 v82, v84, v85
    v_add_u32 v223, s37, v243
    ds_read_b128 a[124:127], v223 offset:1024
    s_waitcnt lgkmcnt(7)
    v_mfma_f32_32x32x16_bf16 v[160:175], v[224:227], v[212:215], v[160:175]
    ds_read_b128 v[224:227], v240 offset:0
    v_exp_f32 v193, v193
    v_fma_f32 v194, v194, s29, -v249
    v_fma_f32 v195, v195, s29, -v249
    v_cvt_pk_bf16_f32 v51, v54, v55
    v_cvt_pk_bf16_f32 v52, v56, v57
    v_cvt_pk_bf16_f32 v53, v58, v59
    v_cvt_pk_bf16_f32 v54, v60, v61
    v_cvt_pk_bf16_f32 v55, v62, v63
    v_cvt_pk_bf16_f32 v83, v86, v87
    v_cvt_pk_bf16_f32 v84, v88, v89
    v_add_u32 v222, s37, v240
    ds_read_b128 a[128:131], v222 offset:2048
    v_mfma_f32_32x32x16_bf16 a[208:223], v[228:231], v[212:215], a[208:223]
    ds_read_b128 v[228:231], v241 offset:0
    v_exp_f32 v194, v194
    v_exp_f32 v195, v195
    v_permlane32_swap_b32 v48, v50
    v_permlane32_swap_b32 v49, v51
    v_permlane32_swap_b32 v52, v54
    v_permlane32_swap_b32 v53, v55
    ds_write_b128 v9, v[48:51] offset:2048
    v_cvt_pk_bf16_f32 v85, v90, v91
    v_cvt_pk_bf16_f32 v86, v92, v93
    v_add_u32 v223, s37, v241
    ds_read_b128 a[132:135], v223 offset:2048
    s_waitcnt lgkmcnt(6)
    v_mfma_f32_32x32x16_bf16 a[240:255], v[232:235], v[212:215], a[240:255]
    ds_read_b128 v[232:235], v242 offset:0
    v_add_f32 v252, v192, v193
    v_cvt_pk_bf16_f32 v192, v192, v193
    v_fma_f32 v196, v196, s29, -v249
    v_fma_f32 v197, v197, s29, -v249
    ds_write_b128 v10, v[52:55] offset:2048
    v_accvgpr_read_b32 v16, a160
    v_accvgpr_read_b32 v17, a161
    v_accvgpr_read_b32 v18, a162
    v_cvt_pk_bf16_f32 v87, v94, v95
    v_permlane32_swap_b32 v80, v82
    v_add_u32 v222, s37, v242
    ds_read_b128 a[136:139], v222 offset:2048
    v_mfma_f32_32x32x16_bf16 a[224:239], v[236:239], v[212:215], a[224:239]
    ds_read_b128 v[236:239], v243 offset:0
    v_exp_f32 v196, v196
    v_exp_f32 v197, v197
    v_add_f32 v252, v252, v194
    v_add_f32 v252, v252, v195
    v_accvgpr_read_b32 v19, a163
    v_accvgpr_read_b32 v20, a164
    v_accvgpr_read_b32 v21, a165
    v_permlane32_swap_b32 v81, v83
    v_permlane32_swap_b32 v84, v86
    v_permlane32_swap_b32 v85, v87
    v_add_u32 v223, s37, v243
    ds_read_b128 a[140:143], v223 offset:2048
    s_waitcnt lgkmcnt(0)
    v_mfma_f32_32x32x16_bf16 v[208:223], v[224:227], a[96:99], 0
    ds_read_b128 v[224:227], v240 offset:1024
    v_accvgpr_read_b32 v22, a166
    v_accvgpr_read_b32 v23, a167
    v_accvgpr_read_b32 v24, a168
    ds_write_b128 v73, v[64:67] offset:0
    v_mbcnt_lo_u32_b32 v184, -1, 0
    s_add_u32 s32, s39, 49152
    v_mbcnt_hi_u32_b32 v184, -1, v184
    v_lshlrev_b32 v184, 4, v184
    v_xor_b32 v184, s32, v184
    ds_read_b128 v[188:191], v184 offset:9216
    ds_read_b128 v[184:187], v184 offset:3072
    v_mfma_f32_32x32x16_bf16 v[208:223], v[228:231], a[100:103], v[208:223]
    ds_read_b128 v[228:231], v241 offset:1024
    v_cvt_pk_bf16_f32 v193, v194, v195
    v_fma_f32 v198, v198, s29, -v249
    v_fma_f32 v199, v199, s29, -v249
    v_exp_f32 v198, v198
    v_accvgpr_read_b32 v25, a169
    v_accvgpr_read_b32 v26, a170
    v_accvgpr_read_b32 v27, a171
    v_accvgpr_read_b32 v28, a172
    v_accvgpr_read_b32 v29, a173
    ds_write_b128 v74, v[68:71] offset:0
    v_mov_b32 v250, v253
    s_nop 1
    v_permlane32_swap_b32 v253, v250
    v_add_f32 v253, v253, v250
    v_mfma_f32_32x32x16_bf16 v[208:223], v[232:235], a[104:107], v[208:223]
    ds_read_b128 v[232:235], v242 offset:1024
    v_exp_f32 v199, v199
    v_add_f32 v252, v252, v196
    v_add_f32 v252, v252, v197
    v_cvt_pk_bf16_f32 v194, v196, v197
    v_fma_f32 v200, v200, s29, -v249
    v_accvgpr_read_b32 v30, a174
    v_accvgpr_read_b32 v31, a175
    v_mul_f32 v16, v16, v8
    v_mul_f32 v17, v17, v8
    ds_write_b128 v75, v[80:83] offset:0
    v_rcp_f32 v253, v253
    s_nop 0
    v_mul_f32 v128, v128, v253
    v_mul_f32 v129, v129, v253
    v_mfma_f32_32x32x16_bf16 v[208:223], v[236:239], a[108:111], v[208:223]
    ds_read_b128 v[236:239], v243 offset:1024
    v_fma_f32 v201, v201, s29, -v249
    v_mul_f32 v18, v18, v8
    v_mul_f32 v19, v19, v8
    v_mul_f32 v20, v20, v8
    v_mul_f32 v21, v21, v8
    v_mul_f32 v22, v22, v8
    ds_write_b128 v76, v[84:87] offset:0
    v_mul_f32 v96, v96, v72
    v_mul_f32 v130, v130, v253
    v_mul_f32 v131, v131, v253
    v_mul_f32 v132, v132, v253
    s_add_u32 s32, s28, 3072
    s_waitcnt lgkmcnt(6)
    buffer_store_dwordx4 v[184:187], v246, s[20:23], s32 offen offset:0 nt
    s_waitcnt lgkmcnt(5)
    v_mfma_f32_32x32x16_bf16 v[208:223], v[224:227], a[112:115], v[208:223]
    ds_read_b128 v[224:227], v240 offset:2048
    v_exp_f32 v200, v200
    v_mul_f32 v23, v23, v8
    v_mul_f32 v24, v24, v8
    v_mul_f32 v25, v25, v8
    v_mul_f32 v26, v26, v8
    v_mul_f32 v97, v97, v72
    v_mul_f32 v98, v98, v72
    v_mul_f32 v133, v133, v253
    v_mul_f32 v134, v134, v253
    v_mul_f32 v135, v135, v253
    s_add_u32 s32, s28, 9216
    buffer_store_dwordx4 v[188:191], v246, s[20:23], s32 offen offset:0 nt
    v_mfma_f32_32x32x16_bf16 v[208:223], v[228:231], a[116:119], v[208:223]
    ds_read_b128 v[228:231], v241 offset:2048
    v_exp_f32 v201, v201
    v_add_f32 v252, v252, v198
    v_add_f32 v252, v252, v199
    v_cvt_pk_bf16_f32 v195, v198, v199
    v_fma_f32 v202, v202, s29, -v249
    v_mul_f32 v27, v27, v8
    v_mul_f32 v28, v28, v8
    v_mul_f32 v29, v29, v8
    v_mul_f32 v30, v30, v8
    v_mul_f32 v31, v31, v8
    v_mul_f32 v99, v99, v72
    v_mul_f32 v136, v136, v253
    v_mul_f32 v137, v137, v253
    v_mul_f32 v138, v138, v253
    s_waitcnt lgkmcnt(3)
    v_mfma_f32_32x32x16_bf16 v[208:223], v[232:235], a[120:123], v[208:223]
    ds_read_b128 v[232:235], v242 offset:2048
    v_fma_f32 v203, v203, s29, -v249
    v_exp_f32 v202, v202
    v_exp_f32 v203, v203
    v_cvt_pk_bf16_f32 v16, v16, v17
    v_cvt_pk_bf16_f32 v17, v18, v19
    v_cvt_pk_bf16_f32 v18, v20, v21
    v_cvt_pk_bf16_f32 v19, v22, v23
    v_cvt_pk_bf16_f32 v20, v24, v25
    v_mul_f32 v100, v100, v72
    v_mul_f32 v101, v101, v72
    v_mul_f32 v139, v139, v253
    v_mul_f32 v140, v140, v253
    v_mul_f32 v141, v141, v253
    v_mfma_f32_32x32x16_bf16 v[208:223], v[236:239], a[124:127], v[208:223]
    ds_read_b128 v[236:239], v243 offset:2048
    v_cvt_pk_bf16_f32 v21, v26, v27
    v_cvt_pk_bf16_f32 v22, v28, v29
    v_cvt_pk_bf16_f32 v23, v30, v31
    v_mul_f32 v102, v102, v72
    v_mul_f32 v103, v103, v72
    v_mul_f32 v142, v142, v253
    v_mul_f32 v143, v143, v253
    v_cvt_pk_bf16_f32 v128, v128, v129
    v_mbcnt_lo_u32_b32 v184, -1, 0
    s_add_u32 s32, s38, 49152
    v_mbcnt_hi_u32_b32 v184, -1, v184
    v_lshlrev_b32 v184, 4, v184
    v_xor_b32 v184, s32, v184
    ds_read_b128 v[188:191], v184 offset:7168
    ds_read_b128 v[184:187], v184 offset:1024
    s_waitcnt lgkmcnt(4)
    v_mfma_f32_32x32x16_bf16 v[208:223], v[224:227], a[128:131], v[208:223]
    v_add_u32 v244, 0xffff7000, v244
    v_add_u32 v245, 0xffff7000, v245
    ds_read_b64_tr_b16 v[224:225], v244 offset:0
    ds_read_b64_tr_b16 v[226:227], v244 offset:3072
    v_add_f32 v252, v252, v200
    v_add_f32 v252, v252, v201
    v_cvt_pk_bf16_f32 v196, v200, v201
    v_fma_f32 v204, v204, s29, -v249
    v_fma_f32 v205, v205, s29, -v249
    v_permlane32_swap_b32 v16, v18
    v_permlane32_swap_b32 v17, v19
    v_permlane32_swap_b32 v20, v22
    v_permlane32_swap_b32 v21, v23
    v_mul_f32 v104, v104, v72
    v_mul_f32 v105, v105, v72
    v_mul_f32 v106, v106, v72
    v_mul_f32 v107, v107, v72
    v_cvt_pk_bf16_f32 v129, v130, v131
    v_cvt_pk_bf16_f32 v130, v132, v133
    v_mfma_f32_32x32x16_bf16 v[208:223], v[228:231], a[132:135], v[208:223]
    ds_read_b64_tr_b16 v[228:229], v245 offset:0
    ds_read_b64_tr_b16 v[230:231], v245 offset:3072
    v_exp_f32 v204, v204
    v_exp_f32 v205, v205
    v_add_f32 v252, v252, v202
    v_add_f32 v252, v252, v203
    v_cvt_pk_bf16_f32 v197, v202, v203
    ds_write_b128 v11, v[16:19] offset:2048
    ds_write_b128 v12, v[20:23] offset:2048
    v_mul_f32 v108, v108, v72
    v_cvt_pk_bf16_f32 v131, v134, v135
    v_cvt_pk_bf16_f32 v132, v136, v137
    v_cvt_pk_bf16_f32 v133, v138, v139
    v_cvt_pk_bf16_f32 v134, v140, v141
    s_waitcnt lgkmcnt(8)
    v_mfma_f32_32x32x16_bf16 v[208:223], v[232:235], a[136:139], v[208:223]
    ds_read_b64_tr_b16 v[232:233], v244 offset:1024
    ds_read_b64_tr_b16 v[234:235], v244 offset:4096
    v_fma_f32 v206, v206, s29, -v249
    v_mul_f32 v109, v109, v72
    v_mul_f32 v110, v110, v72
    v_mul_f32 v111, v111, v72
    v_cvt_pk_bf16_f32 v96, v96, v97
    v_cvt_pk_bf16_f32 v97, v98, v99
    v_cvt_pk_bf16_f32 v98, v100, v101
    v_cvt_pk_bf16_f32 v99, v102, v103
    v_cvt_pk_bf16_f32 v135, v142, v143
    v_permlane32_swap_b32 v128, v130
    v_permlane32_swap_b32 v129, v131
    s_add_u32 s32, s28, 0
    s_waitcnt lgkmcnt(8)
    buffer_store_dwordx4 v[184:187], v246, s[20:23], s32 offen offset:128 nt
    v_mfma_f32_32x32x16_bf16 v[208:223], v[236:239], a[140:143], v[208:223]
    ds_read_b64_tr_b16 v[236:237], v245 offset:1024
    ds_read_b64_tr_b16 v[238:239], v245 offset:4096
    v_fma_f32 v207, v207, s29, -v249
    v_cvt_pk_bf16_f32 v100, v104, v105
    v_cvt_pk_bf16_f32 v101, v106, v107
    v_cvt_pk_bf16_f32 v102, v108, v109
    v_cvt_pk_bf16_f32 v103, v110, v111
    v_permlane32_swap_b32 v96, v98
    v_permlane32_swap_b32 v97, v99
    v_permlane32_swap_b32 v100, v102
    v_permlane32_swap_b32 v132, v134
    v_permlane32_swap_b32 v133, v135
    v_mov_b32 v136, v253
    s_add_u32 s32, s28, 6144
    buffer_store_dwordx4 v[188:191], v246, s[20:23], s32 offen offset:128 nt
    s_waitcnt lgkmcnt(6)
    v_mfma_f32_32x32x16_bf16 v[0:15], v[224:227], v[176:179], 0
    ds_read_b64_tr_b16 v[224:225], v244 offset:2048
    ds_read_b64_tr_b16 v[226:227], v244 offset:5120
    v_exp_f32 v206, v206
    v_exp_f32 v207, v207
    v_add_f32 v252, v252, v204
    v_permlane32_swap_b32 v101, v103
    ds_write_b128 v73, v[96:99] offset:1024
    ds_write_b128 v74, v[100:103] offset:1024
    v_accvgpr_read_b32 v80, a176
    s_add_u32 s32, s36, 0xfffe8000
    v_add_u32 v137, s32, v240
    v_add_u32 v138, s32, v241
    v_add_u32 v139, s32, v242
    v_add_u32 v140, s32, v243
    v_mul_f32 v144, v144, v136
    v_mul_f32 v145, v145, v136
    v_mfma_f32_32x32x16_bf16 v[16:31], v[228:231], v[176:179], 0
    ds_read_b64_tr_b16 v[228:229], v245 offset:2048
    ds_read_b64_tr_b16 v[230:231], v245 offset:5120
    v_add_f32 v252, v252, v205
    v_cvt_pk_bf16_f32 v198, v204, v205
    v_add_f32 v252, v252, v206
    v_add_f32 v252, v252, v207
    v_cvt_pk_bf16_f32 v199, v206, v207
    v_accvgpr_read_b32 v81, a177
    v_accvgpr_read_b32 v82, a178
    v_accvgpr_read_b32 v83, a179
    v_accvgpr_read_b32 v84, a180
    v_accvgpr_read_b32 v85, a181
    v_accvgpr_read_b32 v86, a182
    v_mul_f32 v146, v146, v136
    v_mul_f32 v147, v147, v136
    s_waitcnt lgkmcnt(6)
    v_mfma_f32_32x32x16_bf16 v[32:47], v[232:235], v[176:179], 0
    ds_read_b64_tr_b16 v[232:233], v244 offset:6144
    ds_read_b64_tr_b16 v[234:235], v244 offset:9216
    v_max3_f32 v254, v208, v209, v210
    v_max3_f32 v254, v254, v211, v212
    v_max3_f32 v254, v254, v213, v214
    v_max3_f32 v254, v254, v215, v216
    v_max3_f32 v254, v254, v217, v218
    v_accvgpr_read_b32 v87, a183
    v_accvgpr_read_b32 v88, a184
    v_accvgpr_read_b32 v89, a185
    v_accvgpr_read_b32 v90, a186
    v_accvgpr_read_b32 v91, a187
    v_accvgpr_read_b32 v92, a188
    v_accvgpr_read_b32 v93, a189
    v_mul_f32 v148, v148, v136
    v_mul_f32 v149, v149, v136
    v_mfma_f32_32x32x16_bf16 a[144:159], v[236:239], v[176:179], 0
    ds_read_b64_tr_b16 v[236:237], v245 offset:6144
    ds_read_b64_tr_b16 v[238:239], v245 offset:9216
    v_accvgpr_read_b32 v94, a190
    v_accvgpr_read_b32 v95, a191
    v_mul_f32 v80, v80, v72
    v_mul_f32 v81, v81, v72
    v_mul_f32 v150, v150, v136
    v_mul_f32 v151, v151, v136
    v_mbcnt_lo_u32_b32 v184, -1, 0
    s_add_u32 s32, s39, 49152
    v_mbcnt_hi_u32_b32 v184, -1, v184
    v_lshlrev_b32 v184, 4, v184
    v_xor_b32 v184, s32, v184
    ds_read_b128 v[188:191], v184 offset:10240
    ds_read_b128 v[184:187], v184 offset:4096
    s_waitcnt lgkmcnt(6)
    v_mfma_f32_32x32x16_bf16 v[48:63], v[224:227], v[176:179], 0
    ds_read_b64_tr_b16 v[224:225], v244 offset:7168
    ds_read_b64_tr_b16 v[226:227], v244 offset:10240
    v_max3_f32 v254, v254, v219, v220
    v_max3_f32 v254, v254, v221, v222
    v_max_f32 v254, v254, v223
    v_mov_b32 v255, v254
    v_mul_f32 v82, v82, v72
    v_mul_f32 v83, v83, v72
    v_mul_f32 v84, v84, v72
    v_mul_f32 v85, v85, v72
    v_mul_f32 v86, v86, v72
    v_mul_f32 v87, v87, v72
    v_mul_f32 v88, v88, v72
    v_mul_f32 v152, v152, v136
    v_mul_f32 v153, v153, v136
    v_mul_f32 v154, v154, v136
    v_mfma_f32_32x32x16_bf16 a[160:175], v[228:231], v[176:179], 0
    ds_read_b64_tr_b16 v[228:229], v245 offset:7168
    ds_read_b64_tr_b16 v[230:231], v245 offset:10240
    v_permlane32_swap_b32 v254, v255
    v_max_f32 v254, v254, v255
    v_mul_f32 v250, s29, v254
    v_fma_f32 v208, v208, s29, -v250
    v_fma_f32 v209, v209, s29, -v250
    v_mul_f32 v89, v89, v72
    v_mul_f32 v90, v90, v72
    v_mul_f32 v91, v91, v72
    v_mul_f32 v92, v92, v72
    v_mul_f32 v93, v93, v72
    v_mul_f32 v94, v94, v72
    v_mul_f32 v155, v155, v136
    v_mul_f32 v156, v156, v136
    v_mul_f32 v157, v157, v136
    s_waitcnt lgkmcnt(6)
    v_mfma_f32_32x32x16_bf16 v[0:15], v[232:235], v[180:183], v[0:15]
    ds_read_b64_tr_b16 v[232:233], v244 offset:8192
    ds_read_b64_tr_b16 v[234:235], v244 offset:11264
    v_mul_f32 v95, v95, v72
    v_cvt_pk_bf16_f32 v80, v80, v81
    v_cvt_pk_bf16_f32 v81, v82, v83
    v_cvt_pk_bf16_f32 v82, v84, v85
    v_cvt_pk_bf16_f32 v83, v86, v87
    v_cvt_pk_bf16_f32 v84, v88, v89
    v_cvt_pk_bf16_f32 v85, v90, v91
    v_mul_f32 v158, v158, v136
    v_mul_f32 v159, v159, v136
    s_add_u32 s32, s28, 3072
    s_waitcnt lgkmcnt(6)
    buffer_store_dwordx4 v[184:187], v246, s[20:23], s32 offen offset:128 nt
    v_mfma_f32_32x32x16_bf16 v[16:31], v[236:239], v[180:183], v[16:31]
    s_waitcnt vmcnt(9)
    s_barrier
    s_add_u32 m0, s30, 135168
    s_add_u32 s33, s26, 24576
    ds_read_b64_tr_b16 v[236:237], v245 offset:8192
    ds_read_b64_tr_b16 v[238:239], v245 offset:11264
    v_cvt_pk_bf16_f32 v86, v92, v93
    v_cvt_pk_bf16_f32 v87, v94, v95
    v_cvt_pk_bf16_f32 v144, v144, v145
    v_cvt_pk_bf16_f32 v145, v146, v147
    s_add_u32 s32, s28, 9216
    buffer_store_dwordx4 v[188:191], v246, s[20:23], s32 offen offset:128 nt
    buffer_load_dwordx4 v246, s[12:15], s33 offen offset:0 nt lds
    s_waitcnt lgkmcnt(4)
    v_mfma_f32_32x32x16_bf16 v[32:47], v[224:227], v[180:183], v[32:47]
    v_add_u32 v240, 0xffff7000, v240
    v_add_u32 v241, 0xffff7000, v241
    v_add_u32 v242, 0xffff7000, v242
    v_add_u32 v243, 0xffff7000, v243
    ds_read_b128 v[224:227], v240 offset:0
    v_exp_f32 v208, v208
    v_exp_f32 v209, v209
    v_fma_f32 v210, v210, s29, -v250
    v_permlane32_swap_b32 v80, v82
    v_permlane32_swap_b32 v81, v83
    v_permlane32_swap_b32 v84, v86
    v_permlane32_swap_b32 v85, v87
    ds_write_b128 v75, v[80:83] offset:1024
    v_cvt_pk_bf16_f32 v146, v148, v149
    v_cvt_pk_bf16_f32 v147, v150, v151
    v_mfma_f32_32x32x16_bf16 a[144:159], v[228:231], v[180:183], a[144:159]
    s_add_u32 m0, s30, 136064
    ds_read_b128 v[228:231], v241 offset:0
    v_fma_f32 v211, v211, s29, -v250
    ds_write_b128 v76, v[84:87] offset:1024
    v_mul_f32 v112, v112, v72
    v_mul_f32 v113, v113, v72
    v_mul_f32 v114, v114, v72
    v_mul_f32 v115, v115, v72
    v_mul_f32 v116, v116, v72
    v_cvt_pk_bf16_f32 v148, v152, v153
    v_cvt_pk_bf16_f32 v149, v154, v155
    v_cvt_pk_bf16_f32 v150, v156, v157
    buffer_load_dwordx4 v246, s[12:15], s33 offen offset:128 nt lds
    s_waitcnt lgkmcnt(4)
    v_mfma_f32_32x32x16_bf16 v[48:63], v[232:235], v[180:183], v[48:63]
    ds_read_b128 v[232:235], v242 offset:0
    v_exp_f32 v210, v210
    v_exp_f32 v211, v211
    v_add_f32 v253, v208, v209
    v_cvt_pk_bf16_f32 v208, v208, v209
    v_mul_f32 v117, v117, v72
    v_mul_f32 v118, v118, v72
    v_mul_f32 v119, v119, v72
    v_mul_f32 v120, v120, v72
    v_mul_f32 v121, v121, v72
    v_cvt_pk_bf16_f32 v151, v158, v159
    v_permlane32_swap_b32 v144, v146
    v_mfma_f32_32x32x16_bf16 a[160:175], v[236:239], v[180:183], a[160:175]
    s_add_u32 m0, s30, 136960
    ds_read_b128 v[236:239], v243 offset:0
    v_fma_f32 v212, v212, s29, -v250
    v_mul_f32 v122, v122, v72
    v_mul_f32 v123, v123, v72
    v_mul_f32 v124, v124, v72
    v_mul_f32 v125, v125, v72
    v_mul_f32 v126, v126, v72
    v_mul_f32 v127, v127, v72
    v_cvt_pk_bf16_f32 v112, v112, v113
    v_permlane32_swap_b32 v145, v147
    v_permlane32_swap_b32 v148, v150
    v_permlane32_swap_b32 v149, v151
    buffer_load_dwordx4 v246, s[12:15], s33 offen offset:256 nt lds
    s_waitcnt lgkmcnt(3)
    v_mfma_f32_32x32x16_bf16 v[176:191], v[224:227], a[0:3], 0
    ds_read_b128 v[224:227], v240 offset:1024
    v_fma_f32 v213, v213, s29, -v250
    v_exp_f32 v212, v212
    v_exp_f32 v213, v213
    v_add_f32 v253, v253, v210
    v_cvt_pk_bf16_f32 v113, v114, v115
    v_cvt_pk_bf16_f32 v114, v116, v117
    v_cvt_pk_bf16_f32 v115, v118, v119
    v_cvt_pk_bf16_f32 v116, v120, v121
    v_cvt_pk_bf16_f32 v117, v122, v123
    v_cvt_pk_bf16_f32 v118, v124, v125
    v_mfma_f32_32x32x16_bf16 v[176:191], v[228:231], a[4:7], v[176:191]
    s_add_u32 m0, s30, 147456
    s_add_u32 s33, s26, 24576
    ds_read_b128 v[228:231], v241 offset:1024
    v_add_f32 v253, v253, v211
    v_cvt_pk_bf16_f32 v209, v210, v211
    v_fma_f32 v214, v214, s29, -v250
    v_cvt_pk_bf16_f32 v119, v126, v127
    v_permlane32_swap_b32 v112, v114
    v_permlane32_swap_b32 v113, v115
    v_permlane32_swap_b32 v116, v118
    v_permlane32_swap_b32 v117, v119
    ds_write_b128 v73, v[112:115] offset:2048
    buffer_load_dwordx4 v247, s[16:19], s33 offen offset:0 nt lds
    s_waitcnt lgkmcnt(3)
    v_mfma_f32_32x32x16_bf16 v[176:191], v[232:235], a[8:11], v[176:191]
    ds_read_b128 v[232:235], v242 offset:1024
    ds_write_b128 v74, v[116:119] offset:2048
    v_accvgpr_read_b32 v80, a192
    v_accvgpr_read_b32 v81, a193
    v_accvgpr_read_b32 v82, a194
    ds_write_b128 v137, v[128:131] offset:0
    v_mbcnt_lo_u32_b32 v200, -1, 0
    s_add_u32 s32, s38, 49152
    v_mbcnt_hi_u32_b32 v200, -1, v200
    v_lshlrev_b32 v200, 4, v200
    v_xor_b32 v200, s32, v200
    ds_read_b128 v[204:207], v200 offset:8192
    ds_read_b128 v[200:203], v200 offset:2048
    v_mfma_f32_32x32x16_bf16 v[176:191], v[236:239], a[12:15], v[176:191]
    s_add_u32 m0, s30, 148352
    ds_read_b128 v[236:239], v243 offset:1024
    v_fma_f32 v215, v215, s29, -v250
    v_exp_f32 v214, v214
    v_accvgpr_read_b32 v83, a195
    v_accvgpr_read_b32 v84, a196
    v_accvgpr_read_b32 v85, a197
    v_accvgpr_read_b32 v86, a198
    v_accvgpr_read_b32 v87, a199
    v_accvgpr_read_b32 v88, a200
    buffer_load_dwordx4 v247, s[16:19], s33 offen offset:128 nt lds
    s_waitcnt lgkmcnt(7)
    v_mfma_f32_32x32x16_bf16 v[176:191], v[224:227], a[16:19], v[176:191]
    ds_read_b128 v[224:227], v240 offset:2048
    v_exp_f32 v215, v215
    v_add_f32 v253, v253, v212
    v_add_f32 v253, v253, v213
    v_cvt_pk_bf16_f32 v210, v212, v213
    v_accvgpr_read_b32 v89, a201
    v_accvgpr_read_b32 v90, a202
    v_accvgpr_read_b32 v91, a203
    v_accvgpr_read_b32 v92, a204
    v_accvgpr_read_b32 v93, a205
    v_accvgpr_read_b32 v94, a206
    v_accvgpr_read_b32 v95, a207
    ds_write_b128 v138, v[132:135] offset:0
    v_mfma_f32_32x32x16_bf16 v[176:191], v[228:231], a[20:23], v[176:191]
    s_add_u32 m0, s30, 149248
    ds_read_b128 v[228:231], v241 offset:2048
    v_mul_f32 v80, v80, v72
    v_mul_f32 v81, v81, v72
    v_mul_f32 v82, v82, v72
    v_mul_f32 v83, v83, v72
    v_mul_f32 v84, v84, v72
    s_add_u32 s32, s28, 0
    s_waitcnt lgkmcnt(4)
    buffer_store_dwordx4 v[200:203], v246, s[20:23], s32 offen offset:256 nt
    buffer_load_dwordx4 v247, s[16:19], s33 offen offset:256 nt lds
    s_waitcnt lgkmcnt(3)
    v_mfma_f32_32x32x16_bf16 v[176:191], v[232:235], a[24:27], v[176:191]
    ds_read_b128 v[232:235], v242 offset:2048
    v_fma_f32 v216, v216, s29, -v250
    v_mul_f32 v85, v85, v72
    v_mul_f32 v86, v86, v72
    v_mul_f32 v87, v87, v72
    v_mul_f32 v88, v88, v72
    v_mul_f32 v89, v89, v72
    v_mul_f32 v90, v90, v72
    v_mul_f32 v91, v91, v72
    s_add_u32 s32, s28, 6144
    buffer_store_dwordx4 v[204:207], v246, s[20:23], s32 offen offset:256 nt
    v_mfma_f32_32x32x16_bf16 v[176:191], v[236:239], a[28:31], v[176:191]
    ds_read_b128 v[236:239], v243 offset:2048
    v_fma_f32 v217, v217, s29, -v250
    v_exp_f32 v216, v216
    v_exp_f32 v217, v217
    v_add_f32 v253, v253, v214
    v_mul_f32 v92, v92, v72
    v_mul_f32 v93, v93, v72
    v_mul_f32 v94, v94, v72
    v_mul_f32 v95, v95, v72
    v_cvt_pk_bf16_f32 v80, v80, v81
    v_cvt_pk_bf16_f32 v81, v82, v83
    v_cvt_pk_bf16_f32 v82, v84, v85
    s_waitcnt lgkmcnt(2)
    v_mfma_f32_32x32x16_bf16 v[176:191], v[224:227], a[32:35], v[176:191]
    ds_read_b64_tr_b16 v[224:225], v244 offset:0
    ds_read_b64_tr_b16 v[226:227], v244 offset:3072
    v_add_f32 v253, v253, v215
    v_cvt_pk_bf16_f32 v211, v214, v215
    v_fma_f32 v218, v218, s29, -v250
    v_fma_f32 v219, v219, s29, -v250
    v_exp_f32 v218, v218
    v_cvt_pk_bf16_f32 v83, v86, v87
    v_cvt_pk_bf16_f32 v84, v88, v89
    v_cvt_pk_bf16_f32 v85, v90, v91
    v_cvt_pk_bf16_f32 v86, v92, v93
    v_cvt_pk_bf16_f32 v87, v94, v95
    v_permlane32_swap_b32 v80, v82
    ds_write_b128 v139, v[144:147] offset:0
    v_mfma_f32_32x32x16_bf16 v[176:191], v[228:231], a[36:39], v[176:191]
    ds_read_b64_tr_b16 v[228:229], v245 offset:0
    ds_read_b64_tr_b16 v[230:231], v245 offset:3072
    v_exp_f32 v219, v219
    v_add_f32 v253, v253, v216
    v_add_f32 v253, v253, v217
    v_cvt_pk_bf16_f32 v212, v216, v217
    v_permlane32_swap_b32 v81, v83
    v_permlane32_swap_b32 v84, v86
    v_permlane32_swap_b32 v85, v87
    ds_write_b128 v75, v[80:83] offset:2048
    ds_write_b128 v76, v[84:87] offset:2048
    s_waitcnt lgkmcnt(7)
    v_mfma_f32_32x32x16_bf16 v[176:191], v[232:235], a[40:43], v[176:191]
    ds_read_b64_tr_b16 v[232:233], v244 offset:1024
    ds_read_b64_tr_b16 v[234:235], v244 offset:4096
    v_fma_f32 v220, v220, s29, -v250
    v_fma_f32 v221, v221, s29, -v250
    v_exp_f32 v220, v220
    v_exp_f32 v221, v221
    ds_write_b128 v140, v[148:151] offset:0
    v_mul_f32 v160, v160, v136
    v_mul_f32 v161, v161, v136
    v_mul_f32 v162, v162, v136
    v_mul_f32 v163, v163, v136
    v_mul_f32 v164, v164, v136
    v_mfma_f32_32x32x16_bf16 v[176:191], v[236:239], a[44:47], v[176:191]
    ds_read_b64_tr_b16 v[236:237], v245 offset:1024
    ds_read_b64_tr_b16 v[238:239], v245 offset:4096
    v_add_f32 v253, v253, v218
    v_add_f32 v253, v253, v219
    v_cvt_pk_bf16_f32 v213, v218, v219
    v_fma_f32 v222, v222, s29, -v250
    v_fma_f32 v223, v223, s29, -v250
    v_mul_f32 v165, v165, v136
    v_mul_f32 v166, v166, v136
    v_mul_f32 v167, v167, v136
    v_mul_f32 v168, v168, v136
    v_mul_f32 v169, v169, v136
    v_mul_f32 v170, v170, v136
    v_mul_f32 v171, v171, v136
    v_mul_f32 v172, v172, v136
    s_waitcnt lgkmcnt(7)
    v_mfma_f32_32x32x16_bf16 v[64:79], v[224:227], v[192:195], 0
    ds_read_b64_tr_b16 v[224:225], v244 offset:2048
    ds_read_b64_tr_b16 v[226:227], v244 offset:5120
    v_exp_f32 v222, v222
    v_exp_f32 v223, v223
    v_add_f32 v253, v253, v220
    v_mul_f32 v173, v173, v136
    v_mul_f32 v174, v174, v136
    v_mul_f32 v175, v175, v136
    v_cvt_pk_bf16_f32 v160, v160, v161
    v_cvt_pk_bf16_f32 v161, v162, v163
    v_cvt_pk_bf16_f32 v162, v164, v165
    v_cvt_pk_bf16_f32 v163, v166, v167
    v_mfma_f32_32x32x16_bf16 v[80:95], v[228:231], v[192:195], 0
    ds_read_b64_tr_b16 v[228:229], v245 offset:2048
    ds_read_b64_tr_b16 v[230:231], v245 offset:5120
    v_add_f32 v253, v253, v221
    v_cvt_pk_bf16_f32 v214, v220, v221
    v_add_f32 v253, v253, v222
    v_add_f32 v253, v253, v223
    v_cvt_pk_bf16_f32 v215, v222, v223
    v_cvt_pk_bf16_f32 v164, v168, v169
    v_cvt_pk_bf16_f32 v165, v170, v171
    v_cvt_pk_bf16_f32 v166, v172, v173
    v_cvt_pk_bf16_f32 v167, v174, v175
    v_permlane32_swap_b32 v160, v162
    v_permlane32_swap_b32 v161, v163
    s_waitcnt lgkmcnt(4)
    v_mfma_f32_32x32x16_bf16 v[96:111], v[232:235], v[192:195], 0
    ds_read_b64_tr_b16 v[232:233], v244 offset:6144
    ds_read_b64_tr_b16 v[234:235], v244 offset:9216
    v_permlane32_swap_b32 v164, v166
    v_permlane32_swap_b32 v165, v167
    ds_write_b128 v137, v[160:163] offset:1024
    ds_write_b128 v138, v[164:167] offset:1024
    v_mbcnt_lo_u32_b32 v216, -1, 0
    s_add_u32 s32, s39, 49152
    v_mbcnt_hi_u32_b32 v216, -1, v216
    v_lshlrev_b32 v216, 4, v216
    v_xor_b32 v216, s32, v216
    ds_read_b128 v[220:223], v216 offset:11264
    ds_read_b128 v[216:219], v216 offset:5120
    v_mfma_f32_32x32x16_bf16 a[176:191], v[236:239], v[192:195], 0
    ds_read_b64_tr_b16 v[236:237], v245 offset:6144
    ds_read_b64_tr_b16 v[238:239], v245 offset:9216
    v_max3_f32 v254, v176, v177, v178
    v_max3_f32 v254, v254, v179, v180
    v_max3_f32 v254, v254, v181, v182
    v_max3_f32 v254, v254, v183, v184
    v_accvgpr_read_b32 v144, a208
    v_accvgpr_read_b32 v145, a209
    v_accvgpr_read_b32 v146, a210
    v_accvgpr_read_b32 v147, a211
    v_accvgpr_read_b32 v148, a212
    v_accvgpr_read_b32 v149, a213
    v_accvgpr_read_b32 v150, a214
    s_waitcnt lgkmcnt(8)
    v_mfma_f32_32x32x16_bf16 v[112:127], v[224:227], v[192:195], 0
    ds_read_b64_tr_b16 v[224:225], v244 offset:7168
    ds_read_b64_tr_b16 v[226:227], v244 offset:10240
    v_max3_f32 v254, v254, v185, v186
    v_max3_f32 v254, v254, v187, v188
    v_max3_f32 v254, v254, v189, v190
    v_max_f32 v254, v254, v191
    v_accvgpr_read_b32 v151, a215
    v_accvgpr_read_b32 v152, a216
    v_accvgpr_read_b32 v153, a217
    v_accvgpr_read_b32 v154, a218
    v_accvgpr_read_b32 v155, a219
    v_accvgpr_read_b32 v156, a220
    v_accvgpr_read_b32 v157, a221
    v_accvgpr_read_b32 v158, a222
    v_mfma_f32_32x32x16_bf16 a[192:207], v[228:231], v[192:195], 0
    ds_read_b64_tr_b16 v[228:229], v245 offset:7168
    ds_read_b64_tr_b16 v[230:231], v245 offset:10240
    v_accvgpr_read_b32 v159, a223
    v_mul_f32 v144, v144, v136
    v_mul_f32 v145, v145, v136
    v_mul_f32 v146, v146, v136
    v_mul_f32 v147, v147, v136
    v_mul_f32 v148, v148, v136
    v_mul_f32 v149, v149, v136
    v_mul_f32 v150, v150, v136
    s_add_u32 s32, s28, 3072
    s_waitcnt lgkmcnt(6)
    buffer_store_dwordx4 v[216:219], v246, s[20:23], s32 offen offset:256 nt
    s_waitcnt lgkmcnt(4)
    v_mfma_f32_32x32x16_bf16 v[64:79], v[232:235], v[196:199], v[64:79]
    ds_read_b64_tr_b16 v[232:233], v244 offset:8192
    ds_read_b64_tr_b16 v[234:235], v244 offset:11264
    v_mul_f32 v151, v151, v136
    v_mul_f32 v152, v152, v136
    v_mul_f32 v153, v153, v136
    v_mul_f32 v154, v154, v136
    v_mul_f32 v155, v155, v136
    v_mul_f32 v156, v156, v136
    v_mul_f32 v157, v157, v136
    s_add_u32 s32, s28, 9216
    buffer_store_dwordx4 v[220:223], v246, s[20:23], s32 offen offset:256 nt
    v_mfma_f32_32x32x16_bf16 v[80:95], v[236:239], v[196:199], v[80:95]
    ds_read_b64_tr_b16 v[236:237], v245 offset:8192
    ds_read_b64_tr_b16 v[238:239], v245 offset:11264
    v_fma_f32 v255, v254, s29, -v248
    v_cmp_lt_f32 vcc, s31, v255
    s_cbranch_vccnz L_slow6
L_ret6:
    v_fma_f32 v176, v176, s29, -v248
    v_mul_f32 v158, v158, v136
    v_mul_f32 v159, v159, v136
    v_cvt_pk_bf16_f32 v144, v144, v145
    v_cvt_pk_bf16_f32 v145, v146, v147
    v_cvt_pk_bf16_f32 v146, v148, v149
    v_cvt_pk_bf16_f32 v147, v150, v151
    v_cvt_pk_bf16_f32 v148, v152, v153
    v_cvt_pk_bf16_f32 v149, v154, v155
    s_waitcnt lgkmcnt(4)
    v_mfma_f32_32x32x16_bf16 v[96:111], v[224:227], v[196:199], v[96:111]
    ds_read_b128 v[224:227], v240 offset:0
    v_fma_f32 v177, v177, s29, -v248
    v_exp_f32 v176, v176
    v_exp_f32 v177, v177
    v_cvt_pk_bf16_f32 v150, v156, v157
    v_cvt_pk_bf16_f32 v151, v158, v159
    v_permlane32_swap_b32 v144, v146
    v_permlane32_swap_b32 v145, v147
    v_permlane32_swap_b32 v148, v150
    v_permlane32_swap_b32 v149, v151
    v_mfma_f32_32x32x16_bf16 a[176:191], v[228:231], v[196:199], a[176:191]
    ds_read_b128 v[228:231], v241 offset:0
    v_fma_f32 v178, v178, s29, -v248
    v_fma_f32 v179, v179, s29, -v248
    v_exp_f32 v178, v178
    ds_write_b128 v139, v[144:147] offset:1024
    ds_write_b128 v140, v[148:151] offset:1024
    v_accvgpr_read_b32 v144, a240
    v_accvgpr_read_b32 v145, a241
    v_accvgpr_read_b32 v146, a242
    v_accvgpr_read_b32 v147, a243
    v_accvgpr_read_b32 v148, a244
    s_waitcnt lgkmcnt(4)
    v_mfma_f32_32x32x16_bf16 v[112:127], v[232:235], v[196:199], v[112:127]
    ds_read_b128 v[232:235], v242 offset:0
    v_exp_f32 v179, v179
    v_add_f32 v251, v251, v176
    v_accvgpr_read_b32 v149, a245
    v_accvgpr_read_b32 v150, a246
    v_accvgpr_read_b32 v151, a247
    v_accvgpr_read_b32 v152, a248
    v_accvgpr_read_b32 v153, a249
    v_accvgpr_read_b32 v154, a250
    v_accvgpr_read_b32 v155, a251
    v_accvgpr_read_b32 v156, a252
    v_mfma_f32_32x32x16_bf16 a[192:207], v[236:239], v[196:199], a[192:207]
    ds_read_b128 v[236:239], v243 offset:0
    v_add_f32 v251, v251, v177
    v_cvt_pk_bf16_f32 v176, v176, v177
    v_fma_f32 v180, v180, s29, -v248
    v_fma_f32 v181, v181, s29, -v248
    v_accvgpr_read_b32 v157, a253
    v_accvgpr_read_b32 v158, a254
    v_accvgpr_read_b32 v159, a255
    v_mul_f32 v144, v144, v136
    v_mul_f32 v145, v145, v136
    v_mul_f32 v146, v146, v136
    v_mul_f32 v147, v147, v136
    v_mul_f32 v148, v148, v136
    s_waitcnt lgkmcnt(4)
    v_mfma_f32_32x32x16_bf16 v[192:207], v[224:227], a[48:51], 0
    ds_read_b128 v[224:227], v240 offset:1024
    v_exp_f32 v180, v180
    v_exp_f32 v181, v181
    v_add_f32 v251, v251, v178
    v_mul_f32 v149, v149, v136
    v_mul_f32 v150, v150, v136
    v_mul_f32 v151, v151, v136
    v_mul_f32 v152, v152, v136
    v_mul_f32 v153, v153, v136
    v_mul_f32 v154, v154, v136
    v_mul_f32 v155, v155, v136
    v_mul_f32 v156, v156, v136
    v_mfma_f32_32x32x16_bf16 v[192:207], v[228:231], a[52:55], v[192:207]
    ds_read_b128 v[228:231], v241 offset:1024
    v_add_f32 v251, v251, v179
    v_cvt_pk_bf16_f32 v177, v178, v179
    v_fma_f32 v182, v182, s29, -v248
    v_fma_f32 v183, v183, s29, -v248
    v_exp_f32 v182, v182
    v_mul_f32 v157, v157, v136
    v_mul_f32 v158, v158, v136
    v_mul_f32 v159, v159, v136
    v_cvt_pk_bf16_f32 v144, v144, v145
    v_cvt_pk_bf16_f32 v145, v146, v147
    v_cvt_pk_bf16_f32 v146, v148, v149
    v_cvt_pk_bf16_f32 v147, v150, v151
    s_waitcnt lgkmcnt(2)
    v_mfma_f32_32x32x16_bf16 v[192:207], v[232:235], a[56:59], v[192:207]
    ds_read_b128 v[232:235], v242 offset:1024
    v_exp_f32 v183, v183
    v_add_f32 v251, v251, v180
    v_add_f32 v251, v251, v181
    v_cvt_pk_bf16_f32 v148, v152, v153
    v_cvt_pk_bf16_f32 v149, v154, v155
    v_cvt_pk_bf16_f32 v150, v156, v157
    v_cvt_pk_bf16_f32 v151, v158, v159
    v_permlane32_swap_b32 v144, v146
    v_permlane32_swap_b32 v145, v147
    v_permlane32_swap_b32 v148, v150
    v_permlane32_swap_b32 v149, v151
    v_mfma_f32_32x32x16_bf16 v[192:207], v[236:239], a[60:63], v[192:207]
    ds_read_b128 v[236:239], v243 offset:1024
    ds_write_b128 v137, v[144:147] offset:2048
    ds_write_b128 v138, v[148:151] offset:2048
    v_accvgpr_read_b32 v144, a224
    v_accvgpr_read_b32 v145, a225
    v_mbcnt_lo_u32_b32 v216, -1, 0
    s_add_u32 s32, s38, 0
    v_mbcnt_hi_u32_b32 v216, -1, v216
    v_lshlrev_b32 v216, 4, v216
    v_xor_b32 v216, s32, v216
    ds_read_b128 v[220:223], v216 offset:6144
    ds_read_b128 v[216:219], v216 offset:0
    s_waitcnt lgkmcnt(6)
    v_mfma_f32_32x32x16_bf16 v[192:207], v[224:227], a[64:67], v[192:207]
    ds_read_b128 v[224:227], v240 offset:2048
    v_cvt_pk_bf16_f32 v178, v180, v181
    v_fma_f32 v184, v184, s29, -v248
    v_fma_f32 v185, v185, s29, -v248
    v_exp_f32 v184, v184
    v_accvgpr_read_b32 v146, a226
    v_accvgpr_read_b32 v147, a227
    v_accvgpr_read_b32 v148, a228
    v_accvgpr_read_b32 v149, a229
    v_accvgpr_read_b32 v150, a230
    v_accvgpr_read_b32 v151, a231
    v_accvgpr_read_b32 v152, a232
    v_accvgpr_read_b32 v153, a233
    v_mfma_f32_32x32x16_bf16 v[192:207], v[228:231], a[68:71], v[192:207]
    ds_read_b128 v[228:231], v241 offset:2048
    v_exp_f32 v185, v185
    v_add_f32 v251, v251, v182
    v_add_f32 v251, v251, v183
    v_cvt_pk_bf16_f32 v179, v182, v183
    v_accvgpr_read_b32 v154, a234
    v_accvgpr_read_b32 v155, a235
    v_accvgpr_read_b32 v156, a236
    v_accvgpr_read_b32 v157, a237
    v_accvgpr_read_b32 v158, a238
    v_accvgpr_read_b32 v159, a239
    v_mul_f32 v144, v144, v136
    v_mul_f32 v145, v145, v136
    s_waitcnt lgkmcnt(6)
    v_mfma_f32_32x32x16_bf16 v[192:207], v[232:235], a[72:75], v[192:207]
    ds_read_b128 v[232:235], v242 offset:2048
    v_fma_f32 v186, v186, s29, -v248
    v_mul_f32 v146, v146, v136
    v_mul_f32 v147, v147, v136
    v_mul_f32 v148, v148, v136
    v_mul_f32 v149, v149, v136
    v_mul_f32 v150, v150, v136
    v_mul_f32 v151, v151, v136
    v_mul_f32 v152, v152, v136
    v_mul_f32 v153, v153, v136
    s_add_u32 s32, s28, 12288
    s_waitcnt lgkmcnt(3)
    buffer_store_dwordx4 v[216:219], v246, s[20:23], s32 offen offset:0 nt
    v_mfma_f32_32x32x16_bf16 v[192:207], v[236:239], a[76:79], v[192:207]
    ds_read_b128 v[236:239], v243 offset:2048
    v_fma_f32 v187, v187, s29, -v248
    v_mul_f32 v154, v154, v136
    v_mul_f32 v155, v155, v136
    v_mul_f32 v156, v156, v136
    v_mul_f32 v157, v157, v136
    v_mul_f32 v158, v158, v136
    v_mul_f32 v159, v159, v136
    v_cvt_pk_bf16_f32 v144, v144, v145
    s_add_u32 s32, s28, 18432
    buffer_store_dwordx4 v[220:223], v246, s[20:23], s32 offen offset:0 nt
    s_waitcnt lgkmcnt(2)
    v_mfma_f32_32x32x16_bf16 v[192:207], v[224:227], a[80:83], v[192:207]
    ds_read_b64_tr_b16 v[224:225], v244 offset:0
    ds_read_b64_tr_b16 v[226:227], v244 offset:3072
    v_exp_f32 v186, v186
    v_exp_f32 v187, v187
    v_add_f32 v251, v251, v184
    v_cvt_pk_bf16_f32 v145, v146, v147
    v_cvt_pk_bf16_f32 v146, v148, v149
    v_cvt_pk_bf16_f32 v147, v150, v151
    v_cvt_pk_bf16_f32 v148, v152, v153
    v_cvt_pk_bf16_f32 v149, v154, v155
    v_cvt_pk_bf16_f32 v150, v156, v157
    v_cvt_pk_bf16_f32 v151, v158, v159
    v_permlane32_swap_b32 v144, v146
    v_mfma_f32_32x32x16_bf16 v[192:207], v[228:231], a[84:87], v[192:207]
    ds_read_b64_tr_b16 v[228:229], v245 offset:0
    ds_read_b64_tr_b16 v[230:231], v245 offset:3072
    v_add_f32 v251, v251, v185
    v_cvt_pk_bf16_f32 v180, v184, v185
    v_fma_f32 v188, v188, s29, -v248
    v_fma_f32 v189, v189, s29, -v248
    v_exp_f32 v188, v188
    v_permlane32_swap_b32 v145, v147
    v_permlane32_swap_b32 v148, v150
    v_permlane32_swap_b32 v149, v151
    ds_write_b128 v139, v[144:147] offset:2048
    ds_write_b128 v140, v[148:151] offset:2048
    s_waitcnt lgkmcnt(6)
    v_mfma_f32_32x32x16_bf16 v[192:207], v[232:235], a[88:91], v[192:207]
    ds_read_b64_tr_b16 v[232:233], v244 offset:1024
    ds_read_b64_tr_b16 v[234:235], v244 offset:4096
    v_exp_f32 v189, v189
    v_add_f32 v251, v251, v186
    v_add_f32 v251, v251, v187
    v_mfma_f32_32x32x16_bf16 v[192:207], v[236:239], a[92:95], v[192:207]
    ds_read_b64_tr_b16 v[236:237], v245 offset:1024
    ds_read_b64_tr_b16 v[238:239], v245 offset:4096
    v_cvt_pk_bf16_f32 v181, v186, v187
    v_fma_f32 v190, v190, s29, -v248
    v_fma_f32 v191, v191, s29, -v248
    v_exp_f32 v190, v190
L_join:
    s_waitcnt lgkmcnt(6)
    v_mfma_f32_32x32x16_bf16 v[128:143], v[224:227], v[208:211], 0
    ds_read_b64_tr_b16 v[224:225], v244 offset:2048
    ds_read_b64_tr_b16 v[226:227], v244 offset:5120
    v_exp_f32 v191, v191
    v_add_f32 v251, v251, v188
    v_add_f32 v251, v251, v189
    v_mfma_f32_32x32x16_bf16 v[144:159], v[228:231], v[208:211], 0
    ds_read_b64_tr_b16 v[228:229], v245 offset:2048
    ds_read_b64_tr_b16 v[230:231], v245 offset:5120
    v_cvt_pk_bf16_f32 v182, v188, v189
    v_add_f32 v251, v251, v190
    v_add_f32 v251, v251, v191
    v_cvt_pk_bf16_f32 v183, v190, v191
    s_waitcnt lgkmcnt(4)
    v_mfma_f32_32x32x16_bf16 v[160:175], v[232:235], v[208:211], 0
    ds_read_b64_tr_b16 v[232:233], v244 offset:6144
    ds_read_b64_tr_b16 v[234:235], v244 offset:9216
    v_max3_f32 v254, v192, v193, v194
    v_max3_f32 v254, v254, v195, v196
    v_max3_f32 v254, v254, v197, v198
    v_mfma_f32_32x32x16_bf16 a[208:223], v[236:239], v[208:211], 0
    ds_read_b64_tr_b16 v[236:237], v245 offset:6144
    ds_read_b64_tr_b16 v[238:239], v245 offset:9216
    v_max3_f32 v254, v254, v199, v200
    v_max3_f32 v254, v254, v201, v202
    v_max3_f32 v254, v254, v203, v204
    v_max3_f32 v254, v254, v205, v206
    s_waitcnt lgkmcnt(4)
    v_mfma_f32_32x32x16_bf16 a[240:255], v[224:227], v[208:211], 0
    ds_read_b64_tr_b16 v[224:225], v244 offset:7168
    ds_read_b64_tr_b16 v[226:227], v244 offset:10240
    v_max_f32 v254, v254, v207
    v_fma_f32 v255, v254, s29, -v249
    v_cmp_lt_f32 vcc, s31, v255
    v_mfma_f32_32x32x16_bf16 a[224:239], v[228:231], v[208:211], 0
    ds_read_b64_tr_b16 v[228:229], v245 offset:7168
    ds_read_b64_tr_b16 v[230:231], v245 offset:10240
    s_cbranch_vccnz L_slow8
L_ret8:
    v_fma_f32 v192, v192, s29, -v249
    v_fma_f32 v193, v193, s29, -v249
    s_waitcnt lgkmcnt(4)
    v_mfma_f32_32x32x16_bf16 v[128:143], v[232:235], v[212:215], v[128:143]
    ds_read_b64_tr_b16 v[232:233], v244 offset:8192
    ds_read_b64_tr_b16 v[234:235], v244 offset:11264
    v_exp_f32 v192, v192
    v_exp_f32 v193, v193
    v_mfma_f32_32x32x16_bf16 v[144:159], v[236:239], v[212:215], v[144:159]
    ds_read_b64_tr_b16 v[236:237], v245 offset:8192
    ds_read_b64_tr_b16 v[238:239], v245 offset:11264
    v_fma_f32 v194, v194, s29, -v249
    v_fma_f32 v195, v195, s29, -v249
    v_exp_f32 v194, v194
    s_waitcnt lgkmcnt(4)
    v_mfma_f32_32x32x16_bf16 v[160:175], v[224:227], v[212:215], v[160:175]
    ds_read_b128 v[224:227], v240 offset:0
    v_exp_f32 v195, v195
    v_add_f32 v252, v252, v192
    v_mfma_f32_32x32x16_bf16 a[208:223], v[228:231], v[212:215], a[208:223]
    ds_read_b128 v[228:231], v241 offset:0
    v_add_f32 v252, v252, v193
    v_cvt_pk_bf16_f32 v192, v192, v193
    v_fma_f32 v196, v196, s29, -v249
    v_fma_f32 v197, v197, s29, -v249
    s_waitcnt lgkmcnt(2)
    v_mfma_f32_32x32x16_bf16 a[240:255], v[232:235], v[212:215], a[240:255]
    ds_read_b128 v[232:235], v242 offset:0
    v_exp_f32 v196, v196
    v_exp_f32 v197, v197
    v_mfma_f32_32x32x16_bf16 a[224:239], v[236:239], v[212:215], a[224:239]
    ds_read_b128 v[236:239], v243 offset:0
    v_add_f32 v252, v252, v194
    v_add_f32 v252, v252, v195
    v_cvt_pk_bf16_f32 v193, v194, v195
    s_waitcnt lgkmcnt(2)
    v_mfma_f32_32x32x16_bf16 v[208:223], v[224:227], a[96:99], 0
    ds_read_b128 v[224:227], v240 offset:1024
    v_fma_f32 v198, v198, s29, -v249
    v_fma_f32 v199, v199, s29, -v249
    v_exp_f32 v198, v198
    v_mfma_f32_32x32x16_bf16 v[208:223], v[228:231], a[100:103], v[208:223]
    ds_read_b128 v[228:231], v241 offset:1024
    v_exp_f32 v199, v199
    v_add_f32 v252, v252, v196
    v_add_f32 v252, v252, v197
    v_cvt_pk_bf16_f32 v194, v196, v197
    s_waitcnt lgkmcnt(2)
    v_mfma_f32_32x32x16_bf16 v[208:223], v[232:235], a[104:107], v[208:223]
    ds_read_b128 v[232:235], v242 offset:1024
    v_fma_f32 v200, v200, s29, -v249
    v_fma_f32 v201, v201, s29, -v249
    v_exp_f32 v200, v200
    v_mfma_f32_32x32x16_bf16 v[208:223], v[236:239], a[108:111], v[208:223]
    ds_read_b128 v[236:239], v243 offset:1024
    v_mbcnt_lo_u32_b32 v184, -1, 0
    s_add_u32 s32, s39, 0
    v_mbcnt_hi_u32_b32 v184, -1, v184
    v_lshlrev_b32 v184, 4, v184
    v_xor_b32 v184, s32, v184
    ds_read_b128 v[188:191], v184 offset:9216
    ds_read_b128 v[184:187], v184 offset:3072
    s_waitcnt lgkmcnt(4)
    v_mfma_f32_32x32x16_bf16 v[208:223], v[224:227], a[112:115], v[208:223]
    ds_read_b128 v[224:227], v240 offset:2048
    v_exp_f32 v201, v201
    v_add_f32 v252, v252, v198
    v_add_f32 v252, v252, v199
    v_cvt_pk_bf16_f32 v195, v198, v199
    v_mfma_f32_32x32x16_bf16 v[208:223], v[228:231], a[116:119], v[208:223]
    ds_read_b128 v[228:231], v241 offset:2048
    v_fma_f32 v202, v202, s29, -v249
    v_fma_f32 v203, v203, s29, -v249
    v_exp_f32 v202, v202
    s_waitcnt lgkmcnt(4)
    v_mfma_f32_32x32x16_bf16 v[208:223], v[232:235], a[120:123], v[208:223]
    ds_read_b128 v[232:235], v242 offset:2048
    s_add_u32 s32, s28, 15360
    s_waitcnt lgkmcnt(3)
    buffer_store_dwordx4 v[184:187], v246, s[20:23], s32 offen offset:0 nt
    v_mfma_f32_32x32x16_bf16 v[208:223], v[236:239], a[124:127], v[208:223]
    ds_read_b128 v[236:239], v243 offset:2048
    v_exp_f32 v203, v203
    s_add_u32 s32, s28, 21504
    buffer_store_dwordx4 v[188:191], v246, s[20:23], s32 offen offset:0 nt
    s_waitcnt lgkmcnt(2)
    v_mfma_f32_32x32x16_bf16 v[208:223], v[224:227], a[128:131], v[208:223]
    ds_read_b64_tr_b16 v[224:225], v244 offset:24576
    ds_read_b64_tr_b16 v[226:227], v244 offset:27648
    v_add_f32 v252, v252, v200
    v_add_f32 v252, v252, v201
    v_cvt_pk_bf16_f32 v196, v200, v201
    v_fma_f32 v204, v204, s29, -v249
    v_mfma_f32_32x32x16_bf16 v[208:223], v[228:231], a[132:135], v[208:223]
    ds_read_b64_tr_b16 v[228:229], v245 offset:24576
    ds_read_b64_tr_b16 v[230:231], v245 offset:27648
    v_fma_f32 v205, v205, s29, -v249
    v_exp_f32 v204, v204
    v_exp_f32 v205, v205
    s_waitcnt lgkmcnt(4)
    v_mfma_f32_32x32x16_bf16 v[208:223], v[232:235], a[136:139], v[208:223]
    ds_read_b64_tr_b16 v[232:233], v244 offset:25600
    ds_read_b64_tr_b16 v[234:235], v244 offset:28672
    v_add_f32 v252, v252, v202
    v_add_f32 v252, v252, v203
    v_cvt_pk_bf16_f32 v197, v202, v203
    v_fma_f32 v206, v206, s29, -v249
    v_mfma_f32_32x32x16_bf16 v[208:223], v[236:239], a[140:143], v[208:223]
    ds_read_b64_tr_b16 v[236:237], v245 offset:25600
    ds_read_b64_tr_b16 v[238:239], v245 offset:28672
    v_fma_f32 v207, v207, s29, -v249
    v_exp_f32 v206, v206
    v_exp_f32 v207, v207
    s_waitcnt lgkmcnt(4)
    v_mfma_f32_32x32x16_bf16 v[0:15], v[224:227], v[176:179], v[0:15]
    ds_read_b64_tr_b16 v[224:225], v244 offset:26624
    ds_read_b64_tr_b16 v[226:227], v244 offset:29696
    v_add_f32 v252, v252, v204
    v_add_f32 v252, v252, v205
    v_cvt_pk_bf16_f32 v198, v204, v205
    v_mfma_f32_32x32x16_bf16 v[16:31], v[228:231], v[176:179], v[16:31]
    ds_read_b64_tr_b16 v[228:229], v245 offset:26624
    ds_read_b64_tr_b16 v[230:231], v245 offset:29696
    v_add_f32 v252, v252, v206
    v_add_f32 v252, v252, v207
    v_cvt_pk_bf16_f32 v199, v206, v207
    s_waitcnt lgkmcnt(4)
    v_mfma_f32_32x32x16_bf16 v[32:47], v[232:235], v[176:179], v[32:47]
    ds_read_b64_tr_b16 v[232:233], v244 offset:30720
    ds_read_b64_tr_b16 v[234:235], v244 offset:33792
    v_max3_f32 v254, v208, v209, v210
    v_max3_f32 v254, v254, v211, v212
    v_max3_f32 v254, v254, v213, v214
    v_max3_f32 v254, v254, v215, v216
    v_mfma_f32_32x32x16_bf16 a[144:159], v[236:239], v[176:179], a[144:159]
    ds_read_b64_tr_b16 v[236:237], v245 offset:30720
    ds_read_b64_tr_b16 v[238:239], v245 offset:33792
    v_max3_f32 v254, v254, v217, v218
    v_max3_f32 v254, v254, v219, v220
    v_max3_f32 v254, v254, v221, v222
    s_waitcnt lgkmcnt(4)
    v_mfma_f32_32x32x16_bf16 v[48:63], v[224:227], v[176:179], v[48:63]
    ds_read_b64_tr_b16 v[224:225], v244 offset:31744
    ds_read_b64_tr_b16 v[226:227], v244 offset:34816
    v_max_f32 v254, v254, v223
    v_fma_f32 v255, v254, s29, -v250
    v_cmp_lt_f32 vcc, s31, v255
    s_cbranch_vccnz L_slow10
L_ret10:
    v_mfma_f32_32x32x16_bf16 a[160:175], v[228:231], v[176:179], a[160:175]
    ds_read_b64_tr_b16 v[228:229], v245 offset:31744
    ds_read_b64_tr_b16 v[230:231], v245 offset:34816
    v_fma_f32 v208, v208, s29, -v250
    v_fma_f32 v209, v209, s29, -v250
    v_exp_f32 v208, v208
    s_waitcnt lgkmcnt(4)
    v_mfma_f32_32x32x16_bf16 v[0:15], v[232:235], v[180:183], v[0:15]
    ds_read_b64_tr_b16 v[232:233], v244 offset:32768
    ds_read_b64_tr_b16 v[234:235], v244 offset:35840
    v_exp_f32 v209, v209
    v_fma_f32 v210, v210, s29, -v250
    v_fma_f32 v211, v211, s29, -v250
    v_mfma_f32_32x32x16_bf16 v[16:31], v[236:239], v[180:183], v[16:31]
    s_waitcnt vmcnt(7)
    s_barrier
    s_add_u32 m0, s30, 98304
    s_add_u32 s33, s26, 36864
    ds_read_b64_tr_b16 v[236:237], v245 offset:32768
    ds_read_b64_tr_b16 v[238:239], v245 offset:35840
    buffer_load_dwordx4 v246, s[12:15], s33 offen offset:0 nt lds
    s_waitcnt lgkmcnt(4)
    v_mfma_f32_32x32x16_bf16 v[32:47], v[224:227], v[180:183], v[32:47]
    ds_read_b128 v[224:227], v240 offset:24576
    v_exp_f32 v210, v210
    v_exp_f32 v211, v211
    v_mfma_f32_32x32x16_bf16 a[144:159], v[228:231], v[180:183], a[144:159]
    s_add_u32 m0, s30, 99200
    ds_read_b128 v[228:231], v241 offset:24576
    buffer_load_dwordx4 v246, s[12:15], s33 offen offset:128 nt lds
    s_waitcnt lgkmcnt(2)
    v_mfma_f32_32x32x16_bf16 v[48:63], v[232:235], v[180:183], v[48:63]
    ds_read_b128 v[232:235], v242 offset:24576
    v_add_f32 v253, v253, v208
    v_add_f32 v253, v253, v209
    v_cvt_pk_bf16_f32 v208, v208, v209
    v_fma_f32 v212, v212, s29, -v250
    v_mfma_f32_32x32x16_bf16 a[160:175], v[236:239], v[180:183], a[160:175]
    s_add_u32 m0, s30, 100096
    ds_read_b128 v[236:239], v243 offset:24576
    v_fma_f32 v213, v213, s29, -v250
    buffer_load_dwordx4 v246, s[12:15], s33 offen offset:256 nt lds
    s_waitcnt lgkmcnt(2)
    v_mfma_f32_32x32x16_bf16 v[176:191], v[224:227], a[0:3], 0
    ds_read_b128 v[224:227], v240 offset:25600
    v_exp_f32 v212, v212
    v_exp_f32 v213, v213
    v_mfma_f32_32x32x16_bf16 v[176:191], v[228:231], a[4:7], v[176:191]
    s_add_u32 m0, s30, 110592
    s_add_u32 s33, s26, 36864
    ds_read_b128 v[228:231], v241 offset:25600
    v_add_f32 v253, v253, v210
    v_add_f32 v253, v253, v211
    buffer_load_dwordx4 v247, s[16:19], s33 offen offset:0 nt lds
    s_waitcnt lgkmcnt(2)
    v_mfma_f32_32x32x16_bf16 v[176:191], v[232:235], a[8:11], v[176:191]
    ds_read_b128 v[232:235], v242 offset:25600
    v_cvt_pk_bf16_f32 v209, v210, v211
    v_fma_f32 v214, v214, s29, -v250
    v_fma_f32 v215, v215, s29, -v250
    v_exp_f32 v214, v214
    v_mfma_f32_32x32x16_bf16 v[176:191], v[236:239], a[12:15], v[176:191]
    s_add_u32 m0, s30, 111488
    ds_read_b128 v[236:239], v243 offset:25600
    v_exp_f32 v215, v215
    buffer_load_dwordx4 v247, s[16:19], s33 offen offset:128 nt lds
    s_waitcnt lgkmcnt(2)
    v_mfma_f32_32x32x16_bf16 v[176:191], v[224:227], a[16:19], v[176:191]
    ds_read_b128 v[224:227], v240 offset:26624
    v_add_f32 v253, v253, v212
    v_add_f32 v253, v253, v213
    v_cvt_pk_bf16_f32 v210, v212, v213
    v_fma_f32 v216, v216, s29, -v250
    v_mfma_f32_32x32x16_bf16 v[176:191], v[228:231], a[20:23], v[176:191]
    s_add_u32 m0, s30, 112384
    ds_read_b128 v[228:231], v241 offset:26624
    v_fma_f32 v217, v217, s29, -v250
    v_exp_f32 v216, v216
    buffer_load_dwordx4 v247, s[16:19], s33 offen offset:256 nt lds
    s_waitcnt lgkmcnt(2)
    v_mfma_f32_32x32x16_bf16 v[176:191], v[232:235], a[24:27], v[176:191]
    ds_read_b128 v[232:235], v242 offset:26624
    v_exp_f32 v217, v217
    v_add_f32 v253, v253, v214
    v_add_f32 v253, v253, v215
    v_mfma_f32_32x32x16_bf16 v[176:191], v[236:239], a[28:31], v[176:191]
    ds_read_b128 v[236:239], v243 offset:26624
    v_cvt_pk_bf16_f32 v211, v214, v215
    v_fma_f32 v218, v218, s29, -v250
    v_fma_f32 v219, v219, s29, -v250
    v_exp_f32 v218, v218
    s_waitcnt lgkmcnt(2)
    v_mfma_f32_32x32x16_bf16 v[176:191], v[224:227], a[32:35], v[176:191]
    ds_read_b64_tr_b16 v[224:225], v244 offset:24576
    ds_read_b64_tr_b16 v[226:227], v244 offset:27648
    v_exp_f32 v219, v219
    v_add_f32 v253, v253, v216
    v_add_f32 v253, v253, v217
    v_mfma_f32_32x32x16_bf16 v[176:191], v[228:231], a[36:39], v[176:191]
    ds_read_b64_tr_b16 v[228:229], v245 offset:24576
    ds_read_b64_tr_b16 v[230:231], v245 offset:27648
    v_cvt_pk_bf16_f32 v212, v216, v217
    v_fma_f32 v220, v220, s29, -v250
    v_fma_f32 v221, v221, s29, -v250
    v_exp_f32 v220, v220
    s_waitcnt lgkmcnt(4)
    v_mfma_f32_32x32x16_bf16 v[176:191], v[232:235], a[40:43], v[176:191]
    ds_read_b64_tr_b16 v[232:233], v244 offset:25600
    ds_read_b64_tr_b16 v[234:235], v244 offset:28672
    v_exp_f32 v221, v221
    v_add_f32 v253, v253, v218
    v_add_f32 v253, v253, v219
    v_cvt_pk_bf16_f32 v213, v218, v219
    v_mfma_f32_32x32x16_bf16 v[176:191], v[236:239], a[44:47], v[176:191]
    ds_read_b64_tr_b16 v[236:237], v245 offset:25600
    ds_read_b64_tr_b16 v[238:239], v245 offset:28672
    v_fma_f32 v222, v222, s29, -v250
    v_fma_f32 v223, v223, s29, -v250
    v_exp_f32 v222, v222
    s_waitcnt lgkmcnt(4)
    v_mfma_f32_32x32x16_bf16 v[64:79], v[224:227], v[192:195], v[64:79]
    ds_read_b64_tr_b16 v[224:225], v244 offset:26624
    ds_read_b64_tr_b16 v[226:227], v244 offset:29696
    v_exp_f32 v223, v223
    v_add_f32 v253, v253, v220
    v_add_f32 v253, v253, v221
    v_mfma_f32_32x32x16_bf16 v[80:95], v[228:231], v[192:195], v[80:95]
    ds_read_b64_tr_b16 v[228:229], v245 offset:26624
    ds_read_b64_tr_b16 v[230:231], v245 offset:29696
    v_cvt_pk_bf16_f32 v214, v220, v221
    v_add_f32 v253, v253, v222
    v_add_f32 v253, v253, v223
    v_cvt_pk_bf16_f32 v215, v222, v223
    s_waitcnt lgkmcnt(4)
    v_mfma_f32_32x32x16_bf16 v[96:111], v[232:235], v[192:195], v[96:111]
    ds_read_b64_tr_b16 v[232:233], v244 offset:30720
    ds_read_b64_tr_b16 v[234:235], v244 offset:33792
    v_max3_f32 v254, v176, v177, v178
    v_max3_f32 v254, v254, v179, v180
    v_max3_f32 v254, v254, v181, v182
    v_mfma_f32_32x32x16_bf16 a[176:191], v[236:239], v[192:195], a[176:191]
    ds_read_b64_tr_b16 v[236:237], v245 offset:30720
    ds_read_b64_tr_b16 v[238:239], v245 offset:33792
    v_mbcnt_lo_u32_b32 v216, -1, 0
    s_add_u32 s32, s38, 0
    v_mbcnt_hi_u32_b32 v216, -1, v216
    v_lshlrev_b32 v216, 4, v216
    v_xor_b32 v216, s32, v216
    ds_read_b128 v[220:223], v216 offset:7168
    ds_read_b128 v[216:219], v216 offset:1024
    s_waitcnt lgkmcnt(6)
    v_mfma_f32_32x32x16_bf16 v[112:127], v[224:227], v[192:195], v[112:127]
    ds_read_b64_tr_b16 v[224:225], v244 offset:31744
    ds_read_b64_tr_b16 v[226:227], v244 offset:34816
    v_max3_f32 v254, v254, v183, v184
    v_max3_f32 v254, v254, v185, v186
    v_max3_f32 v254, v254, v187, v188
    v_max3_f32 v254, v254, v189, v190
    v_mfma_f32_32x32x16_bf16 a[192:207], v[228:231], v[192:195], a[192:207]
    ds_read_b64_tr_b16 v[228:229], v245 offset:31744
    ds_read_b64_tr_b16 v[230:231], v245 offset:34816
    v_max_f32 v254, v254, v191
    v_fma_f32 v255, v254, s29, -v248
    v_cmp_lt_f32 vcc, s31, v255
    s_waitcnt lgkmcnt(6)
    v_mfma_f32_32x32x16_bf16 v[64:79], v[232:235], v[196:199], v[64:79]
    ds_read_b64_tr_b16 v[232:233], v244 offset:32768
    ds_read_b64_tr_b16 v[234:235], v244 offset:35840
    s_add_u32 s32, s28, 12288
    s_waitcnt lgkmcnt(6)
    buffer_store_dwordx4 v[216:219], v246, s[20:23], s32 offen offset:128 nt
    v_mfma_f32_32x32x16_bf16 v[80:95], v[236:239], v[196:199], v[80:95]
    ds_read_b64_tr_b16 v[236:237], v245 offset:32768
    ds_read_b64_tr_b16 v[238:239], v245 offset:35840
    s_add_u32 s32, s28, 18432
    buffer_store_dwordx4 v[220:223], v246, s[20:23], s32 offen offset:128 nt
    s_waitcnt lgkmcnt(4)
    v_mfma_f32_32x32x16_bf16 v[96:111], v[224:227], v[196:199], v[96:111]
    ds_read_b128 v[224:227], v240 offset:24576
    s_cbranch_vccnz L_slow12
L_ret12:
    v_fma_f32 v176, v176, s29, -v248
    v_fma_f32 v177, v177, s29, -v248
    v_mfma_f32_32x32x16_bf16 a[176:191], v[228:231], v[196:199], a[176:191]
    ds_read_b128 v[228:231], v241 offset:24576
    v_exp_f32 v176, v176
    v_exp_f32 v177, v177
    s_waitcnt lgkmcnt(2)
    v_mfma_f32_32x32x16_bf16 v[112:127], v[232:235], v[196:199], v[112:127]
    ds_read_b128 v[232:235], v242 offset:24576
    v_fma_f32 v178, v178, s29, -v248
    v_fma_f32 v179, v179, s29, -v248
    v_exp_f32 v178, v178
    v_mfma_f32_32x32x16_bf16 a[192:207], v[236:239], v[196:199], a[192:207]
    ds_read_b128 v[236:239], v243 offset:24576
    v_exp_f32 v179, v179
    v_add_f32 v251, v251, v176
    s_waitcnt lgkmcnt(2)
    v_mfma_f32_32x32x16_bf16 v[192:207], v[224:227], a[48:51], 0
    ds_read_b128 v[224:227], v240 offset:25600
    v_add_f32 v251, v251, v177
    v_cvt_pk_bf16_f32 v176, v176, v177
    v_fma_f32 v180, v180, s29, -v248
    v_fma_f32 v181, v181, s29, -v248
    v_mfma_f32_32x32x16_bf16 v[192:207], v[228:231], a[52:55], v[192:207]
    ds_read_b128 v[228:231], v241 offset:25600
    v_exp_f32 v180, v180
    v_exp_f32 v181, v181
    s_waitcnt lgkmcnt(2)
    v_mfma_f32_32x32x16_bf16 v[192:207], v[232:235], a[56:59], v[192:207]
    ds_read_b128 v[232:235], v242 offset:25600
    v_add_f32 v251, v251, v178
    v_add_f32 v251, v251, v179
    v_cvt_pk_bf16_f32 v177, v178, v179
    v_fma_f32 v182, v182, s29, -v248
    v_fma_f32 v183, v183, s29, -v248
    v_mfma_f32_32x32x16_bf16 v[192:207], v[236:239], a[60:63], v[192:207]
    ds_read_b128 v[236:239], v243 offset:25600
    v_exp_f32 v182, v182
    v_exp_f32 v183, v183
    s_waitcnt lgkmcnt(2)
    v_mfma_f32_32x32x16_bf16 v[192:207], v[224:227], a[64:67], v[192:207]
    ds_read_b128 v[224:227], v240 offset:26624
    v_add_f32 v251, v251, v180
    v_add_f32 v251, v251, v181
    v_cvt_pk_bf16_f32 v178, v180, v181
    v_fma_f32 v184, v184, s29, -v248
    v_fma_f32 v185, v185, s29, -v248
    v_mfma_f32_32x32x16_bf16 v[192:207], v[228:231], a[68:71], v[192:207]
    ds_read_b128 v[228:231], v241 offset:26624
    v_exp_f32 v184, v184
    v_exp_f32 v185, v185
    s_waitcnt lgkmcnt(2)
    v_mfma_f32_32x32x16_bf16 v[192:207], v[232:235], a[72:75], v[192:207]
    ds_read_b128 v[232:235], v242 offset:26624
    v_add_f32 v251, v251, v182
    v_add_f32 v251, v251, v183
    v_cvt_pk_bf16_f32 v179, v182, v183
    v_fma_f32 v186, v186, s29, -v248
    v_mfma_f32_32x32x16_bf16 v[192:207], v[236:239], a[76:79], v[192:207]
    ds_read_b128 v[236:239], v243 offset:26624
    v_fma_f32 v187, v187, s29, -v248
    v_exp_f32 v186, v186
    v_exp_f32 v187, v187
    s_waitcnt lgkmcnt(2)
    v_mfma_f32_32x32x16_bf16 v[192:207], v[224:227], a[80:83], v[192:207]
    ds_read_b64_tr_b16 v[224:225], v244 offset:24576
    ds_read_b64_tr_b16 v[226:227], v244 offset:27648
    v_add_f32 v251, v251, v184
    v_add_f32 v251, v251, v185
    v_cvt_pk_bf16_f32 v180, v184, v185
    v_fma_f32 v188, v188, s29, -v248
    v_mfma_f32_32x32x16_bf16 v[192:207], v[228:231], a[84:87], v[192:207]
    ds_read_b64_tr_b16 v[228:229], v245 offset:24576
    ds_read_b64_tr_b16 v[230:231], v245 offset:27648
    v_fma_f32 v189, v189, s29, -v248
    v_exp_f32 v188, v188
    v_exp_f32 v189, v189
    s_waitcnt lgkmcnt(4)
    v_mfma_f32_32x32x16_bf16 v[192:207], v[232:235], a[88:91], v[192:207]
    ds_read_b64_tr_b16 v[232:233], v244 offset:25600
    ds_read_b64_tr_b16 v[234:235], v244 offset:28672
    v_add_f32 v251, v251, v186
    v_add_f32 v251, v251, v187
    v_cvt_pk_bf16_f32 v181, v186, v187
    v_fma_f32 v190, v190, s29, -v248
    v_mfma_f32_32x32x16_bf16 v[192:207], v[236:239], a[92:95], v[192:207]
    ds_read_b64_tr_b16 v[236:237], v245 offset:25600
    ds_read_b64_tr_b16 v[238:239], v245 offset:28672
    v_fma_f32 v191, v191, s29, -v248
    v_exp_f32 v190, v190
    v_exp_f32 v191, v191
    s_waitcnt lgkmcnt(4)
    v_mfma_f32_32x32x16_bf16 v[128:143], v[224:227], v[208:211], v[128:143]
    ds_read_b64_tr_b16 v[224:225], v244 offset:26624
    ds_read_b64_tr_b16 v[226:227], v244 offset:29696
    v_add_f32 v251, v251, v188
    v_add_f32 v251, v251, v189
    v_cvt_pk_bf16_f32 v182, v188, v189
    v_mfma_f32_32x32x16_bf16 v[144:159], v[228:231], v[208:211], v[144:159]
    ds_read_b64_tr_b16 v[228:229], v245 offset:26624
    ds_read_b64_tr_b16 v[230:231], v245 offset:29696
    v_add_f32 v251, v251, v190
    v_add_f32 v251, v251, v191
    v_cvt_pk_bf16_f32 v183, v190, v191
    s_waitcnt lgkmcnt(4)
    v_mfma_f32_32x32x16_bf16 v[160:175], v[232:235], v[208:211], v[160:175]
    ds_read_b64_tr_b16 v[232:233], v244 offset:30720
    ds_read_b64_tr_b16 v[234:235], v244 offset:33792
    v_max3_f32 v254, v192, v193, v194
    v_max3_f32 v254, v254, v195, v196
    v_max3_f32 v254, v254, v197, v198
    v_mfma_f32_32x32x16_bf16 a[208:223], v[236:239], v[208:211], a[208:223]
    ds_read_b64_tr_b16 v[236:237], v245 offset:30720
    ds_read_b64_tr_b16 v[238:239], v245 offset:33792
    v_mbcnt_lo_u32_b32 v184, -1, 0
    s_add_u32 s32, s39, 0
    v_mbcnt_hi_u32_b32 v184, -1, v184
    v_lshlrev_b32 v184, 4, v184
    v_xor_b32 v184, s32, v184
    ds_read_b128 v[188:191], v184 offset:10240
    ds_read_b128 v[184:187], v184 offset:4096
    s_waitcnt lgkmcnt(6)
    v_mfma_f32_32x32x16_bf16 a[240:255], v[224:227], v[208:211], a[240:255]
    ds_read_b64_tr_b16 v[224:225], v244 offset:31744
    ds_read_b64_tr_b16 v[226:227], v244 offset:34816
    v_max3_f32 v254, v254, v199, v200
    v_max3_f32 v254, v254, v201, v202
    v_max3_f32 v254, v254, v203, v204
    v_max3_f32 v254, v254, v205, v206
    v_mfma_f32_32x32x16_bf16 a[224:239], v[228:231], v[208:211], a[224:239]
    ds_read_b64_tr_b16 v[228:229], v245 offset:31744
    ds_read_b64_tr_b16 v[230:231], v245 offset:34816
    v_max_f32 v254, v254, v207
    v_fma_f32 v255, v254, s29, -v249
    v_cmp_lt_f32 vcc, s31, v255
    s_waitcnt lgkmcnt(6)
    v_mfma_f32_32x32x16_bf16 v[128:143], v[232:235], v[212:215], v[128:143]
    ds_read_b64_tr_b16 v[232:233], v244 offset:32768
    ds_read_b64_tr_b16 v[234:235], v244 offset:35840
    s_add_u32 s32, s28, 15360
    s_waitcnt lgkmcnt(6)
    buffer_store_dwordx4 v[184:187], v246, s[20:23], s32 offen offset:128 nt
    v_mfma_f32_32x32x16_bf16 v[144:159], v[236:239], v[212:215], v[144:159]
    ds_read_b64_tr_b16 v[236:237], v245 offset:32768
    ds_read_b64_tr_b16 v[238:239], v245 offset:35840
    s_add_u32 s32, s28, 21504
    buffer_store_dwordx4 v[188:191], v246, s[20:23], s32 offen offset:128 nt
    s_waitcnt lgkmcnt(4)
    v_mfma_f32_32x32x16_bf16 v[160:175], v[224:227], v[212:215], v[160:175]
    ds_read_b128 v[224:227], v240 offset:24576
    s_cbranch_vccnz L_slow14
L_ret14:
    v_fma_f32 v192, v192, s29, -v249
    v_fma_f32 v193, v193, s29, -v249
    v_mfma_f32_32x32x16_bf16 a[208:223], v[228:231], v[212:215], a[208:223]
    ds_read_b128 v[228:231], v241 offset:24576
    v_exp_f32 v192, v192
    v_exp_f32 v193, v193
    s_waitcnt lgkmcnt(2)
    v_mfma_f32_32x32x16_bf16 a[240:255], v[232:235], v[212:215], a[240:255]
    ds_read_b128 v[232:235], v242 offset:24576
    v_fma_f32 v194, v194, s29, -v249
    v_fma_f32 v195, v195, s29, -v249
    v_exp_f32 v194, v194
    v_mfma_f32_32x32x16_bf16 a[224:239], v[236:239], v[212:215], a[224:239]
    ds_read_b128 v[236:239], v243 offset:24576
    v_exp_f32 v195, v195
    v_add_f32 v252, v252, v192
    s_waitcnt lgkmcnt(2)
    v_mfma_f32_32x32x16_bf16 v[208:223], v[224:227], a[96:99], 0
    ds_read_b128 v[224:227], v240 offset:25600
    v_add_f32 v252, v252, v193
    v_cvt_pk_bf16_f32 v192, v192, v193
    v_fma_f32 v196, v196, s29, -v249
    v_fma_f32 v197, v197, s29, -v249
    v_mfma_f32_32x32x16_bf16 v[208:223], v[228:231], a[100:103], v[208:223]
    ds_read_b128 v[228:231], v241 offset:25600
    v_exp_f32 v196, v196
    v_exp_f32 v197, v197
    s_waitcnt lgkmcnt(2)
    v_mfma_f32_32x32x16_bf16 v[208:223], v[232:235], a[104:107], v[208:223]
    ds_read_b128 v[232:235], v242 offset:25600
    v_add_f32 v252, v252, v194
    v_add_f32 v252, v252, v195
    v_cvt_pk_bf16_f32 v193, v194, v195
    v_fma_f32 v198, v198, s29, -v249
    v_fma_f32 v199, v199, s29, -v249
    v_mfma_f32_32x32x16_bf16 v[208:223], v[236:239], a[108:111], v[208:223]
    ds_read_b128 v[236:239], v243 offset:25600
    v_exp_f32 v198, v198
    v_exp_f32 v199, v199
    s_waitcnt lgkmcnt(2)
    v_mfma_f32_32x32x16_bf16 v[208:223], v[224:227], a[112:115], v[208:223]
    ds_read_b128 v[224:227], v240 offset:26624
    v_add_f32 v252, v252, v196
    v_add_f32 v252, v252, v197
    v_cvt_pk_bf16_f32 v194, v196, v197
    v_fma_f32 v200, v200, s29, -v249
    v_fma_f32 v201, v201, s29, -v249
    v_mfma_f32_32x32x16_bf16 v[208:223], v[228:231], a[116:119], v[208:223]
    ds_read_b128 v[228:231], v241 offset:26624
    v_exp_f32 v200, v200
    v_exp_f32 v201, v201
    s_waitcnt lgkmcnt(2)
    v_mfma_f32_32x32x16_bf16 v[208:223], v[232:235], a[120:123], v[208:223]
    ds_read_b128 v[232:235], v242 offset:26624
    v_add_f32 v252, v252, v198
    v_add_f32 v252, v252, v199
    v_cvt_pk_bf16_f32 v195, v198, v199
    v_fma_f32 v202, v202, s29, -v249
    v_mfma_f32_32x32x16_bf16 v[208:223], v[236:239], a[124:127], v[208:223]
    ds_read_b128 v[236:239], v243 offset:26624
    v_fma_f32 v203, v203, s29, -v249
    v_exp_f32 v202, v202
    v_exp_f32 v203, v203
    s_waitcnt lgkmcnt(2)
    v_mfma_f32_32x32x16_bf16 v[208:223], v[224:227], a[128:131], v[208:223]
    ds_read_b64_tr_b16 v[224:225], v244 offset:49152
    ds_read_b64_tr_b16 v[226:227], v244 offset:52224
    v_add_f32 v252, v252, v200
    v_add_f32 v252, v252, v201
    v_cvt_pk_bf16_f32 v196, v200, v201
    v_fma_f32 v204, v204, s29, -v249
    v_mfma_f32_32x32x16_bf16 v[208:223], v[228:231], a[132:135], v[208:223]
    ds_read_b64_tr_b16 v[228:229], v245 offset:49152
    ds_read_b64_tr_b16 v[230:231], v245 offset:52224
    v_fma_f32 v205, v205, s29, -v249
    v_exp_f32 v204, v204
    v_exp_f32 v205, v205
    s_waitcnt lgkmcnt(4)
    v_mfma_f32_32x32x16_bf16 v[208:223], v[232:235], a[136:139], v[208:223]
    ds_read_b64_tr_b16 v[232:233], v244 offset:50176
    ds_read_b64_tr_b16 v[234:235], v244 offset:53248
    v_add_f32 v252, v252, v202
    v_add_f32 v252, v252, v203
    v_cvt_pk_bf16_f32 v197, v202, v203
    v_fma_f32 v206, v206, s29, -v249
    v_mfma_f32_32x32x16_bf16 v[208:223], v[236:239], a[140:143], v[208:223]
    ds_read_b64_tr_b16 v[236:237], v245 offset:50176
    ds_read_b64_tr_b16 v[238:239], v245 offset:53248
    v_fma_f32 v207, v207, s29, -v249
    v_exp_f32 v206, v206
    v_exp_f32 v207, v207
    s_waitcnt lgkmcnt(4)
    v_mfma_f32_32x32x16_bf16 v[0:15], v[224:227], v[176:179], v[0:15]
    ds_read_b64_tr_b16 v[224:225], v244 offset:51200
    ds_read_b64_tr_b16 v[226:227], v244 offset:54272
    v_add_f32 v252, v252, v204
    v_add_f32 v252, v252, v205
    v_cvt_pk_bf16_f32 v198, v204, v205
    v_mfma_f32_32x32x16_bf16 v[16:31], v[228:231], v[176:179], v[16:31]
    ds_read_b64_tr_b16 v[228:229], v245 offset:51200
    ds_read_b64_tr_b16 v[230:231], v245 offset:54272
    v_add_f32 v252, v252, v206
    v_add_f32 v252, v252, v207
    v_cvt_pk_bf16_f32 v199, v206, v207
    s_waitcnt lgkmcnt(4)
    v_mfma_f32_32x32x16_bf16 v[32:47], v[232:235], v[176:179], v[32:47]
    ds_read_b64_tr_b16 v[232:233], v244 offset:55296
    ds_read_b64_tr_b16 v[234:235], v244 offset:58368
    v_max3_f32 v254, v208, v209, v210
    v_max3_f32 v254, v254, v211, v212
    v_max3_f32 v254, v254, v213, v214
    v_max3_f32 v254, v254, v215, v216
    v_mfma_f32_32x32x16_bf16 a[144:159], v[236:239], v[176:179], a[144:159]
    ds_read_b64_tr_b16 v[236:237], v245 offset:55296
    ds_read_b64_tr_b16 v[238:239], v245 offset:58368
    v_max3_f32 v254, v254, v217, v218
    v_max3_f32 v254, v254, v219, v220
    v_max3_f32 v254, v254, v221, v222
    v_max_f32 v254, v254, v223
    s_waitcnt lgkmcnt(4)
    v_mfma_f32_32x32x16_bf16 v[48:63], v[224:227], v[176:179], v[48:63]
    ds_read_b64_tr_b16 v[224:225], v244 offset:56320
    ds_read_b64_tr_b16 v[226:227], v244 offset:59392
    v_fma_f32 v255, v254, s29, -v250
    v_cmp_lt_f32 vcc, s31, v255
    s_cbranch_vccnz L_slow16
L_ret16:
    v_fma_f32 v208, v208, s29, -v250
    v_fma_f32 v209, v209, s29, -v250
    v_mfma_f32_32x32x16_bf16 a[160:175], v[228:231], v[176:179], a[160:175]
    ds_read_b64_tr_b16 v[228:229], v245 offset:56320
    ds_read_b64_tr_b16 v[230:231], v245 offset:59392
    v_exp_f32 v208, v208
    v_exp_f32 v209, v209
    s_waitcnt lgkmcnt(4)
    v_mfma_f32_32x32x16_bf16 v[0:15], v[232:235], v[180:183], v[0:15]
    ds_read_b64_tr_b16 v[232:233], v244 offset:57344
    ds_read_b64_tr_b16 v[234:235], v244 offset:60416
    v_fma_f32 v210, v210, s29, -v250
    v_fma_f32 v211, v211, s29, -v250
    v_exp_f32 v210, v210
    v_mfma_f32_32x32x16_bf16 v[16:31], v[236:239], v[180:183], v[16:31]
    s_waitcnt vmcnt(4)
    s_barrier
    s_add_u32 m0, s30, 122880
    s_add_u32 s33, s26, 49152
    ds_read_b64_tr_b16 v[236:237], v245 offset:57344
    ds_read_b64_tr_b16 v[238:239], v245 offset:60416
    buffer_load_dwordx4 v246, s[12:15], s33 offen offset:0 nt lds
    s_waitcnt lgkmcnt(4)
    v_mfma_f32_32x32x16_bf16 v[32:47], v[224:227], v[180:183], v[32:47]
    v_add_u32 v240, 0xffffd000, v240
    v_add_u32 v241, 0xffffd000, v241
    v_add_u32 v242, 0xffffd000, v242
    v_add_u32 v243, 0xffffd000, v243
    ds_read_b128 v[224:227], v240 offset:0
    v_exp_f32 v211, v211
    v_add_f32 v253, v253, v208
    v_add_f32 v253, v253, v209
    v_mfma_f32_32x32x16_bf16 a[144:159], v[228:231], v[180:183], a[144:159]
    s_add_u32 m0, s30, 123776
    ds_read_b128 v[228:231], v241 offset:0
    v_cvt_pk_bf16_f32 v208, v208, v209
    buffer_load_dwordx4 v246, s[12:15], s33 offen offset:128 nt lds
    s_waitcnt lgkmcnt(2)
    v_mfma_f32_32x32x16_bf16 v[48:63], v[232:235], v[180:183], v[48:63]
    ds_read_b128 v[232:235], v242 offset:0
    v_fma_f32 v212, v212, s29, -v250
    v_fma_f32 v213, v213, s29, -v250
    v_exp_f32 v212, v212
    v_mfma_f32_32x32x16_bf16 a[160:175], v[236:239], v[180:183], a[160:175]
    s_add_u32 m0, s30, 124672
    ds_read_b128 v[236:239], v243 offset:0
    v_exp_f32 v213, v213
    buffer_load_dwordx4 v246, s[12:15], s33 offen offset:256 nt lds
    s_waitcnt lgkmcnt(2)
    v_mfma_f32_32x32x16_bf16 v[176:191], v[224:227], a[0:3], 0
    ds_read_b128 v[224:227], v240 offset:1024
    v_add_f32 v253, v253, v210
    v_add_f32 v253, v253, v211
    v_cvt_pk_bf16_f32 v209, v210, v211
    v_fma_f32 v214, v214, s29, -v250
    v_fma_f32 v215, v215, s29, -v250
    v_mfma_f32_32x32x16_bf16 v[176:191], v[228:231], a[4:7], v[176:191]
    s_add_u32 m0, s30, 135168
    s_add_u32 s33, s26, 49152
    ds_read_b128 v[228:231], v241 offset:1024
    v_exp_f32 v214, v214
    buffer_load_dwordx4 v247, s[16:19], s33 offen offset:0 nt lds
    s_waitcnt lgkmcnt(2)
    v_mfma_f32_32x32x16_bf16 v[176:191], v[232:235], a[8:11], v[176:191]
    ds_read_b128 v[232:235], v242 offset:1024
    v_exp_f32 v215, v215
    v_add_f32 v253, v253, v212
    v_add_f32 v253, v253, v213
    v_cvt_pk_bf16_f32 v210, v212, v213
    v_mfma_f32_32x32x16_bf16 v[176:191], v[236:239], a[12:15], v[176:191]
    s_add_u32 m0, s30, 136064
    ds_read_b128 v[236:239], v243 offset:1024
    v_mbcnt_lo_u32_b32 v200, -1, 0
    s_add_u32 s32, s38, 0
    v_mbcnt_hi_u32_b32 v200, -1, v200
    v_lshlrev_b32 v200, 4, v200
    v_xor_b32 v200, s32, v200
    ds_read_b128 v[204:207], v200 offset:8192
    ds_read_b128 v[200:203], v200 offset:2048
    buffer_load_dwordx4 v247, s[16:19], s33 offen offset:128 nt lds
    s_waitcnt lgkmcnt(4)
    v_mfma_f32_32x32x16_bf16 v[176:191], v[224:227], a[16:19], v[176:191]
    ds_read_b128 v[224:227], v240 offset:2048
    v_fma_f32 v216, v216, s29, -v250
    v_fma_f32 v217, v217, s29, -v250
    v_exp_f32 v216, v216
    v_exp_f32 v217, v217
    v_mfma_f32_32x32x16_bf16 v[176:191], v[228:231], a[20:23], v[176:191]
    s_add_u32 m0, s30, 136960
    ds_read_b128 v[228:231], v241 offset:2048
    v_add_f32 v253, v253, v214
    v_add_f32 v253, v253, v215
    buffer_load_dwordx4 v247, s[16:19], s33 offen offset:256 nt lds
    s_waitcnt lgkmcnt(4)
    v_mfma_f32_32x32x16_bf16 v[176:191], v[232:235], a[24:27], v[176:191]
    ds_read_b128 v[232:235], v242 offset:2048
    v_cvt_pk_bf16_f32 v211, v214, v215
    s_add_u32 s32, s28, 12288
    s_waitcnt lgkmcnt(3)
    buffer_store_dwordx4 v[200:203], v246, s[20:23], s32 offen offset:256 nt
    v_mfma_f32_32x32x16_bf16 v[176:191], v[236:239], a[28:31], v[176:191]
    ds_read_b128 v[236:239], v243 offset:2048
    v_fma_f32 v218, v218, s29, -v250
    s_add_u32 s32, s28, 18432
    buffer_store_dwordx4 v[204:207], v246, s[20:23], s32 offen offset:256 nt
    s_waitcnt lgkmcnt(2)
    v_mfma_f32_32x32x16_bf16 v[176:191], v[224:227], a[32:35], v[176:191]
    ds_read_b64_tr_b16 v[224:225], v244 offset:49152
    ds_read_b64_tr_b16 v[226:227], v244 offset:52224
    v_fma_f32 v219, v219, s29, -v250
    v_exp_f32 v218, v218
    v_exp_f32 v219, v219
    v_mfma_f32_32x32x16_bf16 v[176:191], v[228:231], a[36:39], v[176:191]
    ds_read_b64_tr_b16 v[228:229], v245 offset:49152
    ds_read_b64_tr_b16 v[230:231], v245 offset:52224
    v_add_f32 v253, v253, v216
    v_add_f32 v253, v253, v217
    v_cvt_pk_bf16_f32 v212, v216, v217
    v_fma_f32 v220, v220, s29, -v250
    v_fma_f32 v221, v221, s29, -v250
    s_waitcnt lgkmcnt(4)
    v_mfma_f32_32x32x16_bf16 v[176:191], v[232:235], a[40:43], v[176:191]
    ds_read_b64_tr_b16 v[232:233], v244 offset:50176
    ds_read_b64_tr_b16 v[234:235], v244 offset:53248
    v_exp_f32 v220, v220
    v_exp_f32 v221, v221
    v_add_f32 v253, v253, v218
    v_mfma_f32_32x32x16_bf16 v[176:191], v[236:239], a[44:47], v[176:191]
    ds_read_b64_tr_b16 v[236:237], v245 offset:50176
    ds_read_b64_tr_b16 v[238:239], v245 offset:53248
    v_add_f32 v253, v253, v219
    v_cvt_pk_bf16_f32 v213, v218, v219
    v_fma_f32 v222, v222, s29, -v250
    v_fma_f32 v223, v223, s29, -v250
    v_exp_f32 v222, v222
    s_waitcnt lgkmcnt(4)
    v_mfma_f32_32x32x16_bf16 v[64:79], v[224:227], v[192:195], v[64:79]
    ds_read_b64_tr_b16 v[224:225], v244 offset:51200
    ds_read_b64_tr_b16 v[226:227], v244 offset:54272
    v_exp_f32 v223, v223
    v_add_f32 v253, v253, v220
    v_add_f32 v253, v253, v221
    v_mfma_f32_32x32x16_bf16 v[80:95], v[228:231], v[192:195], v[80:95]
    ds_read_b64_tr_b16 v[228:229], v245 offset:51200
    ds_read_b64_tr_b16 v[230:231], v245 offset:54272
    v_cvt_pk_bf16_f32 v214, v220, v221
    v_add_f32 v253, v253, v222
    v_add_f32 v253, v253, v223
    v_cvt_pk_bf16_f32 v215, v222, v223
    s_waitcnt lgkmcnt(4)
    v_mfma_f32_32x32x16_bf16 v[96:111], v[232:235], v[192:195], v[96:111]
    ds_read_b64_tr_b16 v[232:233], v244 offset:55296
    ds_read_b64_tr_b16 v[234:235], v244 offset:58368
    v_max3_f32 v254, v176, v177, v178
    v_max3_f32 v254, v254, v179, v180
    v_max3_f32 v254, v254, v181, v182
    v_mfma_f32_32x32x16_bf16 a[176:191], v[236:239], v[192:195], a[176:191]
    ds_read_b64_tr_b16 v[236:237], v245 offset:55296
    ds_read_b64_tr_b16 v[238:239], v245 offset:58368
    v_max3_f32 v254, v254, v183, v184
    v_max3_f32 v254, v254, v185, v186
    v_max3_f32 v254, v254, v187, v188
    v_max3_f32 v254, v254, v189, v190
    s_waitcnt lgkmcnt(4)
    v_mfma_f32_32x32x16_bf16 v[112:127], v[224:227], v[192:195], v[112:127]
    ds_read_b64_tr_b16 v[224:225], v244 offset:56320
    ds_read_b64_tr_b16 v[226:227], v244 offset:59392
    v_max_f32 v254, v254, v191
    v_fma_f32 v255, v254, s29, -v248
    v_cmp_lt_f32 vcc, s31, v255
    v_mfma_f32_32x32x16_bf16 a[192:207], v[228:231], v[192:195], a[192:207]
    ds_read_b64_tr_b16 v[228:229], v245 offset:56320
    ds_read_b64_tr_b16 v[230:231], v245 offset:59392
    s_cbranch_vccnz L_slow18
L_ret18:
    v_fma_f32 v176, v176, s29, -v248
    v_fma_f32 v177, v177, s29, -v248
    s_waitcnt lgkmcnt(4)
    v_mfma_f32_32x32x16_bf16 v[64:79], v[232:235], v[196:199], v[64:79]
    ds_read_b64_tr_b16 v[232:233], v244 offset:57344
    ds_read_b64_tr_b16 v[234:235], v244 offset:60416
    v_exp_f32 v176, v176
    v_exp_f32 v177, v177
    v_mfma_f32_32x32x16_bf16 v[80:95], v[236:239], v[196:199], v[80:95]
    ds_read_b64_tr_b16 v[236:237], v245 offset:57344
    ds_read_b64_tr_b16 v[238:239], v245 offset:60416
    v_fma_f32 v178, v178, s29, -v248
    v_fma_f32 v179, v179, s29, -v248
    v_exp_f32 v178, v178
    s_waitcnt lgkmcnt(4)
    v_mfma_f32_32x32x16_bf16 v[96:111], v[224:227], v[196:199], v[96:111]
    ds_read_b128 v[224:227], v240 offset:0
    v_exp_f32 v179, v179
    v_add_f32 v251, v251, v176
    v_mfma_f32_32x32x16_bf16 a[176:191], v[228:231], v[196:199], a[176:191]
    ds_read_b128 v[228:231], v241 offset:0
    v_add_f32 v251, v251, v177
    v_cvt_pk_bf16_f32 v176, v176, v177
    v_fma_f32 v180, v180, s29, -v248
    v_fma_f32 v181, v181, s29, -v248
    s_waitcnt lgkmcnt(2)
    v_mfma_f32_32x32x16_bf16 v[112:127], v[232:235], v[196:199], v[112:127]
    ds_read_b128 v[232:235], v242 offset:0
    v_exp_f32 v180, v180
    v_exp_f32 v181, v181
    v_mfma_f32_32x32x16_bf16 a[192:207], v[236:239], v[196:199], a[192:207]
    ds_read_b128 v[236:239], v243 offset:0
    v_add_f32 v251, v251, v178
    v_add_f32 v251, v251, v179
    v_cvt_pk_bf16_f32 v177, v178, v179
    s_waitcnt lgkmcnt(2)
    v_mfma_f32_32x32x16_bf16 v[192:207], v[224:227], a[48:51], 0
    ds_read_b128 v[224:227], v240 offset:1024
    v_fma_f32 v182, v182, s29, -v248
    v_fma_f32 v183, v183, s29, -v248
    v_exp_f32 v182, v182
    v_mfma_f32_32x32x16_bf16 v[192:207], v[228:231], a[52:55], v[192:207]
    ds_read_b128 v[228:231], v241 offset:1024
    v_exp_f32 v183, v183
    v_add_f32 v251, v251, v180
    v_add_f32 v251, v251, v181
    v_cvt_pk_bf16_f32 v178, v180, v181
    s_waitcnt lgkmcnt(2)
    v_mfma_f32_32x32x16_bf16 v[192:207], v[232:235], a[56:59], v[192:207]
    ds_read_b128 v[232:235], v242 offset:1024
    v_fma_f32 v184, v184, s29, -v248
    v_fma_f32 v185, v185, s29, -v248
    v_exp_f32 v184, v184
    v_mfma_f32_32x32x16_bf16 v[192:207], v[236:239], a[60:63], v[192:207]
    ds_read_b128 v[236:239], v243 offset:1024
    v_mbcnt_lo_u32_b32 v216, -1, 0
    s_add_u32 s32, s39, 0
    v_mbcnt_hi_u32_b32 v216, -1, v216
    v_lshlrev_b32 v216, 4, v216
    v_xor_b32 v216, s32, v216
    ds_read_b128 v[220:223], v216 offset:11264
    ds_read_b128 v[216:219], v216 offset:5120
    s_waitcnt lgkmcnt(4)
    v_mfma_f32_32x32x16_bf16 v[192:207], v[224:227], a[64:67], v[192:207]
    ds_read_b128 v[224:227], v240 offset:2048
    v_exp_f32 v185, v185
    v_add_f32 v251, v251, v182
    v_add_f32 v251, v251, v183
    v_cvt_pk_bf16_f32 v179, v182, v183
    v_mfma_f32_32x32x16_bf16 v[192:207], v[228:231], a[68:71], v[192:207]
    ds_read_b128 v[228:231], v241 offset:2048
    v_fma_f32 v186, v186, s29, -v248
    v_fma_f32 v187, v187, s29, -v248
    v_exp_f32 v186, v186
    s_waitcnt lgkmcnt(4)
    v_mfma_f32_32x32x16_bf16 v[192:207], v[232:235], a[72:75], v[192:207]
    ds_read_b128 v[232:235], v242 offset:2048
    s_add_u32 s32, s28, 15360
    s_waitcnt lgkmcnt(3)
    buffer_store_dwordx4 v[216:219], v246, s[20:23], s32 offen offset:256 nt
    v_mfma_f32_32x32x16_bf16 v[192:207], v[236:239], a[76:79], v[192:207]
    ds_read_b128 v[236:239], v243 offset:2048
    v_exp_f32 v187, v187
    s_add_u32 s32, s28, 21504
    buffer_store_dwordx4 v[220:223], v246, s[20:23], s32 offen offset:256 nt
    s_waitcnt lgkmcnt(2)
    v_mfma_f32_32x32x16_bf16 v[192:207], v[224:227], a[80:83], v[192:207]
    ds_read_b64_tr_b16 v[224:225], v244 offset:49152
    ds_read_b64_tr_b16 v[226:227], v244 offset:52224
    v_add_f32 v251, v251, v184
    v_add_f32 v251, v251, v185
    v_cvt_pk_bf16_f32 v180, v184, v185
    v_fma_f32 v188, v188, s29, -v248
    v_mfma_f32_32x32x16_bf16 v[192:207], v[228:231], a[84:87], v[192:207]
    ds_read_b64_tr_b16 v[228:229], v245 offset:49152
    ds_read_b64_tr_b16 v[230:231], v245 offset:52224
    v_fma_f32 v189, v189, s29, -v248
    v_exp_f32 v188, v188
    v_exp_f32 v189, v189
    s_waitcnt lgkmcnt(4)
    v_mfma_f32_32x32x16_bf16 v[192:207], v[232:235], a[88:91], v[192:207]
    ds_read_b64_tr_b16 v[232:233], v244 offset:50176
    ds_read_b64_tr_b16 v[234:235], v244 offset:53248
    v_add_f32 v251, v251, v186
    v_add_f32 v251, v251, v187
    v_cvt_pk_bf16_f32 v181, v186, v187
    v_fma_f32 v190, v190, s29, -v248
    v_mfma_f32_32x32x16_bf16 v[192:207], v[236:239], a[92:95], v[192:207]
    ds_read_b64_tr_b16 v[236:237], v245 offset:50176
    ds_read_b64_tr_b16 v[238:239], v245 offset:53248
    v_fma_f32 v191, v191, s29, -v248
    v_exp_f32 v190, v190
    v_exp_f32 v191, v191
    s_waitcnt lgkmcnt(4)
    v_mfma_f32_32x32x16_bf16 v[128:143], v[224:227], v[208:211], v[128:143]
    ds_read_b64_tr_b16 v[224:225], v244 offset:51200
    ds_read_b64_tr_b16 v[226:227], v244 offset:54272
    v_add_f32 v251, v251, v188
    v_add_f32 v251, v251, v189
    v_cvt_pk_bf16_f32 v182, v188, v189
    v_mfma_f32_32x32x16_bf16 v[144:159], v[228:231], v[208:211], v[144:159]
    ds_read_b64_tr_b16 v[228:229], v245 offset:51200
    ds_read_b64_tr_b16 v[230:231], v245 offset:54272
    v_add_f32 v251, v251, v190
    v_add_f32 v251, v251, v191
    v_cvt_pk_bf16_f32 v183, v190, v191
    s_waitcnt lgkmcnt(4)
    v_mfma_f32_32x32x16_bf16 v[160:175], v[232:235], v[208:211], v[160:175]
    ds_read_b64_tr_b16 v[232:233], v244 offset:55296
    ds_read_b64_tr_b16 v[234:235], v244 offset:58368
    v_max3_f32 v254, v192, v193, v194
    v_max3_f32 v254, v254, v195, v196
    v_max3_f32 v254, v254, v197, v198
    v_mfma_f32_32x32x16_bf16 a[208:223], v[236:239], v[208:211], a[208:223]
    ds_read_b64_tr_b16 v[236:237], v245 offset:55296
    ds_read_b64_tr_b16 v[238:239], v245 offset:58368
    v_max3_f32 v254, v254, v199, v200
    v_max3_f32 v254, v254, v201, v202
    v_max3_f32 v254, v254, v203, v204
    s_waitcnt lgkmcnt(4)
    v_mfma_f32_32x32x16_bf16 a[240:255], v[224:227], v[208:211], a[240:255]
    ds_read_b64_tr_b16 v[224:225], v244 offset:56320
    ds_read_b64_tr_b16 v[226:227], v244 offset:59392
    v_max3_f32 v254, v254, v205, v206
    v_max_f32 v254, v254, v207
    v_fma_f32 v255, v254, s29, -v249
    v_mfma_f32_32x32x16_bf16 a[224:239], v[228:231], v[208:211], a[224:239]
    ds_read_b64_tr_b16 v[228:229], v245 offset:56320
    ds_read_b64_tr_b16 v[230:231], v245 offset:59392
    v_cmp_lt_f32 vcc, s31, v255
    s_cbranch_vccnz L_slow20
L_ret20:
    v_fma_f32 v192, v192, s29, -v249
    s_waitcnt lgkmcnt(4)
    v_mfma_f32_32x32x16_bf16 v[128:143], v[232:235], v[212:215], v[128:143]
    ds_read_b64_tr_b16 v[232:233], v244 offset:57344
    ds_read_b64_tr_b16 v[234:235], v244 offset:60416
    v_fma_f32 v193, v193, s29, -v249
    v_exp_f32 v192, v192
    v_mfma_f32_32x32x16_bf16 v[144:159], v[236:239], v[212:215], v[144:159]
    ds_read_b64_tr_b16 v[236:237], v245 offset:57344
    ds_read_b64_tr_b16 v[238:239], v245 offset:60416
    v_exp_f32 v193, v193
    v_fma_f32 v194, v194, s29, -v249
    s_waitcnt lgkmcnt(4)
    v_mfma_f32_32x32x16_bf16 v[160:175], v[224:227], v[212:215], v[160:175]
    ds_read_b128 v[224:227], v240 offset:0
    v_fma_f32 v195, v195, s29, -v249
    v_exp_f32 v194, v194
    v_mfma_f32_32x32x16_bf16 a[208:223], v[228:231], v[212:215], a[208:223]
    ds_read_b128 v[228:231], v241 offset:0
    v_exp_f32 v195, v195
    v_add_f32 v252, v252, v192
    s_waitcnt lgkmcnt(2)
    v_mfma_f32_32x32x16_bf16 a[240:255], v[232:235], v[212:215], a[240:255]
    ds_read_b128 v[232:235], v242 offset:0
    v_add_f32 v252, v252, v193
    v_cvt_pk_bf16_f32 v192, v192, v193
    v_fma_f32 v196, v196, s29, -v249
    v_mfma_f32_32x32x16_bf16 a[224:239], v[236:239], v[212:215], a[224:239]
    ds_read_b128 v[236:239], v243 offset:0
    v_fma_f32 v197, v197, s29, -v249
    v_exp_f32 v196, v196
    s_waitcnt lgkmcnt(2)
    v_mfma_f32_32x32x16_bf16 v[208:223], v[224:227], a[96:99], 0
    ds_read_b128 v[224:227], v240 offset:1024
    v_exp_f32 v197, v197
    v_add_f32 v252, v252, v194
    v_add_f32 v252, v252, v195
    v_mfma_f32_32x32x16_bf16 v[208:223], v[228:231], a[100:103], v[208:223]
    ds_read_b128 v[228:231], v241 offset:1024
    v_cvt_pk_bf16_f32 v193, v194, v195
    v_fma_f32 v198, v198, s29, -v249
    v_fma_f32 v199, v199, s29, -v249
    s_waitcnt lgkmcnt(2)
    v_mfma_f32_32x32x16_bf16 v[208:223], v[232:235], a[104:107], v[208:223]
    ds_read_b128 v[232:235], v242 offset:1024
    v_exp_f32 v198, v198
    v_exp_f32 v199, v199
    v_mfma_f32_32x32x16_bf16 v[208:223], v[236:239], a[108:111], v[208:223]
    ds_read_b128 v[236:239], v243 offset:1024
    v_add_f32 v252, v252, v196
    v_add_f32 v252, v252, v197
    v_cvt_pk_bf16_f32 v194, v196, v197
    v_fma_f32 v200, v200, s29, -v249
    s_waitcnt lgkmcnt(2)
    v_mfma_f32_32x32x16_bf16 v[208:223], v[224:227], a[112:115], v[208:223]
    ds_read_b128 v[224:227], v240 offset:2048
    v_fma_f32 v201, v201, s29, -v249
    v_exp_f32 v200, v200
    v_exp_f32 v201, v201
    v_mfma_f32_32x32x16_bf16 v[208:223], v[228:231], a[116:119], v[208:223]
    ds_read_b128 v[228:231], v241 offset:2048
    v_add_f32 v252, v252, v198
    v_add_f32 v252, v252, v199
    v_cvt_pk_bf16_f32 v195, v198, v199
    s_waitcnt lgkmcnt(2)
    v_mfma_f32_32x32x16_bf16 v[208:223], v[232:235], a[120:123], v[208:223]
    ds_read_b128 v[232:235], v242 offset:2048
    v_fma_f32 v202, v202, s29, -v249
    v_fma_f32 v203, v203, s29, -v249
    v_exp_f32 v202, v202
    v_mfma_f32_32x32x16_bf16 v[208:223], v[236:239], a[124:127], v[208:223]
    ds_read_b128 v[236:239], v243 offset:2048
    v_exp_f32 v203, v203
    v_add_f32 v252, v252, v200
    v_add_f32 v252, v252, v201
    s_waitcnt lgkmcnt(2)
    v_mfma_f32_32x32x16_bf16 v[208:223], v[224:227], a[128:131], v[208:223]
    ds_read_b64_tr_b16 v[224:225], v244 offset:12288
    ds_read_b64_tr_b16 v[226:227], v244 offset:15360
    v_cvt_pk_bf16_f32 v196, v200, v201
    v_fma_f32 v204, v204, s29, -v249
    v_fma_f32 v205, v205, s29, -v249
    v_exp_f32 v204, v204
    v_mfma_f32_32x32x16_bf16 v[208:223], v[228:231], a[132:135], v[208:223]
    ds_read_b64_tr_b16 v[228:229], v245 offset:12288
    ds_read_b64_tr_b16 v[230:231], v245 offset:15360
    v_exp_f32 v205, v205
    v_add_f32 v252, v252, v202
    s_waitcnt lgkmcnt(4)
    v_mfma_f32_32x32x16_bf16 v[208:223], v[232:235], a[136:139], v[208:223]
    ds_read_b64_tr_b16 v[232:233], v244 offset:13312
    ds_read_b64_tr_b16 v[234:235], v244 offset:16384
    v_add_f32 v252, v252, v203
    v_cvt_pk_bf16_f32 v197, v202, v203
    v_fma_f32 v206, v206, s29, -v249
    v_fma_f32 v207, v207, s29, -v249
    v_mfma_f32_32x32x16_bf16 v[208:223], v[236:239], a[140:143], v[208:223]
    ds_read_b64_tr_b16 v[236:237], v245 offset:13312
    ds_read_b64_tr_b16 v[238:239], v245 offset:16384
    v_exp_f32 v206, v206
    v_exp_f32 v207, v207
    s_waitcnt lgkmcnt(4)
    v_mfma_f32_32x32x16_bf16 v[0:15], v[224:227], v[176:179], v[0:15]
    ds_read_b64_tr_b16 v[224:225], v244 offset:14336
    ds_read_b64_tr_b16 v[226:227], v244 offset:17408
    v_add_f32 v252, v252, v204
    v_add_f32 v252, v252, v205
    v_cvt_pk_bf16_f32 v198, v204, v205
    v_mfma_f32_32x32x16_bf16 v[16:31], v[228:231], v[176:179], v[16:31]
    ds_read_b64_tr_b16 v[228:229], v245 offset:14336
    ds_read_b64_tr_b16 v[230:231], v245 offset:17408
    v_add_f32 v252, v252, v206
    v_add_f32 v252, v252, v207
    v_cvt_pk_bf16_f32 v199, v206, v207
    s_waitcnt lgkmcnt(4)
    v_mfma_f32_32x32x16_bf16 v[32:47], v[232:235], v[176:179], v[32:47]
    ds_read_b64_tr_b16 v[232:233], v244 offset:18432
    ds_read_b64_tr_b16 v[234:235], v244 offset:21504
    v_max3_f32 v254, v208, v209, v210
    v_max3_f32 v254, v254, v211, v212
    v_max3_f32 v254, v254, v213, v214
    v_max3_f32 v254, v254, v215, v216
    v_max3_f32 v254, v254, v217, v218
    v_mfma_f32_32x32x16_bf16 a[144:159], v[236:239], v[176:179], a[144:159]
    ds_read_b64_tr_b16 v[236:237], v245 offset:18432
    ds_read_b64_tr_b16 v[238:239], v245 offset:21504
    v_max3_f32 v254, v254, v219, v220
    v_max3_f32 v254, v254, v221, v222
    v_max_f32 v254, v254, v223
    v_fma_f32 v255, v254, s29, -v250
    s_waitcnt lgkmcnt(4)
    v_mfma_f32_32x32x16_bf16 v[48:63], v[224:227], v[176:179], v[48:63]
    ds_read_b64_tr_b16 v[224:225], v244 offset:19456
    ds_read_b64_tr_b16 v[226:227], v244 offset:22528
    v_cmp_lt_f32 vcc, s31, v255
    s_cbranch_vccnz L_slow22
L_ret22:
    v_fma_f32 v208, v208, s29, -v250
    v_fma_f32 v209, v209, s29, -v250
    v_exp_f32 v208, v208
    v_mfma_f32_32x32x16_bf16 a[160:175], v[228:231], v[176:179], a[160:175]
    ds_read_b64_tr_b16 v[228:229], v245 offset:19456
    ds_read_b64_tr_b16 v[230:231], v245 offset:22528
    v_exp_f32 v209, v209
    v_fma_f32 v210, v210, s29, -v250
    v_fma_f32 v211, v211, s29, -v250
    s_waitcnt lgkmcnt(4)
    v_mfma_f32_32x32x16_bf16 v[0:15], v[232:235], v[180:183], v[0:15]
    ds_read_b64_tr_b16 v[232:233], v244 offset:20480
    ds_read_b64_tr_b16 v[234:235], v244 offset:23552
    v_exp_f32 v210, v210
    v_exp_f32 v211, v211
    v_mfma_f32_32x32x16_bf16 v[16:31], v[236:239], v[180:183], v[16:31]
    s_waitcnt vmcnt(4)
    s_barrier
    s_add_u32 m0, s30, 147456
    s_add_u32 s33, s26, 61440
    ds_read_b64_tr_b16 v[236:237], v245 offset:20480
    ds_read_b64_tr_b16 v[238:239], v245 offset:23552
    buffer_load_dwordx4 v246, s[12:15], s33 offen offset:0 nt lds
    s_waitcnt lgkmcnt(4)
    v_mfma_f32_32x32x16_bf16 v[32:47], v[224:227], v[180:183], v[32:47]
    ds_read_b128 v[224:227], v240 offset:24576
    v_add_f32 v253, v253, v208
    v_add_f32 v253, v253, v209
    v_cvt_pk_bf16_f32 v208, v208, v209
    v_fma_f32 v212, v212, s29, -v250
    v_fma_f32 v213, v213, s29, -v250
    v_mfma_f32_32x32x16_bf16 a[144:159], v[228:231], v[180:183], a[144:159]
    s_add_u32 m0, s30, 148352
    ds_read_b128 v[228:231], v241 offset:24576
    v_exp_f32 v212, v212
    buffer_load_dwordx4 v246, s[12:15], s33 offen offset:128 nt lds
    s_waitcnt lgkmcnt(2)
    v_mfma_f32_32x32x16_bf16 v[48:63], v[232:235], v[180:183], v[48:63]
    ds_read_b128 v[232:235], v242 offset:24576
    v_exp_f32 v213, v213
    v_add_f32 v253, v253, v210
    v_add_f32 v253, v253, v211
    v_mfma_f32_32x32x16_bf16 a[160:175], v[236:239], v[180:183], a[160:175]
    s_add_u32 m0, s30, 149248
    ds_read_b128 v[236:239], v243 offset:24576
    v_cvt_pk_bf16_f32 v209, v210, v211
    v_fma_f32 v214, v214, s29, -v250
    buffer_load_dwordx4 v246, s[12:15], s33 offen offset:256 nt lds
    s_waitcnt lgkmcnt(2)
    v_mfma_f32_32x32x16_bf16 v[176:191], v[224:227], a[0:3], 0
    ds_read_b128 v[224:227], v240 offset:25600
    v_fma_f32 v215, v215, s29, -v250
    v_exp_f32 v214, v214
    v_exp_f32 v215, v215
    v_add_f32 v253, v253, v212
    v_mfma_f32_32x32x16_bf16 v[176:191], v[228:231], a[4:7], v[176:191]
    s_add_u32 m0, s30, 0
    s_add_u32 s33, s26, 61440
    ds_read_b128 v[228:231], v241 offset:25600
    v_add_f32 v253, v253, v213
    v_cvt_pk_bf16_f32 v210, v212, v213
    buffer_load_dwordx4 v247, s[16:19], s33 offen offset:0 nt lds
    s_waitcnt lgkmcnt(2)
    v_mfma_f32_32x32x16_bf16 v[176:191], v[232:235], a[8:11], v[176:191]
    ds_read_b128 v[232:235], v242 offset:25600
    v_fma_f32 v216, v216, s29, -v250
    v_fma_f32 v217, v217, s29, -v250
    v_exp_f32 v216, v216
    v_exp_f32 v217, v217
    v_mfma_f32_32x32x16_bf16 v[176:191], v[236:239], a[12:15], v[176:191]
    s_add_u32 m0, s30, 896
    ds_read_b128 v[236:239], v243 offset:25600
    v_mbcnt_lo_u32_b32 v200, -1, 0
    s_add_u32 s32, s38, 49152
    v_mbcnt_hi_u32_b32 v200, -1, v200
    v_lshlrev_b32 v200, 4, v200
    v_xor_b32 v200, s32, v200
    ds_read_b128 v[204:207], v200 offset:6144
    ds_read_b128 v[200:203], v200 offset:0
    buffer_load_dwordx4 v247, s[16:19], s33 offen offset:128 nt lds
    s_waitcnt lgkmcnt(4)
    v_mfma_f32_32x32x16_bf16 v[176:191], v[224:227], a[16:19], v[176:191]
    ds_read_b128 v[224:227], v240 offset:26624
    v_add_f32 v253, v253, v214
    v_add_f32 v253, v253, v215
    v_cvt_pk_bf16_f32 v211, v214, v215
    v_fma_f32 v218, v218, s29, -v250
    v_fma_f32 v219, v219, s29, -v250
    v_mfma_f32_32x32x16_bf16 v[176:191], v[228:231], a[20:23], v[176:191]
    s_add_u32 m0, s30, 1792
    ds_read_b128 v[228:231], v241 offset:26624
    v_exp_f32 v218, v218
    v_exp_f32 v219, v219
    buffer_load_dwordx4 v247, s[16:19], s33 offen offset:256 nt lds
    s_waitcnt lgkmcnt(4)
    v_mfma_f32_32x32x16_bf16 v[176:191], v[232:235], a[24:27], v[176:191]
    ds_read_b128 v[232:235], v242 offset:26624
    v_add_f32 v253, v253, v216
    s_add_u32 s32, s28, 24576
    s_waitcnt lgkmcnt(3)
    buffer_store_dwordx4 v[200:203], v246, s[20:23], s32 offen offset:0 nt
    v_mfma_f32_32x32x16_bf16 v[176:191], v[236:239], a[28:31], v[176:191]
    s_add_u32 m0, s30, 12288
    s_add_u32 s33, s26, 73728
    ds_read_b128 v[236:239], v243 offset:26624
    s_add_u32 s32, s28, 30720
    buffer_store_dwordx4 v[204:207], v246, s[20:23], s32 offen offset:0 nt
    buffer_load_dwordx4 v246, s[12:15], s33 offen offset:0 nt lds
    s_waitcnt lgkmcnt(2)
    v_mfma_f32_32x32x16_bf16 v[176:191], v[224:227], a[32:35], v[176:191]
    ds_read_b64_tr_b16 v[224:225], v244 offset:12288
    ds_read_b64_tr_b16 v[226:227], v244 offset:15360
    v_add_f32 v253, v253, v217
    v_cvt_pk_bf16_f32 v212, v216, v217
    v_fma_f32 v220, v220, s29, -v250
    v_fma_f32 v221, v221, s29, -v250
    v_exp_f32 v220, v220
    v_mfma_f32_32x32x16_bf16 v[176:191], v[228:231], a[36:39], v[176:191]
    s_add_u32 m0, s30, 13184
    ds_read_b64_tr_b16 v[228:229], v245 offset:12288
    ds_read_b64_tr_b16 v[230:231], v245 offset:15360
    v_exp_f32 v221, v221
    buffer_load_dwordx4 v246, s[12:15], s33 offen offset:128 nt lds
    s_waitcnt lgkmcnt(4)
    v_mfma_f32_32x32x16_bf16 v[176:191], v[232:235], a[40:43], v[176:191]
    ds_read_b64_tr_b16 v[232:233], v244 offset:13312
    ds_read_b64_tr_b16 v[234:235], v244 offset:16384
    v_add_f32 v253, v253, v218
    v_add_f32 v253, v253, v219
    v_cvt_pk_bf16_f32 v213, v218, v219
    v_fma_f32 v222, v222, s29, -v250
    v_fma_f32 v223, v223, s29, -v250
    v_exp_f32 v222, v222
    v_mfma_f32_32x32x16_bf16 v[176:191], v[236:239], a[44:47], v[176:191]
    s_add_u32 m0, s30, 14080
    ds_read_b64_tr_b16 v[236:237], v245 offset:13312
    ds_read_b64_tr_b16 v[238:239], v245 offset:16384
    v_exp_f32 v223, v223
    buffer_load_dwordx4 v246, s[12:15], s33 offen offset:256 nt lds
    s_waitcnt lgkmcnt(4)
    v_mfma_f32_32x32x16_bf16 v[64:79], v[224:227], v[192:195], v[64:79]
    ds_read_b64_tr_b16 v[224:225], v244 offset:14336
    ds_read_b64_tr_b16 v[226:227], v244 offset:17408
    v_add_f32 v253, v253, v220
    v_add_f32 v253, v253, v221
    v_cvt_pk_bf16_f32 v214, v220, v221
    v_add_f32 v253, v253, v222
    v_mfma_f32_32x32x16_bf16 v[80:95], v[228:231], v[192:195], v[80:95]
    s_add_u32 m0, s30, 24576
    s_add_u32 s33, s26, 73728
    ds_read_b64_tr_b16 v[228:229], v245 offset:14336
    ds_read_b64_tr_b16 v[230:231], v245 offset:17408
    v_add_f32 v253, v253, v223
    v_cvt_pk_bf16_f32 v215, v222, v223
    buffer_load_dwordx4 v247, s[16:19], s33 offen offset:0 nt lds
    s_waitcnt lgkmcnt(4)
    v_mfma_f32_32x32x16_bf16 v[96:111], v[232:235], v[192:195], v[96:111]
    ds_read_b64_tr_b16 v[232:233], v244 offset:18432
    ds_read_b64_tr_b16 v[234:235], v244 offset:21504
    v_max3_f32 v254, v176, v177, v178
    v_max3_f32 v254, v254, v179, v180
    v_max3_f32 v254, v254, v181, v182
    v_max3_f32 v254, v254, v183, v184
    v_mfma_f32_32x32x16_bf16 a[176:191], v[236:239], v[192:195], a[176:191]
    s_add_u32 m0, s30, 25472
    ds_read_b64_tr_b16 v[236:237], v245 offset:18432
    ds_read_b64_tr_b16 v[238:239], v245 offset:21504
    buffer_load_dwordx4 v247, s[16:19], s33 offen offset:128 nt lds
    s_waitcnt lgkmcnt(4)
    v_mfma_f32_32x32x16_bf16 v[112:127], v[224:227], v[192:195], v[112:127]
    ds_read_b64_tr_b16 v[224:225], v244 offset:19456
    ds_read_b64_tr_b16 v[226:227], v244 offset:22528
    v_max3_f32 v254, v254, v185, v186
    v_max3_f32 v254, v254, v187, v188
    v_max3_f32 v254, v254, v189, v190
    v_max_f32 v254, v254, v191
    v_mfma_f32_32x32x16_bf16 a[192:207], v[228:231], v[192:195], a[192:207]
    s_add_u32 m0, s30, 26368
    ds_read_b64_tr_b16 v[228:229], v245 offset:19456
    ds_read_b64_tr_b16 v[230:231], v245 offset:22528
    v_fma_f32 v255, v254, s29, -v248
    buffer_load_dwordx4 v247, s[16:19], s33 offen offset:256 nt lds
    s_waitcnt lgkmcnt(4)
    v_mfma_f32_32x32x16_bf16 v[64:79], v[232:235], v[196:199], v[64:79]
    ds_read_b64_tr_b16 v[232:233], v244 offset:20480
    ds_read_b64_tr_b16 v[234:235], v244 offset:23552
    v_cmp_lt_f32 vcc, s31, v255
    s_cbranch_vccnz L_slow24
L_ret24:
    v_fma_f32 v176, v176, s29, -v248
    v_fma_f32 v177, v177, s29, -v248
    v_mfma_f32_32x32x16_bf16 v[80:95], v[236:239], v[196:199], v[80:95]
    ds_read_b64_tr_b16 v[236:237], v245 offset:20480
    ds_read_b64_tr_b16 v[238:239], v245 offset:23552
    v_exp_f32 v176, v176
    v_exp_f32 v177, v177
    s_waitcnt lgkmcnt(4)
    v_mfma_f32_32x32x16_bf16 v[96:111], v[224:227], v[196:199], v[96:111]
    ds_read_b128 v[224:227], v240 offset:24576
    v_fma_f32 v178, v178, s29, -v248
    v_fma_f32 v179, v179, s29, -v248
    v_exp_f32 v178, v178
    v_mfma_f32_32x32x16_bf16 a[176:191], v[228:231], v[196:199], a[176:191]
    ds_read_b128 v[228:231], v241 offset:24576
    v_exp_f32 v179, v179
    v_add_f32 v251, v251, v176
    s_waitcnt lgkmcnt(2)
    v_mfma_f32_32x32x16_bf16 v[112:127], v[232:235], v[196:199], v[112:127]
    ds_read_b128 v[232:235], v242 offset:24576
    v_add_f32 v251, v251, v177
    v_cvt_pk_bf16_f32 v176, v176, v177
    v_fma_f32 v180, v180, s29, -v248
    v_fma_f32 v181, v181, s29, -v248
    v_mfma_f32_32x32x16_bf16 a[192:207], v[236:239], v[196:199], a[192:207]
    ds_read_b128 v[236:239], v243 offset:24576
    v_exp_f32 v180, v180
    v_exp_f32 v181, v181
    s_waitcnt lgkmcnt(2)
    v_mfma_f32_32x32x16_bf16 v[192:207], v[224:227], a[48:51], 0
    ds_read_b128 v[224:227], v240 offset:25600
    v_add_f32 v251, v251, v178
    v_add_f32 v251, v251, v179
    v_cvt_pk_bf16_f32 v177, v178, v179
    v_fma_f32 v182, v182, s29, -v248
    v_mfma_f32_32x32x16_bf16 v[192:207], v[228:231], a[52:55], v[192:207]
    ds_read_b128 v[228:231], v241 offset:25600
    v_fma_f32 v183, v183, s29, -v248
    v_exp_f32 v182, v182
    v_exp_f32 v183, v183
    s_waitcnt lgkmcnt(2)
    v_mfma_f32_32x32x16_bf16 v[192:207], v[232:235], a[56:59], v[192:207]
    ds_read_b128 v[232:235], v242 offset:25600
    v_add_f32 v251, v251, v180
    v_add_f32 v251, v251, v181
    v_cvt_pk_bf16_f32 v178, v180, v181
    v_fma_f32 v184, v184, s29, -v248
    v_fma_f32 v185, v185, s29, -v248
    v_mfma_f32_32x32x16_bf16 v[192:207], v[236:239], a[60:63], v[192:207]
    ds_read_b128 v[236:239], v243 offset:25600
    v_mbcnt_lo_u32_b32 v216, -1, 0
    s_add_u32 s32, s39, 49152
    v_mbcnt_hi_u32_b32 v216, -1, v216
    v_lshlrev_b32 v216, 4, v216
    v_xor_b32 v216, s32, v216
    ds_read_b128 v[220:223], v216 offset:9216
    ds_read_b128 v[216:219], v216 offset:3072
    s_waitcnt lgkmcnt(4)
    v_mfma_f32_32x32x16_bf16 v[192:207], v[224:227], a[64:67], v[192:207]
    ds_read_b128 v[224:227], v240 offset:26624
    v_exp_f32 v184, v184
    v_exp_f32 v185, v185
    v_mfma_f32_32x32x16_bf16 v[192:207], v[228:231], a[68:71], v[192:207]
    ds_read_b128 v[228:231], v241 offset:26624
    v_add_f32 v251, v251, v182
    v_add_f32 v251, v251, v183
    v_cvt_pk_bf16_f32 v179, v182, v183
    v_fma_f32 v186, v186, s29, -v248
    v_fma_f32 v187, v187, s29, -v248
    s_waitcnt lgkmcnt(4)
    v_mfma_f32_32x32x16_bf16 v[192:207], v[232:235], a[72:75], v[192:207]
    ds_read_b128 v[232:235], v242 offset:26624
    s_add_u32 s32, s28, 27648
    s_waitcnt lgkmcnt(3)
    buffer_store_dwordx4 v[216:219], v246, s[20:23], s32 offen offset:0 nt
    v_mfma_f32_32x32x16_bf16 v[192:207], v[236:239], a[76:79], v[192:207]
    ds_read_b128 v[236:239], v243 offset:26624
    v_exp_f32 v186, v186
    s_add_u32 s32, s28, 33792
    buffer_store_dwordx4 v[220:223], v246, s[20:23], s32 offen offset:0 nt
    s_waitcnt lgkmcnt(2)
    v_mfma_f32_32x32x16_bf16 v[192:207], v[224:227], a[80:83], v[192:207]
    ds_read_b64_tr_b16 v[224:225], v244 offset:12288
    ds_read_b64_tr_b16 v[226:227], v244 offset:15360
    v_exp_f32 v187, v187
    v_add_f32 v251, v251, v184
    v_add_f32 v251, v251, v185
    v_mfma_f32_32x32x16_bf16 v[192:207], v[228:231], a[84:87], v[192:207]
    ds_read_b64_tr_b16 v[228:229], v245 offset:12288
    ds_read_b64_tr_b16 v[230:231], v245 offset:15360
    v_cvt_pk_bf16_f32 v180, v184, v185
    v_fma_f32 v188, v188, s29, -v248
    v_fma_f32 v189, v189, s29, -v248
    v_exp_f32 v188, v188
    s_waitcnt lgkmcnt(4)
    v_mfma_f32_32x32x16_bf16 v[192:207], v[232:235], a[88:91], v[192:207]
    ds_read_b64_tr_b16 v[232:233], v244 offset:13312
    ds_read_b64_tr_b16 v[234:235], v244 offset:16384
    v_exp_f32 v189, v189
    v_add_f32 v251, v251, v186
    v_add_f32 v251, v251, v187
    v_cvt_pk_bf16_f32 v181, v186, v187
    v_mfma_f32_32x32x16_bf16 v[192:207], v[236:239], a[92:95], v[192:207]
    ds_read_b64_tr_b16 v[236:237], v245 offset:13312
    ds_read_b64_tr_b16 v[238:239], v245 offset:16384
    v_fma_f32 v190, v190, s29, -v248
    v_fma_f32 v191, v191, s29, -v248
    v_exp_f32 v190, v190
    s_waitcnt lgkmcnt(4)
    v_mfma_f32_32x32x16_bf16 v[128:143], v[224:227], v[208:211], v[128:143]
    ds_read_b64_tr_b16 v[224:225], v244 offset:14336
    ds_read_b64_tr_b16 v[226:227], v244 offset:17408
    v_exp_f32 v191, v191
    v_add_f32 v251, v251, v188
    v_add_f32 v251, v251, v189
    v_mfma_f32_32x32x16_bf16 v[144:159], v[228:231], v[208:211], v[144:159]
    ds_read_b64_tr_b16 v[228:229], v245 offset:14336
    ds_read_b64_tr_b16 v[230:231], v245 offset:17408
    v_cvt_pk_bf16_f32 v182, v188, v189
    v_add_f32 v251, v251, v190
    v_add_f32 v251, v251, v191
    v_cvt_pk_bf16_f32 v183, v190, v191
    s_waitcnt lgkmcnt(4)
    v_mfma_f32_32x32x16_bf16 v[160:175], v[232:235], v[208:211], v[160:175]
    ds_read_b64_tr_b16 v[232:233], v244 offset:18432
    ds_read_b64_tr_b16 v[234:235], v244 offset:21504
    v_max3_f32 v254, v192, v193, v194
    v_max3_f32 v254, v254, v195, v196
    v_max3_f32 v254, v254, v197, v198
    v_mfma_f32_32x32x16_bf16 a[208:223], v[236:239], v[208:211], a[208:223]
    ds_read_b64_tr_b16 v[236:237], v245 offset:18432
    ds_read_b64_tr_b16 v[238:239], v245 offset:21504
    v_max3_f32 v254, v254, v199, v200
    v_max3_f32 v254, v254, v201, v202
    v_max3_f32 v254, v254, v203, v204
    s_waitcnt lgkmcnt(4)
    v_mfma_f32_32x32x16_bf16 a[240:255], v[224:227], v[208:211], a[240:255]
    ds_read_b64_tr_b16 v[224:225], v244 offset:19456
    ds_read_b64_tr_b16 v[226:227], v244 offset:22528
    v_max3_f32 v254, v254, v205, v206
    v_max_f32 v254, v254, v207
    v_fma_f32 v255, v254, s29, -v249
    v_mfma_f32_32x32x16_bf16 a[224:239], v[228:231], v[208:211], a[224:239]
    ds_read_b64_tr_b16 v[228:229], v245 offset:19456
    ds_read_b64_tr_b16 v[230:231], v245 offset:22528
    v_cmp_lt_f32 vcc, s31, v255
    s_cbranch_vccnz L_slow26
L_ret26:
    v_fma_f32 v192, v192, s29, -v249
    s_waitcnt lgkmcnt(4)
    v_mfma_f32_32x32x16_bf16 v[128:143], v[232:235], v[212:215], v[128:143]
    ds_read_b64_tr_b16 v[232:233], v244 offset:20480
    ds_read_b64_tr_b16 v[234:235], v244 offset:23552
    v_fma_f32 v193, v193, s29, -v249
    v_exp_f32 v192, v192
    v_mfma_f32_32x32x16_bf16 v[144:159], v[236:239], v[212:215], v[144:159]
    ds_read_b64_tr_b16 v[236:237], v245 offset:20480
    ds_read_b64_tr_b16 v[238:239], v245 offset:23552
    v_exp_f32 v193, v193
    v_fma_f32 v194, v194, s29, -v249
    s_waitcnt lgkmcnt(4)
    v_mfma_f32_32x32x16_bf16 v[160:175], v[224:227], v[212:215], v[160:175]
    ds_read_b128 v[224:227], v240 offset:24576
    v_fma_f32 v195, v195, s29, -v249
    v_exp_f32 v194, v194
    v_mfma_f32_32x32x16_bf16 a[208:223], v[228:231], v[212:215], a[208:223]
    ds_read_b128 v[228:231], v241 offset:24576
    v_exp_f32 v195, v195
    v_add_f32 v252, v252, v192
    s_waitcnt lgkmcnt(2)
    v_mfma_f32_32x32x16_bf16 a[240:255], v[232:235], v[212:215], a[240:255]
    ds_read_b128 v[232:235], v242 offset:24576
    v_add_f32 v252, v252, v193
    v_cvt_pk_bf16_f32 v192, v192, v193
    v_fma_f32 v196, v196, s29, -v249
    v_mfma_f32_32x32x16_bf16 a[224:239], v[236:239], v[212:215], a[224:239]
    ds_read_b128 v[236:239], v243 offset:24576
    v_fma_f32 v197, v197, s29, -v249
    v_exp_f32 v196, v196
    s_waitcnt lgkmcnt(2)
    v_mfma_f32_32x32x16_bf16 v[208:223], v[224:227], a[96:99], 0
    ds_read_b128 v[224:227], v240 offset:25600
    v_exp_f32 v197, v197
    v_add_f32 v252, v252, v194
    v_add_f32 v252, v252, v195
    v_mfma_f32_32x32x16_bf16 v[208:223], v[228:231], a[100:103], v[208:223]
    ds_read_b128 v[228:231], v241 offset:25600
    v_cvt_pk_bf16_f32 v193, v194, v195
    v_fma_f32 v198, v198, s29, -v249
    v_fma_f32 v199, v199, s29, -v249
    s_waitcnt lgkmcnt(2)
    v_mfma_f32_32x32x16_bf16 v[208:223], v[232:235], a[104:107], v[208:223]
    ds_read_b128 v[232:235], v242 offset:25600
    v_exp_f32 v198, v198
    v_exp_f32 v199, v199
    v_mfma_f32_32x32x16_bf16 v[208:223], v[236:239], a[108:111], v[208:223]
    ds_read_b128 v[236:239], v243 offset:25600
    v_add_f32 v252, v252, v196
    v_add_f32 v252, v252, v197
    v_cvt_pk_bf16_f32 v194, v196, v197
    v_fma_f32 v200, v200, s29, -v249
    s_waitcnt lgkmcnt(2)
    v_mfma_f32_32x32x16_bf16 v[208:223], v[224:227], a[112:115], v[208:223]
    ds_read_b128 v[224:227], v240 offset:26624
    v_fma_f32 v201, v201, s29, -v249
    v_exp_f32 v200, v200
    v_exp_f32 v201, v201
    v_mfma_f32_32x32x16_bf16 v[208:223], v[228:231], a[116:119], v[208:223]
    ds_read_b128 v[228:231], v241 offset:26624
    v_add_f32 v252, v252, v198
    v_add_f32 v252, v252, v199
    v_cvt_pk_bf16_f32 v195, v198, v199
    s_waitcnt lgkmcnt(2)
    v_mfma_f32_32x32x16_bf16 v[208:223], v[232:235], a[120:123], v[208:223]
    ds_read_b128 v[232:235], v242 offset:26624
    v_fma_f32 v202, v202, s29, -v249
    v_fma_f32 v203, v203, s29, -v249
    v_exp_f32 v202, v202
    v_mfma_f32_32x32x16_bf16 v[208:223], v[236:239], a[124:127], v[208:223]
    ds_read_b128 v[236:239], v243 offset:26624
    v_exp_f32 v203, v203
    v_add_f32 v252, v252, v200
    v_add_f32 v252, v252, v201
    s_waitcnt lgkmcnt(2)
    v_mfma_f32_32x32x16_bf16 v[208:223], v[224:227], a[128:131], v[208:223]
    ds_read_b64_tr_b16 v[224:225], v244 offset:36864
    ds_read_b64_tr_b16 v[226:227], v244 offset:39936
    v_cvt_pk_bf16_f32 v196, v200, v201
    v_fma_f32 v204, v204, s29, -v249
    v_fma_f32 v205, v205, s29, -v249
    v_exp_f32 v204, v204
    v_mfma_f32_32x32x16_bf16 v[208:223], v[228:231], a[132:135], v[208:223]
    ds_read_b64_tr_b16 v[228:229], v245 offset:36864
    ds_read_b64_tr_b16 v[230:231], v245 offset:39936
    v_exp_f32 v205, v205
    v_add_f32 v252, v252, v202
    s_waitcnt lgkmcnt(4)
    v_mfma_f32_32x32x16_bf16 v[208:223], v[232:235], a[136:139], v[208:223]
    ds_read_b64_tr_b16 v[232:233], v244 offset:37888
    ds_read_b64_tr_b16 v[234:235], v244 offset:40960
    v_add_f32 v252, v252, v203
    v_cvt_pk_bf16_f32 v197, v202, v203
    v_fma_f32 v206, v206, s29, -v249
    v_fma_f32 v207, v207, s29, -v249
    v_mfma_f32_32x32x16_bf16 v[208:223], v[236:239], a[140:143], v[208:223]
    ds_read_b64_tr_b16 v[236:237], v245 offset:37888
    ds_read_b64_tr_b16 v[238:239], v245 offset:40960
    v_exp_f32 v206, v206
    v_exp_f32 v207, v207
    s_waitcnt lgkmcnt(4)
    v_mfma_f32_32x32x16_bf16 v[0:15], v[224:227], v[176:179], v[0:15]
    ds_read_b64_tr_b16 v[224:225], v244 offset:38912
    ds_read_b64_tr_b16 v[226:227], v244 offset:41984
    v_add_f32 v252, v252, v204
    v_add_f32 v252, v252, v205
    v_cvt_pk_bf16_f32 v198, v204, v205
    v_mfma_f32_32x32x16_bf16 v[16:31], v[228:231], v[176:179], v[16:31]
    ds_read_b64_tr_b16 v[228:229], v245 offset:38912
    ds_read_b64_tr_b16 v[230:231], v245 offset:41984
    v_add_f32 v252, v252, v206
    v_add_f32 v252, v252, v207
    v_cvt_pk_bf16_f32 v199, v206, v207
    s_waitcnt lgkmcnt(4)
    v_mfma_f32_32x32x16_bf16 v[32:47], v[232:235], v[176:179], v[32:47]
    ds_read_b64_tr_b16 v[232:233], v244 offset:43008
    ds_read_b64_tr_b16 v[234:235], v244 offset:46080
    v_max3_f32 v254, v208, v209, v210
    v_max3_f32 v254, v254, v211, v212
    v_max3_f32 v254, v254, v213, v214
    v_max3_f32 v254, v254, v215, v216
    v_mfma_f32_32x32x16_bf16 a[144:159], v[236:239], v[176:179], a[144:159]
    ds_read_b64_tr_b16 v[236:237], v245 offset:43008
    ds_read_b64_tr_b16 v[238:239], v245 offset:46080
    v_mbcnt_lo_u32_b32 v184, -1, 0
    s_add_u32 s32, s38, 49152
    v_mbcnt_hi_u32_b32 v184, -1, v184
    v_lshlrev_b32 v184, 4, v184
    v_xor_b32 v184, s32, v184
    ds_read_b128 v[188:191], v184 offset:7168
    ds_read_b128 v[184:187], v184 offset:1024
    s_waitcnt lgkmcnt(6)
    v_mfma_f32_32x32x16_bf16 v[48:63], v[224:227], v[176:179], v[48:63]
    ds_read_b64_tr_b16 v[224:225], v244 offset:44032
    ds_read_b64_tr_b16 v[226:227], v244 offset:47104
    v_max3_f32 v254, v254, v217, v218
    v_max3_f32 v254, v254, v219, v220
    v_max3_f32 v254, v254, v221, v222
    v_max_f32 v254, v254, v223
    v_mfma_f32_32x32x16_bf16 a[160:175], v[228:231], v[176:179], a[160:175]
    ds_read_b64_tr_b16 v[228:229], v245 offset:44032
    ds_read_b64_tr_b16 v[230:231], v245 offset:47104
    v_fma_f32 v255, v254, s29, -v250
    v_cmp_lt_f32 vcc, s31, v255
    s_cbranch_vccnz L_slow28
L_ret28:
    v_fma_f32 v208, v208, s29, -v250
    v_fma_f32 v209, v209, s29, -v250
    s_waitcnt lgkmcnt(6)
    v_mfma_f32_32x32x16_bf16 v[0:15], v[232:235], v[180:183], v[0:15]
    ds_read_b64_tr_b16 v[232:233], v244 offset:45056
    ds_read_b64_tr_b16 v[234:235], v244 offset:48128
    s_add_u32 s32, s28, 24576
    s_waitcnt lgkmcnt(6)
    buffer_store_dwordx4 v[184:187], v246, s[20:23], s32 offen offset:128 nt
    v_mfma_f32_32x32x16_bf16 v[16:31], v[236:239], v[180:183], v[16:31]
    s_waitcnt vmcnt(11)
    s_barrier
    ds_read_b64_tr_b16 v[236:237], v245 offset:45056
    ds_read_b64_tr_b16 v[238:239], v245 offset:48128
    s_add_u32 s32, s28, 30720
    buffer_store_dwordx4 v[188:191], v246, s[20:23], s32 offen offset:128 nt
    s_waitcnt lgkmcnt(4)
    v_mfma_f32_32x32x16_bf16 v[32:47], v[224:227], v[180:183], v[32:47]
    ds_read_b128 v[224:227], v240 offset:49152
    v_exp_f32 v208, v208
    v_exp_f32 v209, v209
    v_mfma_f32_32x32x16_bf16 a[144:159], v[228:231], v[180:183], a[144:159]
    ds_read_b128 v[228:231], v241 offset:49152
    v_fma_f32 v210, v210, s29, -v250
    v_fma_f32 v211, v211, s29, -v250
    v_exp_f32 v210, v210
    s_waitcnt lgkmcnt(2)
    v_mfma_f32_32x32x16_bf16 v[48:63], v[232:235], v[180:183], v[48:63]
    ds_read_b128 v[232:235], v242 offset:49152
    v_exp_f32 v211, v211
    v_add_f32 v253, v253, v208
    v_add_f32 v253, v253, v209
    v_cvt_pk_bf16_f32 v208, v208, v209
    v_mfma_f32_32x32x16_bf16 a[160:175], v[236:239], v[180:183], a[160:175]
    s_add_u32 m0, s30, 36864
    s_add_u32 s33, s26, 86016
    ds_read_b128 v[236:239], v243 offset:49152
    v_fma_f32 v212, v212, s29, -v250
    buffer_load_dwordx4 v246, s[12:15], s33 offen offset:0 nt lds
    s_waitcnt lgkmcnt(2)
    v_mfma_f32_32x32x16_bf16 v[176:191], v[224:227], a[0:3], 0
    ds_read_b128 v[224:227], v240 offset:50176
    v_fma_f32 v213, v213, s29, -v250
    v_exp_f32 v212, v212
    v_exp_f32 v213, v213
    v_mfma_f32_32x32x16_bf16 v[176:191], v[228:231], a[4:7], v[176:191]
    s_add_u32 m0, s30, 37760
    ds_read_b128 v[228:231], v241 offset:50176
    v_add_f32 v253, v253, v210
    v_add_f32 v253, v253, v211
    buffer_load_dwordx4 v246, s[12:15], s33 offen offset:128 nt lds
    s_waitcnt lgkmcnt(2)
    v_mfma_f32_32x32x16_bf16 v[176:191], v[232:235], a[8:11], v[176:191]
    ds_read_b128 v[232:235], v242 offset:50176
    v_cvt_pk_bf16_f32 v209, v210, v211
    v_fma_f32 v214, v214, s29, -v250
    v_fma_f32 v215, v215, s29, -v250
    v_exp_f32 v214, v214
    v_mfma_f32_32x32x16_bf16 v[176:191], v[236:239], a[12:15], v[176:191]
    s_add_u32 m0, s30, 38656
    ds_read_b128 v[236:239], v243 offset:50176
    v_exp_f32 v215, v215
    v_add_f32 v253, v253, v212
    buffer_load_dwordx4 v246, s[12:15], s33 offen offset:256 nt lds
    s_waitcnt lgkmcnt(2)
    v_mfma_f32_32x32x16_bf16 v[176:191], v[224:227], a[16:19], v[176:191]
    ds_read_b128 v[224:227], v240 offset:51200
    v_add_f32 v253, v253, v213
    v_cvt_pk_bf16_f32 v210, v212, v213
    v_fma_f32 v216, v216, s29, -v250
    v_fma_f32 v217, v217, s29, -v250
    v_mfma_f32_32x32x16_bf16 v[176:191], v[228:231], a[20:23], v[176:191]
    s_add_u32 m0, s30, 98304
    s_add_u32 s33, s26, 86016
    ds_read_b128 v[228:231], v241 offset:51200
    v_exp_f32 v216, v216
    v_exp_f32 v217, v217
    buffer_load_dwordx4 v247, s[16:19], s33 offen offset:0 nt lds
    s_waitcnt lgkmcnt(2)
    v_mfma_f32_32x32x16_bf16 v[176:191], v[232:235], a[24:27], v[176:191]
    ds_read_b128 v[232:235], v242 offset:51200
    v_add_f32 v253, v253, v214
    v_add_f32 v253, v253, v215
    v_cvt_pk_bf16_f32 v211, v214, v215
    v_fma_f32 v218, v218, s29, -v250
    v_mfma_f32_32x32x16_bf16 v[176:191], v[236:239], a[28:31], v[176:191]
    s_add_u32 m0, s30, 99200
    ds_read_b128 v[236:239], v243 offset:51200
    v_fma_f32 v219, v219, s29, -v250
    v_exp_f32 v218, v218
    buffer_load_dwordx4 v247, s[16:19], s33 offen offset:128 nt lds
    s_waitcnt lgkmcnt(2)
    v_mfma_f32_32x32x16_bf16 v[176:191], v[224:227], a[32:35], v[176:191]
    ds_read_b64_tr_b16 v[224:225], v244 offset:36864
    ds_read_b64_tr_b16 v[226:227], v244 offset:39936
    v_exp_f32 v219, v219
    v_add_f32 v253, v253, v216
    v_add_f32 v253, v253, v217
    v_cvt_pk_bf16_f32 v212, v216, v217
    v_mfma_f32_32x32x16_bf16 v[176:191], v[228:231], a[36:39], v[176:191]
    s_add_u32 m0, s30, 100096
    ds_read_b64_tr_b16 v[228:229], v245 offset:36864
    ds_read_b64_tr_b16 v[230:231], v245 offset:39936
    v_fma_f32 v220, v220, s29, -v250
    v_fma_f32 v221, v221, s29, -v250
    buffer_load_dwordx4 v247, s[16:19], s33 offen offset:256 nt lds
    s_waitcnt lgkmcnt(4)
    v_mfma_f32_32x32x16_bf16 v[176:191], v[232:235], a[40:43], v[176:191]
    ds_read_b64_tr_b16 v[232:233], v244 offset:37888
    ds_read_b64_tr_b16 v[234:235], v244 offset:40960
    v_exp_f32 v220, v220
    v_exp_f32 v221, v221
    v_add_f32 v253, v253, v218
    v_mfma_f32_32x32x16_bf16 v[176:191], v[236:239], a[44:47], v[176:191]
    ds_read_b64_tr_b16 v[236:237], v245 offset:37888
    ds_read_b64_tr_b16 v[238:239], v245 offset:40960
    v_add_f32 v253, v253, v219
    v_cvt_pk_bf16_f32 v213, v218, v219
    v_fma_f32 v222, v222, s29, -v250
    v_fma_f32 v223, v223, s29, -v250
    v_exp_f32 v222, v222
    s_waitcnt lgkmcnt(4)
    v_mfma_f32_32x32x16_bf16 v[64:79], v[224:227], v[192:195], v[64:79]
    ds_read_b64_tr_b16 v[224:225], v244 offset:38912
    ds_read_b64_tr_b16 v[226:227], v244 offset:41984
    v_exp_f32 v223, v223
    v_add_f32 v253, v253, v220
    v_add_f32 v253, v253, v221
    v_mfma_f32_32x32x16_bf16 v[80:95], v[228:231], v[192:195], v[80:95]
    ds_read_b64_tr_b16 v[228:229], v245 offset:38912
    ds_read_b64_tr_b16 v[230:231], v245 offset:41984
    v_cvt_pk_bf16_f32 v214, v220, v221
    v_add_f32 v253, v253, v222
    v_add_f32 v253, v253, v223
    v_cvt_pk_bf16_f32 v215, v222, v223
    s_waitcnt lgkmcnt(4)
    v_mfma_f32_32x32x16_bf16 v[96:111], v[232:235], v[192:195], v[96:111]
    ds_read_b64_tr_b16 v[232:233], v244 offset:43008
    ds_read_b64_tr_b16 v[234:235], v244 offset:46080
    v_max3_f32 v254, v176, v177, v178
    v_max3_f32 v254, v254, v179, v180
    v_max3_f32 v254, v254, v181, v182
    v_mfma_f32_32x32x16_bf16 a[176:191], v[236:239], v[192:195], a[176:191]
    ds_read_b64_tr_b16 v[236:237], v245 offset:43008
    ds_read_b64_tr_b16 v[238:239], v245 offset:46080
    v_mbcnt_lo_u32_b32 v216, -1, 0
    s_add_u32 s32, s39, 49152
    v_mbcnt_hi_u32_b32 v216, -1, v216
    v_lshlrev_b32 v216, 4, v216
    v_xor_b32 v216, s32, v216
    ds_read_b128 v[220:223], v216 offset:10240
    ds_read_b128 v[216:219], v216 offset:4096
    s_waitcnt lgkmcnt(6)
    v_mfma_f32_32x32x16_bf16 v[112:127], v[224:227], v[192:195], v[112:127]
    ds_read_b64_tr_b16 v[224:225], v244 offset:44032
    ds_read_b64_tr_b16 v[226:227], v244 offset:47104
    v_max3_f32 v254, v254, v183, v184
    v_max3_f32 v254, v254, v185, v186
    v_max3_f32 v254, v254, v187, v188
    v_max3_f32 v254, v254, v189, v190
    v_mfma_f32_32x32x16_bf16 a[192:207], v[228:231], v[192:195], a[192:207]
    ds_read_b64_tr_b16 v[228:229], v245 offset:44032
    ds_read_b64_tr_b16 v[230:231], v245 offset:47104
    v_max_f32 v254, v254, v191
    v_fma_f32 v255, v254, s29, -v248
    v_cmp_lt_f32 vcc, s31, v255
    s_waitcnt lgkmcnt(6)
    v_mfma_f32_32x32x16_bf16 v[64:79], v[232:235], v[196:199], v[64:79]
    ds_read_b64_tr_b16 v[232:233], v244 offset:45056
    ds_read_b64_tr_b16 v[234:235], v244 offset:48128
    s_add_u32 s32, s28, 27648
    s_waitcnt lgkmcnt(6)
    buffer_store_dwordx4 v[216:219], v246, s[20:23], s32 offen offset:128 nt
    v_mfma_f32_32x32x16_bf16 v[80:95], v[236:239], v[196:199], v[80:95]
    ds_read_b64_tr_b16 v[236:237], v245 offset:45056
    ds_read_b64_tr_b16 v[238:239], v245 offset:48128
    s_add_u32 s32, s28, 33792
    buffer_store_dwordx4 v[220:223], v246, s[20:23], s32 offen offset:128 nt
    s_waitcnt lgkmcnt(4)
    v_mfma_f32_32x32x16_bf16 v[96:111], v[224:227], v[196:199], v[96:111]
    ds_read_b128 v[224:227], v240 offset:49152
    s_cbranch_vccnz L_slow30
L_ret30:
    v_fma_f32 v176, v176, s29, -v248
    v_fma_f32 v177, v177, s29, -v248
    v_mfma_f32_32x32x16_bf16 a[176:191], v[228:231], v[196:199], a[176:191]
    ds_read_b128 v[228:231], v241 offset:49152
    v_exp_f32 v176, v176
    v_exp_f32 v177, v177
    s_waitcnt lgkmcnt(2)
    v_mfma_f32_32x32x16_bf16 v[112:127], v[232:235], v[196:199], v[112:127]
    ds_read_b128 v[232:235], v242 offset:49152
    v_fma_f32 v178, v178, s29, -v248
    v_fma_f32 v179, v179, s29, -v248
    v_exp_f32 v178, v178
    v_mfma_f32_32x32x16_bf16 a[192:207], v[236:239], v[196:199], a[192:207]
    ds_read_b128 v[236:239], v243 offset:49152
    v_exp_f32 v179, v179
    v_add_f32 v251, v251, v176
    s_waitcnt lgkmcnt(2)
    v_mfma_f32_32x32x16_bf16 v[192:207], v[224:227], a[48:51], 0
    ds_read_b128 v[224:227], v240 offset:50176
    v_add_f32 v251, v251, v177
    v_cvt_pk_bf16_f32 v176, v176, v177
    v_fma_f32 v180, v180, s29, -v248
    v_fma_f32 v181, v181, s29, -v248
    v_mfma_f32_32x32x16_bf16 v[192:207], v[228:231], a[52:55], v[192:207]
    ds_read_b128 v[228:231], v241 offset:50176
    v_exp_f32 v180, v180
    v_exp_f32 v181, v181
    s_waitcnt lgkmcnt(2)
    v_mfma_f32_32x32x16_bf16 v[192:207], v[232:235], a[56:59], v[192:207]
    ds_read_b128 v[232:235], v242 offset:50176
    v_add_f32 v251, v251, v178
    v_add_f32 v251, v251, v179
    v_cvt_pk_bf16_f32 v177, v178, v179
    v_fma_f32 v182, v182, s29, -v248
    v_fma_f32 v183, v183, s29, -v248
    v_mfma_f32_32x32x16_bf16 v[192:207], v[236:239], a[60:63], v[192:207]
    ds_read_b128 v[236:239], v243 offset:50176
    v_exp_f32 v182, v182
    v_exp_f32 v183, v183
    s_waitcnt lgkmcnt(2)
    v_mfma_f32_32x32x16_bf16 v[192:207], v[224:227], a[64:67], v[192:207]
    ds_read_b128 v[224:227], v240 offset:51200
    v_add_f32 v251, v251, v180
    v_add_f32 v251, v251, v181
    v_cvt_pk_bf16_f32 v178, v180, v181
    v_fma_f32 v184, v184, s29, -v248
    v_fma_f32 v185, v185, s29, -v248
    v_mfma_f32_32x32x16_bf16 v[192:207], v[228:231], a[68:71], v[192:207]
    ds_read_b128 v[228:231], v241 offset:51200
    v_exp_f32 v184, v184
    v_exp_f32 v185, v185
    s_waitcnt lgkmcnt(2)
    v_mfma_f32_32x32x16_bf16 v[192:207], v[232:235], a[72:75], v[192:207]
    ds_read_b128 v[232:235], v242 offset:51200
    v_add_f32 v251, v251, v182
    v_add_f32 v251, v251, v183
    v_cvt_pk_bf16_f32 v179, v182, v183
    v_fma_f32 v186, v186, s29, -v248
    v_mfma_f32_32x32x16_bf16 v[192:207], v[236:239], a[76:79], v[192:207]
    ds_read_b128 v[236:239], v243 offset:51200
    v_fma_f32 v187, v187, s29, -v248
    v_exp_f32 v186, v186
    v_exp_f32 v187, v187
    s_waitcnt lgkmcnt(2)
    v_mfma_f32_32x32x16_bf16 v[192:207], v[224:227], a[80:83], v[192:207]
    ds_read_b64_tr_b16 v[224:225], v244 offset:36864
    ds_read_b64_tr_b16 v[226:227], v244 offset:39936
    v_add_f32 v251, v251, v184
    v_add_f32 v251, v251, v185
    v_cvt_pk_bf16_f32 v180, v184, v185
    v_fma_f32 v188, v188, s29, -v248
    v_mfma_f32_32x32x16_bf16 v[192:207], v[228:231], a[84:87], v[192:207]
    ds_read_b64_tr_b16 v[228:229], v245 offset:36864
    ds_read_b64_tr_b16 v[230:231], v245 offset:39936
    v_fma_f32 v189, v189, s29, -v248
    v_exp_f32 v188, v188
    v_exp_f32 v189, v189
    s_waitcnt lgkmcnt(4)
    v_mfma_f32_32x32x16_bf16 v[192:207], v[232:235], a[88:91], v[192:207]
    ds_read_b64_tr_b16 v[232:233], v244 offset:37888
    ds_read_b64_tr_b16 v[234:235], v244 offset:40960
    v_add_f32 v251, v251, v186
    v_add_f32 v251, v251, v187
    v_cvt_pk_bf16_f32 v181, v186, v187
    v_fma_f32 v190, v190, s29, -v248
    v_mfma_f32_32x32x16_bf16 v[192:207], v[236:239], a[92:95], v[192:207]
    ds_read_b64_tr_b16 v[236:237], v245 offset:37888
    ds_read_b64_tr_b16 v[238:239], v245 offset:40960
    v_fma_f32 v191, v191, s29, -v248
    v_exp_f32 v190, v190
    v_exp_f32 v191, v191
    s_waitcnt lgkmcnt(4)
    v_mfma_f32_32x32x16_bf16 v[128:143], v[224:227], v[208:211], v[128:143]
    ds_read_b64_tr_b16 v[224:225], v244 offset:38912
    ds_read_b64_tr_b16 v[226:227], v244 offset:41984
    v_add_f32 v251, v251, v188
    v_add_f32 v251, v251, v189
    v_cvt_pk_bf16_f32 v182, v188, v189
    v_mfma_f32_32x32x16_bf16 v[144:159], v[228:231], v[208:211], v[144:159]
    ds_read_b64_tr_b16 v[228:229], v245 offset:38912
    ds_read_b64_tr_b16 v[230:231], v245 offset:41984
    v_add_f32 v251, v251, v190
    v_add_f32 v251, v251, v191
    v_cvt_pk_bf16_f32 v183, v190, v191
    s_waitcnt lgkmcnt(4)
    v_mfma_f32_32x32x16_bf16 v[160:175], v[232:235], v[208:211], v[160:175]
    ds_read_b64_tr_b16 v[232:233], v244 offset:43008
    ds_read_b64_tr_b16 v[234:235], v244 offset:46080
    v_max3_f32 v254, v192, v193, v194
    v_max3_f32 v254, v254, v195, v196
    v_max3_f32 v254, v254, v197, v198
    v_mfma_f32_32x32x16_bf16 a[208:223], v[236:239], v[208:211], a[208:223]
    ds_read_b64_tr_b16 v[236:237], v245 offset:43008
    ds_read_b64_tr_b16 v[238:239], v245 offset:46080
    v_max3_f32 v254, v254, v199, v200
    v_max3_f32 v254, v254, v201, v202
    v_max3_f32 v254, v254, v203, v204
    v_max3_f32 v254, v254, v205, v206
    s_waitcnt lgkmcnt(4)
    v_mfma_f32_32x32x16_bf16 a[240:255], v[224:227], v[208:211], a[240:255]
    ds_read_b64_tr_b16 v[224:225], v244 offset:44032
    ds_read_b64_tr_b16 v[226:227], v244 offset:47104
    v_max_f32 v254, v254, v207
    v_fma_f32 v255, v254, s29, -v249
    v_cmp_lt_f32 vcc, s31, v255
    v_mfma_f32_32x32x16_bf16 a[224:239], v[228:231], v[208:211], a[224:239]
    ds_read_b64_tr_b16 v[228:229], v245 offset:44032
    ds_read_b64_tr_b16 v[230:231], v245 offset:47104
    s_cbranch_vccnz L_slow32
L_ret32:
    v_fma_f32 v192, v192, s29, -v249
    v_fma_f32 v193, v193, s29, -v249
    s_waitcnt lgkmcnt(4)
    v_mfma_f32_32x32x16_bf16 v[128:143], v[232:235], v[212:215], v[128:143]
    ds_read_b64_tr_b16 v[232:233], v244 offset:45056
    ds_read_b64_tr_b16 v[234:235], v244 offset:48128
    v_exp_f32 v192, v192
    v_exp_f32 v193, v193
    v_mfma_f32_32x32x16_bf16 v[144:159], v[236:239], v[212:215], v[144:159]
    ds_read_b64_tr_b16 v[236:237], v245 offset:45056
    ds_read_b64_tr_b16 v[238:239], v245 offset:48128
    v_fma_f32 v194, v194, s29, -v249
    v_fma_f32 v195, v195, s29, -v249
    v_exp_f32 v194, v194
    s_waitcnt lgkmcnt(4)
    v_mfma_f32_32x32x16_bf16 v[160:175], v[224:227], v[212:215], v[160:175]
    ds_read_b128 v[224:227], v240 offset:49152
    v_exp_f32 v195, v195
    v_add_f32 v252, v252, v192
    v_mfma_f32_32x32x16_bf16 a[208:223], v[228:231], v[212:215], a[208:223]
    ds_read_b128 v[228:231], v241 offset:49152
    v_add_f32 v252, v252, v193
    v_cvt_pk_bf16_f32 v192, v192, v193
    v_fma_f32 v196, v196, s29, -v249
    v_fma_f32 v197, v197, s29, -v249
    s_waitcnt lgkmcnt(2)
    v_mfma_f32_32x32x16_bf16 a[240:255], v[232:235], v[212:215], a[240:255]
    ds_read_b128 v[232:235], v242 offset:49152
    v_exp_f32 v196, v196
    v_exp_f32 v197, v197
    v_mfma_f32_32x32x16_bf16 a[224:239], v[236:239], v[212:215], a[224:239]
    ds_read_b128 v[236:239], v243 offset:49152
    v_add_f32 v252, v252, v194
    v_add_f32 v252, v252, v195
    v_cvt_pk_bf16_f32 v193, v194, v195
    s_waitcnt lgkmcnt(2)
    v_mfma_f32_32x32x16_bf16 v[208:223], v[224:227], a[96:99], 0
    ds_read_b128 v[224:227], v240 offset:50176
    v_fma_f32 v198, v198, s29, -v249
    v_fma_f32 v199, v199, s29, -v249
    v_exp_f32 v198, v198
    v_mfma_f32_32x32x16_bf16 v[208:223], v[228:231], a[100:103], v[208:223]
    ds_read_b128 v[228:231], v241 offset:50176
    v_exp_f32 v199, v199
    v_add_f32 v252, v252, v196
    v_add_f32 v252, v252, v197
    v_cvt_pk_bf16_f32 v194, v196, v197
    s_waitcnt lgkmcnt(2)
    v_mfma_f32_32x32x16_bf16 v[208:223], v[232:235], a[104:107], v[208:223]
    ds_read_b128 v[232:235], v242 offset:50176
    v_fma_f32 v200, v200, s29, -v249
    v_fma_f32 v201, v201, s29, -v249
    v_exp_f32 v200, v200
    v_mfma_f32_32x32x16_bf16 v[208:223], v[236:239], a[108:111], v[208:223]
    ds_read_b128 v[236:239], v243 offset:50176
    v_mbcnt_lo_u32_b32 v184, -1, 0
    s_add_u32 s32, s38, 49152
    v_mbcnt_hi_u32_b32 v184, -1, v184
    v_lshlrev_b32 v184, 4, v184
    v_xor_b32 v184, s32, v184
    ds_read_b128 v[188:191], v184 offset:8192
    ds_read_b128 v[184:187], v184 offset:2048
    s_waitcnt lgkmcnt(4)
    v_mfma_f32_32x32x16_bf16 v[208:223], v[224:227], a[112:115], v[208:223]
    ds_read_b128 v[224:227], v240 offset:51200
    v_exp_f32 v201, v201
    v_add_f32 v252, v252, v198
    v_add_f32 v252, v252, v199
    v_cvt_pk_bf16_f32 v195, v198, v199
    v_mfma_f32_32x32x16_bf16 v[208:223], v[228:231], a[116:119], v[208:223]
    ds_read_b128 v[228:231], v241 offset:51200
    v_fma_f32 v202, v202, s29, -v249
    v_fma_f32 v203, v203, s29, -v249
    v_exp_f32 v202, v202
    s_waitcnt lgkmcnt(4)
    v_mfma_f32_32x32x16_bf16 v[208:223], v[232:235], a[120:123], v[208:223]
    ds_read_b128 v[232:235], v242 offset:51200
    s_add_u32 s32, s28, 24576
    s_waitcnt lgkmcnt(3)
    buffer_store_dwordx4 v[184:187], v246, s[20:23], s32 offen offset:256 nt
    v_mfma_f32_32x32x16_bf16 v[208:223], v[236:239], a[124:127], v[208:223]
    ds_read_b128 v[236:239], v243 offset:51200
    v_exp_f32 v203, v203
    s_add_u32 s32, s28, 30720
    buffer_store_dwordx4 v[188:191], v246, s[20:23], s32 offen offset:256 nt
    s_waitcnt lgkmcnt(2)
    v_mfma_f32_32x32x16_bf16 v[208:223], v[224:227], a[128:131], v[208:223]
    v_add_u32 v244, 0xfffe8000, v244
    v_add_u32 v245, 0xfffe8000, v245
    ds_read_b64_tr_b16 v[224:225], v244 offset:0
    ds_read_b64_tr_b16 v[226:227], v244 offset:3072
    v_add_f32 v252, v252, v200
    v_add_f32 v252, v252, v201
    v_cvt_pk_bf16_f32 v196, v200, v201
    v_fma_f32 v204, v204, s29, -v249
    v_mfma_f32_32x32x16_bf16 v[208:223], v[228:231], a[132:135], v[208:223]
    ds_read_b64_tr_b16 v[228:229], v245 offset:0
    ds_read_b64_tr_b16 v[230:231], v245 offset:3072
    v_fma_f32 v205, v205, s29, -v249
    v_exp_f32 v204, v204
    v_exp_f32 v205, v205
    s_waitcnt lgkmcnt(4)
    v_mfma_f32_32x32x16_bf16 v[208:223], v[232:235], a[136:139], v[208:223]
    ds_read_b64_tr_b16 v[232:233], v244 offset:1024
    ds_read_b64_tr_b16 v[234:235], v244 offset:4096
    v_add_f32 v252, v252, v202
    v_add_f32 v252, v252, v203
    v_cvt_pk_bf16_f32 v197, v202, v203
    v_fma_f32 v206, v206, s29, -v249
    v_mfma_f32_32x32x16_bf16 v[208:223], v[236:239], a[140:143], v[208:223]
    ds_read_b64_tr_b16 v[236:237], v245 offset:1024
    ds_read_b64_tr_b16 v[238:239], v245 offset:4096
    v_fma_f32 v207, v207, s29, -v249
    v_exp_f32 v206, v206
    v_exp_f32 v207, v207
    s_waitcnt lgkmcnt(4)
    v_mfma_f32_32x32x16_bf16 v[0:15], v[224:227], v[176:179], v[0:15]
    ds_read_b64_tr_b16 v[224:225], v244 offset:2048
    ds_read_b64_tr_b16 v[226:227], v244 offset:5120
    v_add_f32 v252, v252, v204
    v_add_f32 v252, v252, v205
    v_cvt_pk_bf16_f32 v198, v204, v205
    v_mfma_f32_32x32x16_bf16 v[16:31], v[228:231], v[176:179], v[16:31]
    ds_read_b64_tr_b16 v[228:229], v245 offset:2048
    ds_read_b64_tr_b16 v[230:231], v245 offset:5120
    v_add_f32 v252, v252, v206
    v_add_f32 v252, v252, v207
    v_cvt_pk_bf16_f32 v199, v206, v207
    s_waitcnt lgkmcnt(4)
    v_mfma_f32_32x32x16_bf16 v[32:47], v[232:235], v[176:179], v[32:47]
    ds_read_b64_tr_b16 v[232:233], v244 offset:6144
    ds_read_b64_tr_b16 v[234:235], v244 offset:9216
    v_max3_f32 v254, v208, v209, v210
    v_max3_f32 v254, v254, v211, v212
    v_max3_f32 v254, v254, v213, v214
    v_max3_f32 v254, v254, v215, v216
    v_mfma_f32_32x32x16_bf16 a[144:159], v[236:239], v[176:179], a[144:159]
    ds_read_b64_tr_b16 v[236:237], v245 offset:6144
    ds_read_b64_tr_b16 v[238:239], v245 offset:9216
    v_max3_f32 v254, v254, v217, v218
    v_max3_f32 v254, v254, v219, v220
    v_max3_f32 v254, v254, v221, v222
    v_max_f32 v254, v254, v223
    s_waitcnt lgkmcnt(4)
    v_mfma_f32_32x32x16_bf16 v[48:63], v[224:227], v[176:179], v[48:63]
    ds_read_b64_tr_b16 v[224:225], v244 offset:7168
    ds_read_b64_tr_b16 v[226:227], v244 offset:10240
    v_fma_f32 v255, v254, s29, -v250
    v_cmp_lt_f32 vcc, s31, v255
    s_cbranch_vccnz L_slow34
L_ret34:
    v_fma_f32 v208, v208, s29, -v250
    v_fma_f32 v209, v209, s29, -v250
    v_mfma_f32_32x32x16_bf16 a[160:175], v[228:231], v[176:179], a[160:175]
    ds_read_b64_tr_b16 v[228:229], v245 offset:7168
    ds_read_b64_tr_b16 v[230:231], v245 offset:10240
    v_exp_f32 v208, v208
    v_exp_f32 v209, v209
    s_waitcnt lgkmcnt(4)
    v_mfma_f32_32x32x16_bf16 v[0:15], v[232:235], v[180:183], v[0:15]
    ds_read_b64_tr_b16 v[232:233], v244 offset:8192
    ds_read_b64_tr_b16 v[234:235], v244 offset:11264
    v_fma_f32 v210, v210, s29, -v250
    v_fma_f32 v211, v211, s29, -v250
    v_exp_f32 v210, v210
    v_mfma_f32_32x32x16_bf16 v[16:31], v[236:239], v[180:183], v[16:31]
    s_waitcnt vmcnt(14)
    s_barrier
    ds_read_b64_tr_b16 v[236:237], v245 offset:8192
    ds_read_b64_tr_b16 v[238:239], v245 offset:11264
    v_exp_f32 v211, v211
    s_waitcnt lgkmcnt(4)
    v_mfma_f32_32x32x16_bf16 v[32:47], v[224:227], v[180:183], v[32:47]
    v_add_u32 v240, 0xfffeb000, v240
    v_add_u32 v241, 0xfffeb000, v241
    v_add_u32 v242, 0xfffeb000, v242
    v_add_u32 v243, 0xfffeb000, v243
    ds_read_b128 v[224:227], v240 offset:0
    v_add_f32 v253, v253, v208
    v_add_f32 v253, v253, v209
    v_cvt_pk_bf16_f32 v208, v208, v209
    v_mfma_f32_32x32x16_bf16 a[144:159], v[228:231], v[180:183], a[144:159]
    ds_read_b128 v[228:231], v241 offset:0
    v_fma_f32 v212, v212, s29, -v250
    v_fma_f32 v213, v213, s29, -v250
    v_exp_f32 v212, v212
    s_waitcnt lgkmcnt(2)
    v_mfma_f32_32x32x16_bf16 v[48:63], v[232:235], v[180:183], v[48:63]
    ds_read_b128 v[232:235], v242 offset:0
    v_exp_f32 v213, v213
    v_add_f32 v253, v253, v210
    v_add_f32 v253, v253, v211
    v_cvt_pk_bf16_f32 v209, v210, v211
    v_mfma_f32_32x32x16_bf16 a[160:175], v[236:239], v[180:183], a[160:175]
    s_add_u32 m0, s30, 110592
    s_add_u32 s33, s26, 98304
    ds_read_b128 v[236:239], v243 offset:0
    v_fma_f32 v214, v214, s29, -v250
    buffer_load_dwordx4 v246, s[12:15], s33 offen offset:0 nt lds
    s_waitcnt lgkmcnt(2)
    v_mfma_f32_32x32x16_bf16 v[176:191], v[224:227], a[0:3], 0
    ds_read_b128 v[224:227], v240 offset:1024
    v_fma_f32 v215, v215, s29, -v250
    v_exp_f32 v214, v214
    v_exp_f32 v215, v215
    v_mfma_f32_32x32x16_bf16 v[176:191], v[228:231], a[4:7], v[176:191]
    s_add_u32 m0, s30, 111488
    ds_read_b128 v[228:231], v241 offset:1024
    v_add_f32 v253, v253, v212
    v_add_f32 v253, v253, v213
    buffer_load_dwordx4 v246, s[12:15], s33 offen offset:128 nt lds
    s_waitcnt lgkmcnt(2)
    v_mfma_f32_32x32x16_bf16 v[176:191], v[232:235], a[8:11], v[176:191]
    ds_read_b128 v[232:235], v242 offset:1024
    v_cvt_pk_bf16_f32 v210, v212, v213
    v_fma_f32 v216, v216, s29, -v250
    v_fma_f32 v217, v217, s29, -v250
    v_exp_f32 v216, v216
    v_mfma_f32_32x32x16_bf16 v[176:191], v[236:239], a[12:15], v[176:191]
    s_add_u32 m0, s30, 112384
    ds_read_b128 v[236:239], v243 offset:1024
    v_mbcnt_lo_u32_b32 v200, -1, 0
    s_add_u32 s32, s39, 49152
    v_mbcnt_hi_u32_b32 v200, -1, v200
    v_lshlrev_b32 v200, 4, v200
    v_xor_b32 v200, s32, v200
    ds_read_b128 v[204:207], v200 offset:11264
    ds_read_b128 v[200:203], v200 offset:5120
    buffer_load_dwordx4 v246, s[12:15], s33 offen offset:256 nt lds
    s_waitcnt lgkmcnt(4)
    v_mfma_f32_32x32x16_bf16 v[176:191], v[224:227], a[16:19], v[176:191]
    ds_read_b128 v[224:227], v240 offset:2048
    v_exp_f32 v217, v217
    v_add_f32 v253, v253, v214
    v_add_f32 v253, v253, v215
    v_cvt_pk_bf16_f32 v211, v214, v215
    v_fma_f32 v218, v218, s29, -v250
    v_mfma_f32_32x32x16_bf16 v[176:191], v[228:231], a[20:23], v[176:191]
    s_add_u32 m0, s30, 122880
    s_add_u32 s33, s26, 98304
    ds_read_b128 v[228:231], v241 offset:2048
    v_fma_f32 v219, v219, s29, -v250
    buffer_load_dwordx4 v247, s[16:19], s33 offen offset:0 nt lds
    s_waitcnt lgkmcnt(4)
    v_mfma_f32_32x32x16_bf16 v[176:191], v[232:235], a[24:27], v[176:191]
    ds_read_b128 v[232:235], v242 offset:2048
    v_exp_f32 v218, v218
    s_add_u32 s32, s28, 27648
    s_waitcnt lgkmcnt(3)
    buffer_store_dwordx4 v[200:203], v246, s[20:23], s32 offen offset:256 nt
    v_mfma_f32_32x32x16_bf16 v[176:191], v[236:239], a[28:31], v[176:191]
    s_add_u32 m0, s30, 123776
    ds_read_b128 v[236:239], v243 offset:2048
    s_add_u32 s32, s28, 33792
    buffer_store_dwordx4 v[204:207], v246, s[20:23], s32 offen offset:256 nt
    buffer_load_dwordx4 v247, s[16:19], s33 offen offset:128 nt lds
    s_waitcnt lgkmcnt(2)
    v_mfma_f32_32x32x16_bf16 v[176:191], v[224:227], a[32:35], v[176:191]
    ds_read_b64_tr_b16 v[224:225], v244 offset:0
    ds_read_b64_tr_b16 v[226:227], v244 offset:3072
    v_exp_f32 v219, v219
    v_add_f32 v253, v253, v216
    v_add_f32 v253, v253, v217
    v_cvt_pk_bf16_f32 v212, v216, v217
    v_mfma_f32_32x32x16_bf16 v[176:191], v[228:231], a[36:39], v[176:191]
    s_add_u32 m0, s30, 124672
    ds_read_b64_tr_b16 v[228:229], v245 offset:0
    ds_read_b64_tr_b16 v[230:231], v245 offset:3072
    v_fma_f32 v220, v220, s29, -v250
    v_fma_f32 v221, v221, s29, -v250
    buffer_load_dwordx4 v247, s[16:19], s33 offen offset:256 nt lds
    s_waitcnt lgkmcnt(4)
    v_mfma_f32_32x32x16_bf16 v[176:191], v[232:235], a[40:43], v[176:191]
    ds_read_b64_tr_b16 v[232:233], v244 offset:1024
    ds_read_b64_tr_b16 v[234:235], v244 offset:4096
    v_exp_f32 v220, v220
    v_exp_f32 v221, v221
    v_add_f32 v253, v253, v218
    v_mfma_f32_32x32x16_bf16 v[176:191], v[236:239], a[44:47], v[176:191]
    ds_read_b64_tr_b16 v[236:237], v245 offset:1024
    ds_read_b64_tr_b16 v[238:239], v245 offset:4096
    v_add_f32 v253, v253, v219
    v_cvt_pk_bf16_f32 v213, v218, v219
    v_fma_f32 v222, v222, s29, -v250
    v_fma_f32 v223, v223, s29, -v250
    v_exp_f32 v222, v222
    s_add_u32 s28, s26, s35
    s_mov_b32 s22, 150994944
    s_waitcnt lgkmcnt(4)
    v_mfma_f32_32x32x16_bf16 v[64:79], v[224:227], v[192:195], v[64:79]
    ds_read_b64_tr_b16 v[224:225], v244 offset:2048
    ds_read_b64_tr_b16 v[226:227], v244 offset:5120
    v_exp_f32 v223, v223
    v_add_f32 v253, v253, v220
    v_add_f32 v253, v253, v221
    v_mfma_f32_32x32x16_bf16 v[80:95], v[228:231], v[192:195], v[80:95]
    ds_read_b64_tr_b16 v[228:229], v245 offset:2048
    ds_read_b64_tr_b16 v[230:231], v245 offset:5120
    v_cvt_pk_bf16_f32 v214, v220, v221
    v_add_f32 v253, v253, v222
    v_add_f32 v253, v253, v223
    v_cvt_pk_bf16_f32 v215, v222, v223
    s_waitcnt lgkmcnt(4)
    v_mfma_f32_32x32x16_bf16 v[96:111], v[232:235], v[192:195], v[96:111]
    ds_read_b64_tr_b16 v[232:233], v244 offset:6144
    ds_read_b64_tr_b16 v[234:235], v244 offset:9216
    v_max3_f32 v254, v176, v177, v178
    v_max3_f32 v254, v254, v179, v180
    v_max3_f32 v254, v254, v181, v182
    v_mfma_f32_32x32x16_bf16 a[176:191], v[236:239], v[192:195], a[176:191]
    ds_read_b64_tr_b16 v[236:237], v245 offset:6144
    ds_read_b64_tr_b16 v[238:239], v245 offset:9216
    v_max3_f32 v254, v254, v183, v184
    v_max3_f32 v254, v254, v185, v186
    v_max3_f32 v254, v254, v187, v188
    s_waitcnt lgkmcnt(4)
    v_mfma_f32_32x32x16_bf16 v[112:127], v[224:227], v[192:195], v[112:127]
    ds_read_b64_tr_b16 v[224:225], v244 offset:7168
    ds_read_b64_tr_b16 v[226:227], v244 offset:10240
    v_max3_f32 v254, v254, v189, v190
    v_max_f32 v254, v254, v191
    v_fma_f32 v255, v254, s29, -v248
    v_mfma_f32_32x32x16_bf16 a[192:207], v[228:231], v[192:195], a[192:207]
    ds_read_b64_tr_b16 v[228:229], v245 offset:7168
    ds_read_b64_tr_b16 v[230:231], v245 offset:10240
    v_cmp_lt_f32 vcc, s31, v255
    s_cbranch_vccnz L_slow36
L_ret36:
    v_fma_f32 v176, v176, s29, -v248
    s_waitcnt lgkmcnt(4)
    v_mfma_f32_32x32x16_bf16 v[64:79], v[232:235], v[196:199], v[64:79]
    ds_read_b64_tr_b16 v[232:233], v244 offset:8192
    ds_read_b64_tr_b16 v[234:235], v244 offset:11264
    v_fma_f32 v177, v177, s29, -v248
    v_exp_f32 v176, v176
    v_mfma_f32_32x32x16_bf16 v[80:95], v[236:239], v[196:199], v[80:95]
    ds_read_b64_tr_b16 v[236:237], v245 offset:8192
    ds_read_b64_tr_b16 v[238:239], v245 offset:11264
    v_exp_f32 v177, v177
    v_fma_f32 v178, v178, s29, -v248
    s_waitcnt lgkmcnt(4)
    v_mfma_f32_32x32x16_bf16 v[96:111], v[224:227], v[196:199], v[96:111]
    ds_read_b128 v[224:227], v240 offset:0
    v_fma_f32 v179, v179, s29, -v248
    v_exp_f32 v178, v178
    v_mfma_f32_32x32x16_bf16 a[176:191], v[228:231], v[196:199], a[176:191]
    ds_read_b128 v[228:231], v241 offset:0
    v_exp_f32 v179, v179
    v_add_f32 v251, v251, v176
    s_waitcnt lgkmcnt(2)
    v_mfma_f32_32x32x16_bf16 v[112:127], v[232:235], v[196:199], v[112:127]
    ds_read_b128 v[232:235], v242 offset:0
    v_add_f32 v251, v251, v177
    v_cvt_pk_bf16_f32 v176, v176, v177
    v_fma_f32 v180, v180, s29, -v248
    v_mfma_f32_32x32x16_bf16 a[192:207], v[236:239], v[196:199], a[192:207]
    ds_read_b128 v[236:239], v243 offset:0
    v_fma_f32 v181, v181, s29, -v248
    v_exp_f32 v180, v180
    s_waitcnt lgkmcnt(2)
    v_mfma_f32_32x32x16_bf16 v[192:207], v[224:227], a[48:51], 0
    ds_read_b128 v[224:227], v240 offset:1024
    v_exp_f32 v181, v181
    v_add_f32 v251, v251, v178
    v_add_f32 v251, v251, v179
    v_mfma_f32_32x32x16_bf16 v[192:207], v[228:231], a[52:55], v[192:207]
    ds_read_b128 v[228:231], v241 offset:1024
    v_cvt_pk_bf16_f32 v177, v178, v179
    v_fma_f32 v182, v182, s29, -v248
    v_fma_f32 v183, v183, s29, -v248
    s_waitcnt lgkmcnt(2)
    v_mfma_f32_32x32x16_bf16 v[192:207], v[232:235], a[56:59], v[192:207]
    ds_read_b128 v[232:235], v242 offset:1024
    v_exp_f32 v182, v182
    v_exp_f32 v183, v183
    v_mfma_f32_32x32x16_bf16 v[192:207], v[236:239], a[60:63], v[192:207]
    ds_read_b128 v[236:239], v243 offset:1024
    v_add_f32 v251, v251, v180
    v_add_f32 v251, v251, v181
    v_cvt_pk_bf16_f32 v178, v180, v181
    v_fma_f32 v184, v184, s29, -v248
    s_waitcnt lgkmcnt(2)
    v_mfma_f32_32x32x16_bf16 v[192:207], v[224:227], a[64:67], v[192:207]
    ds_read_b128 v[224:227], v240 offset:2048
    v_fma_f32 v185, v185, s29, -v248
    v_exp_f32 v184, v184
    v_exp_f32 v185, v185
    v_mfma_f32_32x32x16_bf16 v[192:207], v[228:231], a[68:71], v[192:207]
    ds_read_b128 v[228:231], v241 offset:2048
    v_add_f32 v251, v251, v182
    v_add_f32 v251, v251, v183
    v_cvt_pk_bf16_f32 v179, v182, v183
    s_waitcnt lgkmcnt(2)
    v_mfma_f32_32x32x16_bf16 v[192:207], v[232:235], a[72:75], v[192:207]
    ds_read_b128 v[232:235], v242 offset:2048
    v_fma_f32 v186, v186, s29, -v248
    v_fma_f32 v187, v187, s29, -v248
    v_exp_f32 v186, v186
    v_mfma_f32_32x32x16_bf16 v[192:207], v[236:239], a[76:79], v[192:207]
    ds_read_b128 v[236:239], v243 offset:2048
    v_exp_f32 v187, v187
    v_add_f32 v251, v251, v184
    v_add_f32 v251, v251, v185
    s_waitcnt lgkmcnt(2)
    v_mfma_f32_32x32x16_bf16 v[192:207], v[224:227], a[80:83], v[192:207]
    ds_read_b64_tr_b16 v[224:225], v244 offset:0
    ds_read_b64_tr_b16 v[226:227], v244 offset:3072
    v_cvt_pk_bf16_f32 v180, v184, v185
    v_fma_f32 v188, v188, s29, -v248
    v_fma_f32 v189, v189, s29, -v248
    v_exp_f32 v188, v188
    v_mfma_f32_32x32x16_bf16 v[192:207], v[228:231], a[84:87], v[192:207]
    ds_read_b64_tr_b16 v[228:229], v245 offset:0
    ds_read_b64_tr_b16 v[230:231], v245 offset:3072
    v_exp_f32 v189, v189
    v_add_f32 v251, v251, v186
    s_waitcnt lgkmcnt(4)
    v_mfma_f32_32x32x16_bf16 v[192:207], v[232:235], a[88:91], v[192:207]
    ds_read_b64_tr_b16 v[232:233], v244 offset:1024
    ds_read_b64_tr_b16 v[234:235], v244 offset:4096
    v_add_f32 v251, v251, v187
    v_cvt_pk_bf16_f32 v181, v186, v187
    v_fma_f32 v190, v190, s29, -v248
    v_fma_f32 v191, v191, s29, -v248
    v_mfma_f32_32x32x16_bf16 v[192:207], v[236:239], a[92:95], v[192:207]
    ds_read_b64_tr_b16 v[236:237], v245 offset:1024
    ds_read_b64_tr_b16 v[238:239], v245 offset:4096
    v_exp_f32 v190, v190
    v_exp_f32 v191, v191
    s_waitcnt lgkmcnt(4)
    v_mfma_f32_32x32x16_bf16 v[128:143], v[224:227], v[208:211], v[128:143]
    ds_read_b64_tr_b16 v[224:225], v244 offset:2048
    ds_read_b64_tr_b16 v[226:227], v244 offset:5120
    v_add_f32 v251, v251, v188
    v_add_f32 v251, v251, v189
    v_cvt_pk_bf16_f32 v182, v188, v189
    v_mfma_f32_32x32x16_bf16 v[144:159], v[228:231], v[208:211], v[144:159]
    ds_read_b64_tr_b16 v[228:229], v245 offset:2048
    ds_read_b64_tr_b16 v[230:231], v245 offset:5120
    v_add_f32 v251, v251, v190
    v_add_f32 v251, v251, v191
    v_cvt_pk_bf16_f32 v183, v190, v191
    s_waitcnt lgkmcnt(4)
    v_mfma_f32_32x32x16_bf16 v[160:175], v[232:235], v[208:211], v[160:175]
    ds_read_b64_tr_b16 v[232:233], v244 offset:6144
    ds_read_b64_tr_b16 v[234:235], v244 offset:9216
    v_max3_f32 v254, v192, v193, v194
    v_max3_f32 v254, v254, v195, v196
    v_max3_f32 v254, v254, v197, v198
    v_mfma_f32_32x32x16_bf16 a[208:223], v[236:239], v[208:211], a[208:223]
    ds_read_b64_tr_b16 v[236:237], v245 offset:6144
    ds_read_b64_tr_b16 v[238:239], v245 offset:9216
    v_max3_f32 v254, v254, v199, v200
    v_max3_f32 v254, v254, v201, v202
    v_max3_f32 v254, v254, v203, v204
    s_waitcnt lgkmcnt(4)
    v_mfma_f32_32x32x16_bf16 a[240:255], v[224:227], v[208:211], a[240:255]
    ds_read_b64_tr_b16 v[224:225], v244 offset:7168
    ds_read_b64_tr_b16 v[226:227], v244 offset:10240
    v_max3_f32 v254, v254, v205, v206
    v_max_f32 v254, v254, v207
    v_fma_f32 v255, v254, s29, -v249
    v_mfma_f32_32x32x16_bf16 a[224:239], v[228:231], v[208:211], a[224:239]
    ds_read_b64_tr_b16 v[228:229], v245 offset:7168
    ds_read_b64_tr_b16 v[230:231], v245 offset:10240
    v_cmp_lt_f32 vcc, s31, v255
    s_cbranch_vccnz L_slow38
L_ret38:
    v_fma_f32 v192, v192, s29, -v249
    s_waitcnt lgkmcnt(4)
    v_mfma_f32_32x32x16_bf16 v[128:143], v[232:235], v[212:215], v[128:143]
    ds_read_b64_tr_b16 v[232:233], v244 offset:8192
    ds_read_b64_tr_b16 v[234:235], v244 offset:11264
    v_fma_f32 v193, v193, s29, -v249
    v_exp_f32 v192, v192
    v_mfma_f32_32x32x16_bf16 v[144:159], v[236:239], v[212:215], v[144:159]
    ds_read_b64_tr_b16 v[236:237], v245 offset:8192
    ds_read_b64_tr_b16 v[238:239], v245 offset:11264
    v_exp_f32 v193, v193
    v_fma_f32 v194, v194, s29, -v249
    s_waitcnt lgkmcnt(4)
    v_mfma_f32_32x32x16_bf16 v[160:175], v[224:227], v[212:215], v[160:175]
    ds_read_b128 v[224:227], v240 offset:0
    v_fma_f32 v195, v195, s29, -v249
    v_exp_f32 v194, v194
    v_mfma_f32_32x32x16_bf16 a[208:223], v[228:231], v[212:215], a[208:223]
    ds_read_b128 v[228:231], v241 offset:0
    v_exp_f32 v195, v195
    v_add_f32 v252, v252, v192
    s_waitcnt lgkmcnt(2)
    v_mfma_f32_32x32x16_bf16 a[240:255], v[232:235], v[212:215], a[240:255]
    ds_read_b128 v[232:235], v242 offset:0
    v_add_f32 v252, v252, v193
    v_cvt_pk_bf16_f32 v192, v192, v193
    v_fma_f32 v196, v196, s29, -v249
    v_mfma_f32_32x32x16_bf16 a[224:239], v[236:239], v[212:215], a[224:239]
    ds_read_b128 v[236:239], v243 offset:0
    v_fma_f32 v197, v197, s29, -v249
    v_exp_f32 v196, v196
    s_waitcnt lgkmcnt(2)
    v_mfma_f32_32x32x16_bf16 v[208:223], v[224:227], a[96:99], 0
    ds_read_b128 v[224:227], v240 offset:1024
    v_exp_f32 v197, v197
    v_add_f32 v252, v252, v194
    v_add_f32 v252, v252, v195
    v_mfma_f32_32x32x16_bf16 v[208:223], v[228:231], a[100:103], v[208:223]
    ds_read_b128 v[228:231], v241 offset:1024
    v_cvt_pk_bf16_f32 v193, v194, v195
    v_fma_f32 v198, v198, s29, -v249
    v_fma_f32 v199, v199, s29, -v249
    s_waitcnt lgkmcnt(2)
    v_mfma_f32_32x32x16_bf16 v[208:223], v[232:235], a[104:107], v[208:223]
    ds_read_b128 v[232:235], v242 offset:1024
    v_exp_f32 v198, v198
    v_exp_f32 v199, v199
    v_mfma_f32_32x32x16_bf16 v[208:223], v[236:239], a[108:111], v[208:223]
    ds_read_b128 v[236:239], v243 offset:1024
    v_add_f32 v252, v252, v196
    v_add_f32 v252, v252, v197
    v_cvt_pk_bf16_f32 v194, v196, v197
    v_fma_f32 v200, v200, s29, -v249
    s_waitcnt lgkmcnt(2)
    v_mfma_f32_32x32x16_bf16 v[208:223], v[224:227], a[112:115], v[208:223]
    ds_read_b128 v[224:227], v240 offset:2048
    v_fma_f32 v201, v201, s29, -v249
    v_exp_f32 v200, v200
    v_exp_f32 v201, v201
    v_mfma_f32_32x32x16_bf16 v[208:223], v[228:231], a[116:119], v[208:223]
    ds_read_b128 v[228:231], v241 offset:2048
    v_add_f32 v252, v252, v198
    v_add_f32 v252, v252, v199
    v_cvt_pk_bf16_f32 v195, v198, v199
    s_waitcnt lgkmcnt(2)
    v_mfma_f32_32x32x16_bf16 v[208:223], v[232:235], a[120:123], v[208:223]
    ds_read_b128 v[232:235], v242 offset:2048
    v_fma_f32 v202, v202, s29, -v249
    v_fma_f32 v203, v203, s29, -v249
    v_exp_f32 v202, v202
    v_mfma_f32_32x32x16_bf16 v[208:223], v[236:239], a[124:127], v[208:223]
    ds_read_b128 v[236:239], v243 offset:2048
    v_exp_f32 v203, v203
    v_add_f32 v252, v252, v200
    v_add_f32 v252, v252, v201
    s_waitcnt lgkmcnt(2)
    v_mfma_f32_32x32x16_bf16 v[208:223], v[224:227], a[128:131], v[208:223]
    ds_read_b64_tr_b16 v[224:225], v244 offset:24576
    ds_read_b64_tr_b16 v[226:227], v244 offset:27648
    v_cvt_pk_bf16_f32 v196, v200, v201
    v_fma_f32 v204, v204, s29, -v249
    v_fma_f32 v205, v205, s29, -v249
    v_exp_f32 v204, v204
    v_mfma_f32_32x32x16_bf16 v[208:223], v[228:231], a[132:135], v[208:223]
    ds_read_b64_tr_b16 v[228:229], v245 offset:24576
    ds_read_b64_tr_b16 v[230:231], v245 offset:27648
    v_exp_f32 v205, v205
    v_add_f32 v252, v252, v202
    s_waitcnt lgkmcnt(4)
    v_mfma_f32_32x32x16_bf16 v[208:223], v[232:235], a[136:139], v[208:223]
    ds_read_b64_tr_b16 v[232:233], v244 offset:25600
    ds_read_b64_tr_b16 v[234:235], v244 offset:28672
    v_add_f32 v252, v252, v203
    v_cvt_pk_bf16_f32 v197, v202, v203
    v_fma_f32 v206, v206, s29, -v249
    v_fma_f32 v207, v207, s29, -v249
    v_mfma_f32_32x32x16_bf16 v[208:223], v[236:239], a[140:143], v[208:223]
    ds_read_b64_tr_b16 v[236:237], v245 offset:25600
    ds_read_b64_tr_b16 v[238:239], v245 offset:28672
    v_exp_f32 v206, v206
    v_exp_f32 v207, v207
    s_waitcnt lgkmcnt(4)
    v_mfma_f32_32x32x16_bf16 v[0:15], v[224:227], v[176:179], v[0:15]
    ds_read_b64_tr_b16 v[224:225], v244 offset:26624
    ds_read_b64_tr_b16 v[226:227], v244 offset:29696
    v_add_f32 v252, v252, v204
    v_add_f32 v252, v252, v205
    v_cvt_pk_bf16_f32 v198, v204, v205
    v_mfma_f32_32x32x16_bf16 v[16:31], v[228:231], v[176:179], v[16:31]
    ds_read_b64_tr_b16 v[228:229], v245 offset:26624
    ds_read_b64_tr_b16 v[230:231], v245 offset:29696
    v_add_f32 v252, v252, v206
    v_add_f32 v252, v252, v207
    v_cvt_pk_bf16_f32 v199, v206, v207
    s_waitcnt lgkmcnt(4)
    v_mfma_f32_32x32x16_bf16 v[32:47], v[232:235], v[176:179], v[32:47]
    ds_read_b64_tr_b16 v[232:233], v244 offset:30720
    ds_read_b64_tr_b16 v[234:235], v244 offset:33792
    v_max3_f32 v254, v208, v209, v210
    v_max3_f32 v254, v254, v211, v212
    v_max3_f32 v254, v254, v213, v214
    v_max3_f32 v254, v254, v215, v216
    v_mfma_f32_32x32x16_bf16 a[144:159], v[236:239], v[176:179], a[144:159]
    ds_read_b64_tr_b16 v[236:237], v245 offset:30720
    ds_read_b64_tr_b16 v[238:239], v245 offset:33792
    v_max3_f32 v254, v254, v217, v218
    v_max3_f32 v254, v254, v219, v220
    v_max3_f32 v254, v254, v221, v222
    v_max_f32 v254, v254, v223
    s_waitcnt lgkmcnt(4)
    v_mfma_f32_32x32x16_bf16 v[48:63], v[224:227], v[176:179], v[48:63]
    ds_read_b64_tr_b16 v[224:225], v244 offset:31744
    ds_read_b64_tr_b16 v[226:227], v244 offset:34816
    v_fma_f32 v255, v254, s29, -v250
    v_cmp_lt_f32 vcc, s31, v255
    s_cbranch_vccnz L_slow40
L_ret40:
    v_fma_f32 v208, v208, s29, -v250
    v_mfma_f32_32x32x16_bf16 a[160:175], v[228:231], v[176:179], a[160:175]
    ds_read_b64_tr_b16 v[228:229], v245 offset:31744
    ds_read_b64_tr_b16 v[230:231], v245 offset:34816
    v_fma_f32 v209, v209, s29, -v250
    v_exp_f32 v208, v208
    s_waitcnt lgkmcnt(4)
    v_mfma_f32_32x32x16_bf16 v[0:15], v[232:235], v[180:183], v[0:15]
    ds_read_b64_tr_b16 v[232:233], v244 offset:32768
    ds_read_b64_tr_b16 v[234:235], v244 offset:35840
    v_exp_f32 v209, v209
    v_fma_f32 v210, v210, s29, -v250
    v_fma_f32 v211, v211, s29, -v250
    v_mfma_f32_32x32x16_bf16 v[16:31], v[236:239], v[180:183], v[16:31]
    s_waitcnt vmcnt(12)
    s_barrier
    ds_read_b64_tr_b16 v[236:237], v245 offset:32768
    ds_read_b64_tr_b16 v[238:239], v245 offset:35840
    v_exp_f32 v210, v210
    s_waitcnt lgkmcnt(4)
    v_mfma_f32_32x32x16_bf16 v[32:47], v[224:227], v[180:183], v[32:47]
    ds_read_b128 v[224:227], v240 offset:24576
    v_exp_f32 v211, v211
    v_add_f32 v253, v253, v208
    v_mfma_f32_32x32x16_bf16 a[144:159], v[228:231], v[180:183], a[144:159]
    ds_read_b128 v[228:231], v241 offset:24576
    v_add_f32 v253, v253, v209
    v_cvt_pk_bf16_f32 v208, v208, v209
    v_fma_f32 v212, v212, s29, -v250
    v_fma_f32 v213, v213, s29, -v250
    s_waitcnt lgkmcnt(2)
    v_mfma_f32_32x32x16_bf16 v[48:63], v[232:235], v[180:183], v[48:63]
    ds_read_b128 v[232:235], v242 offset:24576
    v_exp_f32 v212, v212
    v_exp_f32 v213, v213
    v_mfma_f32_32x32x16_bf16 a[160:175], v[236:239], v[180:183], a[160:175]
    s_add_u32 m0, s30, 135168
    s_add_u32 s33, s26, 110592
    ds_read_b128 v[236:239], v243 offset:24576
    buffer_load_dwordx4 v246, s[12:15], s33 offen offset:0 nt lds
    s_waitcnt lgkmcnt(2)
    v_mfma_f32_32x32x16_bf16 v[176:191], v[224:227], a[0:3], 0
    ds_read_b128 v[224:227], v240 offset:25600
    v_add_f32 v253, v253, v210
    v_add_f32 v253, v253, v211
    v_cvt_pk_bf16_f32 v209, v210, v211
    v_fma_f32 v214, v214, s29, -v250
    v_fma_f32 v215, v215, s29, -v250
    v_mfma_f32_32x32x16_bf16 v[176:191], v[228:231], a[4:7], v[176:191]
    s_add_u32 m0, s30, 136064
    ds_read_b128 v[228:231], v241 offset:25600
    v_exp_f32 v214, v214
    buffer_load_dwordx4 v246, s[12:15], s33 offen offset:128 nt lds
    s_waitcnt lgkmcnt(2)
    v_mfma_f32_32x32x16_bf16 v[176:191], v[232:235], a[8:11], v[176:191]
    ds_read_b128 v[232:235], v242 offset:25600
    v_exp_f32 v215, v215
    v_add_f32 v253, v253, v212
    v_add_f32 v253, v253, v213
    v_cvt_pk_bf16_f32 v210, v212, v213
    v_mfma_f32_32x32x16_bf16 v[176:191], v[236:239], a[12:15], v[176:191]
    s_add_u32 m0, s30, 136960
    ds_read_b128 v[236:239], v243 offset:25600
    v_fma_f32 v216, v216, s29, -v250
    v_fma_f32 v217, v217, s29, -v250
    buffer_load_dwordx4 v246, s[12:15], s33 offen offset:256 nt lds
    s_waitcnt lgkmcnt(2)
    v_mfma_f32_32x32x16_bf16 v[176:191], v[224:227], a[16:19], v[176:191]
    ds_read_b128 v[224:227], v240 offset:26624
    v_exp_f32 v216, v216
    v_exp_f32 v217, v217
    v_add_f32 v253, v253, v214
    v_mfma_f32_32x32x16_bf16 v[176:191], v[228:231], a[20:23], v[176:191]
    s_add_u32 m0, s30, 147456
    s_add_u32 s33, s26, 110592
    ds_read_b128 v[228:231], v241 offset:26624
    v_add_f32 v253, v253, v215
    buffer_load_dwordx4 v247, s[16:19], s33 offen offset:0 nt lds
    s_waitcnt lgkmcnt(2)
    v_mfma_f32_32x32x16_bf16 v[176:191], v[232:235], a[24:27], v[176:191]
    ds_read_b128 v[232:235], v242 offset:26624
    v_cvt_pk_bf16_f32 v211, v214, v215
    v_fma_f32 v218, v218, s29, -v250
    v_fma_f32 v219, v219, s29, -v250
    v_exp_f32 v218, v218
    v_mfma_f32_32x32x16_bf16 v[176:191], v[236:239], a[28:31], v[176:191]
    s_add_u32 m0, s30, 148352
    ds_read_b128 v[236:239], v243 offset:26624
    v_exp_f32 v219, v219
    buffer_load_dwordx4 v247, s[16:19], s33 offen offset:128 nt lds
    s_waitcnt lgkmcnt(2)
    v_mfma_f32_32x32x16_bf16 v[176:191], v[224:227], a[32:35], v[176:191]
    ds_read_b64_tr_b16 v[224:225], v244 offset:24576
    ds_read_b64_tr_b16 v[226:227], v244 offset:27648
    v_add_f32 v253, v253, v216
    v_add_f32 v253, v253, v217
    v_cvt_pk_bf16_f32 v212, v216, v217
    v_fma_f32 v220, v220, s29, -v250
    v_fma_f32 v221, v221, s29, -v250
    v_mfma_f32_32x32x16_bf16 v[176:191], v[228:231], a[36:39], v[176:191]
    s_add_u32 m0, s30, 149248
    ds_read_b64_tr_b16 v[228:229], v245 offset:24576
    ds_read_b64_tr_b16 v[230:231], v245 offset:27648
    v_exp_f32 v220, v220
    buffer_load_dwordx4 v247, s[16:19], s33 offen offset:256 nt lds
    s_waitcnt lgkmcnt(4)
    v_mfma_f32_32x32x16_bf16 v[176:191], v[232:235], a[40:43], v[176:191]
    ds_read_b64_tr_b16 v[232:233], v244 offset:25600
    ds_read_b64_tr_b16 v[234:235], v244 offset:28672
    v_exp_f32 v221, v221
    v_add_f32 v253, v253, v218
    v_add_f32 v253, v253, v219
    v_cvt_pk_bf16_f32 v213, v218, v219
    v_mfma_f32_32x32x16_bf16 v[176:191], v[236:239], a[44:47], v[176:191]
    ds_read_b64_tr_b16 v[236:237], v245 offset:25600
    ds_read_b64_tr_b16 v[238:239], v245 offset:28672
    v_fma_f32 v222, v222, s29, -v250
    v_fma_f32 v223, v223, s29, -v250
    v_exp_f32 v222, v222
    s_waitcnt lgkmcnt(4)
    v_mfma_f32_32x32x16_bf16 v[64:79], v[224:227], v[192:195], v[64:79]
    ds_read_b64_tr_b16 v[224:225], v244 offset:26624
    ds_read_b64_tr_b16 v[226:227], v244 offset:29696
    v_exp_f32 v223, v223
    v_add_f32 v253, v253, v220
    v_add_f32 v253, v253, v221
    v_mfma_f32_32x32x16_bf16 v[80:95], v[228:231], v[192:195], v[80:95]
    ds_read_b64_tr_b16 v[228:229], v245 offset:26624
    ds_read_b64_tr_b16 v[230:231], v245 offset:29696
    v_cvt_pk_bf16_f32 v214, v220, v221
    v_add_f32 v253, v253, v222
    v_add_f32 v253, v253, v223
    v_cvt_pk_bf16_f32 v215, v222, v223
    s_waitcnt lgkmcnt(4)
    v_mfma_f32_32x32x16_bf16 v[96:111], v[232:235], v[192:195], v[96:111]
    ds_read_b64_tr_b16 v[232:233], v244 offset:30720
    ds_read_b64_tr_b16 v[234:235], v244 offset:33792
    v_max3_f32 v254, v176, v177, v178
    v_max3_f32 v254, v254, v179, v180
    v_max3_f32 v254, v254, v181, v182
    v_mfma_f32_32x32x16_bf16 a[176:191], v[236:239], v[192:195], a[176:191]
    ds_read_b64_tr_b16 v[236:237], v245 offset:30720
    ds_read_b64_tr_b16 v[238:239], v245 offset:33792
    v_max3_f32 v254, v254, v183, v184
    v_max3_f32 v254, v254, v185, v186
    v_max3_f32 v254, v254, v187, v188
    s_waitcnt lgkmcnt(4)
    v_mfma_f32_32x32x16_bf16 v[112:127], v[224:227], v[192:195], v[112:127]
    ds_read_b64_tr_b16 v[224:225], v244 offset:31744
    ds_read_b64_tr_b16 v[226:227], v244 offset:34816
    v_max3_f32 v254, v254, v189, v190
    v_max_f32 v254, v254, v191
    v_fma_f32 v255, v254, s29, -v248
    v_mfma_f32_32x32x16_bf16 a[192:207], v[228:231], v[192:195], a[192:207]
    ds_read_b64_tr_b16 v[228:229], v245 offset:31744
    ds_read_b64_tr_b16 v[230:231], v245 offset:34816
    v_cmp_lt_f32 vcc, s31, v255
    s_cbranch_vccnz L_slow42
L_ret42:
    v_fma_f32 v176, v176, s29, -v248
    s_waitcnt lgkmcnt(4)
    v_mfma_f32_32x32x16_bf16 v[64:79], v[232:235], v[196:199], v[64:79]
    ds_read_b64_tr_b16 v[232:233], v244 offset:32768
    ds_read_b64_tr_b16 v[234:235], v244 offset:35840
    v_fma_f32 v177, v177, s29, -v248
    v_exp_f32 v176, v176
    v_mfma_f32_32x32x16_bf16 v[80:95], v[236:239], v[196:199], v[80:95]
    ds_read_b64_tr_b16 v[236:237], v245 offset:32768
    ds_read_b64_tr_b16 v[238:239], v245 offset:35840
    v_exp_f32 v177, v177
    v_fma_f32 v178, v178, s29, -v248
    s_waitcnt lgkmcnt(4)
    v_mfma_f32_32x32x16_bf16 v[96:111], v[224:227], v[196:199], v[96:111]
    ds_read_b128 v[224:227], v240 offset:24576
    v_fma_f32 v179, v179, s29, -v248
    v_exp_f32 v178, v178
    v_mfma_f32_32x32x16_bf16 a[176:191], v[228:231], v[196:199], a[176:191]
    ds_read_b128 v[228:231], v241 offset:24576
    v_exp_f32 v179, v179
    v_add_f32 v251, v251, v176
    s_waitcnt lgkmcnt(2)
    v_mfma_f32_32x32x16_bf16 v[112:127], v[232:235], v[196:199], v[112:127]
    ds_read_b128 v[232:235], v242 offset:24576
    v_add_f32 v251, v251, v177
    v_cvt_pk_bf16_f32 v176, v176, v177
    v_fma_f32 v180, v180, s29, -v248
    v_mfma_f32_32x32x16_bf16 a[192:207], v[236:239], v[196:199], a[192:207]
    ds_read_b128 v[236:239], v243 offset:24576
    v_fma_f32 v181, v181, s29, -v248
    v_exp_f32 v180, v180
    s_waitcnt lgkmcnt(2)
    v_mfma_f32_32x32x16_bf16 v[192:207], v[224:227], a[48:51], 0
    ds_read_b128 v[224:227], v240 offset:25600
    v_exp_f32 v181, v181
    v_add_f32 v251, v251, v178
    v_add_f32 v251, v251, v179
    v_mfma_f32_32x32x16_bf16 v[192:207], v[228:231], a[52:55], v[192:207]
    ds_read_b128 v[228:231], v241 offset:25600
    v_cvt_pk_bf16_f32 v177, v178, v179
    v_fma_f32 v182, v182, s29, -v248
    v_fma_f32 v183, v183, s29, -v248
    s_waitcnt lgkmcnt(2)
    v_mfma_f32_32x32x16_bf16 v[192:207], v[232:235], a[56:59], v[192:207]
    ds_read_b128 v[232:235], v242 offset:25600
    v_exp_f32 v182, v182
    v_exp_f32 v183, v183
    v_mfma_f32_32x32x16_bf16 v[192:207], v[236:239], a[60:63], v[192:207]
    ds_read_b128 v[236:239], v243 offset:25600
    v_add_f32 v251, v251, v180
    v_add_f32 v251, v251, v181
    v_cvt_pk_bf16_f32 v178, v180, v181
    v_fma_f32 v184, v184, s29, -v248
    s_waitcnt lgkmcnt(2)
    v_mfma_f32_32x32x16_bf16 v[192:207], v[224:227], a[64:67], v[192:207]
    ds_read_b128 v[224:227], v240 offset:26624
    v_fma_f32 v185, v185, s29, -v248
    v_exp_f32 v184, v184
    v_exp_f32 v185, v185
    v_mfma_f32_32x32x16_bf16 v[192:207], v[228:231], a[68:71], v[192:207]
    ds_read_b128 v[228:231], v241 offset:26624
    v_add_f32 v251, v251, v182
    v_add_f32 v251, v251, v183
    v_cvt_pk_bf16_f32 v179, v182, v183
    s_waitcnt lgkmcnt(2)
    v_mfma_f32_32x32x16_bf16 v[192:207], v[232:235], a[72:75], v[192:207]
    ds_read_b128 v[232:235], v242 offset:26624
    v_fma_f32 v186, v186, s29, -v248
    v_fma_f32 v187, v187, s29, -v248
    v_exp_f32 v186, v186
    v_mfma_f32_32x32x16_bf16 v[192:207], v[236:239], a[76:79], v[192:207]
    ds_read_b128 v[236:239], v243 offset:26624
    v_exp_f32 v187, v187
    v_add_f32 v251, v251, v184
    v_add_f32 v251, v251, v185
    s_waitcnt lgkmcnt(2)
    v_mfma_f32_32x32x16_bf16 v[192:207], v[224:227], a[80:83], v[192:207]
    ds_read_b64_tr_b16 v[224:225], v244 offset:24576
    ds_read_b64_tr_b16 v[226:227], v244 offset:27648
    v_cvt_pk_bf16_f32 v180, v184, v185
    v_fma_f32 v188, v188, s29, -v248
    v_fma_f32 v189, v189, s29, -v248
    v_exp_f32 v188, v188
    v_mfma_f32_32x32x16_bf16 v[192:207], v[228:231], a[84:87], v[192:207]
    ds_read_b64_tr_b16 v[228:229], v245 offset:24576
    ds_read_b64_tr_b16 v[230:231], v245 offset:27648
    v_exp_f32 v189, v189
    v_add_f32 v251, v251, v186
    s_waitcnt lgkmcnt(4)
    v_mfma_f32_32x32x16_bf16 v[192:207], v[232:235], a[88:91], v[192:207]
    ds_read_b64_tr_b16 v[232:233], v244 offset:25600
    ds_read_b64_tr_b16 v[234:235], v244 offset:28672
    v_add_f32 v251, v251, v187
    v_cvt_pk_bf16_f32 v181, v186, v187
    v_fma_f32 v190, v190, s29, -v248
    v_fma_f32 v191, v191, s29, -v248
    v_mfma_f32_32x32x16_bf16 v[192:207], v[236:239], a[92:95], v[192:207]
    ds_read_b64_tr_b16 v[236:237], v245 offset:25600
    ds_read_b64_tr_b16 v[238:239], v245 offset:28672
    v_exp_f32 v190, v190
    v_exp_f32 v191, v191
    s_waitcnt lgkmcnt(4)
    v_mfma_f32_32x32x16_bf16 v[128:143], v[224:227], v[208:211], v[128:143]
    ds_read_b64_tr_b16 v[224:225], v244 offset:26624
    ds_read_b64_tr_b16 v[226:227], v244 offset:29696
    v_add_f32 v251, v251, v188
    v_add_f32 v251, v251, v189
    v_cvt_pk_bf16_f32 v182, v188, v189
    v_mfma_f32_32x32x16_bf16 v[144:159], v[228:231], v[208:211], v[144:159]
    ds_read_b64_tr_b16 v[228:229], v245 offset:26624
    ds_read_b64_tr_b16 v[230:231], v245 offset:29696
    v_add_f32 v251, v251, v190
    v_add_f32 v251, v251, v191
    v_cvt_pk_bf16_f32 v183, v190, v191
    s_waitcnt lgkmcnt(4)
    v_mfma_f32_32x32x16_bf16 v[160:175], v[232:235], v[208:211], v[160:175]
    ds_read_b64_tr_b16 v[232:233], v244 offset:30720
    ds_read_b64_tr_b16 v[234:235], v244 offset:33792
    v_max3_f32 v254, v192, v193, v194
    v_max3_f32 v254, v254, v195, v196
    v_max3_f32 v254, v254, v197, v198
    v_mfma_f32_32x32x16_bf16 a[208:223], v[236:239], v[208:211], a[208:223]
    ds_read_b64_tr_b16 v[236:237], v245 offset:30720
    ds_read_b64_tr_b16 v[238:239], v245 offset:33792
    v_max3_f32 v254, v254, v199, v200
    v_max3_f32 v254, v254, v201, v202
    v_max3_f32 v254, v254, v203, v204
    s_waitcnt lgkmcnt(4)
    v_mfma_f32_32x32x16_bf16 a[240:255], v[224:227], v[208:211], a[240:255]
    ds_read_b64_tr_b16 v[224:225], v244 offset:31744
    ds_read_b64_tr_b16 v[226:227], v244 offset:34816
    v_max3_f32 v254, v254, v205, v206
    v_max_f32 v254, v254, v207
    v_fma_f32 v255, v254, s29, -v249
    v_mfma_f32_32x32x16_bf16 a[224:239], v[228:231], v[208:211], a[224:239]
    ds_read_b64_tr_b16 v[228:229], v245 offset:31744
    ds_read_b64_tr_b16 v[230:231], v245 offset:34816
    v_cmp_lt_f32 vcc, s31, v255
    s_cbranch_vccnz L_slow44
L_ret44:
    v_fma_f32 v192, v192, s29, -v249
    s_waitcnt lgkmcnt(4)
    v_mfma_f32_32x32x16_bf16 v[128:143], v[232:235], v[212:215], v[128:143]
    ds_read_b64_tr_b16 v[232:233], v244 offset:32768
    ds_read_b64_tr_b16 v[234:235], v244 offset:35840
    v_fma_f32 v193, v193, s29, -v249
    v_exp_f32 v192, v192
    v_mfma_f32_32x32x16_bf16 v[144:159], v[236:239], v[212:215], v[144:159]
    ds_read_b64_tr_b16 v[236:237], v245 offset:32768
    ds_read_b64_tr_b16 v[238:239], v245 offset:35840
    v_exp_f32 v193, v193
    v_fma_f32 v194, v194, s29, -v249
    s_waitcnt lgkmcnt(4)
    v_mfma_f32_32x32x16_bf16 v[160:175], v[224:227], v[212:215], v[160:175]
    ds_read_b128 v[224:227], v240 offset:24576
    v_fma_f32 v195, v195, s29, -v249
    v_exp_f32 v194, v194
    v_mfma_f32_32x32x16_bf16 a[208:223], v[228:231], v[212:215], a[208:223]
    ds_read_b128 v[228:231], v241 offset:24576
    v_exp_f32 v195, v195
    v_add_f32 v252, v252, v192
    s_waitcnt lgkmcnt(2)
    v_mfma_f32_32x32x16_bf16 a[240:255], v[232:235], v[212:215], a[240:255]
    ds_read_b128 v[232:235], v242 offset:24576
    v_add_f32 v252, v252, v193
    v_cvt_pk_bf16_f32 v192, v192, v193
    v_fma_f32 v196, v196, s29, -v249
    v_mfma_f32_32x32x16_bf16 a[224:239], v[236:239], v[212:215], a[224:239]
    ds_read_b128 v[236:239], v243 offset:24576
    v_fma_f32 v197, v197, s29, -v249
    v_exp_f32 v196, v196
    s_waitcnt lgkmcnt(2)
    v_mfma_f32_32x32x16_bf16 v[208:223], v[224:227], a[96:99], 0
    ds_read_b128 v[224:227], v240 offset:25600
    v_exp_f32 v197, v197
    v_add_f32 v252, v252, v194
    v_add_f32 v252, v252, v195
    v_mfma_f32_32x32x16_bf16 v[208:223], v[228:231], a[100:103], v[208:223]
    ds_read_b128 v[228:231], v241 offset:25600
    v_cvt_pk_bf16_f32 v193, v194, v195
    v_fma_f32 v198, v198, s29, -v249
    v_fma_f32 v199, v199, s29, -v249
    s_waitcnt lgkmcnt(2)
    v_mfma_f32_32x32x16_bf16 v[208:223], v[232:235], a[104:107], v[208:223]
    ds_read_b128 v[232:235], v242 offset:25600
    v_exp_f32 v198, v198
    v_exp_f32 v199, v199
    v_mfma_f32_32x32x16_bf16 v[208:223], v[236:239], a[108:111], v[208:223]
    ds_read_b128 v[236:239], v243 offset:25600
    v_add_f32 v252, v252, v196
    v_add_f32 v252, v252, v197
    v_cvt_pk_bf16_f32 v194, v196, v197
    v_fma_f32 v200, v200, s29, -v249
    s_waitcnt lgkmcnt(2)
    v_mfma_f32_32x32x16_bf16 v[208:223], v[224:227], a[112:115], v[208:223]
    ds_read_b128 v[224:227], v240 offset:26624
    v_fma_f32 v201, v201, s29, -v249
    v_exp_f32 v200, v200
    v_exp_f32 v201, v201
    v_mfma_f32_32x32x16_bf16 v[208:223], v[228:231], a[116:119], v[208:223]
    ds_read_b128 v[228:231], v241 offset:26624
    v_add_f32 v252, v252, v198
    v_add_f32 v252, v252, v199
    v_cvt_pk_bf16_f32 v195, v198, v199
    s_waitcnt lgkmcnt(2)
    v_mfma_f32_32x32x16_bf16 v[208:223], v[232:235], a[120:123], v[208:223]
    ds_read_b128 v[232:235], v242 offset:26624
    v_fma_f32 v202, v202, s29, -v249
    v_fma_f32 v203, v203, s29, -v249
    v_exp_f32 v202, v202
    v_mfma_f32_32x32x16_bf16 v[208:223], v[236:239], a[124:127], v[208:223]
    ds_read_b128 v[236:239], v243 offset:26624
    v_exp_f32 v203, v203
    v_add_f32 v252, v252, v200
    v_add_f32 v252, v252, v201
    s_waitcnt lgkmcnt(2)
    v_mfma_f32_32x32x16_bf16 v[208:223], v[224:227], a[128:131], v[208:223]
    v_add_u32 v244, 0x18000, v244
    v_add_u32 v245, 0x18000, v245
    ds_read_b64_tr_b16 v[224:225], v244 offset:0
    ds_read_b64_tr_b16 v[226:227], v244 offset:3072
    v_cvt_pk_bf16_f32 v196, v200, v201
    v_fma_f32 v204, v204, s29, -v249
    v_fma_f32 v205, v205, s29, -v249
    v_exp_f32 v204, v204
    v_mfma_f32_32x32x16_bf16 v[208:223], v[228:231], a[132:135], v[208:223]
    ds_read_b64_tr_b16 v[228:229], v245 offset:0
    ds_read_b64_tr_b16 v[230:231], v245 offset:3072
    v_exp_f32 v205, v205
    v_add_f32 v252, v252, v202
    s_waitcnt lgkmcnt(4)
    v_mfma_f32_32x32x16_bf16 v[208:223], v[232:235], a[136:139], v[208:223]
    ds_read_b64_tr_b16 v[232:233], v244 offset:1024
    ds_read_b64_tr_b16 v[234:235], v244 offset:4096
    v_add_f32 v252, v252, v203
    v_cvt_pk_bf16_f32 v197, v202, v203
    v_fma_f32 v206, v206, s29, -v249
    v_fma_f32 v207, v207, s29, -v249
    v_mfma_f32_32x32x16_bf16 v[208:223], v[236:239], a[140:143], v[208:223]
    ds_read_b64_tr_b16 v[236:237], v245 offset:1024
    ds_read_b64_tr_b16 v[238:239], v245 offset:4096
    v_exp_f32 v206, v206
    v_exp_f32 v207, v207
    s_waitcnt lgkmcnt(4)
    v_mfma_f32_32x32x16_bf16 v[0:15], v[224:227], v[176:179], v[0:15]
    ds_read_b64_tr_b16 v[224:225], v244 offset:2048
    ds_read_b64_tr_b16 v[226:227], v244 offset:5120
    v_add_f32 v252, v252, v204
    v_add_f32 v252, v252, v205
    v_cvt_pk_bf16_f32 v198, v204, v205
    v_mfma_f32_32x32x16_bf16 v[16:31], v[228:231], v[176:179], v[16:31]
    ds_read_b64_tr_b16 v[228:229], v245 offset:2048
    ds_read_b64_tr_b16 v[230:231], v245 offset:5120
    v_add_f32 v252, v252, v206
    v_add_f32 v252, v252, v207
    v_cvt_pk_bf16_f32 v199, v206, v207
    s_waitcnt lgkmcnt(4)
    v_mfma_f32_32x32x16_bf16 v[32:47], v[232:235], v[176:179], v[32:47]
    ds_read_b64_tr_b16 v[232:233], v244 offset:6144
    ds_read_b64_tr_b16 v[234:235], v244 offset:9216
    v_max3_f32 v254, v208, v209, v210
    v_max3_f32 v254, v254, v211, v212
    v_max3_f32 v254, v254, v213, v214
    v_mfma_f32_32x32x16_bf16 a[144:159], v[236:239], v[176:179], a[144:159]
    ds_read_b64_tr_b16 v[236:237], v245 offset:6144
    ds_read_b64_tr_b16 v[238:239], v245 offset:9216
    v_max3_f32 v254, v254, v215, v216
    v_max3_f32 v254, v254, v217, v218
    v_max3_f32 v254, v254, v219, v220
    v_max3_f32 v254, v254, v221, v222
    s_waitcnt lgkmcnt(4)
    v_mfma_f32_32x32x16_bf16 v[48:63], v[224:227], v[176:179], v[48:63]
    ds_read_b64_tr_b16 v[224:225], v244 offset:7168
    ds_read_b64_tr_b16 v[226:227], v244 offset:10240
    v_max_f32 v254, v254, v223
    v_fma_f32 v255, v254, s29, -v250
    v_cmp_lt_f32 vcc, s31, v255
    v_mfma_f32_32x32x16_bf16 a[160:175], v[228:231], v[176:179], a[160:175]
    ds_read_b64_tr_b16 v[228:229], v245 offset:7168
    ds_read_b64_tr_b16 v[230:231], v245 offset:10240
    s_cbranch_vccnz L_slow46
L_ret46:
    v_fma_f32 v208, v208, s29, -v250
    v_fma_f32 v209, v209, s29, -v250
    s_waitcnt lgkmcnt(4)
    v_mfma_f32_32x32x16_bf16 v[0:15], v[232:235], v[180:183], v[0:15]
    ds_read_b64_tr_b16 v[232:233], v244 offset:8192
    ds_read_b64_tr_b16 v[234:235], v244 offset:11264
    v_exp_f32 v208, v208
    v_exp_f32 v209, v209
    v_mfma_f32_32x32x16_bf16 v[16:31], v[236:239], v[180:183], v[16:31]
    s_waitcnt vmcnt(6)
    s_barrier
    s_add_u32 m0, s30, 0
    s_add_u32 s33, s27, 0
    ds_read_b64_tr_b16 v[236:237], v245 offset:8192
    ds_read_b64_tr_b16 v[238:239], v245 offset:11264
    buffer_load_dwordx4 v246, s[64:67], s33 offen offset:0 nt lds
    s_waitcnt lgkmcnt(4)
    v_mfma_f32_32x32x16_bf16 v[32:47], v[224:227], v[180:183], v[32:47]
    v_add_u32 v240, 0x18000, v240
    v_add_u32 v241, 0x18000, v241
    v_add_u32 v242, 0x18000, v242
    v_add_u32 v243, 0x18000, v243
    ds_read_b128 v[224:227], v240 offset:0
    v_fma_f32 v210, v210, s29, -v250
    v_fma_f32 v211, v211, s29, -v250
    v_exp_f32 v210, v210
    v_mfma_f32_32x32x16_bf16 a[144:159], v[228:231], v[180:183], a[144:159]
    ds_read_b128 v[228:231], v241 offset:0
    v_exp_f32 v211, v211
    s_waitcnt lgkmcnt(2)
    v_mfma_f32_32x32x16_bf16 v[48:63], v[232:235], v[180:183], v[48:63]
    ds_read_b128 v[232:235], v242 offset:0
    v_add_f32 v253, v253, v208
    v_add_f32 v253, v253, v209
    v_cvt_pk_bf16_f32 v208, v208, v209
    v_fma_f32 v212, v212, s29, -v250
    v_mfma_f32_32x32x16_bf16 a[160:175], v[236:239], v[180:183], a[160:175]
    ds_read_b128 v[236:239], v243 offset:0
    v_fma_f32 v213, v213, s29, -v250
    v_exp_f32 v212, v212
    s_waitcnt lgkmcnt(2)
    v_mfma_f32_32x32x16_bf16 v[176:191], v[224:227], a[0:3], 0
    ds_read_b128 v[224:227], v240 offset:1024
    v_exp_f32 v213, v213
    v_add_f32 v253, v253, v210
    v_add_f32 v253, v253, v211
    v_mfma_f32_32x32x16_bf16 v[176:191], v[228:231], a[4:7], v[176:191]
    s_add_u32 m0, s30, 49152
    s_add_u32 s33, s27, 12288
    ds_read_b128 v[228:231], v241 offset:1024
    v_cvt_pk_bf16_f32 v209, v210, v211
    v_fma_f32 v214, v214, s29, -v250
    buffer_load_dwordx4 v246, s[64:67], s33 offen offset:0 nt lds
    s_waitcnt lgkmcnt(2)
    v_mfma_f32_32x32x16_bf16 v[176:191], v[232:235], a[8:11], v[176:191]
    ds_read_b128 v[232:235], v242 offset:1024
    v_fma_f32 v215, v215, s29, -v250
    v_exp_f32 v214, v214
    v_exp_f32 v215, v215
    v_mfma_f32_32x32x16_bf16 v[176:191], v[236:239], a[12:15], v[176:191]
    ds_read_b128 v[236:239], v243 offset:1024
    v_add_f32 v253, v253, v212
    v_add_f32 v253, v253, v213
    v_cvt_pk_bf16_f32 v210, v212, v213
    v_fma_f32 v216, v216, s29, -v250
    s_waitcnt lgkmcnt(2)
    v_mfma_f32_32x32x16_bf16 v[176:191], v[224:227], a[16:19], v[176:191]
    ds_read_b128 v[224:227], v240 offset:2048
    v_fma_f32 v217, v217, s29, -v250
    v_exp_f32 v216, v216
    v_mfma_f32_32x32x16_bf16 v[176:191], v[228:231], a[20:23], v[176:191]
    ds_read_b128 v[228:231], v241 offset:2048
    v_exp_f32 v217, v217
    v_add_f32 v253, v253, v214
    v_add_f32 v253, v253, v215
    v_cvt_pk_bf16_f32 v211, v214, v215
    s_waitcnt lgkmcnt(2)
    v_mfma_f32_32x32x16_bf16 v[176:191], v[232:235], a[24:27], v[176:191]
    ds_read_b128 v[232:235], v242 offset:2048
    v_fma_f32 v218, v218, s29, -v250
    v_fma_f32 v219, v219, s29, -v250
    v_exp_f32 v218, v218
    v_mfma_f32_32x32x16_bf16 v[176:191], v[236:239], a[28:31], v[176:191]
    ds_read_b128 v[236:239], v243 offset:2048
    v_exp_f32 v219, v219
    v_add_f32 v253, v253, v216
    v_add_f32 v253, v253, v217
    v_cvt_pk_bf16_f32 v212, v216, v217
    s_waitcnt lgkmcnt(2)
    v_mfma_f32_32x32x16_bf16 v[176:191], v[224:227], a[32:35], v[176:191]
    ds_read_b64_tr_b16 v[224:225], v244 offset:0
    ds_read_b64_tr_b16 v[226:227], v244 offset:3072
    v_fma_f32 v220, v220, s29, -v250
    v_fma_f32 v221, v221, s29, -v250
    v_exp_f32 v220, v220
    v_mfma_f32_32x32x16_bf16 v[176:191], v[228:231], a[36:39], v[176:191]
    ds_read_b64_tr_b16 v[228:229], v245 offset:0
    ds_read_b64_tr_b16 v[230:231], v245 offset:3072
    v_exp_f32 v221, v221
    v_add_f32 v253, v253, v218
    v_add_f32 v253, v253, v219
    v_cvt_pk_bf16_f32 v213, v218, v219
    s_waitcnt lgkmcnt(4)
    v_mfma_f32_32x32x16_bf16 v[176:191], v[232:235], a[40:43], v[176:191]
    ds_read_b64_tr_b16 v[232:233], v244 offset:1024
    ds_read_b64_tr_b16 v[234:235], v244 offset:4096
    v_fma_f32 v222, v222, s29, -v250
    v_fma_f32 v223, v223, s29, -v250
    v_exp_f32 v222, v222
    v_mfma_f32_32x32x16_bf16 v[176:191], v[236:239], a[44:47], v[176:191]
    ds_read_b64_tr_b16 v[236:237], v245 offset:1024
    ds_read_b64_tr_b16 v[238:239], v245 offset:4096
    v_exp_f32 v223, v223
    v_add_f32 v253, v253, v220
    v_add_f32 v253, v253, v221
    s_waitcnt lgkmcnt(4)
    v_mfma_f32_32x32x16_bf16 v[64:79], v[224:227], v[192:195], v[64:79]
    ds_read_b64_tr_b16 v[224:225], v244 offset:2048
    ds_read_b64_tr_b16 v[226:227], v244 offset:5120
    v_cvt_pk_bf16_f32 v214, v220, v221
    v_add_f32 v253, v253, v222
    v_add_f32 v253, v253, v223
    v_cvt_pk_bf16_f32 v215, v222, v223
    v_mfma_f32_32x32x16_bf16 v[80:95], v[228:231], v[192:195], v[80:95]
    s_add_u32 m0, s30, 896
    s_add_u32 s33, s27, 0
    ds_read_b64_tr_b16 v[228:229], v245 offset:2048
    ds_read_b64_tr_b16 v[230:231], v245 offset:5120
    buffer_load_dwordx4 v246, s[64:67], s33 offen offset:128 nt lds
    s_waitcnt lgkmcnt(4)
    v_mfma_f32_32x32x16_bf16 v[96:111], v[232:235], v[192:195], v[96:111]
    ds_read_b64_tr_b16 v[232:233], v244 offset:6144
    ds_read_b64_tr_b16 v[234:235], v244 offset:9216
    v_max3_f32 v254, v176, v177, v178
    v_max3_f32 v254, v254, v179, v180
    v_max3_f32 v254, v254, v181, v182
    v_mfma_f32_32x32x16_bf16 a[176:191], v[236:239], v[192:195], a[176:191]
    ds_read_b64_tr_b16 v[236:237], v245 offset:6144
    ds_read_b64_tr_b16 v[238:239], v245 offset:9216
    v_max3_f32 v254, v254, v183, v184
    v_max3_f32 v254, v254, v185, v186
    v_max3_f32 v254, v254, v187, v188
    s_waitcnt lgkmcnt(4)
    v_mfma_f32_32x32x16_bf16 v[112:127], v[224:227], v[192:195], v[112:127]
    ds_read_b64_tr_b16 v[224:225], v244 offset:7168
    ds_read_b64_tr_b16 v[226:227], v244 offset:10240
    v_max3_f32 v254, v254, v189, v190
    v_max_f32 v254, v254, v191
    v_fma_f32 v255, v254, s29, -v248
    v_cmp_lt_f32 vcc, s31, v255
    v_mfma_f32_32x32x16_bf16 a[192:207], v[228:231], v[192:195], a[192:207]
    ds_read_b64_tr_b16 v[228:229], v245 offset:7168
    ds_read_b64_tr_b16 v[230:231], v245 offset:10240
    s_cbranch_vccnz L_slow48
L_ret48:
    v_fma_f32 v176, v176, s29, -v248
    v_fma_f32 v177, v177, s29, -v248
    s_waitcnt lgkmcnt(4)
    v_mfma_f32_32x32x16_bf16 v[64:79], v[232:235], v[196:199], v[64:79]
    ds_read_b64_tr_b16 v[232:233], v244 offset:8192
    ds_read_b64_tr_b16 v[234:235], v244 offset:11264
    v_exp_f32 v176, v176
    v_exp_f32 v177, v177
    v_mfma_f32_32x32x16_bf16 v[80:95], v[236:239], v[196:199], v[80:95]
    ds_read_b64_tr_b16 v[236:237], v245 offset:8192
    ds_read_b64_tr_b16 v[238:239], v245 offset:11264
    v_fma_f32 v178, v178, s29, -v248
    v_fma_f32 v179, v179, s29, -v248
    s_waitcnt lgkmcnt(4)
    v_mfma_f32_32x32x16_bf16 v[96:111], v[224:227], v[196:199], v[96:111]
    ds_read_b128 v[224:227], v240 offset:0
    v_exp_f32 v178, v178
    v_exp_f32 v179, v179
    v_mfma_f32_32x32x16_bf16 a[176:191], v[228:231], v[196:199], a[176:191]
    ds_read_b128 v[228:231], v241 offset:0
    v_add_f32 v251, v251, v176
    v_add_f32 v251, v251, v177
    v_cvt_pk_bf16_f32 v176, v176, v177
    s_waitcnt lgkmcnt(2)
    v_mfma_f32_32x32x16_bf16 v[112:127], v[232:235], v[196:199], v[112:127]
    s_add_u32 m0, s30, 50048
    s_add_u32 s33, s27, 12288
    ds_read_b128 v[232:235], v242 offset:0
    buffer_load_dwordx4 v246, s[64:67], s33 offen offset:128 nt lds
    v_mfma_f32_32x32x16_bf16 a[192:207], v[236:239], v[196:199], a[192:207]
    ds_read_b128 v[236:239], v243 offset:0
    v_fma_f32 v180, v180, s29, -v248
    v_fma_f32 v181, v181, s29, -v248
    v_exp_f32 v180, v180
    s_waitcnt lgkmcnt(2)
    v_mfma_f32_32x32x16_bf16 v[192:207], v[224:227], a[48:51], 0
    ds_read_b128 v[224:227], v240 offset:1024
    v_exp_f32 v181, v181
    v_add_f32 v251, v251, v178
    v_mfma_f32_32x32x16_bf16 v[192:207], v[228:231], a[52:55], v[192:207]
    ds_read_b128 v[228:231], v241 offset:1024
    v_add_f32 v251, v251, v179
    v_cvt_pk_bf16_f32 v177, v178, v179
    v_fma_f32 v182, v182, s29, -v248
    v_fma_f32 v183, v183, s29, -v248
    s_waitcnt lgkmcnt(2)
    v_mfma_f32_32x32x16_bf16 v[192:207], v[232:235], a[56:59], v[192:207]
    ds_read_b128 v[232:235], v242 offset:1024
    v_exp_f32 v182, v182
    v_exp_f32 v183, v183
    v_add_f32 v251, v251, v180
    v_mfma_f32_32x32x16_bf16 v[192:207], v[236:239], a[60:63], v[192:207]
    ds_read_b128 v[236:239], v243 offset:1024
    v_add_f32 v251, v251, v181
    v_cvt_pk_bf16_f32 v178, v180, v181
    v_fma_f32 v184, v184, s29, -v248
    v_fma_f32 v185, v185, s29, -v248
    s_waitcnt lgkmcnt(2)
    v_mfma_f32_32x32x16_bf16 v[192:207], v[224:227], a[64:67], v[192:207]
    ds_read_b128 v[224:227], v240 offset:2048
    v_exp_f32 v184, v184
    v_exp_f32 v185, v185
    v_mfma_f32_32x32x16_bf16 v[192:207], v[228:231], a[68:71], v[192:207]
    ds_read_b128 v[228:231], v241 offset:2048
    v_add_f32 v251, v251, v182
    v_add_f32 v251, v251, v183
    v_cvt_pk_bf16_f32 v179, v182, v183
    v_fma_f32 v186, v186, s29, -v248
    s_waitcnt lgkmcnt(2)
    v_mfma_f32_32x32x16_bf16 v[192:207], v[232:235], a[72:75], v[192:207]
    ds_read_b128 v[232:235], v242 offset:2048
    v_fma_f32 v187, v187, s29, -v248
    v_exp_f32 v186, v186
    v_exp_f32 v187, v187
    v_mfma_f32_32x32x16_bf16 v[192:207], v[236:239], a[76:79], v[192:207]
    ds_read_b128 v[236:239], v243 offset:2048
    v_add_f32 v251, v251, v184
    v_add_f32 v251, v251, v185
    v_cvt_pk_bf16_f32 v180, v184, v185
    v_fma_f32 v188, v188, s29, -v248
    s_waitcnt lgkmcnt(2)
    v_mfma_f32_32x32x16_bf16 v[192:207], v[224:227], a[80:83], v[192:207]
    s_add_u32 m0, s30, 1792
    s_add_u32 s33, s27, 0
    ds_read_b64_tr_b16 v[224:225], v244 offset:0
    ds_read_b64_tr_b16 v[226:227], v244 offset:3072
    v_fma_f32 v189, v189, s29, -v248
    buffer_load_dwordx4 v246, s[64:67], s33 offen offset:256 nt lds
    v_mfma_f32_32x32x16_bf16 v[192:207], v[228:231], a[84:87], v[192:207]
    ds_read_b64_tr_b16 v[228:229], v245 offset:0
    ds_read_b64_tr_b16 v[230:231], v245 offset:3072
    v_exp_f32 v188, v188
    v_exp_f32 v189, v189
    s_waitcnt lgkmcnt(4)
    v_mfma_f32_32x32x16_bf16 v[192:207], v[232:235], a[88:91], v[192:207]
    ds_read_b64_tr_b16 v[232:233], v244 offset:1024
    ds_read_b64_tr_b16 v[234:235], v244 offset:4096
    v_add_f32 v251, v251, v186
    v_add_f32 v251, v251, v187
    v_cvt_pk_bf16_f32 v181, v186, v187
    v_fma_f32 v190, v190, s29, -v248
    v_mfma_f32_32x32x16_bf16 v[192:207], v[236:239], a[92:95], v[192:207]
    ds_read_b64_tr_b16 v[236:237], v245 offset:1024
    ds_read_b64_tr_b16 v[238:239], v245 offset:4096
    v_fma_f32 v191, v191, s29, -v248
    v_exp_f32 v190, v190
    v_exp_f32 v191, v191
    s_waitcnt lgkmcnt(4)
    v_mfma_f32_32x32x16_bf16 v[128:143], v[224:227], v[208:211], v[128:143]
    ds_read_b64_tr_b16 v[224:225], v244 offset:2048
    ds_read_b64_tr_b16 v[226:227], v244 offset:5120
    v_add_f32 v251, v251, v188
    v_add_f32 v251, v251, v189
    v_cvt_pk_bf16_f32 v182, v188, v189
    v_mfma_f32_32x32x16_bf16 v[144:159], v[228:231], v[208:211], v[144:159]
    ds_read_b64_tr_b16 v[228:229], v245 offset:2048
    ds_read_b64_tr_b16 v[230:231], v245 offset:5120
    v_add_f32 v251, v251, v190
    v_add_f32 v251, v251, v191
    v_cvt_pk_bf16_f32 v183, v190, v191
    s_waitcnt lgkmcnt(4)
    v_mfma_f32_32x32x16_bf16 v[160:175], v[232:235], v[208:211], v[160:175]
    ds_read_b64_tr_b16 v[232:233], v244 offset:6144
    ds_read_b64_tr_b16 v[234:235], v244 offset:9216
    v_max3_f32 v254, v192, v193, v194
    v_max3_f32 v254, v254, v195, v196
    v_max3_f32 v254, v254, v197, v198
    v_mfma_f32_32x32x16_bf16 a[208:223], v[236:239], v[208:211], a[208:223]
    ds_read_b64_tr_b16 v[236:237], v245 offset:6144
    ds_read_b64_tr_b16 v[238:239], v245 offset:9216
    v_max3_f32 v254, v254, v199, v200
    v_max3_f32 v254, v254, v201, v202
    v_max3_f32 v254, v254, v203, v204
    s_waitcnt lgkmcnt(4)
    v_mfma_f32_32x32x16_bf16 a[240:255], v[224:227], v[208:211], a[240:255]
    ds_read_b64_tr_b16 v[224:225], v244 offset:7168
    ds_read_b64_tr_b16 v[226:227], v244 offset:10240
    v_max3_f32 v254, v254, v205, v206
    v_max_f32 v254, v254, v207
    v_fma_f32 v255, v254, s29, -v249
    v_cmp_lt_f32 vcc, s31, v255
    v_mfma_f32_32x32x16_bf16 a[224:239], v[228:231], v[208:211], a[224:239]
    ds_read_b64_tr_b16 v[228:229], v245 offset:7168
    ds_read_b64_tr_b16 v[230:231], v245 offset:10240
    s_cbranch_vccnz L_slow50
L_ret50:
    v_fma_f32 v192, v192, s29, -v249
    v_fma_f32 v193, v193, s29, -v249
    s_waitcnt lgkmcnt(4)
    v_mfma_f32_32x32x16_bf16 v[128:143], v[232:235], v[212:215], v[128:143]
    ds_read_b64_tr_b16 v[232:233], v244 offset:8192
    ds_read_b64_tr_b16 v[234:235], v244 offset:11264
    v_exp_f32 v192, v192
    v_exp_f32 v193, v193
    v_mfma_f32_32x32x16_bf16 v[144:159], v[236:239], v[212:215], v[144:159]
    s_add_u32 m0, s30, 50944
    s_add_u32 s33, s27, 12288
    ds_read_b64_tr_b16 v[236:237], v245 offset:8192
    ds_read_b64_tr_b16 v[238:239], v245 offset:11264
    buffer_load_dwordx4 v246, s[64:67], s33 offen offset:256 nt lds
    s_waitcnt lgkmcnt(4)
    v_mfma_f32_32x32x16_bf16 v[160:175], v[224:227], v[212:215], v[160:175]
    ds_read_b128 v[224:227], v240 offset:0
    v_fma_f32 v194, v194, s29, -v249
    v_fma_f32 v195, v195, s29, -v249
    v_mfma_f32_32x32x16_bf16 a[208:223], v[228:231], v[212:215], a[208:223]
    ds_read_b128 v[228:231], v241 offset:0
    v_exp_f32 v194, v194
    v_exp_f32 v195, v195
    s_waitcnt lgkmcnt(2)
    v_mfma_f32_32x32x16_bf16 a[240:255], v[232:235], v[212:215], a[240:255]
    ds_read_b128 v[232:235], v242 offset:0
    v_add_f32 v252, v252, v192
    v_add_f32 v252, v252, v193
    v_cvt_pk_bf16_f32 v192, v192, v193
    v_mfma_f32_32x32x16_bf16 a[224:239], v[236:239], v[212:215], a[224:239]
    ds_read_b128 v[236:239], v243 offset:0
    v_fma_f32 v196, v196, s29, -v249
    v_fma_f32 v197, v197, s29, -v249
    v_exp_f32 v196, v196
    s_waitcnt lgkmcnt(2)
    v_mfma_f32_32x32x16_bf16 v[208:223], v[224:227], a[96:99], 0
    ds_read_b128 v[224:227], v240 offset:1024
    v_exp_f32 v197, v197
    v_add_f32 v252, v252, v194
    v_mfma_f32_32x32x16_bf16 v[208:223], v[228:231], a[100:103], v[208:223]
    ds_read_b128 v[228:231], v241 offset:1024
    v_add_f32 v252, v252, v195
    v_cvt_pk_bf16_f32 v193, v194, v195
    v_fma_f32 v198, v198, s29, -v249
    v_fma_f32 v199, v199, s29, -v249
    s_waitcnt lgkmcnt(2)
    v_mfma_f32_32x32x16_bf16 v[208:223], v[232:235], a[104:107], v[208:223]
    s_add_u32 m0, s30, 12288
    s_add_u32 s33, s27, 36864
    ds_read_b128 v[232:235], v242 offset:1024
    v_exp_f32 v198, v198
    buffer_load_dwordx4 v246, s[64:67], s33 offen offset:0 nt lds
    v_mfma_f32_32x32x16_bf16 v[208:223], v[236:239], a[108:111], v[208:223]
    ds_read_b128 v[236:239], v243 offset:1024
    v_exp_f32 v199, v199
    v_add_f32 v252, v252, v196
    v_add_f32 v252, v252, v197
    s_waitcnt lgkmcnt(2)
    v_mfma_f32_32x32x16_bf16 v[208:223], v[224:227], a[112:115], v[208:223]
    ds_read_b128 v[224:227], v240 offset:2048
    v_cvt_pk_bf16_f32 v194, v196, v197
    v_fma_f32 v200, v200, s29, -v249
    v_fma_f32 v201, v201, s29, -v249
    v_exp_f32 v200, v200
    v_mfma_f32_32x32x16_bf16 v[208:223], v[228:231], a[116:119], v[208:223]
    ds_read_b128 v[228:231], v241 offset:2048
    v_exp_f32 v201, v201
    v_add_f32 v252, v252, v198
    s_waitcnt lgkmcnt(2)
    v_mfma_f32_32x32x16_bf16 v[208:223], v[232:235], a[120:123], v[208:223]
    ds_read_b128 v[232:235], v242 offset:2048
    v_add_f32 v252, v252, v199
    v_cvt_pk_bf16_f32 v195, v198, v199
    v_fma_f32 v202, v202, s29, -v249
    v_fma_f32 v203, v203, s29, -v249
    v_mfma_f32_32x32x16_bf16 v[208:223], v[236:239], a[124:127], v[208:223]
    ds_read_b128 v[236:239], v243 offset:2048
    v_exp_f32 v202, v202
    v_exp_f32 v203, v203
    v_add_f32 v252, v252, v200
    s_waitcnt lgkmcnt(2)
    v_mfma_f32_32x32x16_bf16 v[208:223], v[224:227], a[128:131], v[208:223]
    ds_read_b64_tr_b16 v[224:225], v244 offset:24576
    ds_read_b64_tr_b16 v[226:227], v244 offset:27648
    v_add_f32 v252, v252, v201
    v_cvt_pk_bf16_f32 v196, v200, v201
    v_fma_f32 v204, v204, s29, -v249
    v_fma_f32 v205, v205, s29, -v249
    v_mfma_f32_32x32x16_bf16 v[208:223], v[228:231], a[132:135], v[208:223]
    ds_read_b64_tr_b16 v[228:229], v245 offset:24576
    ds_read_b64_tr_b16 v[230:231], v245 offset:27648
    v_exp_f32 v204, v204
    v_exp_f32 v205, v205
    s_waitcnt lgkmcnt(4)
    v_mfma_f32_32x32x16_bf16 v[208:223], v[232:235], a[136:139], v[208:223]
    ds_read_b64_tr_b16 v[232:233], v244 offset:25600
    ds_read_b64_tr_b16 v[234:235], v244 offset:28672
    v_add_f32 v252, v252, v202
    v_add_f32 v252, v252, v203
    v_cvt_pk_bf16_f32 v197, v202, v203
    v_fma_f32 v206, v206, s29, -v249
    v_mfma_f32_32x32x16_bf16 v[208:223], v[236:239], a[140:143], v[208:223]
    ds_read_b64_tr_b16 v[236:237], v245 offset:25600
    ds_read_b64_tr_b16 v[238:239], v245 offset:28672
    v_fma_f32 v207, v207, s29, -v249
    v_exp_f32 v206, v206
    v_exp_f32 v207, v207
    s_waitcnt lgkmcnt(4)
    v_mfma_f32_32x32x16_bf16 v[0:15], v[224:227], v[176:179], v[0:15]
    ds_read_b64_tr_b16 v[224:225], v244 offset:26624
    ds_read_b64_tr_b16 v[226:227], v244 offset:29696
    v_add_f32 v252, v252, v204
    v_add_f32 v252, v252, v205
    v_cvt_pk_bf16_f32 v198, v204, v205
    v_mfma_f32_32x32x16_bf16 v[16:31], v[228:231], v[176:179], v[16:31]
    ds_read_b64_tr_b16 v[228:229], v245 offset:26624
    ds_read_b64_tr_b16 v[230:231], v245 offset:29696
    v_add_f32 v252, v252, v206
    v_add_f32 v252, v252, v207
    v_cvt_pk_bf16_f32 v199, v206, v207
    s_waitcnt lgkmcnt(4)
    v_mfma_f32_32x32x16_bf16 v[32:47], v[232:235], v[176:179], v[32:47]
    ds_read_b64_tr_b16 v[232:233], v244 offset:30720
    ds_read_b64_tr_b16 v[234:235], v244 offset:33792
    v_max3_f32 v254, v208, v209, v210
    v_max3_f32 v254, v254, v211, v212
    v_max3_f32 v254, v254, v213, v214
    v_max3_f32 v254, v254, v215, v216
    v_mfma_f32_32x32x16_bf16 a[144:159], v[236:239], v[176:179], a[144:159]
    ds_read_b64_tr_b16 v[236:237], v245 offset:30720
    ds_read_b64_tr_b16 v[238:239], v245 offset:33792
    v_max3_f32 v254, v254, v217, v218
    v_max3_f32 v254, v254, v219, v220
    v_max3_f32 v254, v254, v221, v222
    v_max_f32 v254, v254, v223
    s_waitcnt lgkmcnt(4)
    v_mfma_f32_32x32x16_bf16 v[48:63], v[224:227], v[176:179], v[48:63]
    s_add_u32 m0, s30, 61440
    s_add_u32 s33, s27, 49152
    ds_read_b64_tr_b16 v[224:225], v244 offset:31744
    ds_read_b64_tr_b16 v[226:227], v244 offset:34816
    v_fma_f32 v255, v254, s29, -v250
    buffer_load_dwordx4 v246, s[64:67], s33 offen offset:0 nt lds
    v_mfma_f32_32x32x16_bf16 a[160:175], v[228:231], v[176:179], a[160:175]
    ds_read_b64_tr_b16 v[228:229], v245 offset:31744
    ds_read_b64_tr_b16 v[230:231], v245 offset:34816
    v_cmp_lt_f32 vcc, s31, v255
    s_cbranch_vccnz L_slow52
L_ret52:
    v_fma_f32 v208, v208, s29, -v250
    v_fma_f32 v209, v209, s29, -v250
    s_waitcnt lgkmcnt(4)
    v_mfma_f32_32x32x16_bf16 v[0:15], v[232:235], v[180:183], v[0:15]
    ds_read_b64_tr_b16 v[232:233], v244 offset:32768
    ds_read_b64_tr_b16 v[234:235], v244 offset:35840
    v_exp_f32 v208, v208
    v_exp_f32 v209, v209
    v_mfma_f32_32x32x16_bf16 v[16:31], v[236:239], v[180:183], v[16:31]
    s_waitcnt vmcnt(8)
    s_barrier
    s_add_u32 m0, s30, 98304
    s_add_u32 s33, s26, 122880
    ds_read_b64_tr_b16 v[236:237], v245 offset:32768
    ds_read_b64_tr_b16 v[238:239], v245 offset:35840
    buffer_load_dwordx4 v246, s[12:15], s33 offen offset:0 nt lds
    s_waitcnt lgkmcnt(4)
    v_mfma_f32_32x32x16_bf16 v[32:47], v[224:227], v[180:183], v[32:47]
    ds_read_b128 v[224:227], v240 offset:24576
    v_fma_f32 v210, v210, s29, -v250
    v_fma_f32 v211, v211, s29, -v250
    v_exp_f32 v210, v210
    v_mfma_f32_32x32x16_bf16 a[144:159], v[228:231], v[180:183], a[144:159]
    s_add_u32 m0, s30, 99200
    ds_read_b128 v[228:231], v241 offset:24576
    buffer_load_dwordx4 v246, s[12:15], s33 offen offset:128 nt lds
    s_add_u32 m0, s30, 13184
    s_add_u32 s33, s27, 36864
    buffer_load_dwordx4 v246, s[64:67], s33 offen offset:128 nt lds
    s_waitcnt lgkmcnt(2)
    v_mfma_f32_32x32x16_bf16 v[48:63], v[232:235], v[180:183], v[48:63]
    ds_read_b128 v[232:235], v242 offset:24576
    v_exp_f32 v211, v211
    v_add_f32 v253, v253, v208
    v_add_f32 v253, v253, v209
    v_mfma_f32_32x32x16_bf16 a[160:175], v[236:239], v[180:183], a[160:175]
    s_add_u32 m0, s30, 100096
    s_add_u32 s33, s26, 122880
    ds_read_b128 v[236:239], v243 offset:24576
    v_cvt_pk_bf16_f32 v208, v208, v209
    buffer_load_dwordx4 v246, s[12:15], s33 offen offset:256 nt lds
    s_waitcnt lgkmcnt(2)
    v_mfma_f32_32x32x16_bf16 v[176:191], v[224:227], a[0:3], 0
    ds_read_b128 v[224:227], v240 offset:25600
    v_fma_f32 v212, v212, s29, -v250
    v_fma_f32 v213, v213, s29, -v250
    v_exp_f32 v212, v212
    v_exp_f32 v213, v213
    v_mfma_f32_32x32x16_bf16 v[176:191], v[228:231], a[4:7], v[176:191]
    s_add_u32 m0, s30, 110592
    s_add_u32 s33, s26, 122880
    ds_read_b128 v[228:231], v241 offset:25600
    v_add_f32 v253, v253, v210
    buffer_load_dwordx4 v247, s[16:19], s33 offen offset:0 nt lds
    s_waitcnt lgkmcnt(2)
    v_mfma_f32_32x32x16_bf16 v[176:191], v[232:235], a[8:11], v[176:191]
    ds_read_b128 v[232:235], v242 offset:25600
    v_add_f32 v253, v253, v211
    v_cvt_pk_bf16_f32 v209, v210, v211
    v_fma_f32 v214, v214, s29, -v250
    v_fma_f32 v215, v215, s29, -v250
    v_exp_f32 v214, v214
    v_mfma_f32_32x32x16_bf16 v[176:191], v[236:239], a[12:15], v[176:191]
    s_add_u32 m0, s30, 111488
    ds_read_b128 v[236:239], v243 offset:25600
    v_exp_f32 v215, v215
    buffer_load_dwordx4 v247, s[16:19], s33 offen offset:128 nt lds
    s_waitcnt lgkmcnt(2)
    v_mfma_f32_32x32x16_bf16 v[176:191], v[224:227], a[16:19], v[176:191]
    ds_read_b128 v[224:227], v240 offset:26624
    v_add_f32 v253, v253, v212
    v_add_f32 v253, v253, v213
    v_cvt_pk_bf16_f32 v210, v212, v213
    v_fma_f32 v216, v216, s29, -v250
    v_fma_f32 v217, v217, s29, -v250
    v_mfma_f32_32x32x16_bf16 v[176:191], v[228:231], a[20:23], v[176:191]
    s_add_u32 m0, s30, 112384
    ds_read_b128 v[228:231], v241 offset:26624
    v_exp_f32 v216, v216
    buffer_load_dwordx4 v247, s[16:19], s33 offen offset:256 nt lds
    s_waitcnt lgkmcnt(2)
    v_mfma_f32_32x32x16_bf16 v[176:191], v[232:235], a[24:27], v[176:191]
    ds_read_b128 v[232:235], v242 offset:26624
    v_exp_f32 v217, v217
    v_add_f32 v253, v253, v214
    v_add_f32 v253, v253, v215
    v_cvt_pk_bf16_f32 v211, v214, v215
    v_mfma_f32_32x32x16_bf16 v[176:191], v[236:239], a[28:31], v[176:191]
    ds_read_b128 v[236:239], v243 offset:26624
    v_fma_f32 v218, v218, s29, -v250
    v_fma_f32 v219, v219, s29, -v250
    v_exp_f32 v218, v218
    s_waitcnt lgkmcnt(2)
    v_mfma_f32_32x32x16_bf16 v[176:191], v[224:227], a[32:35], v[176:191]
    ds_read_b64_tr_b16 v[224:225], v244 offset:24576
    ds_read_b64_tr_b16 v[226:227], v244 offset:27648
    v_exp_f32 v219, v219
    v_add_f32 v253, v253, v216
    v_add_f32 v253, v253, v217
    v_cvt_pk_bf16_f32 v212, v216, v217
    v_fma_f32 v220, v220, s29, -v250
    v_mfma_f32_32x32x16_bf16 v[176:191], v[228:231], a[36:39], v[176:191]
    ds_read_b64_tr_b16 v[228:229], v245 offset:24576
    ds_read_b64_tr_b16 v[230:231], v245 offset:27648
    v_fma_f32 v221, v221, s29, -v250
    v_exp_f32 v220, v220
    v_exp_f32 v221, v221
    s_waitcnt lgkmcnt(4)
    v_mfma_f32_32x32x16_bf16 v[176:191], v[232:235], a[40:43], v[176:191]
    ds_read_b64_tr_b16 v[232:233], v244 offset:25600
    ds_read_b64_tr_b16 v[234:235], v244 offset:28672
    v_add_f32 v253, v253, v218
    v_add_f32 v253, v253, v219
    v_cvt_pk_bf16_f32 v213, v218, v219
    v_fma_f32 v222, v222, s29, -v250
    v_fma_f32 v223, v223, s29, -v250
    v_mfma_f32_32x32x16_bf16 v[176:191], v[236:239], a[44:47], v[176:191]
    ds_read_b64_tr_b16 v[236:237], v245 offset:25600
    ds_read_b64_tr_b16 v[238:239], v245 offset:28672
    v_exp_f32 v222, v222
    v_exp_f32 v223, v223
    v_add_f32 v253, v253, v220
    s_waitcnt lgkmcnt(4)
    v_mfma_f32_32x32x16_bf16 v[64:79], v[224:227], v[192:195], v[64:79]
    ds_read_b64_tr_b16 v[224:225], v244 offset:26624
    ds_read_b64_tr_b16 v[226:227], v244 offset:29696
    v_add_f32 v253, v253, v221
    v_cvt_pk_bf16_f32 v214, v220, v221
    v_add_f32 v253, v253, v222
    v_add_f32 v253, v253, v223
    v_mfma_f32_32x32x16_bf16 v[80:95], v[228:231], v[192:195], v[80:95]
    s_add_u32 m0, s30, 62336
    s_add_u32 s33, s27, 49152
    ds_read_b64_tr_b16 v[228:229], v245 offset:26624
    ds_read_b64_tr_b16 v[230:231], v245 offset:29696
    v_cvt_pk_bf16_f32 v215, v222, v223
    buffer_load_dwordx4 v246, s[64:67], s33 offen offset:128 nt lds
    s_waitcnt lgkmcnt(4)
    v_mfma_f32_32x32x16_bf16 v[96:111], v[232:235], v[192:195], v[96:111]
    ds_read_b64_tr_b16 v[232:233], v244 offset:30720
    ds_read_b64_tr_b16 v[234:235], v244 offset:33792
    v_max3_f32 v254, v176, v177, v178
    v_max3_f32 v254, v254, v179, v180
    v_max3_f32 v254, v254, v181, v182
    v_mfma_f32_32x32x16_bf16 a[176:191], v[236:239], v[192:195], a[176:191]
    s_add_u32 m0, s30, 14080
    s_add_u32 s33, s27, 36864
    ds_read_b64_tr_b16 v[236:237], v245 offset:30720
    ds_read_b64_tr_b16 v[238:239], v245 offset:33792
    v_max3_f32 v254, v254, v183, v184
    buffer_load_dwordx4 v246, s[64:67], s33 offen offset:256 nt lds
    s_waitcnt lgkmcnt(4)
    v_mfma_f32_32x32x16_bf16 v[112:127], v[224:227], v[192:195], v[112:127]
    ds_read_b64_tr_b16 v[224:225], v244 offset:31744
    ds_read_b64_tr_b16 v[226:227], v244 offset:34816
    v_max3_f32 v254, v254, v185, v186
    v_max3_f32 v254, v254, v187, v188
    v_max3_f32 v254, v254, v189, v190
    v_mfma_f32_32x32x16_bf16 a[192:207], v[228:231], v[192:195], a[192:207]
    ds_read_b64_tr_b16 v[228:229], v245 offset:31744
    ds_read_b64_tr_b16 v[230:231], v245 offset:34816
    v_max_f32 v254, v254, v191
    v_fma_f32 v255, v254, s29, -v248
    v_cmp_lt_f32 vcc, s31, v255
    s_waitcnt lgkmcnt(4)
    v_mfma_f32_32x32x16_bf16 v[64:79], v[232:235], v[196:199], v[64:79]
    ds_read_b64_tr_b16 v[232:233], v244 offset:32768
    ds_read_b64_tr_b16 v[234:235], v244 offset:35840
    s_cbranch_vccnz L_slow54
L_ret54:
    v_fma_f32 v176, v176, s29, -v248
    v_fma_f32 v177, v177, s29, -v248
    v_mfma_f32_32x32x16_bf16 v[80:95], v[236:239], v[196:199], v[80:95]
    ds_read_b64_tr_b16 v[236:237], v245 offset:32768
    ds_read_b64_tr_b16 v[238:239], v245 offset:35840
    v_exp_f32 v176, v176
    v_exp_f32 v177, v177
    s_waitcnt lgkmcnt(4)
    v_mfma_f32_32x32x16_bf16 v[96:111], v[224:227], v[196:199], v[96:111]
    ds_read_b128 v[224:227], v240 offset:24576
    v_fma_f32 v178, v178, s29, -v248
    v_fma_f32 v179, v179, s29, -v248
    v_mfma_f32_32x32x16_bf16 a[176:191], v[228:231], v[196:199], a[176:191]
    ds_read_b128 v[228:231], v241 offset:24576
    v_exp_f32 v178, v178
    v_exp_f32 v179, v179
    s_waitcnt lgkmcnt(2)
    v_mfma_f32_32x32x16_bf16 v[112:127], v[232:235], v[196:199], v[112:127]
    ds_read_b128 v[232:235], v242 offset:24576
    v_add_f32 v251, v251, v176
    v_add_f32 v251, v251, v177
    v_cvt_pk_bf16_f32 v176, v176, v177
    v_mfma_f32_32x32x16_bf16 a[192:207], v[236:239], v[196:199], a[192:207]
    ds_read_b128 v[236:239], v243 offset:24576
    v_fma_f32 v180, v180, s29, -v248
    v_fma_f32 v181, v181, s29, -v248
    v_exp_f32 v180, v180
    s_waitcnt lgkmcnt(2)
    v_mfma_f32_32x32x16_bf16 v[192:207], v[224:227], a[48:51], 0
    ds_read_b128 v[224:227], v240 offset:25600
    v_exp_f32 v181, v181
    v_add_f32 v251, v251, v178
    v_add_f32 v251, v251, v179
    v_mfma_f32_32x32x16_bf16 v[192:207], v[228:231], a[52:55], v[192:207]
    ds_read_b128 v[228:231], v241 offset:25600
    v_cvt_pk_bf16_f32 v177, v178, v179
    v_fma_f32 v182, v182, s29, -v248
    v_fma_f32 v183, v183, s29, -v248
    v_exp_f32 v182, v182
    s_waitcnt lgkmcnt(2)
    v_mfma_f32_32x32x16_bf16 v[192:207], v[232:235], a[56:59], v[192:207]
    ds_read_b128 v[232:235], v242 offset:25600
    v_exp_f32 v183, v183
    v_add_f32 v251, v251, v180
    v_mfma_f32_32x32x16_bf16 v[192:207], v[236:239], a[60:63], v[192:207]
    ds_read_b128 v[236:239], v243 offset:25600
    v_add_f32 v251, v251, v181
    v_cvt_pk_bf16_f32 v178, v180, v181
    v_fma_f32 v184, v184, s29, -v248
    v_fma_f32 v185, v185, s29, -v248
    s_waitcnt lgkmcnt(2)
    v_mfma_f32_32x32x16_bf16 v[192:207], v[224:227], a[64:67], v[192:207]
    ds_read_b128 v[224:227], v240 offset:26624
    v_exp_f32 v184, v184
    v_exp_f32 v185, v185
    v_add_f32 v251, v251, v182
    v_mfma_f32_32x32x16_bf16 v[192:207], v[228:231], a[68:71], v[192:207]
    ds_read_b128 v[228:231], v241 offset:26624
    v_add_f32 v251, v251, v183
    v_cvt_pk_bf16_f32 v179, v182, v183
    v_fma_f32 v186, v186, s29, -v248
    v_fma_f32 v187, v187, s29, -v248
    s_waitcnt lgkmcnt(2)
    v_mfma_f32_32x32x16_bf16 v[192:207], v[232:235], a[72:75], v[192:207]
    ds_read_b128 v[232:235], v242 offset:26624
    v_exp_f32 v186, v186
    v_exp_f32 v187, v187
    v_mfma_f32_32x32x16_bf16 v[192:207], v[236:239], a[76:79], v[192:207]
    ds_read_b128 v[236:239], v243 offset:26624
    v_add_f32 v251, v251, v184
    v_add_f32 v251, v251, v185
    v_cvt_pk_bf16_f32 v180, v184, v185
    v_fma_f32 v188, v188, s29, -v248
    v_fma_f32 v189, v189, s29, -v248
    s_waitcnt lgkmcnt(2)
    v_mfma_f32_32x32x16_bf16 v[192:207], v[224:227], a[80:83], v[192:207]
    ds_read_b64_tr_b16 v[224:225], v244 offset:24576
    ds_read_b64_tr_b16 v[226:227], v244 offset:27648
    v_exp_f32 v188, v188
    v_exp_f32 v189, v189
    v_mfma_f32_32x32x16_bf16 v[192:207], v[228:231], a[84:87], v[192:207]
    ds_read_b64_tr_b16 v[228:229], v245 offset:24576
    ds_read_b64_tr_b16 v[230:231], v245 offset:27648
    v_add_f32 v251, v251, v186
    v_add_f32 v251, v251, v187
    v_cvt_pk_bf16_f32 v181, v186, v187
    v_fma_f32 v190, v190, s29, -v248
    s_waitcnt lgkmcnt(4)
    v_mfma_f32_32x32x16_bf16 v[192:207], v[232:235], a[88:91], v[192:207]
    s_add_u32 m0, s30, 24576
    s_add_u32 s33, s27, 73728
    ds_read_b64_tr_b16 v[232:233], v244 offset:25600
    ds_read_b64_tr_b16 v[234:235], v244 offset:28672
    buffer_load_dwordx4 v246, s[64:67], s33 offen offset:0 nt lds
    s_add_u32 m0, s30, 63232
    s_add_u32 s33, s27, 49152
    buffer_load_dwordx4 v246, s[64:67], s33 offen offset:256 nt lds
    v_mfma_f32_32x32x16_bf16 v[192:207], v[236:239], a[92:95], v[192:207]
    ds_read_b64_tr_b16 v[236:237], v245 offset:25600
    ds_read_b64_tr_b16 v[238:239], v245 offset:28672
    v_fma_f32 v191, v191, s29, -v248
    v_exp_f32 v190, v190
    v_exp_f32 v191, v191
    s_waitcnt lgkmcnt(4)
    v_mfma_f32_32x32x16_bf16 v[128:143], v[224:227], v[208:211], v[128:143]
    ds_read_b64_tr_b16 v[224:225], v244 offset:26624
    ds_read_b64_tr_b16 v[226:227], v244 offset:29696
    v_add_f32 v251, v251, v188
    v_add_f32 v251, v251, v189
    v_cvt_pk_bf16_f32 v182, v188, v189
    v_mfma_f32_32x32x16_bf16 v[144:159], v[228:231], v[208:211], v[144:159]
    ds_read_b64_tr_b16 v[228:229], v245 offset:26624
    ds_read_b64_tr_b16 v[230:231], v245 offset:29696
    v_add_f32 v251, v251, v190
    v_add_f32 v251, v251, v191
    v_cvt_pk_bf16_f32 v183, v190, v191
    s_waitcnt lgkmcnt(4)
    v_mfma_f32_32x32x16_bf16 v[160:175], v[232:235], v[208:211], v[160:175]
    ds_read_b64_tr_b16 v[232:233], v244 offset:30720
    ds_read_b64_tr_b16 v[234:235], v244 offset:33792
    v_max3_f32 v254, v192, v193, v194
    v_max3_f32 v254, v254, v195, v196
    v_max3_f32 v254, v254, v197, v198
    v_mfma_f32_32x32x16_bf16 a[208:223], v[236:239], v[208:211], a[208:223]
    ds_read_b64_tr_b16 v[236:237], v245 offset:30720
    ds_read_b64_tr_b16 v[238:239], v245 offset:33792
    v_max3_f32 v254, v254, v199, v200
    v_max3_f32 v254, v254, v201, v202
    v_max3_f32 v254, v254, v203, v204
    s_waitcnt lgkmcnt(4)
    v_mfma_f32_32x32x16_bf16 a[240:255], v[224:227], v[208:211], a[240:255]
    ds_read_b64_tr_b16 v[224:225], v244 offset:31744
    ds_read_b64_tr_b16 v[226:227], v244 offset:34816
    v_max3_f32 v254, v254, v205, v206
    v_max_f32 v254, v254, v207
    v_fma_f32 v255, v254, s29, -v249
    v_cmp_lt_f32 vcc, s31, v255
    v_mfma_f32_32x32x16_bf16 a[224:239], v[228:231], v[208:211], a[224:239]
    ds_read_b64_tr_b16 v[228:229], v245 offset:31744
    ds_read_b64_tr_b16 v[230:231], v245 offset:34816
    s_cbranch_vccnz L_slow56
L_ret56:
    v_fma_f32 v192, v192, s29, -v249
    v_fma_f32 v193, v193, s29, -v249
    s_waitcnt lgkmcnt(4)
    v_mfma_f32_32x32x16_bf16 v[128:143], v[232:235], v[212:215], v[128:143]
    ds_read_b64_tr_b16 v[232:233], v244 offset:32768
    ds_read_b64_tr_b16 v[234:235], v244 offset:35840
    v_exp_f32 v192, v192
    v_exp_f32 v193, v193
    v_mfma_f32_32x32x16_bf16 v[144:159], v[236:239], v[212:215], v[144:159]
    ds_read_b64_tr_b16 v[236:237], v245 offset:32768
    ds_read_b64_tr_b16 v[238:239], v245 offset:35840
    v_fma_f32 v194, v194, s29, -v249
    v_fma_f32 v195, v195, s29, -v249
    s_waitcnt lgkmcnt(4)
    v_mfma_f32_32x32x16_bf16 v[160:175], v[224:227], v[212:215], v[160:175]
    ds_read_b128 v[224:227], v240 offset:24576
    v_exp_f32 v194, v194
    v_exp_f32 v195, v195
    v_mfma_f32_32x32x16_bf16 a[208:223], v[228:231], v[212:215], a[208:223]
    ds_read_b128 v[228:231], v241 offset:24576
    v_add_f32 v252, v252, v192
    v_add_f32 v252, v252, v193
    v_cvt_pk_bf16_f32 v192, v192, v193
    s_waitcnt lgkmcnt(2)
    v_mfma_f32_32x32x16_bf16 a[240:255], v[232:235], v[212:215], a[240:255]
    ds_read_b128 v[232:235], v242 offset:24576
    v_fma_f32 v196, v196, s29, -v249
    v_fma_f32 v197, v197, s29, -v249
    v_mfma_f32_32x32x16_bf16 a[224:239], v[236:239], v[212:215], a[224:239]
    ds_read_b128 v[236:239], v243 offset:24576
    v_exp_f32 v196, v196
    v_exp_f32 v197, v197
    s_waitcnt lgkmcnt(2)
    v_mfma_f32_32x32x16_bf16 v[208:223], v[224:227], a[96:99], 0
    ds_read_b128 v[224:227], v240 offset:25600
    v_add_f32 v252, v252, v194
    v_add_f32 v252, v252, v195
    v_cvt_pk_bf16_f32 v193, v194, v195
    v_fma_f32 v198, v198, s29, -v249
    v_mfma_f32_32x32x16_bf16 v[208:223], v[228:231], a[100:103], v[208:223]
    ds_read_b128 v[228:231], v241 offset:25600
    v_fma_f32 v199, v199, s29, -v249
    v_exp_f32 v198, v198
    v_exp_f32 v199, v199
    s_waitcnt lgkmcnt(2)
    v_mfma_f32_32x32x16_bf16 v[208:223], v[232:235], a[104:107], v[208:223]
    ds_read_b128 v[232:235], v242 offset:25600
    v_add_f32 v252, v252, v196
    v_add_f32 v252, v252, v197
    v_cvt_pk_bf16_f32 v194, v196, v197
    v_fma_f32 v200, v200, s29, -v249
    v_mfma_f32_32x32x16_bf16 v[208:223], v[236:239], a[108:111], v[208:223]
    ds_read_b128 v[236:239], v243 offset:25600
    v_fma_f32 v201, v201, s29, -v249
    v_exp_f32 v200, v200
    s_waitcnt lgkmcnt(2)
    v_mfma_f32_32x32x16_bf16 v[208:223], v[224:227], a[112:115], v[208:223]
    s_add_u32 m0, s30, 25472
    s_add_u32 s33, s27, 73728
    ds_read_b128 v[224:227], v240 offset:26624
    v_exp_f32 v201, v201
    buffer_load_dwordx4 v246, s[64:67], s33 offen offset:128 nt lds
    v_mfma_f32_32x32x16_bf16 v[208:223], v[228:231], a[116:119], v[208:223]
    ds_read_b128 v[228:231], v241 offset:26624
    v_add_f32 v252, v252, v198
    v_add_f32 v252, v252, v199
    v_cvt_pk_bf16_f32 v195, v198, v199
    v_fma_f32 v202, v202, s29, -v249
    s_waitcnt lgkmcnt(2)
    v_mfma_f32_32x32x16_bf16 v[208:223], v[232:235], a[120:123], v[208:223]
    ds_read_b128 v[232:235], v242 offset:26624
    v_fma_f32 v203, v203, s29, -v249
    v_exp_f32 v202, v202
    v_exp_f32 v203, v203
    v_mfma_f32_32x32x16_bf16 v[208:223], v[236:239], a[124:127], v[208:223]
    s_add_u32 m0, s30, 73728
    s_add_u32 s33, s27, 86016
    ds_read_b128 v[236:239], v243 offset:26624
    v_add_f32 v252, v252, v200
    buffer_load_dwordx4 v246, s[64:67], s33 offen offset:0 nt lds
    s_waitcnt lgkmcnt(2)
    v_mfma_f32_32x32x16_bf16 v[208:223], v[224:227], a[128:131], v[208:223]
    ds_read_b64_tr_b16 v[224:225], v244 offset:49152
    ds_read_b64_tr_b16 v[226:227], v244 offset:52224
    v_add_f32 v252, v252, v201
    v_cvt_pk_bf16_f32 v196, v200, v201
    v_fma_f32 v204, v204, s29, -v249
    v_fma_f32 v205, v205, s29, -v249
    v_mfma_f32_32x32x16_bf16 v[208:223], v[228:231], a[132:135], v[208:223]
    ds_read_b64_tr_b16 v[228:229], v245 offset:49152
    ds_read_b64_tr_b16 v[230:231], v245 offset:52224
    v_exp_f32 v204, v204
    v_exp_f32 v205, v205
    s_waitcnt lgkmcnt(4)
    v_mfma_f32_32x32x16_bf16 v[208:223], v[232:235], a[136:139], v[208:223]
    ds_read_b64_tr_b16 v[232:233], v244 offset:50176
    ds_read_b64_tr_b16 v[234:235], v244 offset:53248
    v_add_f32 v252, v252, v202
    v_add_f32 v252, v252, v203
    v_cvt_pk_bf16_f32 v197, v202, v203
    v_fma_f32 v206, v206, s29, -v249
    v_mfma_f32_32x32x16_bf16 v[208:223], v[236:239], a[140:143], v[208:223]
    ds_read_b64_tr_b16 v[236:237], v245 offset:50176
    ds_read_b64_tr_b16 v[238:239], v245 offset:53248
    v_fma_f32 v207, v207, s29, -v249
    v_exp_f32 v206, v206
    v_exp_f32 v207, v207
    s_waitcnt lgkmcnt(4)
    v_mfma_f32_32x32x16_bf16 v[0:15], v[224:227], v[176:179], v[0:15]
    ds_read_b64_tr_b16 v[224:225], v244 offset:51200
    ds_read_b64_tr_b16 v[226:227], v244 offset:54272
    v_add_f32 v252, v252, v204
    v_add_f32 v252, v252, v205
    v_cvt_pk_bf16_f32 v198, v204, v205
    v_mfma_f32_32x32x16_bf16 v[16:31], v[228:231], v[176:179], v[16:31]
    ds_read_b64_tr_b16 v[228:229], v245 offset:51200
    ds_read_b64_tr_b16 v[230:231], v245 offset:54272
    v_add_f32 v252, v252, v206
    v_add_f32 v252, v252, v207
    v_cvt_pk_bf16_f32 v199, v206, v207
    s_waitcnt lgkmcnt(4)
    v_mfma_f32_32x32x16_bf16 v[32:47], v[232:235], v[176:179], v[32:47]
    ds_read_b64_tr_b16 v[232:233], v244 offset:55296
    ds_read_b64_tr_b16 v[234:235], v244 offset:58368
    v_max3_f32 v254, v208, v209, v210
    v_max3_f32 v254, v254, v211, v212
    v_max3_f32 v254, v254, v213, v214
    v_max3_f32 v254, v254, v215, v216
    v_mfma_f32_32x32x16_bf16 a[144:159], v[236:239], v[176:179], a[144:159]
    ds_read_b64_tr_b16 v[236:237], v245 offset:55296
    ds_read_b64_tr_b16 v[238:239], v245 offset:58368
    v_max3_f32 v254, v254, v217, v218
    v_max3_f32 v254, v254, v219, v220
    v_max3_f32 v254, v254, v221, v222
    v_max_f32 v254, v254, v223
    s_waitcnt lgkmcnt(4)
    v_mfma_f32_32x32x16_bf16 v[48:63], v[224:227], v[176:179], v[48:63]
    ds_read_b64_tr_b16 v[224:225], v244 offset:56320
    ds_read_b64_tr_b16 v[226:227], v244 offset:59392
    v_fma_f32 v255, v254, s29, -v250
    v_cmp_lt_f32 vcc, s31, v255
    s_cbranch_vccnz L_slow58
L_ret58:
    v_fma_f32 v208, v208, s29, -v250
    v_mfma_f32_32x32x16_bf16 a[160:175], v[228:231], v[176:179], a[160:175]
    ds_read_b64_tr_b16 v[228:229], v245 offset:56320
    ds_read_b64_tr_b16 v[230:231], v245 offset:59392
    v_fma_f32 v209, v209, s29, -v250
    v_exp_f32 v208, v208
    s_waitcnt lgkmcnt(4)
    v_mfma_f32_32x32x16_bf16 v[0:15], v[232:235], v[180:183], v[0:15]
    ds_read_b64_tr_b16 v[232:233], v244 offset:57344
    ds_read_b64_tr_b16 v[234:235], v244 offset:60416
    v_exp_f32 v209, v209
    v_fma_f32 v210, v210, s29, -v250
    v_fma_f32 v211, v211, s29, -v250
    v_mfma_f32_32x32x16_bf16 v[16:31], v[236:239], v[180:183], v[16:31]
    s_waitcnt vmcnt(6)
    s_barrier
    s_add_u32 m0, s30, 122880
    s_add_u32 s33, s26, 135168
    ds_read_b64_tr_b16 v[236:237], v245 offset:57344
    ds_read_b64_tr_b16 v[238:239], v245 offset:60416
    buffer_load_dwordx4 v246, s[12:15], s33 offen offset:0 nt lds
    s_waitcnt lgkmcnt(4)
    v_mfma_f32_32x32x16_bf16 v[32:47], v[224:227], v[180:183], v[32:47]
    v_add_u32 v240, 0xffffd000, v240
    v_add_u32 v241, 0xffffd000, v241
    v_add_u32 v242, 0xffffd000, v242
    v_add_u32 v243, 0xffffd000, v243
    ds_read_b128 v[224:227], v240 offset:0
    v_exp_f32 v210, v210
    v_exp_f32 v211, v211
    v_mfma_f32_32x32x16_bf16 a[144:159], v[228:231], v[180:183], a[144:159]
    s_add_u32 m0, s30, 123776
    ds_read_b128 v[228:231], v241 offset:0
    v_add_f32 v253, v253, v208
    buffer_load_dwordx4 v246, s[12:15], s33 offen offset:128 nt lds
    s_waitcnt lgkmcnt(2)
    v_mfma_f32_32x32x16_bf16 v[48:63], v[232:235], v[180:183], v[48:63]
    ds_read_b128 v[232:235], v242 offset:0
    v_add_f32 v253, v253, v209
    v_cvt_pk_bf16_f32 v208, v208, v209
    v_fma_f32 v212, v212, s29, -v250
    v_fma_f32 v213, v213, s29, -v250
    v_mfma_f32_32x32x16_bf16 a[160:175], v[236:239], v[180:183], a[160:175]
    s_add_u32 m0, s30, 124672
    ds_read_b128 v[236:239], v243 offset:0
    buffer_load_dwordx4 v246, s[12:15], s33 offen offset:256 nt lds
    s_add_u32 m0, s30, 26368
    s_add_u32 s33, s27, 73728
    buffer_load_dwordx4 v246, s[64:67], s33 offen offset:256 nt lds
    s_waitcnt lgkmcnt(2)
    v_mfma_f32_32x32x16_bf16 v[176:191], v[224:227], a[0:3], 0
    ds_read_b128 v[224:227], v240 offset:1024
    v_exp_f32 v212, v212
    v_exp_f32 v213, v213
    v_add_f32 v253, v253, v210
    v_mfma_f32_32x32x16_bf16 v[176:191], v[228:231], a[4:7], v[176:191]
    s_add_u32 m0, s30, 135168
    s_add_u32 s33, s26, 135168
    ds_read_b128 v[228:231], v241 offset:1024
    v_add_f32 v253, v253, v211
    v_cvt_pk_bf16_f32 v209, v210, v211
    buffer_load_dwordx4 v247, s[16:19], s33 offen offset:0 nt lds
    s_waitcnt lgkmcnt(2)
    v_mfma_f32_32x32x16_bf16 v[176:191], v[232:235], a[8:11], v[176:191]
    ds_read_b128 v[232:235], v242 offset:1024
    v_fma_f32 v214, v214, s29, -v250
    v_fma_f32 v215, v215, s29, -v250
    v_exp_f32 v214, v214
    v_exp_f32 v215, v215
    v_mfma_f32_32x32x16_bf16 v[176:191], v[236:239], a[12:15], v[176:191]
    s_add_u32 m0, s30, 136064
    ds_read_b128 v[236:239], v243 offset:1024
    v_add_f32 v253, v253, v212
    buffer_load_dwordx4 v247, s[16:19], s33 offen offset:128 nt lds
    s_waitcnt lgkmcnt(2)
    v_mfma_f32_32x32x16_bf16 v[176:191], v[224:227], a[16:19], v[176:191]
    s_add_u32 m0, s30, 74624
    s_add_u32 s33, s27, 86016
    ds_read_b128 v[224:227], v240 offset:2048
    v_add_f32 v253, v253, v213
    v_cvt_pk_bf16_f32 v210, v212, v213
    buffer_load_dwordx4 v246, s[64:67], s33 offen offset:128 nt lds
    v_mfma_f32_32x32x16_bf16 v[176:191], v[228:231], a[20:23], v[176:191]
    s_add_u32 m0, s30, 136960
    s_add_u32 s33, s26, 135168
    ds_read_b128 v[228:231], v241 offset:2048
    v_fma_f32 v216, v216, s29, -v250
    v_fma_f32 v217, v217, s29, -v250
    buffer_load_dwordx4 v247, s[16:19], s33 offen offset:256 nt lds
    s_waitcnt lgkmcnt(2)
    v_mfma_f32_32x32x16_bf16 v[176:191], v[232:235], a[24:27], v[176:191]
    ds_read_b128 v[232:235], v242 offset:2048
    v_exp_f32 v216, v216
    v_exp_f32 v217, v217
    v_add_f32 v253, v253, v214
    v_mfma_f32_32x32x16_bf16 v[176:191], v[236:239], a[28:31], v[176:191]
    ds_read_b128 v[236:239], v243 offset:2048
    v_add_f32 v253, v253, v215
    v_cvt_pk_bf16_f32 v211, v214, v215
    v_fma_f32 v218, v218, s29, -v250
    v_fma_f32 v219, v219, s29, -v250
    s_waitcnt lgkmcnt(2)
    v_mfma_f32_32x32x16_bf16 v[176:191], v[224:227], a[32:35], v[176:191]
    ds_read_b64_tr_b16 v[224:225], v244 offset:49152
    ds_read_b64_tr_b16 v[226:227], v244 offset:52224
    v_exp_f32 v218, v218
    v_exp_f32 v219, v219
    v_add_f32 v253, v253, v216
    v_mfma_f32_32x32x16_bf16 v[176:191], v[228:231], a[36:39], v[176:191]
    ds_read_b64_tr_b16 v[228:229], v245 offset:49152
    ds_read_b64_tr_b16 v[230:231], v245 offset:52224
    v_add_f32 v253, v253, v217
    v_cvt_pk_bf16_f32 v212, v216, v217
    v_fma_f32 v220, v220, s29, -v250
    v_fma_f32 v221, v221, s29, -v250
    v_exp_f32 v220, v220
    s_waitcnt lgkmcnt(4)
    v_mfma_f32_32x32x16_bf16 v[176:191], v[232:235], a[40:43], v[176:191]
    ds_read_b64_tr_b16 v[232:233], v244 offset:50176
    ds_read_b64_tr_b16 v[234:235], v244 offset:53248
    v_exp_f32 v221, v221
    v_add_f32 v253, v253, v218
    v_add_f32 v253, v253, v219
    v_mfma_f32_32x32x16_bf16 v[176:191], v[236:239], a[44:47], v[176:191]
    ds_read_b64_tr_b16 v[236:237], v245 offset:50176
    ds_read_b64_tr_b16 v[238:239], v245 offset:53248
    v_cvt_pk_bf16_f32 v213, v218, v219
    v_fma_f32 v222, v222, s29, -v250
    v_fma_f32 v223, v223, s29, -v250
    v_exp_f32 v222, v222
    s_waitcnt lgkmcnt(4)
    v_mfma_f32_32x32x16_bf16 v[64:79], v[224:227], v[192:195], v[64:79]
    ds_read_b64_tr_b16 v[224:225], v244 offset:51200
    ds_read_b64_tr_b16 v[226:227], v244 offset:54272
    v_exp_f32 v223, v223
    v_add_f32 v253, v253, v220
    v_add_f32 v253, v253, v221
    v_mfma_f32_32x32x16_bf16 v[80:95], v[228:231], v[192:195], v[80:95]
    ds_read_b64_tr_b16 v[228:229], v245 offset:51200
    ds_read_b64_tr_b16 v[230:231], v245 offset:54272
    v_cvt_pk_bf16_f32 v214, v220, v221
    v_add_f32 v253, v253, v222
    v_add_f32 v253, v253, v223
    v_cvt_pk_bf16_f32 v215, v222, v223
    s_waitcnt lgkmcnt(4)
    v_mfma_f32_32x32x16_bf16 v[96:111], v[232:235], v[192:195], v[96:111]
    ds_read_b64_tr_b16 v[232:233], v244 offset:55296
    ds_read_b64_tr_b16 v[234:235], v244 offset:58368
    v_max3_f32 v254, v176, v177, v178
    v_max3_f32 v254, v254, v179, v180
    v_max3_f32 v254, v254, v181, v182
    v_mfma_f32_32x32x16_bf16 a[176:191], v[236:239], v[192:195], a[176:191]
    ds_read_b64_tr_b16 v[236:237], v245 offset:55296
    ds_read_b64_tr_b16 v[238:239], v245 offset:58368
    v_max3_f32 v254, v254, v183, v184
    v_max3_f32 v254, v254, v185, v186
    v_max3_f32 v254, v254, v187, v188
    v_max3_f32 v254, v254, v189, v190
    s_waitcnt lgkmcnt(4)
    v_mfma_f32_32x32x16_bf16 v[112:127], v[224:227], v[192:195], v[112:127]
    ds_read_b64_tr_b16 v[224:225], v244 offset:56320
    ds_read_b64_tr_b16 v[226:227], v244 offset:59392
    v_max_f32 v254, v254, v191
    v_fma_f32 v255, v254, s29, -v248
    v_cmp_lt_f32 vcc, s31, v255
    v_mfma_f32_32x32x16_bf16 a[192:207], v[228:231], v[192:195], a[192:207]
    s_add_u32 m0, s30, 36864
    s_add_u32 s33, s27, 110592
    ds_read_b64_tr_b16 v[228:229], v245 offset:56320
    ds_read_b64_tr_b16 v[230:231], v245 offset:59392
    buffer_load_dwordx4 v246, s[64:67], s33 offen offset:0 nt lds
    s_waitcnt lgkmcnt(4)
    v_mfma_f32_32x32x16_bf16 v[64:79], v[232:235], v[196:199], v[64:79]
    ds_read_b64_tr_b16 v[232:233], v244 offset:57344
    ds_read_b64_tr_b16 v[234:235], v244 offset:60416
    s_cbranch_vccnz L_slow60
L_ret60:
    v_fma_f32 v176, v176, s29, -v248
    v_fma_f32 v177, v177, s29, -v248
    v_mfma_f32_32x32x16_bf16 v[80:95], v[236:239], v[196:199], v[80:95]
    ds_read_b64_tr_b16 v[236:237], v245 offset:57344
    ds_read_b64_tr_b16 v[238:239], v245 offset:60416
    v_exp_f32 v176, v176
    v_exp_f32 v177, v177
    s_waitcnt lgkmcnt(4)
    v_mfma_f32_32x32x16_bf16 v[96:111], v[224:227], v[196:199], v[96:111]
    ds_read_b128 v[224:227], v240 offset:0
    v_fma_f32 v178, v178, s29, -v248
    v_fma_f32 v179, v179, s29, -v248
    v_exp_f32 v178, v178
    v_mfma_f32_32x32x16_bf16 a[176:191], v[228:231], v[196:199], a[176:191]
    ds_read_b128 v[228:231], v241 offset:0
    v_exp_f32 v179, v179
    v_add_f32 v251, v251, v176
    s_waitcnt lgkmcnt(2)
    v_mfma_f32_32x32x16_bf16 v[112:127], v[232:235], v[196:199], v[112:127]
    ds_read_b128 v[232:235], v242 offset:0
    v_add_f32 v251, v251, v177
    v_cvt_pk_bf16_f32 v176, v176, v177
    v_fma_f32 v180, v180, s29, -v248
    v_mfma_f32_32x32x16_bf16 a[192:207], v[236:239], v[196:199], a[192:207]
    ds_read_b128 v[236:239], v243 offset:0
    v_fma_f32 v181, v181, s29, -v248
    v_exp_f32 v180, v180
    s_waitcnt lgkmcnt(2)
    v_mfma_f32_32x32x16_bf16 v[192:207], v[224:227], a[48:51], 0
    ds_read_b128 v[224:227], v240 offset:1024
    v_exp_f32 v181, v181
    v_add_f32 v251, v251, v178
    v_add_f32 v251, v251, v179
    v_cvt_pk_bf16_f32 v177, v178, v179
    v_mfma_f32_32x32x16_bf16 v[192:207], v[228:231], a[52:55], v[192:207]
    s_add_u32 m0, s30, 75520
    s_add_u32 s33, s27, 86016
    ds_read_b128 v[228:231], v241 offset:1024
    v_fma_f32 v182, v182, s29, -v248
    buffer_load_dwordx4 v246, s[64:67], s33 offen offset:256 nt lds
    s_waitcnt lgkmcnt(2)
    v_mfma_f32_32x32x16_bf16 v[192:207], v[232:235], a[56:59], v[192:207]
    ds_read_b128 v[232:235], v242 offset:1024
    v_fma_f32 v183, v183, s29, -v248
    v_exp_f32 v182, v182
    v_exp_f32 v183, v183
    v_mfma_f32_32x32x16_bf16 v[192:207], v[236:239], a[60:63], v[192:207]
    ds_read_b128 v[236:239], v243 offset:1024
    v_add_f32 v251, v251, v180
    v_add_f32 v251, v251, v181
    v_cvt_pk_bf16_f32 v178, v180, v181
    v_fma_f32 v184, v184, s29, -v248
    s_waitcnt lgkmcnt(2)
    v_mfma_f32_32x32x16_bf16 v[192:207], v[224:227], a[64:67], v[192:207]
    ds_read_b128 v[224:227], v240 offset:2048
    v_fma_f32 v185, v185, s29, -v248
    v_exp_f32 v184, v184
    v_exp_f32 v185, v185
    v_mfma_f32_32x32x16_bf16 v[192:207], v[228:231], a[68:71], v[192:207]
    ds_read_b128 v[228:231], v241 offset:2048
    v_add_f32 v251, v251, v182
    v_add_f32 v251, v251, v183
    v_cvt_pk_bf16_f32 v179, v182, v183
    s_waitcnt lgkmcnt(2)
    v_mfma_f32_32x32x16_bf16 v[192:207], v[232:235], a[72:75], v[192:207]
    ds_read_b128 v[232:235], v242 offset:2048
    v_fma_f32 v186, v186, s29, -v248
    v_fma_f32 v187, v187, s29, -v248
    v_exp_f32 v186, v186
    v_mfma_f32_32x32x16_bf16 v[192:207], v[236:239], a[76:79], v[192:207]
    ds_read_b128 v[236:239], v243 offset:2048
    v_exp_f32 v187, v187
    v_add_f32 v251, v251, v184
    v_add_f32 v251, v251, v185
    v_cvt_pk_bf16_f32 v180, v184, v185
    s_waitcnt lgkmcnt(2)
    v_mfma_f32_32x32x16_bf16 v[192:207], v[224:227], a[80:83], v[192:207]
    ds_read_b64_tr_b16 v[224:225], v244 offset:49152
    ds_read_b64_tr_b16 v[226:227], v244 offset:52224
    v_fma_f32 v188, v188, s29, -v248
    v_fma_f32 v189, v189, s29, -v248
    v_exp_f32 v188, v188
    v_mfma_f32_32x32x16_bf16 v[192:207], v[228:231], a[84:87], v[192:207]
    ds_read_b64_tr_b16 v[228:229], v245 offset:49152
    ds_read_b64_tr_b16 v[230:231], v245 offset:52224
    v_exp_f32 v189, v189
    v_add_f32 v251, v251, v186
    v_add_f32 v251, v251, v187
    v_cvt_pk_bf16_f32 v181, v186, v187
    s_waitcnt lgkmcnt(4)
    v_mfma_f32_32x32x16_bf16 v[192:207], v[232:235], a[88:91], v[192:207]
    ds_read_b64_tr_b16 v[232:233], v244 offset:50176
    ds_read_b64_tr_b16 v[234:235], v244 offset:53248
    v_fma_f32 v190, v190, s29, -v248
    v_fma_f32 v191, v191, s29, -v248
    v_exp_f32 v190, v190
    v_mfma_f32_32x32x16_bf16 v[192:207], v[236:239], a[92:95], v[192:207]
    ds_read_b64_tr_b16 v[236:237], v245 offset:50176
    ds_read_b64_tr_b16 v[238:239], v245 offset:53248
    v_exp_f32 v191, v191
    v_add_f32 v251, v251, v188
    v_add_f32 v251, v251, v189
    s_waitcnt lgkmcnt(4)
    v_mfma_f32_32x32x16_bf16 v[128:143], v[224:227], v[208:211], v[128:143]
    s_add_u32 m0, s30, 37760
    s_add_u32 s33, s27, 110592
    ds_read_b64_tr_b16 v[224:225], v244 offset:51200
    ds_read_b64_tr_b16 v[226:227], v244 offset:54272
    v_cvt_pk_bf16_f32 v182, v188, v189
    buffer_load_dwordx4 v246, s[64:67], s33 offen offset:128 nt lds
    v_mfma_f32_32x32x16_bf16 v[144:159], v[228:231], v[208:211], v[144:159]
    ds_read_b64_tr_b16 v[228:229], v245 offset:51200
    ds_read_b64_tr_b16 v[230:231], v245 offset:54272
    v_add_f32 v251, v251, v190
    v_add_f32 v251, v251, v191
    v_cvt_pk_bf16_f32 v183, v190, v191
    s_waitcnt lgkmcnt(4)
    v_mfma_f32_32x32x16_bf16 v[160:175], v[232:235], v[208:211], v[160:175]
    ds_read_b64_tr_b16 v[232:233], v244 offset:55296
    ds_read_b64_tr_b16 v[234:235], v244 offset:58368
    v_max3_f32 v254, v192, v193, v194
    v_max3_f32 v254, v254, v195, v196
    v_max3_f32 v254, v254, v197, v198
    v_mfma_f32_32x32x16_bf16 a[208:223], v[236:239], v[208:211], a[208:223]
    ds_read_b64_tr_b16 v[236:237], v245 offset:55296
    ds_read_b64_tr_b16 v[238:239], v245 offset:58368
    v_max3_f32 v254, v254, v199, v200
    v_max3_f32 v254, v254, v201, v202
    v_max3_f32 v254, v254, v203, v204
    s_waitcnt lgkmcnt(4)
    v_mfma_f32_32x32x16_bf16 a[240:255], v[224:227], v[208:211], a[240:255]
    ds_read_b64_tr_b16 v[224:225], v244 offset:56320
    ds_read_b64_tr_b16 v[226:227], v244 offset:59392
    v_max3_f32 v254, v254, v205, v206
    v_max_f32 v254, v254, v207
    v_fma_f32 v255, v254, s29, -v249
    v_cmp_lt_f32 vcc, s31, v255
    v_mfma_f32_32x32x16_bf16 a[224:239], v[228:231], v[208:211], a[224:239]
    ds_read_b64_tr_b16 v[228:229], v245 offset:56320
    ds_read_b64_tr_b16 v[230:231], v245 offset:59392
    s_cbranch_vccnz L_slow62
L_ret62:
    v_fma_f32 v192, v192, s29, -v249
    v_fma_f32 v193, v193, s29, -v249
    s_waitcnt lgkmcnt(4)
    v_mfma_f32_32x32x16_bf16 v[128:143], v[232:235], v[212:215], v[128:143]
    ds_read_b64_tr_b16 v[232:233], v244 offset:57344
    ds_read_b64_tr_b16 v[234:235], v244 offset:60416
    v_exp_f32 v192, v192
    v_exp_f32 v193, v193
    v_mfma_f32_32x32x16_bf16 v[144:159], v[236:239], v[212:215], v[144:159]
    ds_read_b64_tr_b16 v[236:237], v245 offset:57344
    ds_read_b64_tr_b16 v[238:239], v245 offset:60416
    v_fma_f32 v194, v194, s29, -v249
    v_fma_f32 v195, v195, s29, -v249
    s_waitcnt lgkmcnt(4)
    v_mfma_f32_32x32x16_bf16 v[160:175], v[224:227], v[212:215], v[160:175]
    ds_read_b128 v[224:227], v240 offset:0
    v_exp_f32 v194, v194
    v_exp_f32 v195, v195
    v_mfma_f32_32x32x16_bf16 a[208:223], v[228:231], v[212:215], a[208:223]
    ds_read_b128 v[228:231], v241 offset:0
    v_add_f32 v252, v252, v192
    v_add_f32 v252, v252, v193
    v_cvt_pk_bf16_f32 v192, v192, v193
    s_waitcnt lgkmcnt(2)
    v_mfma_f32_32x32x16_bf16 a[240:255], v[232:235], v[212:215], a[240:255]
    s_add_u32 m0, s30, 86016
    s_add_u32 s33, s27, 122880
    ds_read_b128 v[232:235], v242 offset:0
    buffer_load_dwordx4 v246, s[64:67], s33 offen offset:0 nt lds
    v_mfma_f32_32x32x16_bf16 a[224:239], v[236:239], v[212:215], a[224:239]
    ds_read_b128 v[236:239], v243 offset:0
    v_fma_f32 v196, v196, s29, -v249
    v_fma_f32 v197, v197, s29, -v249
    v_exp_f32 v196, v196
    s_waitcnt lgkmcnt(2)
    v_mfma_f32_32x32x16_bf16 v[208:223], v[224:227], a[96:99], 0
    ds_read_b128 v[224:227], v240 offset:1024
    v_exp_f32 v197, v197
    v_add_f32 v252, v252, v194
    v_mfma_f32_32x32x16_bf16 v[208:223], v[228:231], a[100:103], v[208:223]
    ds_read_b128 v[228:231], v241 offset:1024
    v_add_f32 v252, v252, v195
    v_cvt_pk_bf16_f32 v193, v194, v195
    v_fma_f32 v198, v198, s29, -v249
    v_fma_f32 v199, v199, s29, -v249
    s_waitcnt lgkmcnt(2)
    v_mfma_f32_32x32x16_bf16 v[208:223], v[232:235], a[104:107], v[208:223]
    ds_read_b128 v[232:235], v242 offset:1024
    v_exp_f32 v198, v198
    v_exp_f32 v199, v199
    v_add_f32 v252, v252, v196
    v_mfma_f32_32x32x16_bf16 v[208:223], v[236:239], a[108:111], v[208:223]
    ds_read_b128 v[236:239], v243 offset:1024
    v_add_f32 v252, v252, v197
    v_cvt_pk_bf16_f32 v194, v196, v197
    v_fma_f32 v200, v200, s29, -v249
    v_fma_f32 v201, v201, s29, -v249
    s_waitcnt lgkmcnt(2)
    v_mfma_f32_32x32x16_bf16 v[208:223], v[224:227], a[112:115], v[208:223]
    ds_read_b128 v[224:227], v240 offset:2048
    v_exp_f32 v200, v200
    v_exp_f32 v201, v201
    v_mfma_f32_32x32x16_bf16 v[208:223], v[228:231], a[116:119], v[208:223]
    ds_read_b128 v[228:231], v241 offset:2048
    v_add_f32 v252, v252, v198
    v_add_f32 v252, v252, v199
    v_cvt_pk_bf16_f32 v195, v198, v199
    v_fma_f32 v202, v202, s29, -v249
    s_waitcnt lgkmcnt(2)
    v_mfma_f32_32x32x16_bf16 v[208:223], v[232:235], a[120:123], v[208:223]
    s_add_u32 m0, s30, 38656
    s_add_u32 s33, s27, 110592
    ds_read_b128 v[232:235], v242 offset:2048
    v_fma_f32 v203, v203, s29, -v249
    buffer_load_dwordx4 v246, s[64:67], s33 offen offset:256 nt lds
    v_mfma_f32_32x32x16_bf16 v[208:223], v[236:239], a[124:127], v[208:223]
    ds_read_b128 v[236:239], v243 offset:2048
    v_exp_f32 v202, v202
    v_exp_f32 v203, v203
    v_add_f32 v252, v252, v200
    s_waitcnt lgkmcnt(2)
    v_mfma_f32_32x32x16_bf16 v[208:223], v[224:227], a[128:131], v[208:223]
    ds_read_b64_tr_b16 v[224:225], v244 offset:12288
    ds_read_b64_tr_b16 v[226:227], v244 offset:15360
    v_add_f32 v252, v252, v201
    v_cvt_pk_bf16_f32 v196, v200, v201
    v_fma_f32 v204, v204, s29, -v249
    v_fma_f32 v205, v205, s29, -v249
    v_mfma_f32_32x32x16_bf16 v[208:223], v[228:231], a[132:135], v[208:223]
    ds_read_b64_tr_b16 v[228:229], v245 offset:12288
    ds_read_b64_tr_b16 v[230:231], v245 offset:15360
    v_exp_f32 v204, v204
    v_exp_f32 v205, v205
    s_waitcnt lgkmcnt(4)
    v_mfma_f32_32x32x16_bf16 v[208:223], v[232:235], a[136:139], v[208:223]
    ds_read_b64_tr_b16 v[232:233], v244 offset:13312
    ds_read_b64_tr_b16 v[234:235], v244 offset:16384
    v_add_f32 v252, v252, v202
    v_add_f32 v252, v252, v203
    v_cvt_pk_bf16_f32 v197, v202, v203
    v_fma_f32 v206, v206, s29, -v249
    v_mfma_f32_32x32x16_bf16 v[208:223], v[236:239], a[140:143], v[208:223]
    ds_read_b64_tr_b16 v[236:237], v245 offset:13312
    ds_read_b64_tr_b16 v[238:239], v245 offset:16384
    v_fma_f32 v207, v207, s29, -v249
    v_exp_f32 v206, v206
    v_exp_f32 v207, v207
    s_waitcnt lgkmcnt(4)
    v_mfma_f32_32x32x16_bf16 v[0:15], v[224:227], v[176:179], v[0:15]
    ds_read_b64_tr_b16 v[224:225], v244 offset:14336
    ds_read_b64_tr_b16 v[226:227], v244 offset:17408
    v_add_f32 v252, v252, v204
    v_add_f32 v252, v252, v205
    v_cvt_pk_bf16_f32 v198, v204, v205
    v_mfma_f32_32x32x16_bf16 v[16:31], v[228:231], v[176:179], v[16:31]
    ds_read_b64_tr_b16 v[228:229], v245 offset:14336
    ds_read_b64_tr_b16 v[230:231], v245 offset:17408
    v_add_f32 v252, v252, v206
    v_add_f32 v252, v252, v207
    v_cvt_pk_bf16_f32 v199, v206, v207
    s_waitcnt lgkmcnt(4)
    v_mfma_f32_32x32x16_bf16 v[32:47], v[232:235], v[176:179], v[32:47]
    ds_read_b64_tr_b16 v[232:233], v244 offset:18432
    ds_read_b64_tr_b16 v[234:235], v244 offset:21504
    v_max3_f32 v254, v208, v209, v210
    v_max3_f32 v254, v254, v211, v212
    v_max3_f32 v254, v254, v213, v214
    v_mfma_f32_32x32x16_bf16 a[144:159], v[236:239], v[176:179], a[144:159]
    ds_read_b64_tr_b16 v[236:237], v245 offset:18432
    ds_read_b64_tr_b16 v[238:239], v245 offset:21504
    v_max3_f32 v254, v254, v215, v216
    v_max3_f32 v254, v254, v217, v218
    v_max3_f32 v254, v254, v219, v220
    v_max3_f32 v254, v254, v221, v222
    s_waitcnt lgkmcnt(4)
    v_mfma_f32_32x32x16_bf16 v[48:63], v[224:227], v[176:179], v[48:63]
    ds_read_b64_tr_b16 v[224:225], v244 offset:19456
    ds_read_b64_tr_b16 v[226:227], v244 offset:22528
    v_max_f32 v254, v254, v223
    v_fma_f32 v255, v254, s29, -v250
    v_cmp_lt_f32 vcc, s31, v255
    v_mfma_f32_32x32x16_bf16 a[160:175], v[228:231], v[176:179], a[160:175]
    ds_read_b64_tr_b16 v[228:229], v245 offset:19456
    ds_read_b64_tr_b16 v[230:231], v245 offset:22528
    s_cbranch_vccnz L_slow64
L_ret64:
    v_fma_f32 v208, v208, s29, -v250
    v_fma_f32 v209, v209, s29, -v250
    s_waitcnt lgkmcnt(4)
    v_mfma_f32_32x32x16_bf16 v[0:15], v[232:235], v[180:183], v[0:15]
    ds_read_b64_tr_b16 v[232:233], v244 offset:20480
    ds_read_b64_tr_b16 v[234:235], v244 offset:23552
    v_exp_f32 v208, v208
    v_exp_f32 v209, v209
    v_mfma_f32_32x32x16_bf16 v[16:31], v[236:239], v[180:183], v[16:31]
    s_waitcnt vmcnt(10)
    s_barrier
    s_add_u32 m0, s30, 98304
    s_add_u32 s33, s27, 0
    ds_read_b64_tr_b16 v[236:237], v245 offset:20480
    ds_read_b64_tr_b16 v[238:239], v245 offset:23552
    buffer_load_dwordx4 v247, s[72:75], s33 offen offset:0 nt lds
    s_add_u32 m0, s30, 147456
    s_add_u32 s33, s27, 0
    buffer_load_dwordx4 v246, s[68:71], s33 offen offset:0 nt lds
    s_add_u32 m0, s30, 86912
    s_add_u32 s33, s27, 122880
    buffer_load_dwordx4 v246, s[64:67], s33 offen offset:128 nt lds
    s_waitcnt lgkmcnt(4)
    v_mfma_f32_32x32x16_bf16 v[32:47], v[224:227], v[180:183], v[32:47]
    ds_read_b128 v[224:227], v240 offset:24576
    v_fma_f32 v210, v210, s29, -v250
    v_fma_f32 v211, v211, s29, -v250
    v_exp_f32 v210, v210
    v_mfma_f32_32x32x16_bf16 a[144:159], v[228:231], v[180:183], a[144:159]
    s_add_u32 m0, s30, 99200
    s_add_u32 s33, s27, 0
    ds_read_b128 v[228:231], v241 offset:24576
    buffer_load_dwordx4 v247, s[72:75], s33 offen offset:128 nt lds
    s_add_u32 m0, s30, 148352
    s_add_u32 s33, s27, 0
    buffer_load_dwordx4 v246, s[68:71], s33 offen offset:128 nt lds
    s_waitcnt lgkmcnt(2)
    v_mfma_f32_32x32x16_bf16 v[48:63], v[232:235], v[180:183], v[48:63]
    ds_read_b128 v[232:235], v242 offset:24576
    v_exp_f32 v211, v211
    v_add_f32 v253, v253, v208
    v_mfma_f32_32x32x16_bf16 a[160:175], v[236:239], v[180:183], a[160:175]
    s_add_u32 m0, s30, 100096
    s_add_u32 s33, s27, 0
    ds_read_b128 v[236:239], v243 offset:24576
    buffer_load_dwordx4 v247, s[72:75], s33 offen offset:256 nt lds
    s_add_u32 m0, s30, 149248
    s_add_u32 s33, s27, 0
    buffer_load_dwordx4 v246, s[68:71], s33 offen offset:256 nt lds
    s_waitcnt lgkmcnt(2)
    v_mfma_f32_32x32x16_bf16 v[176:191], v[224:227], a[0:3], 0
    ds_read_b128 v[224:227], v240 offset:25600
    v_add_f32 v253, v253, v209
    v_cvt_pk_bf16_f32 v208, v208, v209
    v_fma_f32 v212, v212, s29, -v250
    v_fma_f32 v213, v213, s29, -v250
    v_mfma_f32_32x32x16_bf16 v[176:191], v[228:231], a[4:7], v[176:191]
    ds_read_b128 v[228:231], v241 offset:25600
    v_exp_f32 v212, v212
    v_exp_f32 v213, v213
    s_waitcnt lgkmcnt(2)
    v_mfma_f32_32x32x16_bf16 v[176:191], v[232:235], a[8:11], v[176:191]
    ds_read_b128 v[232:235], v242 offset:25600
    v_add_f32 v253, v253, v210
    v_add_f32 v253, v253, v211
    v_cvt_pk_bf16_f32 v209, v210, v211
    v_fma_f32 v214, v214, s29, -v250
    v_fma_f32 v215, v215, s29, -v250
    v_mfma_f32_32x32x16_bf16 v[176:191], v[236:239], a[12:15], v[176:191]
    ds_read_b128 v[236:239], v243 offset:25600
    v_exp_f32 v214, v214
    v_exp_f32 v215, v215
    s_waitcnt lgkmcnt(2)
    v_mfma_f32_32x32x16_bf16 v[176:191], v[224:227], a[16:19], v[176:191]
    ds_read_b128 v[224:227], v240 offset:26624
    v_add_f32 v253, v253, v212
    v_add_f32 v253, v253, v213
    v_cvt_pk_bf16_f32 v210, v212, v213
    v_fma_f32 v216, v216, s29, -v250
    v_fma_f32 v217, v217, s29, -v250
    v_mfma_f32_32x32x16_bf16 v[176:191], v[228:231], a[20:23], v[176:191]
    ds_read_b128 v[228:231], v241 offset:26624
    v_exp_f32 v216, v216
    v_exp_f32 v217, v217
    s_waitcnt lgkmcnt(2)
    v_mfma_f32_32x32x16_bf16 v[176:191], v[232:235], a[24:27], v[176:191]
    ds_read_b128 v[232:235], v242 offset:26624
    v_add_f32 v253, v253, v214
    v_add_f32 v253, v253, v215
    v_cvt_pk_bf16_f32 v211, v214, v215
    v_fma_f32 v218, v218, s29, -v250
    v_mfma_f32_32x32x16_bf16 v[176:191], v[236:239], a[28:31], v[176:191]
    ds_read_b128 v[236:239], v243 offset:26624
    v_fma_f32 v219, v219, s29, -v250
    v_exp_f32 v218, v218
    v_exp_f32 v219, v219
    s_waitcnt lgkmcnt(2)
    v_mfma_f32_32x32x16_bf16 v[176:191], v[224:227], a[32:35], v[176:191]
    ds_read_b64_tr_b16 v[224:225], v244 offset:12288
    ds_read_b64_tr_b16 v[226:227], v244 offset:15360
    v_add_f32 v253, v253, v216
    v_add_f32 v253, v253, v217
    v_cvt_pk_bf16_f32 v212, v216, v217
    v_fma_f32 v220, v220, s29, -v250
    v_mfma_f32_32x32x16_bf16 v[176:191], v[228:231], a[36:39], v[176:191]
    ds_read_b64_tr_b16 v[228:229], v245 offset:12288
    ds_read_b64_tr_b16 v[230:231], v245 offset:15360
    v_fma_f32 v221, v221, s29, -v250
    v_exp_f32 v220, v220
    v_exp_f32 v221, v221
    s_waitcnt lgkmcnt(4)
    v_mfma_f32_32x32x16_bf16 v[176:191], v[232:235], a[40:43], v[176:191]
    ds_read_b64_tr_b16 v[232:233], v244 offset:13312
    ds_read_b64_tr_b16 v[234:235], v244 offset:16384
    v_add_f32 v253, v253, v218
    v_add_f32 v253, v253, v219
    v_cvt_pk_bf16_f32 v213, v218, v219
    v_fma_f32 v222, v222, s29, -v250
    v_mfma_f32_32x32x16_bf16 v[176:191], v[236:239], a[44:47], v[176:191]
    ds_read_b64_tr_b16 v[236:237], v245 offset:13312
    ds_read_b64_tr_b16 v[238:239], v245 offset:16384
    v_fma_f32 v223, v223, s29, -v250
    v_exp_f32 v222, v222
    v_exp_f32 v223, v223
    s_waitcnt lgkmcnt(4)
    v_mfma_f32_32x32x16_bf16 v[64:79], v[224:227], v[192:195], v[64:79]
    ds_read_b64_tr_b16 v[224:225], v244 offset:14336
    ds_read_b64_tr_b16 v[226:227], v244 offset:17408
    v_add_f32 v253, v253, v220
    v_add_f32 v253, v253, v221
    v_cvt_pk_bf16_f32 v214, v220, v221
    v_mfma_f32_32x32x16_bf16 v[80:95], v[228:231], v[192:195], v[80:95]
    ds_read_b64_tr_b16 v[228:229], v245 offset:14336
    ds_read_b64_tr_b16 v[230:231], v245 offset:17408
    v_add_f32 v253, v253, v222
    v_add_f32 v253, v253, v223
    v_cvt_pk_bf16_f32 v215, v222, v223
    s_waitcnt lgkmcnt(4)
    v_mfma_f32_32x32x16_bf16 v[96:111], v[232:235], v[192:195], v[96:111]
    ds_read_b64_tr_b16 v[232:233], v244 offset:18432
    ds_read_b64_tr_b16 v[234:235], v244 offset:21504
    v_max3_f32 v254, v176, v177, v178
    v_max3_f32 v254, v254, v179, v180
    v_max3_f32 v254, v254, v181, v182
    v_mfma_f32_32x32x16_bf16 a[176:191], v[236:239], v[192:195], a[176:191]
    ds_read_b64_tr_b16 v[236:237], v245 offset:18432
    ds_read_b64_tr_b16 v[238:239], v245 offset:21504
    v_max3_f32 v254, v254, v183, v184
    v_max3_f32 v254, v254, v185, v186
    v_max3_f32 v254, v254, v187, v188
    s_waitcnt lgkmcnt(4)
    v_mfma_f32_32x32x16_bf16 v[112:127], v[224:227], v[192:195], v[112:127]
    s_add_u32 m0, s30, 87808
    s_add_u32 s33, s27, 122880
    ds_read_b64_tr_b16 v[224:225], v244 offset:19456
    ds_read_b64_tr_b16 v[226:227], v244 offset:22528
    v_max3_f32 v254, v254, v189, v190
    buffer_load_dwordx4 v246, s[64:67], s33 offen offset:256 nt lds
    v_mfma_f32_32x32x16_bf16 a[192:207], v[228:231], v[192:195], a[192:207]
    ds_read_b64_tr_b16 v[228:229], v245 offset:19456
    ds_read_b64_tr_b16 v[230:231], v245 offset:22528
    v_max_f32 v254, v254, v191
    v_fma_f32 v255, v254, s29, -v248
    v_cmp_lt_f32 vcc, s31, v255
    s_waitcnt lgkmcnt(4)
    v_mfma_f32_32x32x16_bf16 v[64:79], v[232:235], v[196:199], v[64:79]
    ds_read_b64_tr_b16 v[232:233], v244 offset:20480
    ds_read_b64_tr_b16 v[234:235], v244 offset:23552
    s_cbranch_vccnz L_slow66
L_ret66:
    v_fma_f32 v176, v176, s29, -v248
    v_fma_f32 v177, v177, s29, -v248
    v_mfma_f32_32x32x16_bf16 v[80:95], v[236:239], v[196:199], v[80:95]
    ds_read_b64_tr_b16 v[236:237], v245 offset:20480
    ds_read_b64_tr_b16 v[238:239], v245 offset:23552
    v_exp_f32 v176, v176
    v_exp_f32 v177, v177
    s_waitcnt lgkmcnt(4)
    v_mfma_f32_32x32x16_bf16 v[96:111], v[224:227], v[196:199], v[96:111]
    ds_read_b128 v[224:227], v240 offset:24576
    v_fma_f32 v178, v178, s29, -v248
    v_fma_f32 v179, v179, s29, -v248
    v_mfma_f32_32x32x16_bf16 a[176:191], v[228:231], v[196:199], a[176:191]
    ds_read_b128 v[228:231], v241 offset:24576
    v_exp_f32 v178, v178
    v_exp_f32 v179, v179
    s_waitcnt lgkmcnt(2)
    v_mfma_f32_32x32x16_bf16 v[112:127], v[232:235], v[196:199], v[112:127]
    ds_read_b128 v[232:235], v242 offset:24576
    v_add_f32 v251, v251, v176
    v_add_f32 v251, v251, v177
    v_cvt_pk_bf16_f32 v176, v176, v177
    v_mfma_f32_32x32x16_bf16 a[192:207], v[236:239], v[196:199], a[192:207]
    ds_read_b128 v[236:239], v243 offset:24576
    v_fma_f32 v180, v180, s29, -v248
    v_fma_f32 v181, v181, s29, -v248
    v_exp_f32 v180, v180
    s_waitcnt lgkmcnt(2)
    v_mfma_f32_32x32x16_bf16 v[192:207], v[224:227], a[48:51], 0
    ds_read_b128 v[224:227], v240 offset:25600
    v_exp_f32 v181, v181
    v_add_f32 v251, v251, v178
    v_mfma_f32_32x32x16_bf16 v[192:207], v[228:231], a[52:55], v[192:207]
    ds_read_b128 v[228:231], v241 offset:25600
    v_add_f32 v251, v251, v179
    v_cvt_pk_bf16_f32 v177, v178, v179
    v_fma_f32 v182, v182, s29, -v248
    v_fma_f32 v183, v183, s29, -v248
    s_waitcnt lgkmcnt(2)
    v_mfma_f32_32x32x16_bf16 v[192:207], v[232:235], a[56:59], v[192:207]
    ds_read_b128 v[232:235], v242 offset:25600
    v_exp_f32 v182, v182
    v_exp_f32 v183, v183
    v_add_f32 v251, v251, v180
    v_mfma_f32_32x32x16_bf16 v[192:207], v[236:239], a[60:63], v[192:207]
    ds_read_b128 v[236:239], v243 offset:25600
    v_add_f32 v251, v251, v181
    v_cvt_pk_bf16_f32 v178, v180, v181
    v_fma_f32 v184, v184, s29, -v248
    v_fma_f32 v185, v185, s29, -v248
    s_waitcnt lgkmcnt(2)
    v_mfma_f32_32x32x16_bf16 v[192:207], v[224:227], a[64:67], v[192:207]
    ds_read_b128 v[224:227], v240 offset:26624
    v_exp_f32 v184, v184
    v_exp_f32 v185, v185
    v_mfma_f32_32x32x16_bf16 v[192:207], v[228:231], a[68:71], v[192:207]
    ds_read_b128 v[228:231], v241 offset:26624
    v_add_f32 v251, v251, v182
    v_add_f32 v251, v251, v183
    v_cvt_pk_bf16_f32 v179, v182, v183
    v_fma_f32 v186, v186, s29, -v248
    s_waitcnt lgkmcnt(2)
    v_mfma_f32_32x32x16_bf16 v[192:207], v[232:235], a[72:75], v[192:207]
    ds_read_b128 v[232:235], v242 offset:26624
    v_fma_f32 v187, v187, s29, -v248
    v_exp_f32 v186, v186
    v_exp_f32 v187, v187
    v_mfma_f32_32x32x16_bf16 v[192:207], v[236:239], a[76:79], v[192:207]
    s_waitcnt vmcnt(8)
    s_barrier
    ds_read_b128 v[236:239], v243 offset:26624
    v_add_f32 v251, v251, v184
    s_waitcnt lgkmcnt(2)
    v_mfma_f32_32x32x16_bf16 v[192:207], v[224:227], a[80:83], v[192:207]
    ds_read_b64_tr_b16 v[224:225], v244 offset:12288
    ds_read_b64_tr_b16 v[226:227], v244 offset:15360
    v_add_f32 v251, v251, v185
    v_cvt_pk_bf16_f32 v180, v184, v185
    v_fma_f32 v188, v188, s29, -v248
    v_fma_f32 v189, v189, s29, -v248
    v_mfma_f32_32x32x16_bf16 v[192:207], v[228:231], a[84:87], v[192:207]
    ds_read_b64_tr_b16 v[228:229], v245 offset:12288
    ds_read_b64_tr_b16 v[230:231], v245 offset:15360
    v_exp_f32 v188, v188
    v_exp_f32 v189, v189
    s_waitcnt lgkmcnt(4)
    v_mfma_f32_32x32x16_bf16 v[192:207], v[232:235], a[88:91], v[192:207]
    ds_read_b64_tr_b16 v[232:233], v244 offset:13312
    ds_read_b64_tr_b16 v[234:235], v244 offset:16384
    v_add_f32 v251, v251, v186
    v_add_f32 v251, v251, v187
    v_cvt_pk_bf16_f32 v181, v186, v187
    v_fma_f32 v190, v190, s29, -v248
    v_mfma_f32_32x32x16_bf16 v[192:207], v[236:239], a[92:95], v[192:207]
    ds_read_b64_tr_b16 v[236:237], v245 offset:13312
    ds_read_b64_tr_b16 v[238:239], v245 offset:16384
    v_fma_f32 v191, v191, s29, -v248
    v_exp_f32 v190, v190
    v_exp_f32 v191, v191
    s_waitcnt lgkmcnt(4)
    v_mfma_f32_32x32x16_bf16 v[128:143], v[224:227], v[208:211], v[128:143]
    ds_read_b64_tr_b16 v[224:225], v244 offset:14336
    ds_read_b64_tr_b16 v[226:227], v244 offset:17408
    v_add_f32 v251, v251, v188
    v_add_f32 v251, v251, v189
    v_cvt_pk_bf16_f32 v182, v188, v189
    s_add_u32 s37, s36, 0xfffe8000
    v_add_u32 v222, s37, v240
    ds_read_b128 a[0:3], v222 offset:0
    v_mfma_f32_32x32x16_bf16 v[144:159], v[228:231], v[208:211], v[144:159]
    ds_read_b64_tr_b16 v[228:229], v245 offset:14336
    ds_read_b64_tr_b16 v[230:231], v245 offset:17408
    v_add_f32 v251, v251, v190
    v_add_f32 v251, v251, v191
    v_cvt_pk_bf16_f32 v183, v190, v191
    v_add_u32 v223, s37, v241
    ds_read_b128 a[4:7], v223 offset:0
    s_waitcnt lgkmcnt(6)
    v_mfma_f32_32x32x16_bf16 v[160:175], v[232:235], v[208:211], v[160:175]
    ds_read_b64_tr_b16 v[232:233], v244 offset:18432
    ds_read_b64_tr_b16 v[234:235], v244 offset:21504
    v_max3_f32 v254, v192, v193, v194
    v_max3_f32 v254, v254, v195, v196
    v_max3_f32 v254, v254, v197, v198
    v_add_u32 v222, s37, v242
    ds_read_b128 a[8:11], v222 offset:0
    v_mfma_f32_32x32x16_bf16 a[208:223], v[236:239], v[208:211], a[208:223]
    ds_read_b64_tr_b16 v[236:237], v245 offset:18432
    ds_read_b64_tr_b16 v[238:239], v245 offset:21504
    v_max3_f32 v254, v254, v199, v200
    v_max3_f32 v254, v254, v201, v202
    v_max3_f32 v254, v254, v203, v204
    v_add_u32 v223, s37, v243
    ds_read_b128 a[12:15], v223 offset:0
    s_waitcnt lgkmcnt(7)
    v_mfma_f32_32x32x16_bf16 a[240:255], v[224:227], v[208:211], a[240:255]
    ds_read_b64_tr_b16 v[224:225], v244 offset:19456
    ds_read_b64_tr_b16 v[226:227], v244 offset:22528
    v_max3_f32 v254, v254, v205, v206
    v_max_f32 v254, v254, v207
    v_fma_f32 v255, v254, s29, -v249
    v_add_u32 v222, s37, v240
    ds_read_b128 a[16:19], v222 offset:1024
    v_mfma_f32_32x32x16_bf16 a[224:239], v[228:231], v[208:211], a[224:239]
    ds_read_b64_tr_b16 v[228:229], v245 offset:19456
    ds_read_b64_tr_b16 v[230:231], v245 offset:22528
    v_cmp_lt_f32 vcc, s31, v255
    s_cbranch_vccnz L_slow68
L_ret68:
    v_fma_f32 v192, v192, s29, -v249
    v_add_u32 v223, s37, v241
    ds_read_b128 a[20:23], v223 offset:1024
    s_waitcnt lgkmcnt(7)
    v_mfma_f32_32x32x16_bf16 v[128:143], v[232:235], v[212:215], v[128:143]
    ds_read_b64_tr_b16 v[232:233], v244 offset:20480
    ds_read_b64_tr_b16 v[234:235], v244 offset:23552
    v_fma_f32 v193, v193, s29, -v249
    v_exp_f32 v192, v192
    v_add_u32 v222, s37, v242
    ds_read_b128 a[24:27], v222 offset:1024
    v_mfma_f32_32x32x16_bf16 v[144:159], v[236:239], v[212:215], v[144:159]
    ds_read_b64_tr_b16 v[236:237], v245 offset:20480
    ds_read_b64_tr_b16 v[238:239], v245 offset:23552
    v_exp_f32 v193, v193
    v_fma_f32 v194, v194, s29, -v249
    v_add_u32 v223, s37, v243
    ds_read_b128 a[28:31], v223 offset:1024
    s_waitcnt lgkmcnt(7)
    v_mfma_f32_32x32x16_bf16 v[160:175], v[224:227], v[212:215], v[160:175]
    ds_read_b128 v[224:227], v240 offset:24576
    v_fma_f32 v195, v195, s29, -v249
    v_exp_f32 v194, v194
    v_add_u32 v222, s37, v240
    ds_read_b128 a[32:35], v222 offset:2048
    v_mfma_f32_32x32x16_bf16 a[208:223], v[228:231], v[212:215], a[208:223]
    ds_read_b128 v[228:231], v241 offset:24576
    v_exp_f32 v195, v195
    v_add_f32 v252, v252, v192
    v_add_u32 v223, s37, v241
    ds_read_b128 a[36:39], v223 offset:2048
    s_waitcnt lgkmcnt(5)
    v_mfma_f32_32x32x16_bf16 a[240:255], v[232:235], v[212:215], a[240:255]
    ds_read_b128 v[232:235], v242 offset:24576
    v_add_f32 v252, v252, v193
    v_cvt_pk_bf16_f32 v192, v192, v193
    v_fma_f32 v196, v196, s29, -v249
    v_add_u32 v222, s37, v242
    ds_read_b128 a[40:43], v222 offset:2048
    v_mfma_f32_32x32x16_bf16 a[224:239], v[236:239], v[212:215], a[224:239]
    ds_read_b128 v[236:239], v243 offset:24576
    v_fma_f32 v197, v197, s29, -v249
    v_exp_f32 v196, v196
    v_add_u32 v223, s37, v243
    ds_read_b128 a[44:47], v223 offset:2048
    s_waitcnt lgkmcnt(5)
    v_mfma_f32_32x32x16_bf16 v[208:223], v[224:227], a[96:99], 0
    ds_read_b128 v[224:227], v240 offset:25600
    v_exp_f32 v197, v197
    v_add_f32 v252, v252, v194
    v_add_f32 v252, v252, v195
    v_mfma_f32_32x32x16_bf16 v[208:223], v[228:231], a[100:103], v[208:223]
    ds_read_b128 v[228:231], v241 offset:25600
    v_cvt_pk_bf16_f32 v193, v194, v195
    v_fma_f32 v198, v198, s29, -v249
    v_fma_f32 v199, v199, s29, -v249
    s_waitcnt lgkmcnt(3)
    v_mfma_f32_32x32x16_bf16 v[208:223], v[232:235], a[104:107], v[208:223]
    ds_read_b128 v[232:235], v242 offset:25600
    v_exp_f32 v198, v198
    v_exp_f32 v199, v199
    v_mfma_f32_32x32x16_bf16 v[208:223], v[236:239], a[108:111], v[208:223]
    ds_read_b128 v[236:239], v243 offset:25600
    v_add_f32 v252, v252, v196
    v_add_f32 v252, v252, v197
    v_cvt_pk_bf16_f32 v194, v196, v197
    v_fma_f32 v200, v200, s29, -v249
    s_waitcnt lgkmcnt(2)
    v_mfma_f32_32x32x16_bf16 v[208:223], v[224:227], a[112:115], v[208:223]
    ds_read_b128 v[224:227], v240 offset:26624
    v_fma_f32 v201, v201, s29, -v249
    v_exp_f32 v200, v200
    v_exp_f32 v201, v201
    v_mfma_f32_32x32x16_bf16 v[208:223], v[228:231], a[116:119], v[208:223]
    ds_read_b128 v[228:231], v241 offset:26624
    v_add_f32 v252, v252, v198
    v_add_f32 v252, v252, v199
    v_cvt_pk_bf16_f32 v195, v198, v199
    s_waitcnt lgkmcnt(2)
    v_mfma_f32_32x32x16_bf16 v[208:223], v[232:235], a[120:123], v[208:223]
    ds_read_b128 v[232:235], v242 offset:26624
    v_fma_f32 v202, v202, s29, -v249
    v_fma_f32 v203, v203, s29, -v249
    v_exp_f32 v202, v202
    v_mfma_f32_32x32x16_bf16 v[208:223], v[236:239], a[124:127], v[208:223]
    ds_read_b128 v[236:239], v243 offset:26624
    v_exp_f32 v203, v203
    v_add_f32 v252, v252, v200
    v_add_f32 v252, v252, v201
    s_waitcnt lgkmcnt(2)
    v_mfma_f32_32x32x16_bf16 v[208:223], v[224:227], a[128:131], v[208:223]
    ds_read_b64_tr_b16 v[224:225], v244 offset:36864
    ds_read_b64_tr_b16 v[226:227], v244 offset:39936
    v_cvt_pk_bf16_f32 v196, v200, v201
    v_fma_f32 v204, v204, s29, -v249
    v_fma_f32 v205, v205, s29, -v249
    v_exp_f32 v204, v204
    v_mfma_f32_32x32x16_bf16 v[208:223], v[228:231], a[132:135], v[208:223]
    ds_read_b64_tr_b16 v[228:229], v245 offset:36864
    ds_read_b64_tr_b16 v[230:231], v245 offset:39936
    v_exp_f32 v205, v205
    v_add_f32 v252, v252, v202
    s_waitcnt lgkmcnt(4)
    v_mfma_f32_32x32x16_bf16 v[208:223], v[232:235], a[136:139], v[208:223]
    ds_read_b64_tr_b16 v[232:233], v244 offset:37888
    ds_read_b64_tr_b16 v[234:235], v244 offset:40960
    v_add_f32 v252, v252, v203
    v_cvt_pk_bf16_f32 v197, v202, v203
    v_fma_f32 v206, v206, s29, -v249
    v_fma_f32 v207, v207, s29, -v249
    v_mfma_f32_32x32x16_bf16 v[208:223], v[236:239], a[140:143], v[208:223]
    ds_read_b64_tr_b16 v[236:237], v245 offset:37888
    ds_read_b64_tr_b16 v[238:239], v245 offset:40960
    v_exp_f32 v206, v206
    v_exp_f32 v207, v207
    s_waitcnt lgkmcnt(4)
    v_mfma_f32_32x32x16_bf16 v[0:15], v[224:227], v[176:179], v[0:15]
    ds_read_b64_tr_b16 v[224:225], v244 offset:38912
    ds_read_b64_tr_b16 v[226:227], v244 offset:41984
    v_add_f32 v252, v252, v204
    v_add_f32 v252, v252, v205
    v_cvt_pk_bf16_f32 v198, v204, v205
    v_mfma_f32_32x32x16_bf16 v[16:31], v[228:231], v[176:179], v[16:31]
    ds_read_b64_tr_b16 v[228:229], v245 offset:38912
    ds_read_b64_tr_b16 v[230:231], v245 offset:41984
    v_add_f32 v252, v252, v206
    v_add_f32 v252, v252, v207
    v_cvt_pk_bf16_f32 v199, v206, v207
    s_waitcnt lgkmcnt(4)
    v_mfma_f32_32x32x16_bf16 v[32:47], v[232:235], v[176:179], v[32:47]
    ds_read_b64_tr_b16 v[232:233], v244 offset:43008
    ds_read_b64_tr_b16 v[234:235], v244 offset:46080
    v_max3_f32 v254, v208, v209, v210
    v_max3_f32 v254, v254, v211, v212
    v_max3_f32 v254, v254, v213, v214
    v_max3_f32 v254, v254, v215, v216
    v_max3_f32 v254, v254, v217, v218
    v_mfma_f32_32x32x16_bf16 a[144:159], v[236:239], v[176:179], a[144:159]
    ds_read_b64_tr_b16 v[236:237], v245 offset:43008
    ds_read_b64_tr_b16 v[238:239], v245 offset:46080
    v_max3_f32 v254, v254, v219, v220
    v_max3_f32 v254, v254, v221, v222
    v_max_f32 v254, v254, v223
    v_fma_f32 v255, v254, s29, -v250
    v_cmp_lt_f32 vcc, s31, v255
    s_waitcnt lgkmcnt(4)
    v_mfma_f32_32x32x16_bf16 v[48:63], v[224:227], v[176:179], v[48:63]
    ds_read_b64_tr_b16 v[224:225], v244 offset:44032
    ds_read_b64_tr_b16 v[226:227], v244 offset:47104
    s_cbranch_vccnz L_slow70
L_ret70:
    v_fma_f32 v208, v208, s29, -v250
    v_fma_f32 v209, v209, s29, -v250
    v_exp_f32 v208, v208
    v_mfma_f32_32x32x16_bf16 a[160:175], v[228:231], v[176:179], a[160:175]
    ds_read_b64_tr_b16 v[228:229], v245 offset:44032
    ds_read_b64_tr_b16 v[230:231], v245 offset:47104
    v_exp_f32 v209, v209
    v_fma_f32 v210, v210, s29, -v250
    v_fma_f32 v211, v211, s29, -v250
    v_exp_f32 v210, v210
    s_waitcnt lgkmcnt(4)
    v_mfma_f32_32x32x16_bf16 v[0:15], v[232:235], v[180:183], v[0:15]
    ds_read_b64_tr_b16 v[232:233], v244 offset:45056
    ds_read_b64_tr_b16 v[234:235], v244 offset:48128
    v_exp_f32 v211, v211
    v_add_f32 v253, v253, v208
    v_add_f32 v253, v253, v209
    v_mfma_f32_32x32x16_bf16 v[16:31], v[236:239], v[180:183], v[16:31]
    s_waitcnt vmcnt(0)
    s_barrier
    s_add_u32 m0, s30, 110592
    s_add_u32 s33, s27, 12288
    ds_read_b64_tr_b16 v[236:237], v245 offset:45056
    ds_read_b64_tr_b16 v[238:239], v245 offset:48128
    buffer_load_dwordx4 v246, s[68:71], s33 offen offset:0 nt lds
    s_add_u32 m0, s30, 0
    s_add_u32 s33, s27, 24576
    buffer_load_dwordx4 v246, s[64:67], s33 offen offset:0 nt lds
    s_waitcnt lgkmcnt(4)
    v_mfma_f32_32x32x16_bf16 v[32:47], v[224:227], v[180:183], v[32:47]
    s_add_u32 m0, s30, 896
    ds_read_b128 v[224:227], v240 offset:49152
    v_cvt_pk_bf16_f32 v208, v208, v209
    v_fma_f32 v212, v212, s29, -v250
    v_fma_f32 v213, v213, s29, -v250
    buffer_load_dwordx4 v246, s[64:67], s33 offen offset:128 nt lds
    v_mfma_f32_32x32x16_bf16 a[144:159], v[228:231], v[180:183], a[144:159]
    s_add_u32 m0, s30, 111488
    s_add_u32 s33, s27, 12288
    ds_read_b128 v[228:231], v241 offset:49152
    buffer_load_dwordx4 v246, s[68:71], s33 offen offset:128 nt lds
    s_add_u32 m0, s30, 1792
    s_add_u32 s33, s27, 24576
    buffer_load_dwordx4 v246, s[64:67], s33 offen offset:256 nt lds
    s_waitcnt lgkmcnt(2)
    v_mfma_f32_32x32x16_bf16 v[48:63], v[232:235], v[180:183], v[48:63]
    s_add_u32 m0, s30, 12288
    s_add_u32 s33, s27, 61440
    ds_read_b128 v[232:235], v242 offset:49152
    v_exp_f32 v212, v212
    buffer_load_dwordx4 v246, s[64:67], s33 offen offset:0 nt lds
    v_mfma_f32_32x32x16_bf16 a[160:175], v[236:239], v[180:183], a[160:175]
    s_add_u32 m0, s30, 112384
    s_add_u32 s33, s27, 12288
    ds_read_b128 v[236:239], v243 offset:49152
    buffer_load_dwordx4 v246, s[68:71], s33 offen offset:256 nt lds
    s_add_u32 m0, s30, 13184
    s_add_u32 s33, s27, 61440
    buffer_load_dwordx4 v246, s[64:67], s33 offen offset:128 nt lds
    v_add_u32 v240, 0xc000, v240
    v_add_u32 v241, 0xc000, v241
    v_add_u32 v242, 0xc000, v242
    v_add_u32 v243, 0xc000, v243
    v_add_u32 v244, 0x9000, v244
    v_add_u32 v245, 0x9000, v245
    s_add_u32 s25, s25, 1
    s_cmp_lt_u32 s25, 4
    s_cbranch_scc1 L_loop
    s_nop 7
    s_waitcnt lgkmcnt(0)
    ds_read_b64_tr_b16 v[224:225], v244 offset:0
    ds_read_b64_tr_b16 v[226:227], v244 offset:3072
    ds_read_b64_tr_b16 v[228:229], v245 offset:0
    ds_read_b64_tr_b16 v[230:231], v245 offset:3072
    ds_read_b64_tr_b16 v[232:233], v244 offset:1024
    ds_read_b64_tr_b16 v[234:235], v244 offset:4096
    ds_read_b64_tr_b16 v[236:237], v245 offset:1024
    ds_read_b64_tr_b16 v[238:239], v245 offset:4096
    s_waitcnt lgkmcnt(6)
    v_mfma_f32_32x32x16_bf16 v[64:79], v[224:227], v[192:195], v[64:79]
    ds_read_b64_tr_b16 v[224:225], v244 offset:2048
    ds_read_b64_tr_b16 v[226:227], v244 offset:5120
    v_mov_b32 v248, v251
    s_nop 1
    v_permlane32_swap_b32 v251, v248
    v_add_f32 v251, v251, v248
    v_rcp_f32 v251, v251
    s_nop 0
    v_mul_f32 v0, v0, v251
    v_mul_f32 v1, v1, v251
    v_mul_f32 v2, v2, v251
    v_mul_f32 v3, v3, v251
    v_mul_f32 v4, v4, v251
    s_waitcnt lgkmcnt(6)
    v_mfma_f32_32x32x16_bf16 v[80:95], v[228:231], v[192:195], v[80:95]
    ds_read_b64_tr_b16 v[228:229], v245 offset:2048
    ds_read_b64_tr_b16 v[230:231], v245 offset:5120
    v_mul_f32 v5, v5, v251
    v_mul_f32 v6, v6, v251
    v_mul_f32 v7, v7, v251
    v_mul_f32 v8, v8, v251
    v_mul_f32 v9, v9, v251
    v_mul_f32 v10, v10, v251
    v_mul_f32 v11, v11, v251
    v_mul_f32 v12, v12, v251
    v_mul_f32 v13, v13, v251
    s_waitcnt lgkmcnt(6)
    v_mfma_f32_32x32x16_bf16 v[96:111], v[232:235], v[192:195], v[96:111]
    ds_read_b64_tr_b16 v[232:233], v244 offset:6144
    ds_read_b64_tr_b16 v[234:235], v244 offset:9216
    v_mul_f32 v14, v14, v251
    v_mul_f32 v15, v15, v251
    v_cvt_pk_bf16_f32 v0, v0, v1
    v_cvt_pk_bf16_f32 v1, v2, v3
    v_cvt_pk_bf16_f32 v2, v4, v5
    v_cvt_pk_bf16_f32 v3, v6, v7
    v_cvt_pk_bf16_f32 v4, v8, v9
    v_cvt_pk_bf16_f32 v5, v10, v11
    v_cvt_pk_bf16_f32 v6, v12, v13
    s_waitcnt lgkmcnt(6)
    v_mfma_f32_32x32x16_bf16 a[176:191], v[236:239], v[192:195], a[176:191]
    ds_read_b64_tr_b16 v[236:237], v245 offset:6144
    ds_read_b64_tr_b16 v[238:239], v245 offset:9216
    v_cvt_pk_bf16_f32 v7, v14, v15
    v_permlane32_swap_b32 v0, v2
    v_permlane32_swap_b32 v1, v3
    v_permlane32_swap_b32 v4, v6
    v_permlane32_swap_b32 v5, v7
    v_mov_b32 v8, v251
    s_add_u32 s32, s36, 0xfffe8000
    v_add_u32 v9, s32, v240
    v_add_u32 v10, s32, v241
    v_add_u32 v11, s32, v242
    v_add_u32 v12, s32, v243
    v_mul_f32 v16, v16, v8
    v_mul_f32 v17, v17, v8
    s_waitcnt lgkmcnt(6)
    v_mfma_f32_32x32x16_bf16 v[112:127], v[224:227], v[192:195], v[112:127]
    ds_read_b64_tr_b16 v[224:225], v244 offset:7168
    ds_read_b64_tr_b16 v[226:227], v244 offset:10240
    v_mul_f32 v18, v18, v8
    v_mul_f32 v19, v19, v8
    v_mul_f32 v20, v20, v8
    v_mul_f32 v21, v21, v8
    v_mul_f32 v22, v22, v8
    v_mul_f32 v23, v23, v8
    v_mul_f32 v24, v24, v8
    v_mul_f32 v25, v25, v8
    v_mul_f32 v26, v26, v8
    s_waitcnt lgkmcnt(6)
    v_mfma_f32_32x32x16_bf16 a[192:207], v[228:231], v[192:195], a[192:207]
    ds_read_b64_tr_b16 v[228:229], v245 offset:7168
    ds_read_b64_tr_b16 v[230:231], v245 offset:10240
    v_mul_f32 v27, v27, v8
    v_mul_f32 v28, v28, v8
    v_mul_f32 v29, v29, v8
    v_mul_f32 v30, v30, v8
    v_mul_f32 v31, v31, v8
    v_cvt_pk_bf16_f32 v16, v16, v17
    v_cvt_pk_bf16_f32 v17, v18, v19
    v_cvt_pk_bf16_f32 v18, v20, v21
    v_cvt_pk_bf16_f32 v19, v22, v23
    s_waitcnt lgkmcnt(6)
    v_mfma_f32_32x32x16_bf16 v[64:79], v[232:235], v[196:199], v[64:79]
    ds_read_b64_tr_b16 v[232:233], v244 offset:8192
    ds_read_b64_tr_b16 v[234:235], v244 offset:11264
    v_cvt_pk_bf16_f32 v20, v24, v25
    v_cvt_pk_bf16_f32 v21, v26, v27
    v_cvt_pk_bf16_f32 v22, v28, v29
    v_cvt_pk_bf16_f32 v23, v30, v31
    v_permlane32_swap_b32 v16, v18
    v_permlane32_swap_b32 v17, v19
    v_permlane32_swap_b32 v20, v22
    v_permlane32_swap_b32 v21, v23
    ds_write_b128 v9, v[0:3] offset:0
    s_waitcnt lgkmcnt(7)
    v_mfma_f32_32x32x16_bf16 v[80:95], v[236:239], v[196:199], v[80:95]
    ds_read_b64_tr_b16 v[236:237], v245 offset:8192
    ds_read_b64_tr_b16 v[238:239], v245 offset:11264
    ds_write_b128 v10, v[4:7] offset:0
    ds_write_b128 v11, v[16:19] offset:0
    ds_write_b128 v12, v[20:23] offset:0
    v_mbcnt_lo_u32_b32 v176, -1, 0
    s_add_u32 s32, s38, 49152
    v_mbcnt_hi_u32_b32 v176, -1, v176
    v_lshlrev_b32 v176, 4, v176
    v_xor_b32 v176, s32, v176
    ds_read_b128 v[180:183], v176 offset:6144
    ds_read_b128 v[176:179], v176 offset:0
    v_mbcnt_lo_u32_b32 v184, -1, 0
    s_add_u32 s32, s39, 49152
    v_mbcnt_hi_u32_b32 v184, -1, v184
    v_lshlrev_b32 v184, 4, v184
    v_xor_b32 v184, s32, v184
    ds_read_b128 v[188:191], v184 offset:9216
    ds_read_b128 v[184:187], v184 offset:3072
    v_exp_f32 v213, v213
    v_add_f32 v253, v253, v210
    v_add_f32 v253, v253, v211
    v_cvt_pk_bf16_f32 v209, v210, v211
    s_waitcnt lgkmcnt(14)
    v_mfma_f32_32x32x16_bf16 v[96:111], v[224:227], v[196:199], v[96:111]
    ds_read_b64_tr_b16 v[224:225], v244 offset:0
    ds_read_b64_tr_b16 v[226:227], v244 offset:3072
    v_fma_f32 v214, v214, s29, -v250
    v_fma_f32 v215, v215, s29, -v250
    v_exp_f32 v214, v214
    v_exp_f32 v215, v215
    v_add_f32 v253, v253, v212
    v_add_f32 v253, v253, v213
    v_cvt_pk_bf16_f32 v210, v212, v213
    v_fma_f32 v216, v216, s29, -v250
    v_fma_f32 v217, v217, s29, -v250
    s_waitcnt lgkmcnt(14)
    v_mfma_f32_32x32x16_bf16 a[176:191], v[228:231], v[196:199], a[176:191]
    ds_read_b64_tr_b16 v[228:229], v245 offset:0
    ds_read_b64_tr_b16 v[230:231], v245 offset:3072
    v_exp_f32 v216, v216
    v_exp_f32 v217, v217
    v_add_f32 v253, v253, v214
    v_add_f32 v253, v253, v215
    v_cvt_pk_bf16_f32 v211, v214, v215
    v_fma_f32 v218, v218, s29, -v250
    v_fma_f32 v219, v219, s29, -v250
    v_exp_f32 v218, v218
    v_exp_f32 v219, v219
    s_waitcnt lgkmcnt(14)
    v_mfma_f32_32x32x16_bf16 v[112:127], v[232:235], v[196:199], v[112:127]
    ds_read_b64_tr_b16 v[232:233], v244 offset:1024
    ds_read_b64_tr_b16 v[234:235], v244 offset:4096
    v_add_f32 v253, v253, v216
    v_add_f32 v253, v253, v217
    s_add_u32 s32, s28, 0
    s_waitcnt lgkmcnt(8)
    buffer_store_dwordx4 v[176:179], v246, s[20:23], s32 offen offset:0 nt
    s_add_u32 s32, s28, 6144
    buffer_store_dwordx4 v[180:183], v246, s[20:23], s32 offen offset:0 nt
    s_add_u32 s32, s28, 3072
    s_waitcnt lgkmcnt(6)
    buffer_store_dwordx4 v[184:187], v246, s[20:23], s32 offen offset:0 nt
    s_add_u32 s32, s28, 9216
    buffer_store_dwordx4 v[188:191], v246, s[20:23], s32 offen offset:0 nt
    v_cvt_pk_bf16_f32 v212, v216, v217
    v_fma_f32 v220, v220, s29, -v250
    v_fma_f32 v221, v221, s29, -v250
    v_mfma_f32_32x32x16_bf16 a[192:207], v[236:239], v[196:199], a[192:207]
    ds_read_b64_tr_b16 v[236:237], v245 offset:1024
    ds_read_b64_tr_b16 v[238:239], v245 offset:4096
    v_exp_f32 v220, v220
    v_exp_f32 v221, v221
    v_add_f32 v253, v253, v218
    v_add_f32 v253, v253, v219
    v_cvt_pk_bf16_f32 v213, v218, v219
    v_fma_f32 v222, v222, s29, -v250
    v_fma_f32 v223, v223, s29, -v250
    v_exp_f32 v222, v222
    v_exp_f32 v223, v223
    v_add_f32 v253, v253, v220
    v_add_f32 v253, v253, v221
    v_cvt_pk_bf16_f32 v214, v220, v221
    v_add_f32 v253, v253, v222
    v_add_f32 v253, v253, v223
    v_cvt_pk_bf16_f32 v215, v222, v223
    s_waitcnt lgkmcnt(6)
    v_mfma_f32_32x32x16_bf16 v[128:143], v[224:227], v[208:211], v[128:143]
    ds_read_b64_tr_b16 v[224:225], v244 offset:2048
    ds_read_b64_tr_b16 v[226:227], v244 offset:5120
    v_mul_f32 v32, v32, v8
    v_mul_f32 v33, v33, v8
    v_mul_f32 v34, v34, v8
    v_mul_f32 v35, v35, v8
    v_mul_f32 v36, v36, v8
    v_mul_f32 v37, v37, v8
    v_mul_f32 v38, v38, v8
    v_mul_f32 v39, v39, v8
    v_mul_f32 v40, v40, v8
    s_waitcnt lgkmcnt(6)
    v_mfma_f32_32x32x16_bf16 v[144:159], v[228:231], v[208:211], v[144:159]
    ds_read_b64_tr_b16 v[228:229], v245 offset:2048
    ds_read_b64_tr_b16 v[230:231], v245 offset:5120
    v_mul_f32 v41, v41, v8
    v_mul_f32 v42, v42, v8
    v_mul_f32 v43, v43, v8
    v_mul_f32 v44, v44, v8
    v_mul_f32 v45, v45, v8
    v_mul_f32 v46, v46, v8
    v_mul_f32 v47, v47, v8
    v_cvt_pk_bf16_f32 v32, v32, v33
    v_cvt_pk_bf16_f32 v33, v34, v35
    s_waitcnt lgkmcnt(6)
    v_mfma_f32_32x32x16_bf16 v[160:175], v[232:235], v[208:211], v[160:175]
    ds_read_b64_tr_b16 v[232:233], v244 offset:6144
    ds_read_b64_tr_b16 v[234:235], v244 offset:9216
    v_cvt_pk_bf16_f32 v34, v36, v37
    v_cvt_pk_bf16_f32 v35, v38, v39
    v_cvt_pk_bf16_f32 v36, v40, v41
    v_cvt_pk_bf16_f32 v37, v42, v43
    v_cvt_pk_bf16_f32 v38, v44, v45
    v_cvt_pk_bf16_f32 v39, v46, v47
    v_permlane32_swap_b32 v32, v34
    v_permlane32_swap_b32 v33, v35
    v_permlane32_swap_b32 v36, v38
    s_waitcnt lgkmcnt(6)
    v_mfma_f32_32x32x16_bf16 a[208:223], v[236:239], v[208:211], a[208:223]
    ds_read_b64_tr_b16 v[236:237], v245 offset:6144
    ds_read_b64_tr_b16 v[238:239], v245 offset:9216
    v_permlane32_swap_b32 v37, v39
    ds_write_b128 v9, v[32:35] offset:1024
    ds_write_b128 v10, v[36:39] offset:1024
    v_accvgpr_read_b32 v16, a144
    v_accvgpr_read_b32 v17, a145
    v_accvgpr_read_b32 v18, a146
    v_accvgpr_read_b32 v19, a147
    v_accvgpr_read_b32 v20, a148
    v_accvgpr_read_b32 v21, a149
    s_waitcnt lgkmcnt(8)
    v_mfma_f32_32x32x16_bf16 a[240:255], v[224:227], v[208:211], a[240:255]
    ds_read_b64_tr_b16 v[224:225], v244 offset:7168
    ds_read_b64_tr_b16 v[226:227], v244 offset:10240
    v_accvgpr_read_b32 v22, a150
    v_accvgpr_read_b32 v23, a151
    v_accvgpr_read_b32 v24, a152
    v_accvgpr_read_b32 v25, a153
    v_accvgpr_read_b32 v26, a154
    v_accvgpr_read_b32 v27, a155
    v_accvgpr_read_b32 v28, a156
    v_accvgpr_read_b32 v29, a157
    v_accvgpr_read_b32 v30, a158
    s_waitcnt lgkmcnt(8)
    v_mfma_f32_32x32x16_bf16 a[224:239], v[228:231], v[208:211], a[224:239]
    ds_read_b64_tr_b16 v[228:229], v245 offset:7168
    ds_read_b64_tr_b16 v[230:231], v245 offset:10240
    v_accvgpr_read_b32 v31, a159
    v_mul_f32 v16, v16, v8
    v_mul_f32 v17, v17, v8
    v_mul_f32 v18, v18, v8
    v_mul_f32 v19, v19, v8
    v_mul_f32 v20, v20, v8
    v_mul_f32 v21, v21, v8
    v_mul_f32 v22, v22, v8
    v_mul_f32 v23, v23, v8
    s_waitcnt lgkmcnt(8)
    v_mfma_f32_32x32x16_bf16 v[128:143], v[232:235], v[212:215], v[128:143]
    ds_read_b64_tr_b16 v[232:233], v244 offset:8192
    ds_read_b64_tr_b16 v[234:235], v244 offset:11264
    v_mul_f32 v24, v24, v8
    v_mul_f32 v25, v25, v8
    v_mul_f32 v26, v26, v8
    v_mul_f32 v27, v27, v8
    v_mul_f32 v28, v28, v8
    v_mul_f32 v29, v29, v8
    v_mul_f32 v30, v30, v8
    v_mul_f32 v31, v31, v8
    v_cvt_pk_bf16_f32 v16, v16, v17
    s_waitcnt lgkmcnt(8)
    v_mfma_f32_32x32x16_bf16 v[144:159], v[236:239], v[212:215], v[144:159]
    ds_read_b64_tr_b16 v[236:237], v245 offset:8192
    ds_read_b64_tr_b16 v[238:239], v245 offset:11264
    v_cvt_pk_bf16_f32 v17, v18, v19
    v_cvt_pk_bf16_f32 v18, v20, v21
    v_cvt_pk_bf16_f32 v19, v22, v23
    v_cvt_pk_bf16_f32 v20, v24, v25
    v_cvt_pk_bf16_f32 v21, v26, v27
    v_cvt_pk_bf16_f32 v22, v28, v29
    v_cvt_pk_bf16_f32 v23, v30, v31
    v_permlane32_swap_b32 v16, v18
    v_permlane32_swap_b32 v17, v19
    s_waitcnt lgkmcnt(6)
    v_mfma_f32_32x32x16_bf16 v[160:175], v[224:227], v[212:215], v[160:175]
    v_permlane32_swap_b32 v20, v22
    v_permlane32_swap_b32 v21, v23
    ds_write_b128 v11, v[16:19] offset:1024
    ds_write_b128 v12, v[20:23] offset:1024
    v_mbcnt_lo_u32_b32 v176, -1, 0
    s_add_u32 s32, s38, 49152
    v_mbcnt_hi_u32_b32 v176, -1, v176
    v_lshlrev_b32 v176, 4, v176
    v_xor_b32 v176, s32, v176
    ds_read_b128 v[180:183], v176 offset:7168
    ds_read_b128 v[176:179], v176 offset:1024
    v_mbcnt_lo_u32_b32 v184, -1, 0
    s_add_u32 s32, s39, 49152
    v_mbcnt_hi_u32_b32 v184, -1, v184
    v_lshlrev_b32 v184, 4, v184
    v_xor_b32 v184, s32, v184
    ds_read_b128 v[188:191], v184 offset:10240
    ds_read_b128 v[184:187], v184 offset:4096
    v_mul_f32 v48, v48, v8
    v_mul_f32 v49, v49, v8
    v_mul_f32 v50, v50, v8
    s_waitcnt lgkmcnt(10)
    v_mfma_f32_32x32x16_bf16 a[208:223], v[228:231], v[212:215], a[208:223]
    v_mul_f32 v51, v51, v8
    v_mul_f32 v52, v52, v8
    v_mul_f32 v53, v53, v8
    v_mul_f32 v54, v54, v8
    v_mul_f32 v55, v55, v8
    v_mul_f32 v56, v56, v8
    v_mul_f32 v57, v57, v8
    v_mul_f32 v58, v58, v8
    v_mul_f32 v59, v59, v8
    s_waitcnt lgkmcnt(8)
    v_mfma_f32_32x32x16_bf16 a[240:255], v[232:235], v[212:215], a[240:255]
    v_mul_f32 v60, v60, v8
    v_mul_f32 v61, v61, v8
    v_mul_f32 v62, v62, v8
    v_mul_f32 v63, v63, v8
    v_cvt_pk_bf16_f32 v48, v48, v49
    v_cvt_pk_bf16_f32 v49, v50, v51
    v_cvt_pk_bf16_f32 v50, v52, v53
    v_cvt_pk_bf16_f32 v51, v54, v55
    v_cvt_pk_bf16_f32 v52, v56, v57
    s_waitcnt lgkmcnt(6)
    v_mfma_f32_32x32x16_bf16 a[224:239], v[236:239], v[212:215], a[224:239]
    v_cvt_pk_bf16_f32 v53, v58, v59
    v_cvt_pk_bf16_f32 v54, v60, v61
    v_cvt_pk_bf16_f32 v55, v62, v63
    s_add_u32 s32, s28, 0
    s_waitcnt lgkmcnt(2)
    buffer_store_dwordx4 v[176:179], v246, s[20:23], s32 offen offset:128 nt
    s_add_u32 s32, s28, 6144
    buffer_store_dwordx4 v[180:183], v246, s[20:23], s32 offen offset:128 nt
    s_add_u32 s32, s28, 3072
    s_waitcnt lgkmcnt(0)
    buffer_store_dwordx4 v[184:187], v246, s[20:23], s32 offen offset:128 nt
    s_add_u32 s32, s28, 9216
    buffer_store_dwordx4 v[188:191], v246, s[20:23], s32 offen offset:128 nt
    v_permlane32_swap_b32 v48, v50
    v_permlane32_swap_b32 v49, v51
    v_permlane32_swap_b32 v52, v54
    v_permlane32_swap_b32 v53, v55
    ds_write_b128 v9, v[48:51] offset:2048
    ds_write_b128 v10, v[52:55] offset:2048
    v_accvgpr_read_b32 v16, a160
    v_accvgpr_read_b32 v17, a161
    v_accvgpr_read_b32 v18, a162
    v_accvgpr_read_b32 v19, a163
    v_accvgpr_read_b32 v20, a164
    v_accvgpr_read_b32 v21, a165
    v_accvgpr_read_b32 v22, a166
    v_accvgpr_read_b32 v23, a167
    v_accvgpr_read_b32 v24, a168
    v_accvgpr_read_b32 v25, a169
    v_accvgpr_read_b32 v26, a170
    v_accvgpr_read_b32 v27, a171
    v_accvgpr_read_b32 v28, a172
    v_accvgpr_read_b32 v29, a173
    v_accvgpr_read_b32 v30, a174
    v_accvgpr_read_b32 v31, a175
    v_mul_f32 v16, v16, v8
    v_mul_f32 v17, v17, v8
    v_mul_f32 v18, v18, v8
    v_mul_f32 v19, v19, v8
    v_mul_f32 v20, v20, v8
    v_mul_f32 v21, v21, v8
    v_mul_f32 v22, v22, v8
    v_mul_f32 v23, v23, v8
    v_mul_f32 v24, v24, v8
    v_mul_f32 v25, v25, v8
    v_mul_f32 v26, v26, v8
    v_mul_f32 v27, v27, v8
    v_mul_f32 v28, v28, v8
    v_mul_f32 v29, v29, v8
    v_mul_f32 v30, v30, v8
    v_mul_f32 v31, v31, v8
    v_cvt_pk_bf16_f32 v16, v16, v17
    v_cvt_pk_bf16_f32 v17, v18, v19
    v_cvt_pk_bf16_f32 v18, v20, v21
    v_cvt_pk_bf16_f32 v19, v22, v23
    v_cvt_pk_bf16_f32 v20, v24, v25
    v_cvt_pk_bf16_f32 v21, v26, v27
    v_cvt_pk_bf16_f32 v22, v28, v29
    v_cvt_pk_bf16_f32 v23, v30, v31
    v_permlane32_swap_b32 v16, v18
    v_permlane32_swap_b32 v17, v19
    v_permlane32_swap_b32 v20, v22
    v_permlane32_swap_b32 v21, v23
    ds_write_b128 v11, v[16:19] offset:2048
    ds_write_b128 v12, v[20:23] offset:2048
    v_mbcnt_lo_u32_b32 v176, -1, 0
    s_add_u32 s32, s38, 49152
    v_mbcnt_hi_u32_b32 v176, -1, v176
    v_lshlrev_b32 v176, 4, v176
    v_xor_b32 v176, s32, v176
    ds_read_b128 v[180:183], v176 offset:8192
    ds_read_b128 v[176:179], v176 offset:2048
    v_mbcnt_lo_u32_b32 v184, -1, 0
    s_add_u32 s32, s39, 49152
    v_mbcnt_hi_u32_b32 v184, -1, v184
    v_lshlrev_b32 v184, 4, v184
    v_xor_b32 v184, s32, v184
    ds_read_b128 v[188:191], v184 offset:11264
    ds_read_b128 v[184:187], v184 offset:5120
    s_waitcnt vmcnt(8)
    s_barrier
    v_mov_b32 v249, v252
    s_nop 1
    v_permlane32_swap_b32 v252, v249
    v_add_f32 v252, v252, v249
    v_rcp_f32 v252, v252
    s_nop 0
    v_mul_f32 v64, v64, v252
    v_mul_f32 v65, v65, v252
    v_mul_f32 v66, v66, v252
    v_mul_f32 v67, v67, v252
    v_mul_f32 v68, v68, v252
    v_mul_f32 v69, v69, v252
    v_mul_f32 v70, v70, v252
    v_mul_f32 v71, v71, v252
    v_mul_f32 v72, v72, v252
    v_mul_f32 v73, v73, v252
    v_mul_f32 v74, v74, v252
    v_mul_f32 v75, v75, v252
    v_mul_f32 v76, v76, v252
    v_mul_f32 v77, v77, v252
    v_mul_f32 v78, v78, v252
    v_mul_f32 v79, v79, v252
    v_cvt_pk_bf16_f32 v64, v64, v65
    v_cvt_pk_bf16_f32 v65, v66, v67
    v_cvt_pk_bf16_f32 v66, v68, v69
    v_cvt_pk_bf16_f32 v67, v70, v71
    s_add_u32 s32, s28, 0
    s_waitcnt lgkmcnt(2)
    buffer_store_dwordx4 v[176:179], v246, s[20:23], s32 offen offset:256 nt
    s_add_u32 s32, s28, 6144
    buffer_store_dwordx4 v[180:183], v246, s[20:23], s32 offen offset:256 nt
    s_add_u32 s32, s28, 3072
    s_waitcnt lgkmcnt(0)
    buffer_store_dwordx4 v[184:187], v246, s[20:23], s32 offen offset:256 nt
    s_add_u32 s32, s28, 9216
    buffer_store_dwordx4 v[188:191], v246, s[20:23], s32 offen offset:256 nt
    v_cvt_pk_bf16_f32 v68, v72, v73
    v_cvt_pk_bf16_f32 v69, v74, v75
    v_cvt_pk_bf16_f32 v70, v76, v77
    v_cvt_pk_bf16_f32 v71, v78, v79
    v_permlane32_swap_b32 v64, v66
    v_permlane32_swap_b32 v65, v67
    v_permlane32_swap_b32 v68, v70
    v_permlane32_swap_b32 v69, v71
    v_mov_b32 v72, v252
    s_add_u32 s32, s36, 0xfffdc000
    v_add_u32 v73, s32, v240
    v_add_u32 v74, s32, v241
    v_add_u32 v75, s32, v242
    v_add_u32 v76, s32, v243
    v_mul_f32 v80, v80, v72
    v_mul_f32 v81, v81, v72
    v_mul_f32 v82, v82, v72
    v_mul_f32 v83, v83, v72
    v_mul_f32 v84, v84, v72
    v_mul_f32 v85, v85, v72
    v_mul_f32 v86, v86, v72
    v_mul_f32 v87, v87, v72
    v_mul_f32 v88, v88, v72
    v_mul_f32 v89, v89, v72
    v_mul_f32 v90, v90, v72
    v_mul_f32 v91, v91, v72
    v_mul_f32 v92, v92, v72
    v_mul_f32 v93, v93, v72
    v_mul_f32 v94, v94, v72
    v_mul_f32 v95, v95, v72
    v_cvt_pk_bf16_f32 v80, v80, v81
    v_cvt_pk_bf16_f32 v81, v82, v83
    v_cvt_pk_bf16_f32 v82, v84, v85
    v_cvt_pk_bf16_f32 v83, v86, v87
    v_cvt_pk_bf16_f32 v84, v88, v89
    v_cvt_pk_bf16_f32 v85, v90, v91
    v_cvt_pk_bf16_f32 v86, v92, v93
    v_cvt_pk_bf16_f32 v87, v94, v95
    v_permlane32_swap_b32 v80, v82
    v_permlane32_swap_b32 v81, v83
    v_permlane32_swap_b32 v84, v86
    v_permlane32_swap_b32 v85, v87
    ds_write_b128 v73, v[64:67] offset:0
    ds_write_b128 v74, v[68:71] offset:0
    ds_write_b128 v75, v[80:83] offset:0
    ds_write_b128 v76, v[84:87] offset:0
    v_mbcnt_lo_u32_b32 v176, -1, 0
    s_add_u32 s32, s38, 0
    v_mbcnt_hi_u32_b32 v176, -1, v176
    v_lshlrev_b32 v176, 4, v176
    v_xor_b32 v176, s32, v176
    ds_read_b128 v[180:183], v176 offset:6144
    ds_read_b128 v[176:179], v176 offset:0
    v_mbcnt_lo_u32_b32 v184, -1, 0
    s_add_u32 s32, s39, 0
    v_mbcnt_hi_u32_b32 v184, -1, v184
    v_lshlrev_b32 v184, 4, v184
    v_xor_b32 v184, s32, v184
    ds_read_b128 v[188:191], v184 offset:9216
    ds_read_b128 v[184:187], v184 offset:3072
    v_mul_f32 v96, v96, v72
    v_mul_f32 v97, v97, v72
    v_mul_f32 v98, v98, v72
    v_mul_f32 v99, v99, v72
    v_mul_f32 v100, v100, v72
    v_mul_f32 v101, v101, v72
    v_mul_f32 v102, v102, v72
    v_mul_f32 v103, v103, v72
    v_mul_f32 v104, v104, v72
    v_mul_f32 v105, v105, v72
    v_mul_f32 v106, v106, v72
    v_mul_f32 v107, v107, v72
    v_mul_f32 v108, v108, v72
    v_mul_f32 v109, v109, v72
    v_mul_f32 v110, v110, v72
    v_mul_f32 v111, v111, v72
    v_cvt_pk_bf16_f32 v96, v96, v97
    v_cvt_pk_bf16_f32 v97, v98, v99
    v_cvt_pk_bf16_f32 v98, v100, v101
    v_cvt_pk_bf16_f32 v99, v102, v103
    v_cvt_pk_bf16_f32 v100, v104, v105
    v_cvt_pk_bf16_f32 v101, v106, v107
    v_cvt_pk_bf16_f32 v102, v108, v109
    v_cvt_pk_bf16_f32 v103, v110, v111
    s_add_u32 s32, s28, 12288
    s_waitcnt lgkmcnt(2)
    buffer_store_dwordx4 v[176:179], v246, s[20:23], s32 offen offset:0 nt
    s_add_u32 s32, s28, 18432
    buffer_store_dwordx4 v[180:183], v246, s[20:23], s32 offen offset:0 nt
    s_add_u32 s32, s28, 15360
    s_waitcnt lgkmcnt(0)
    buffer_store_dwordx4 v[184:187], v246, s[20:23], s32 offen offset:0 nt
    s_add_u32 s32, s28, 21504
    buffer_store_dwordx4 v[188:191], v246, s[20:23], s32 offen offset:0 nt
    v_permlane32_swap_b32 v96, v98
    v_permlane32_swap_b32 v97, v99
    v_permlane32_swap_b32 v100, v102
    v_permlane32_swap_b32 v101, v103
    ds_write_b128 v73, v[96:99] offset:1024
    ds_write_b128 v74, v[100:103] offset:1024
    v_accvgpr_read_b32 v80, a176
    v_accvgpr_read_b32 v81, a177
    v_accvgpr_read_b32 v82, a178
    v_accvgpr_read_b32 v83, a179
    v_accvgpr_read_b32 v84, a180
    v_accvgpr_read_b32 v85, a181
    v_accvgpr_read_b32 v86, a182
    v_accvgpr_read_b32 v87, a183
    v_accvgpr_read_b32 v88, a184
    v_accvgpr_read_b32 v89, a185
    v_accvgpr_read_b32 v90, a186
    v_accvgpr_read_b32 v91, a187
    v_accvgpr_read_b32 v92, a188
    v_accvgpr_read_b32 v93, a189
    v_accvgpr_read_b32 v94, a190
    v_accvgpr_read_b32 v95, a191
    v_mul_f32 v80, v80, v72
    v_mul_f32 v81, v81, v72
    v_mul_f32 v82, v82, v72
    v_mul_f32 v83, v83, v72
    v_mul_f32 v84, v84, v72
    v_mul_f32 v85, v85, v72
    v_mul_f32 v86, v86, v72
    v_mul_f32 v87, v87, v72
    v_mul_f32 v88, v88, v72
    v_mul_f32 v89, v89, v72
    v_mul_f32 v90, v90, v72
    v_mul_f32 v91, v91, v72
    v_mul_f32 v92, v92, v72
    v_mul_f32 v93, v93, v72
    v_mul_f32 v94, v94, v72
    v_mul_f32 v95, v95, v72
    v_cvt_pk_bf16_f32 v80, v80, v81
    v_cvt_pk_bf16_f32 v81, v82, v83
    v_cvt_pk_bf16_f32 v82, v84, v85
    v_cvt_pk_bf16_f32 v83, v86, v87
    v_cvt_pk_bf16_f32 v84, v88, v89
    v_cvt_pk_bf16_f32 v85, v90, v91
    v_cvt_pk_bf16_f32 v86, v92, v93
    v_cvt_pk_bf16_f32 v87, v94, v95
    v_permlane32_swap_b32 v80, v82
    v_permlane32_swap_b32 v81, v83
    v_permlane32_swap_b32 v84, v86
    v_permlane32_swap_b32 v85, v87
    ds_write_b128 v75, v[80:83] offset:1024
    ds_write_b128 v76, v[84:87] offset:1024
    v_mbcnt_lo_u32_b32 v176, -1, 0
    s_add_u32 s32, s38, 0
    v_mbcnt_hi_u32_b32 v176, -1, v176
    v_lshlrev_b32 v176, 4, v176
    v_xor_b32 v176, s32, v176
    ds_read_b128 v[180:183], v176 offset:7168
    ds_read_b128 v[176:179], v176 offset:1024
    v_mbcnt_lo_u32_b32 v184, -1, 0
    s_add_u32 s32, s39, 0
    v_mbcnt_hi_u32_b32 v184, -1, v184
    v_lshlrev_b32 v184, 4, v184
    v_xor_b32 v184, s32, v184
    ds_read_b128 v[188:191], v184 offset:10240
    ds_read_b128 v[184:187], v184 offset:4096
    v_mul_f32 v112, v112, v72
    v_mul_f32 v113, v113, v72
    v_mul_f32 v114, v114, v72
    v_mul_f32 v115, v115, v72
    v_mul_f32 v116, v116, v72
    v_mul_f32 v117, v117, v72
    v_mul_f32 v118, v118, v72
    v_mul_f32 v119, v119, v72
    v_mul_f32 v120, v120, v72
    v_mul_f32 v121, v121, v72
    v_mul_f32 v122, v122, v72
    v_mul_f32 v123, v123, v72
    v_mul_f32 v124, v124, v72
    v_mul_f32 v125, v125, v72
    v_mul_f32 v126, v126, v72
    v_mul_f32 v127, v127, v72
    v_cvt_pk_bf16_f32 v112, v112, v113
    v_cvt_pk_bf16_f32 v113, v114, v115
    v_cvt_pk_bf16_f32 v114, v116, v117
    v_cvt_pk_bf16_f32 v115, v118, v119
    v_cvt_pk_bf16_f32 v116, v120, v121
    v_cvt_pk_bf16_f32 v117, v122, v123
    v_cvt_pk_bf16_f32 v118, v124, v125
    v_cvt_pk_bf16_f32 v119, v126, v127
    s_add_u32 s32, s28, 12288
    s_waitcnt lgkmcnt(2)
    buffer_store_dwordx4 v[176:179], v246, s[20:23], s32 offen offset:128 nt
    s_add_u32 s32, s28, 18432
    buffer_store_dwordx4 v[180:183], v246, s[20:23], s32 offen offset:128 nt
    s_add_u32 s32, s28, 15360
    s_waitcnt lgkmcnt(0)
    buffer_store_dwordx4 v[184:187], v246, s[20:23], s32 offen offset:128 nt
    s_add_u32 s32, s28, 21504
    buffer_store_dwordx4 v[188:191], v246, s[20:23], s32 offen offset:128 nt
    v_permlane32_swap_b32 v112, v114
    v_permlane32_swap_b32 v113, v115
    v_permlane32_swap_b32 v116, v118
    v_permlane32_swap_b32 v117, v119
    ds_write_b128 v73, v[112:115] offset:2048
    ds_write_b128 v74, v[116:119] offset:2048
    v_accvgpr_read_b32 v80, a192
    v_accvgpr_read_b32 v81, a193
    v_accvgpr_read_b32 v82, a194
    v_accvgpr_read_b32 v83, a195
    v_accvgpr_read_b32 v84, a196
    v_accvgpr_read_b32 v85, a197
    v_accvgpr_read_b32 v86, a198
    v_accvgpr_read_b32 v87, a199
    v_accvgpr_read_b32 v88, a200
    v_accvgpr_read_b32 v89, a201
    v_accvgpr_read_b32 v90, a202
    v_accvgpr_read_b32 v91, a203
    v_accvgpr_read_b32 v92, a204
    v_accvgpr_read_b32 v93, a205
    v_accvgpr_read_b32 v94, a206
    v_accvgpr_read_b32 v95, a207
    v_mul_f32 v80, v80, v72
    v_mul_f32 v81, v81, v72
    v_mul_f32 v82, v82, v72
    v_mul_f32 v83, v83, v72
    v_mul_f32 v84, v84, v72
    v_mul_f32 v85, v85, v72
    v_mul_f32 v86, v86, v72
    v_mul_f32 v87, v87, v72
    v_mul_f32 v88, v88, v72
    v_mul_f32 v89, v89, v72
    v_mul_f32 v90, v90, v72
    v_mul_f32 v91, v91, v72
    v_mul_f32 v92, v92, v72
    v_mul_f32 v93, v93, v72
    v_mul_f32 v94, v94, v72
    v_mul_f32 v95, v95, v72
    v_cvt_pk_bf16_f32 v80, v80, v81
    v_cvt_pk_bf16_f32 v81, v82, v83
    v_cvt_pk_bf16_f32 v82, v84, v85
    v_cvt_pk_bf16_f32 v83, v86, v87
    v_cvt_pk_bf16_f32 v84, v88, v89
    v_cvt_pk_bf16_f32 v85, v90, v91
    v_cvt_pk_bf16_f32 v86, v92, v93
    v_cvt_pk_bf16_f32 v87, v94, v95
    v_permlane32_swap_b32 v80, v82
    v_permlane32_swap_b32 v81, v83
    v_permlane32_swap_b32 v84, v86
    v_permlane32_swap_b32 v85, v87
    ds_write_b128 v75, v[80:83] offset:2048
    ds_write_b128 v76, v[84:87] offset:2048
    v_mbcnt_lo_u32_b32 v176, -1, 0
    s_add_u32 s32, s38, 0
    v_mbcnt_hi_u32_b32 v176, -1, v176
    v_lshlrev_b32 v176, 4, v176
    v_xor_b32 v176, s32, v176
    ds_read_b128 v[180:183], v176 offset:8192
    ds_read_b128 v[176:179], v176 offset:2048
    v_mbcnt_lo_u32_b32 v184, -1, 0
    s_add_u32 s32, s39, 0
    v_mbcnt_hi_u32_b32 v184, -1, v184
    v_lshlrev_b32 v184, 4, v184
    v_xor_b32 v184, s32, v184
    ds_read_b128 v[188:191], v184 offset:11264
    ds_read_b128 v[184:187], v184 offset:5120
    v_mov_b32 v250, v253
    s_nop 1
    v_permlane32_swap_b32 v253, v250
    v_add_f32 v253, v253, v250
    v_rcp_f32 v253, v253
    s_nop 0
    v_mul_f32 v128, v128, v253
    v_mul_f32 v129, v129, v253
    v_mul_f32 v130, v130, v253
    v_mul_f32 v131, v131, v253
    v_mul_f32 v132, v132, v253
    v_mul_f32 v133, v133, v253
    v_mul_f32 v134, v134, v253
    v_mul_f32 v135, v135, v253
    v_mul_f32 v136, v136, v253
    v_mul_f32 v137, v137, v253
    v_mul_f32 v138, v138, v253
    v_mul_f32 v139, v139, v253
    v_mul_f32 v140, v140, v253
    v_mul_f32 v141, v141, v253
    v_mul_f32 v142, v142, v253
    v_mul_f32 v143, v143, v253
    v_cvt_pk_bf16_f32 v128, v128, v129
    v_cvt_pk_bf16_f32 v129, v130, v131
    v_cvt_pk_bf16_f32 v130, v132, v133
    v_cvt_pk_bf16_f32 v131, v134, v135
    s_add_u32 s32, s28, 12288
    s_waitcnt lgkmcnt(2)
    buffer_store_dwordx4 v[176:179], v246, s[20:23], s32 offen offset:256 nt
    s_add_u32 s32, s28, 18432
    buffer_store_dwordx4 v[180:183], v246, s[20:23], s32 offen offset:256 nt
    s_add_u32 s32, s28, 15360
    s_waitcnt lgkmcnt(0)
    buffer_store_dwordx4 v[184:187], v246, s[20:23], s32 offen offset:256 nt
    s_add_u32 s32, s28, 21504
    buffer_store_dwordx4 v[188:191], v246, s[20:23], s32 offen offset:256 nt
    v_cvt_pk_bf16_f32 v132, v136, v137
    v_cvt_pk_bf16_f32 v133, v138, v139
    v_cvt_pk_bf16_f32 v134, v140, v141
    v_cvt_pk_bf16_f32 v135, v142, v143
    v_permlane32_swap_b32 v128, v130
    v_permlane32_swap_b32 v129, v131
    v_permlane32_swap_b32 v132, v134
    v_permlane32_swap_b32 v133, v135
    v_mov_b32 v136, v253
    s_add_u32 s32, s36, 0xfffe8000
    v_add_u32 v137, s32, v240
    v_add_u32 v138, s32, v241
    v_add_u32 v139, s32, v242
    v_add_u32 v140, s32, v243
    v_mul_f32 v144, v144, v136
    v_mul_f32 v145, v145, v136
    v_mul_f32 v146, v146, v136
    v_mul_f32 v147, v147, v136
    v_mul_f32 v148, v148, v136
    v_mul_f32 v149, v149, v136
    v_mul_f32 v150, v150, v136
    v_mul_f32 v151, v151, v136
    v_mul_f32 v152, v152, v136
    v_mul_f32 v153, v153, v136
    v_mul_f32 v154, v154, v136
    v_mul_f32 v155, v155, v136
    v_mul_f32 v156, v156, v136
    v_mul_f32 v157, v157, v136
    v_mul_f32 v158, v158, v136
    v_mul_f32 v159, v159, v136
    v_cvt_pk_bf16_f32 v144, v144, v145
    v_cvt_pk_bf16_f32 v145, v146, v147
    v_cvt_pk_bf16_f32 v146, v148, v149
    v_cvt_pk_bf16_f32 v147, v150, v151
    v_cvt_pk_bf16_f32 v148, v152, v153
    v_cvt_pk_bf16_f32 v149, v154, v155
    v_cvt_pk_bf16_f32 v150, v156, v157
    v_cvt_pk_bf16_f32 v151, v158, v159
    v_permlane32_swap_b32 v144, v146
    v_permlane32_swap_b32 v145, v147
    v_permlane32_swap_b32 v148, v150
    v_permlane32_swap_b32 v149, v151
    ds_write_b128 v137, v[128:131] offset:0
    ds_write_b128 v138, v[132:135] offset:0
    ds_write_b128 v139, v[144:147] offset:0
    ds_write_b128 v140, v[148:151] offset:0
    v_mbcnt_lo_u32_b32 v176, -1, 0
    s_add_u32 s32, s38, 49152
    v_mbcnt_hi_u32_b32 v176, -1, v176
    v_lshlrev_b32 v176, 4, v176
    v_xor_b32 v176, s32, v176
    ds_read_b128 v[180:183], v176 offset:6144
    ds_read_b128 v[176:179], v176 offset:0
    v_mbcnt_lo_u32_b32 v184, -1, 0
    s_add_u32 s32, s39, 49152
    v_mbcnt_hi_u32_b32 v184, -1, v184
    v_lshlrev_b32 v184, 4, v184
    v_xor_b32 v184, s32, v184
    ds_read_b128 v[188:191], v184 offset:9216
    ds_read_b128 v[184:187], v184 offset:3072
    v_mul_f32 v160, v160, v136
    v_mul_f32 v161, v161, v136
    v_mul_f32 v162, v162, v136
    v_mul_f32 v163, v163, v136
    v_mul_f32 v164, v164, v136
    v_mul_f32 v165, v165, v136
    v_mul_f32 v166, v166, v136
    v_mul_f32 v167, v167, v136
    v_mul_f32 v168, v168, v136
    v_mul_f32 v169, v169, v136
    v_mul_f32 v170, v170, v136
    v_mul_f32 v171, v171, v136
    v_mul_f32 v172, v172, v136
    v_mul_f32 v173, v173, v136
    v_mul_f32 v174, v174, v136
    v_mul_f32 v175, v175, v136
    v_cvt_pk_bf16_f32 v160, v160, v161
    v_cvt_pk_bf16_f32 v161, v162, v163
    v_cvt_pk_bf16_f32 v162, v164, v165
    v_cvt_pk_bf16_f32 v163, v166, v167
    v_cvt_pk_bf16_f32 v164, v168, v169
    v_cvt_pk_bf16_f32 v165, v170, v171
    v_cvt_pk_bf16_f32 v166, v172, v173
    v_cvt_pk_bf16_f32 v167, v174, v175
    s_add_u32 s32, s28, 24576
    s_waitcnt lgkmcnt(2)
    buffer_store_dwordx4 v[176:179], v246, s[20:23], s32 offen offset:0 nt
    s_add_u32 s32, s28, 30720
    buffer_store_dwordx4 v[180:183], v246, s[20:23], s32 offen offset:0 nt
    s_add_u32 s32, s28, 27648
    s_waitcnt lgkmcnt(0)
    buffer_store_dwordx4 v[184:187], v246, s[20:23], s32 offen offset:0 nt
    s_add_u32 s32, s28, 33792
    buffer_store_dwordx4 v[188:191], v246, s[20:23], s32 offen offset:0 nt
    v_permlane32_swap_b32 v160, v162
    v_permlane32_swap_b32 v161, v163
    v_permlane32_swap_b32 v164, v166
    v_permlane32_swap_b32 v165, v167
    ds_write_b128 v137, v[160:163] offset:1024
    ds_write_b128 v138, v[164:167] offset:1024
    v_accvgpr_read_b32 v144, a208
    v_accvgpr_read_b32 v145, a209
    v_accvgpr_read_b32 v146, a210
    v_accvgpr_read_b32 v147, a211
    v_accvgpr_read_b32 v148, a212
    v_accvgpr_read_b32 v149, a213
    v_accvgpr_read_b32 v150, a214
    v_accvgpr_read_b32 v151, a215
    v_accvgpr_read_b32 v152, a216
    v_accvgpr_read_b32 v153, a217
    v_accvgpr_read_b32 v154, a218
    v_accvgpr_read_b32 v155, a219
    v_accvgpr_read_b32 v156, a220
    v_accvgpr_read_b32 v157, a221
    v_accvgpr_read_b32 v158, a222
    v_accvgpr_read_b32 v159, a223
    v_mul_f32 v144, v144, v136
    v_mul_f32 v145, v145, v136
    v_mul_f32 v146, v146, v136
    v_mul_f32 v147, v147, v136
    v_mul_f32 v148, v148, v136
    v_mul_f32 v149, v149, v136
    v_mul_f32 v150, v150, v136
    v_mul_f32 v151, v151, v136
    v_mul_f32 v152, v152, v136
    v_mul_f32 v153, v153, v136
    v_mul_f32 v154, v154, v136
    v_mul_f32 v155, v155, v136
    v_mul_f32 v156, v156, v136
    v_mul_f32 v157, v157, v136
    v_mul_f32 v158, v158, v136
    v_mul_f32 v159, v159, v136
    v_cvt_pk_bf16_f32 v144, v144, v145
    v_cvt_pk_bf16_f32 v145, v146, v147
    v_cvt_pk_bf16_f32 v146, v148, v149
    v_cvt_pk_bf16_f32 v147, v150, v151
    v_cvt_pk_bf16_f32 v148, v152, v153
    v_cvt_pk_bf16_f32 v149, v154, v155
    v_cvt_pk_bf16_f32 v150, v156, v157
    v_cvt_pk_bf16_f32 v151, v158, v159
    v_permlane32_swap_b32 v144, v146
    v_permlane32_swap_b32 v145, v147
    v_permlane32_swap_b32 v148, v150
    v_permlane32_swap_b32 v149, v151
    ds_write_b128 v139, v[144:147] offset:1024
    ds_write_b128 v140, v[148:151] offset:1024
    v_mbcnt_lo_u32_b32 v176, -1, 0
    s_add_u32 s32, s38, 49152
    v_mbcnt_hi_u32_b32 v176, -1, v176
    v_lshlrev_b32 v176, 4, v176
    v_xor_b32 v176, s32, v176
    ds_read_b128 v[180:183], v176 offset:7168
    ds_read_b128 v[176:179], v176 offset:1024
    v_mbcnt_lo_u32_b32 v184, -1, 0
    s_add_u32 s32, s39, 49152
    v_mbcnt_hi_u32_b32 v184, -1, v184
    v_lshlrev_b32 v184, 4, v184
    v_xor_b32 v184, s32, v184
    ds_read_b128 v[188:191], v184 offset:10240
    ds_read_b128 v[184:187], v184 offset:4096
    v_accvgpr_read_b32 v144, a240
    v_accvgpr_read_b32 v145, a241
    v_accvgpr_read_b32 v146, a242
    v_accvgpr_read_b32 v147, a243
    v_accvgpr_read_b32 v148, a244
    v_accvgpr_read_b32 v149, a245
    v_accvgpr_read_b32 v150, a246
    v_accvgpr_read_b32 v151, a247
    v_accvgpr_read_b32 v152, a248
    v_accvgpr_read_b32 v153, a249
    v_accvgpr_read_b32 v154, a250
    v_accvgpr_read_b32 v155, a251
    v_accvgpr_read_b32 v156, a252
    v_accvgpr_read_b32 v157, a253
    v_accvgpr_read_b32 v158, a254
    v_accvgpr_read_b32 v159, a255
    v_mul_f32 v144, v144, v136
    v_mul_f32 v145, v145, v136
    v_mul_f32 v146, v146, v136
    v_mul_f32 v147, v147, v136
    v_mul_f32 v148, v148, v136
    v_mul_f32 v149, v149, v136
    v_mul_f32 v150, v150, v136
    v_mul_f32 v151, v151, v136
    s_add_u32 s32, s28, 24576
    s_waitcnt lgkmcnt(2)
    buffer_store_dwordx4 v[176:179], v246, s[20:23], s32 offen offset:128 nt
    s_add_u32 s32, s28, 30720
    buffer_store_dwordx4 v[180:183], v246, s[20:23], s32 offen offset:128 nt
    s_add_u32 s32, s28, 27648
    s_waitcnt lgkmcnt(0)
    buffer_store_dwordx4 v[184:187], v246, s[20:23], s32 offen offset:128 nt
    s_add_u32 s32, s28, 33792
    buffer_store_dwordx4 v[188:191], v246, s[20:23], s32 offen offset:128 nt
    v_mul_f32 v152, v152, v136
    v_mul_f32 v153, v153, v136
    v_mul_f32 v154, v154, v136
    v_mul_f32 v155, v155, v136
    v_mul_f32 v156, v156, v136
    v_mul_f32 v157, v157, v136
    v_mul_f32 v158, v158, v136
    v_mul_f32 v159, v159, v136
    v_cvt_pk_bf16_f32 v144, v144, v145
    v_cvt_pk_bf16_f32 v145, v146, v147
    v_cvt_pk_bf16_f32 v146, v148, v149
    v_cvt_pk_bf16_f32 v147, v150, v151
    v_cvt_pk_bf16_f32 v148, v152, v153
    v_cvt_pk_bf16_f32 v149, v154, v155
    v_cvt_pk_bf16_f32 v150, v156, v157
    v_cvt_pk_bf16_f32 v151, v158, v159
    v_permlane32_swap_b32 v144, v146
    v_permlane32_swap_b32 v145, v147
    v_permlane32_swap_b32 v148, v150
    v_permlane32_swap_b32 v149, v151
    ds_write_b128 v137, v[144:147] offset:2048
    ds_write_b128 v138, v[148:151] offset:2048
    v_accvgpr_read_b32 v144, a224
    v_accvgpr_read_b32 v145, a225
    v_accvgpr_read_b32 v146, a226
    v_accvgpr_read_b32 v147, a227
    v_accvgpr_read_b32 v148, a228
    v_accvgpr_read_b32 v149, a229
    v_accvgpr_read_b32 v150, a230
    v_accvgpr_read_b32 v151, a231
    v_accvgpr_read_b32 v152, a232
    v_accvgpr_read_b32 v153, a233
    v_accvgpr_read_b32 v154, a234
    v_accvgpr_read_b32 v155, a235
    v_accvgpr_read_b32 v156, a236
    v_accvgpr_read_b32 v157, a237
    v_accvgpr_read_b32 v158, a238
    v_accvgpr_read_b32 v159, a239
    v_mul_f32 v144, v144, v136
    v_mul_f32 v145, v145, v136
    v_mul_f32 v146, v146, v136
    v_mul_f32 v147, v147, v136
    v_mul_f32 v148, v148, v136
    v_mul_f32 v149, v149, v136
    v_mul_f32 v150, v150, v136
    v_mul_f32 v151, v151, v136
    v_mul_f32 v152, v152, v136
    v_mul_f32 v153, v153, v136
    v_mul_f32 v154, v154, v136
    v_mul_f32 v155, v155, v136
    v_mul_f32 v156, v156, v136
    v_mul_f32 v157, v157, v136
    v_mul_f32 v158, v158, v136
    v_mul_f32 v159, v159, v136
    v_cvt_pk_bf16_f32 v144, v144, v145
    v_cvt_pk_bf16_f32 v145, v146, v147
    v_cvt_pk_bf16_f32 v146, v148, v149
    v_cvt_pk_bf16_f32 v147, v150, v151
    v_cvt_pk_bf16_f32 v148, v152, v153
    v_cvt_pk_bf16_f32 v149, v154, v155
    v_cvt_pk_bf16_f32 v150, v156, v157
    v_cvt_pk_bf16_f32 v151, v158, v159
    v_permlane32_swap_b32 v144, v146
    v_permlane32_swap_b32 v145, v147
    v_permlane32_swap_b32 v148, v150
    v_permlane32_swap_b32 v149, v151
    ds_write_b128 v139, v[144:147] offset:2048
    ds_write_b128 v140, v[148:151] offset:2048
    v_mbcnt_lo_u32_b32 v176, -1, 0
    s_add_u32 s32, s38, 49152
    v_mbcnt_hi_u32_b32 v176, -1, v176
    v_lshlrev_b32 v176, 4, v176
    v_xor_b32 v176, s32, v176
    ds_read_b128 v[180:183], v176 offset:8192
    ds_read_b128 v[176:179], v176 offset:2048
    v_mbcnt_lo_u32_b32 v184, -1, 0
    s_add_u32 s32, s39, 49152
    v_mbcnt_hi_u32_b32 v184, -1, v184
    v_lshlrev_b32 v184, 4, v184
    v_xor_b32 v184, s32, v184
    ds_read_b128 v[188:191], v184 offset:11264
    ds_read_b128 v[184:187], v184 offset:5120
    s_add_u32 s32, s28, 24576
    s_waitcnt lgkmcnt(2)
    buffer_store_dwordx4 v[176:179], v246, s[20:23], s32 offen offset:256 nt
    s_add_u32 s32, s28, 30720
    buffer_store_dwordx4 v[180:183], v246, s[20:23], s32 offen offset:256 nt
    s_add_u32 s32, s28, 27648
    s_waitcnt lgkmcnt(0)
    buffer_store_dwordx4 v[184:187], v246, s[20:23], s32 offen offset:256 nt
    s_add_u32 s32, s28, 33792
    buffer_store_dwordx4 v[188:191], v246, s[20:23], s32 offen offset:256 nt
L_end:
    s_endpgm
L_slow6first:
    s_nop 1
    v_mov_b32 v255, v254
    s_nop 1
    v_permlane32_swap_b32 v254, v255
    v_max_f32 v254, v254, v255
    v_mul_f32 v254, s29, v254
    v_max_f32 v254, v254, v248
    v_sub_f32 v255, v248, v254
    v_exp_f32 v255, v255
    v_mov_b32 v248, v254
    v_mul_f32 v251, v251, v255
    v_mul_f32 v0, v0, v255
    v_mul_f32 v1, v1, v255
    v_mul_f32 v2, v2, v255
    v_mul_f32 v3, v3, v255
    v_mul_f32 v4, v4, v255
    v_mul_f32 v5, v5, v255
    v_mul_f32 v6, v6, v255
    v_mul_f32 v7, v7, v255
    v_mul_f32 v8, v8, v255
    v_mul_f32 v9, v9, v255
    v_mul_f32 v10, v10, v255
    v_mul_f32 v11, v11, v255
    v_mul_f32 v12, v12, v255
    v_mul_f32 v13, v13, v255
    v_mul_f32 v14, v14, v255
    v_mul_f32 v15, v15, v255
    v_mul_f32 v16, v16, v255
    v_mul_f32 v17, v17, v255
    v_mul_f32 v18, v18, v255
    v_mul_f32 v19, v19, v255
    v_mul_f32 v20, v20, v255
    v_mul_f32 v21, v21, v255
    v_mul_f32 v22, v22, v255
    v_mul_f32 v23, v23, v255
    v_mul_f32 v24, v24, v255
    v_mul_f32 v25, v25, v255
    v_mul_f32 v26, v26, v255
    v_mul_f32 v27, v27, v255
    v_mul_f32 v28, v28, v255
    v_mul_f32 v29, v29, v255
    v_mul_f32 v30, v30, v255
    v_mul_f32 v31, v31, v255
    v_mul_f32 v32, v32, v255
    v_mul_f32 v33, v33, v255
    v_mul_f32 v34, v34, v255
    v_mul_f32 v35, v35, v255
    v_mul_f32 v36, v36, v255
    v_mul_f32 v37, v37, v255
    v_mul_f32 v38, v38, v255
    v_mul_f32 v39, v39, v255
    v_mul_f32 v40, v40, v255
    v_mul_f32 v41, v41, v255
    v_mul_f32 v42, v42, v255
    v_mul_f32 v43, v43, v255
    v_mul_f32 v44, v44, v255
    v_mul_f32 v45, v45, v255
    v_mul_f32 v46, v46, v255
    v_mul_f32 v47, v47, v255
    v_accvgpr_read_b32 v254, a144
    v_mul_f32 v254, v254, v255
    v_accvgpr_write_b32 a144, v254
    v_accvgpr_read_b32 v254, a145
    v_mul_f32 v254, v254, v255
    v_accvgpr_write_b32 a145, v254
    v_accvgpr_read_b32 v254, a146
    v_mul_f32 v254, v254, v255
    v_accvgpr_write_b32 a146, v254
    v_accvgpr_read_b32 v254, a147
    v_mul_f32 v254, v254, v255
    v_accvgpr_write_b32 a147, v254
    v_accvgpr_read_b32 v254, a148
    v_mul_f32 v254, v254, v255
    v_accvgpr_write_b32 a148, v254
    v_accvgpr_read_b32 v254, a149
    v_mul_f32 v254, v254, v255
    v_accvgpr_write_b32 a149, v254
    v_accvgpr_read_b32 v254, a150
    v_mul_f32 v254, v254, v255
    v_accvgpr_write_b32 a150, v254
    v_accvgpr_read_b32 v254, a151
    v_mul_f32 v254, v254, v255
    v_accvgpr_write_b32 a151, v254
    v_accvgpr_read_b32 v254, a152
    v_mul_f32 v254, v254, v255
    v_accvgpr_write_b32 a152, v254
    v_accvgpr_read_b32 v254, a153
    v_mul_f32 v254, v254, v255
    v_accvgpr_write_b32 a153, v254
    v_accvgpr_read_b32 v254, a154
    v_mul_f32 v254, v254, v255
    v_accvgpr_write_b32 a154, v254
    v_accvgpr_read_b32 v254, a155
    v_mul_f32 v254, v254, v255
    v_accvgpr_write_b32 a155, v254
    v_accvgpr_read_b32 v254, a156
    v_mul_f32 v254, v254, v255
    v_accvgpr_write_b32 a156, v254
    v_accvgpr_read_b32 v254, a157
    v_mul_f32 v254, v254, v255
    v_accvgpr_write_b32 a157, v254
    v_accvgpr_read_b32 v254, a158
    v_mul_f32 v254, v254, v255
    v_accvgpr_write_b32 a158, v254
    v_accvgpr_read_b32 v254, a159
    v_mul_f32 v254, v254, v255
    v_accvgpr_write_b32 a159, v254
    v_mul_f32 v48, v48, v255
    v_mul_f32 v49, v49, v255
    v_mul_f32 v50, v50, v255
    v_mul_f32 v51, v51, v255
    v_mul_f32 v52, v52, v255
    v_mul_f32 v53, v53, v255
    v_mul_f32 v54, v54, v255
    v_mul_f32 v55, v55, v255
    v_mul_f32 v56, v56, v255
    v_mul_f32 v57, v57, v255
    v_mul_f32 v58, v58, v255
    v_mul_f32 v59, v59, v255
    v_mul_f32 v60, v60, v255
    v_mul_f32 v61, v61, v255
    v_mul_f32 v62, v62, v255
    v_mul_f32 v63, v63, v255
    v_accvgpr_read_b32 v254, a160
    v_mul_f32 v254, v254, v255
    v_accvgpr_write_b32 a160, v254
    v_accvgpr_read_b32 v254, a161
    v_mul_f32 v254, v254, v255
    v_accvgpr_write_b32 a161, v254
    v_accvgpr_read_b32 v254, a162
    v_mul_f32 v254, v254, v255
    v_accvgpr_write_b32 a162, v254
    v_accvgpr_read_b32 v254, a163
    v_mul_f32 v254, v254, v255
    v_accvgpr_write_b32 a163, v254
    v_accvgpr_read_b32 v254, a164
    v_mul_f32 v254, v254, v255
    v_accvgpr_write_b32 a164, v254
    v_accvgpr_read_b32 v254, a165
    v_mul_f32 v254, v254, v255
    v_accvgpr_write_b32 a165, v254
    v_accvgpr_read_b32 v254, a166
    v_mul_f32 v254, v254, v255
    v_accvgpr_write_b32 a166, v254
    v_accvgpr_read_b32 v254, a167
    v_mul_f32 v254, v254, v255
    v_accvgpr_write_b32 a167, v254
    v_accvgpr_read_b32 v254, a168
    v_mul_f32 v254, v254, v255
    v_accvgpr_write_b32 a168, v254
    v_accvgpr_read_b32 v254, a169
    v_mul_f32 v254, v254, v255
    v_accvgpr_write_b32 a169, v254
    v_accvgpr_read_b32 v254, a170
    v_mul_f32 v254, v254, v255
    v_accvgpr_write_b32 a170, v254
    v_accvgpr_read_b32 v254, a171
    v_mul_f32 v254, v254, v255
    v_accvgpr_write_b32 a171, v254
    v_accvgpr_read_b32 v254, a172
    v_mul_f32 v254, v254, v255
    v_accvgpr_write_b32 a172, v254
    v_accvgpr_read_b32 v254, a173
    v_mul_f32 v254, v254, v255
    v_accvgpr_write_b32 a173, v254
    v_accvgpr_read_b32 v254, a174
    v_mul_f32 v254, v254, v255
    v_accvgpr_write_b32 a174, v254
    v_accvgpr_read_b32 v254, a175
    v_mul_f32 v254, v254, v255
    v_accvgpr_write_b32 a175, v254
    s_nop 1
    s_branch L_ret6first
L_slow6:
    s_nop 1
    v_mov_b32 v255, v254
    s_nop 1
    v_permlane32_swap_b32 v254, v255
    v_max_f32 v254, v254, v255
    v_mul_f32 v254, s29, v254
    v_max_f32 v254, v254, v248
    v_sub_f32 v255, v248, v254
    v_exp_f32 v255, v255
    v_mov_b32 v248, v254
    v_mul_f32 v251, v251, v255
    v_mul_f32 v0, v0, v255
    v_mul_f32 v1, v1, v255
    v_mul_f32 v2, v2, v255
    v_mul_f32 v3, v3, v255
    v_mul_f32 v4, v4, v255
    v_mul_f32 v5, v5, v255
    v_mul_f32 v6, v6, v255
    v_mul_f32 v7, v7, v255
    v_mul_f32 v8, v8, v255
    v_mul_f32 v9, v9, v255
    v_mul_f32 v10, v10, v255
    v_mul_f32 v11, v11, v255
    v_mul_f32 v12, v12, v255
    v_mul_f32 v13, v13, v255
    v_mul_f32 v14, v14, v255
    v_mul_f32 v15, v15, v255
    v_mul_f32 v16, v16, v255
    v_mul_f32 v17, v17, v255
    v_mul_f32 v18, v18, v255
    v_mul_f32 v19, v19, v255
    v_mul_f32 v20, v20, v255
    v_mul_f32 v21, v21, v255
    v_mul_f32 v22, v22, v255
    v_mul_f32 v23, v23, v255
    v_mul_f32 v24, v24, v255
    v_mul_f32 v25, v25, v255
    v_mul_f32 v26, v26, v255
    v_mul_f32 v27, v27, v255
    v_mul_f32 v28, v28, v255
    v_mul_f32 v29, v29, v255
    v_mul_f32 v30, v30, v255
    v_mul_f32 v31, v31, v255
    v_mul_f32 v32, v32, v255
    v_mul_f32 v33, v33, v255
    v_mul_f32 v34, v34, v255
    v_mul_f32 v35, v35, v255
    v_mul_f32 v36, v36, v255
    v_mul_f32 v37, v37, v255
    v_mul_f32 v38, v38, v255
    v_mul_f32 v39, v39, v255
    v_mul_f32 v40, v40, v255
    v_mul_f32 v41, v41, v255
    v_mul_f32 v42, v42, v255
    v_mul_f32 v43, v43, v255
    v_mul_f32 v44, v44, v255
    v_mul_f32 v45, v45, v255
    v_mul_f32 v46, v46, v255
    v_mul_f32 v47, v47, v255
    v_accvgpr_read_b32 v254, a144
    v_mul_f32 v254, v254, v255
    v_accvgpr_write_b32 a144, v254
    v_accvgpr_read_b32 v254, a145
    v_mul_f32 v254, v254, v255
    v_accvgpr_write_b32 a145, v254
    v_accvgpr_read_b32 v254, a146
    v_mul_f32 v254, v254, v255
    v_accvgpr_write_b32 a146, v254
    v_accvgpr_read_b32 v254, a147
    v_mul_f32 v254, v254, v255
    v_accvgpr_write_b32 a147, v254
    v_accvgpr_read_b32 v254, a148
    v_mul_f32 v254, v254, v255
    v_accvgpr_write_b32 a148, v254
    v_accvgpr_read_b32 v254, a149
    v_mul_f32 v254, v254, v255
    v_accvgpr_write_b32 a149, v254
    v_accvgpr_read_b32 v254, a150
    v_mul_f32 v254, v254, v255
    v_accvgpr_write_b32 a150, v254
    v_accvgpr_read_b32 v254, a151
    v_mul_f32 v254, v254, v255
    v_accvgpr_write_b32 a151, v254
    v_accvgpr_read_b32 v254, a152
    v_mul_f32 v254, v254, v255
    v_accvgpr_write_b32 a152, v254
    v_accvgpr_read_b32 v254, a153
    v_mul_f32 v254, v254, v255
    v_accvgpr_write_b32 a153, v254
    v_accvgpr_read_b32 v254, a154
    v_mul_f32 v254, v254, v255
    v_accvgpr_write_b32 a154, v254
    v_accvgpr_read_b32 v254, a155
    v_mul_f32 v254, v254, v255
    v_accvgpr_write_b32 a155, v254
    v_accvgpr_read_b32 v254, a156
    v_mul_f32 v254, v254, v255
    v_accvgpr_write_b32 a156, v254
    v_accvgpr_read_b32 v254, a157
    v_mul_f32 v254, v254, v255
    v_accvgpr_write_b32 a157, v254
    v_accvgpr_read_b32 v254, a158
    v_mul_f32 v254, v254, v255
    v_accvgpr_write_b32 a158, v254
    v_accvgpr_read_b32 v254, a159
    v_mul_f32 v254, v254, v255
    v_accvgpr_write_b32 a159, v254
    v_mul_f32 v48, v48, v255
    v_mul_f32 v49, v49, v255
    v_mul_f32 v50, v50, v255
    v_mul_f32 v51, v51, v255
    v_mul_f32 v52, v52, v255
    v_mul_f32 v53, v53, v255
    v_mul_f32 v54, v54, v255
    v_mul_f32 v55, v55, v255
    v_mul_f32 v56, v56, v255
    v_mul_f32 v57, v57, v255
    v_mul_f32 v58, v58, v255
    v_mul_f32 v59, v59, v255
    v_mul_f32 v60, v60, v255
    v_mul_f32 v61, v61, v255
    v_mul_f32 v62, v62, v255
    v_mul_f32 v63, v63, v255
    v_accvgpr_read_b32 v254, a160
    v_mul_f32 v254, v254, v255
    v_accvgpr_write_b32 a160, v254
    v_accvgpr_read_b32 v254, a161
    v_mul_f32 v254, v254, v255
    v_accvgpr_write_b32 a161, v254
    v_accvgpr_read_b32 v254, a162
    v_mul_f32 v254, v254, v255
    v_accvgpr_write_b32 a162, v254
    v_accvgpr_read_b32 v254, a163
    v_mul_f32 v254, v254, v255
    v_accvgpr_write_b32 a163, v254
    v_accvgpr_read_b32 v254, a164
    v_mul_f32 v254, v254, v255
    v_accvgpr_write_b32 a164, v254
    v_accvgpr_read_b32 v254, a165
    v_mul_f32 v254, v254, v255
    v_accvgpr_write_b32 a165, v254
    v_accvgpr_read_b32 v254, a166
    v_mul_f32 v254, v254, v255
    v_accvgpr_write_b32 a166, v254
    v_accvgpr_read_b32 v254, a167
    v_mul_f32 v254, v254, v255
    v_accvgpr_write_b32 a167, v254
    v_accvgpr_read_b32 v254, a168
    v_mul_f32 v254, v254, v255
    v_accvgpr_write_b32 a168, v254
    v_accvgpr_read_b32 v254, a169
    v_mul_f32 v254, v254, v255
    v_accvgpr_write_b32 a169, v254
    v_accvgpr_read_b32 v254, a170
    v_mul_f32 v254, v254, v255
    v_accvgpr_write_b32 a170, v254
    v_accvgpr_read_b32 v254, a171
    v_mul_f32 v254, v254, v255
    v_accvgpr_write_b32 a171, v254
    v_accvgpr_read_b32 v254, a172
    v_mul_f32 v254, v254, v255
    v_accvgpr_write_b32 a172, v254
    v_accvgpr_read_b32 v254, a173
    v_mul_f32 v254, v254, v255
    v_accvgpr_write_b32 a173, v254
    v_accvgpr_read_b32 v254, a174
    v_mul_f32 v254, v254, v255
    v_accvgpr_write_b32 a174, v254
    v_accvgpr_read_b32 v254, a175
    v_mul_f32 v254, v254, v255
    v_accvgpr_write_b32 a175, v254
    s_nop 1
    s_branch L_ret6
L_slow8:
    s_nop 1
    v_mov_b32 v255, v254
    s_nop 1
    v_permlane32_swap_b32 v254, v255
    v_max_f32 v254, v254, v255
    v_mul_f32 v254, s29, v254
    v_max_f32 v254, v254, v249
    v_sub_f32 v255, v249, v254
    v_exp_f32 v255, v255
    v_mov_b32 v249, v254
    v_mul_f32 v252, v252, v255
    v_mul_f32 v64, v64, v255
    v_mul_f32 v65, v65, v255
    v_mul_f32 v66, v66, v255
    v_mul_f32 v67, v67, v255
    v_mul_f32 v68, v68, v255
    v_mul_f32 v69, v69, v255
    v_mul_f32 v70, v70, v255
    v_mul_f32 v71, v71, v255
    v_mul_f32 v72, v72, v255
    v_mul_f32 v73, v73, v255
    v_mul_f32 v74, v74, v255
    v_mul_f32 v75, v75, v255
    v_mul_f32 v76, v76, v255
    v_mul_f32 v77, v77, v255
    v_mul_f32 v78, v78, v255
    v_mul_f32 v79, v79, v255
    v_mul_f32 v80, v80, v255
    v_mul_f32 v81, v81, v255
    v_mul_f32 v82, v82, v255
    v_mul_f32 v83, v83, v255
    v_mul_f32 v84, v84, v255
    v_mul_f32 v85, v85, v255
    v_mul_f32 v86, v86, v255
    v_mul_f32 v87, v87, v255
    v_mul_f32 v88, v88, v255
    v_mul_f32 v89, v89, v255
    v_mul_f32 v90, v90, v255
    v_mul_f32 v91, v91, v255
    v_mul_f32 v92, v92, v255
    v_mul_f32 v93, v93, v255
    v_mul_f32 v94, v94, v255
    v_mul_f32 v95, v95, v255
    v_mul_f32 v96, v96, v255
    v_mul_f32 v97, v97, v255
    v_mul_f32 v98, v98, v255
    v_mul_f32 v99, v99, v255
    v_mul_f32 v100, v100, v255
    v_mul_f32 v101, v101, v255
    v_mul_f32 v102, v102, v255
    v_mul_f32 v103, v103, v255
    v_mul_f32 v104, v104, v255
    v_mul_f32 v105, v105, v255
    v_mul_f32 v106, v106, v255
    v_mul_f32 v107, v107, v255
    v_mul_f32 v108, v108, v255
    v_mul_f32 v109, v109, v255
    v_mul_f32 v110, v110, v255
    v_mul_f32 v111, v111, v255
    v_accvgpr_read_b32 v254, a176
    v_mul_f32 v254, v254, v255
    v_accvgpr_write_b32 a176, v254
    v_accvgpr_read_b32 v254, a177
    v_mul_f32 v254, v254, v255
    v_accvgpr_write_b32 a177, v254
    v_accvgpr_read_b32 v254, a178
    v_mul_f32 v254, v254, v255
    v_accvgpr_write_b32 a178, v254
    v_accvgpr_read_b32 v254, a179
    v_mul_f32 v254, v254, v255
    v_accvgpr_write_b32 a179, v254
    v_accvgpr_read_b32 v254, a180
    v_mul_f32 v254, v254, v255
    v_accvgpr_write_b32 a180, v254
    v_accvgpr_read_b32 v254, a181
    v_mul_f32 v254, v254, v255
    v_accvgpr_write_b32 a181, v254
    v_accvgpr_read_b32 v254, a182
    v_mul_f32 v254, v254, v255
    v_accvgpr_write_b32 a182, v254
    v_accvgpr_read_b32 v254, a183
    v_mul_f32 v254, v254, v255
    v_accvgpr_write_b32 a183, v254
    v_accvgpr_read_b32 v254, a184
    v_mul_f32 v254, v254, v255
    v_accvgpr_write_b32 a184, v254
    v_accvgpr_read_b32 v254, a185
    v_mul_f32 v254, v254, v255
    v_accvgpr_write_b32 a185, v254
    v_accvgpr_read_b32 v254, a186
    v_mul_f32 v254, v254, v255
    v_accvgpr_write_b32 a186, v254
    v_accvgpr_read_b32 v254, a187
    v_mul_f32 v254, v254, v255
    v_accvgpr_write_b32 a187, v254
    v_accvgpr_read_b32 v254, a188
    v_mul_f32 v254, v254, v255
    v_accvgpr_write_b32 a188, v254
    v_accvgpr_read_b32 v254, a189
    v_mul_f32 v254, v254, v255
    v_accvgpr_write_b32 a189, v254
    v_accvgpr_read_b32 v254, a190
    v_mul_f32 v254, v254, v255
    v_accvgpr_write_b32 a190, v254
    v_accvgpr_read_b32 v254, a191
    v_mul_f32 v254, v254, v255
    v_accvgpr_write_b32 a191, v254
    v_mul_f32 v112, v112, v255
    v_mul_f32 v113, v113, v255
    v_mul_f32 v114, v114, v255
    v_mul_f32 v115, v115, v255
    v_mul_f32 v116, v116, v255
    v_mul_f32 v117, v117, v255
    v_mul_f32 v118, v118, v255
    v_mul_f32 v119, v119, v255
    v_mul_f32 v120, v120, v255
    v_mul_f32 v121, v121, v255
    v_mul_f32 v122, v122, v255
    v_mul_f32 v123, v123, v255
    v_mul_f32 v124, v124, v255
    v_mul_f32 v125, v125, v255
    v_mul_f32 v126, v126, v255
    v_mul_f32 v127, v127, v255
    v_accvgpr_read_b32 v254, a192
    v_mul_f32 v254, v254, v255
    v_accvgpr_write_b32 a192, v254
    v_accvgpr_read_b32 v254, a193
    v_mul_f32 v254, v254, v255
    v_accvgpr_write_b32 a193, v254
    v_accvgpr_read_b32 v254, a194
    v_mul_f32 v254, v254, v255
    v_accvgpr_write_b32 a194, v254
    v_accvgpr_read_b32 v254, a195
    v_mul_f32 v254, v254, v255
    v_accvgpr_write_b32 a195, v254
    v_accvgpr_read_b32 v254, a196
    v_mul_f32 v254, v254, v255
    v_accvgpr_write_b32 a196, v254
    v_accvgpr_read_b32 v254, a197
    v_mul_f32 v254, v254, v255
    v_accvgpr_write_b32 a197, v254
    v_accvgpr_read_b32 v254, a198
    v_mul_f32 v254, v254, v255
    v_accvgpr_write_b32 a198, v254
    v_accvgpr_read_b32 v254, a199
    v_mul_f32 v254, v254, v255
    v_accvgpr_write_b32 a199, v254
    v_accvgpr_read_b32 v254, a200
    v_mul_f32 v254, v254, v255
    v_accvgpr_write_b32 a200, v254
    v_accvgpr_read_b32 v254, a201
    v_mul_f32 v254, v254, v255
    v_accvgpr_write_b32 a201, v254
    v_accvgpr_read_b32 v254, a202
    v_mul_f32 v254, v254, v255
    v_accvgpr_write_b32 a202, v254
    v_accvgpr_read_b32 v254, a203
    v_mul_f32 v254, v254, v255
    v_accvgpr_write_b32 a203, v254
    v_accvgpr_read_b32 v254, a204
    v_mul_f32 v254, v254, v255
    v_accvgpr_write_b32 a204, v254
    v_accvgpr_read_b32 v254, a205
    v_mul_f32 v254, v254, v255
    v_accvgpr_write_b32 a205, v254
    v_accvgpr_read_b32 v254, a206
    v_mul_f32 v254, v254, v255
    v_accvgpr_write_b32 a206, v254
    v_accvgpr_read_b32 v254, a207
    v_mul_f32 v254, v254, v255
    v_accvgpr_write_b32 a207, v254
    s_nop 1
    s_branch L_ret8
L_slow10:
    s_nop 1
    v_mov_b32 v255, v254
    s_nop 1
    v_permlane32_swap_b32 v254, v255
    v_max_f32 v254, v254, v255
    v_mul_f32 v254, s29, v254
    v_max_f32 v254, v254, v250
    v_sub_f32 v255, v250, v254
    v_exp_f32 v255, v255
    v_mov_b32 v250, v254
    v_mul_f32 v253, v253, v255
    v_mul_f32 v128, v128, v255
    v_mul_f32 v129, v129, v255
    v_mul_f32 v130, v130, v255
    v_mul_f32 v131, v131, v255
    v_mul_f32 v132, v132, v255
    v_mul_f32 v133, v133, v255
    v_mul_f32 v134, v134, v255
    v_mul_f32 v135, v135, v255
    v_mul_f32 v136, v136, v255
    v_mul_f32 v137, v137, v255
    v_mul_f32 v138, v138, v255
    v_mul_f32 v139, v139, v255
    v_mul_f32 v140, v140, v255
    v_mul_f32 v141, v141, v255
    v_mul_f32 v142, v142, v255
    v_mul_f32 v143, v143, v255
    v_mul_f32 v144, v144, v255
    v_mul_f32 v145, v145, v255
    v_mul_f32 v146, v146, v255
    v_mul_f32 v147, v147, v255
    v_mul_f32 v148, v148, v255
    v_mul_f32 v149, v149, v255
    v_mul_f32 v150, v150, v255
    v_mul_f32 v151, v151, v255
    v_mul_f32 v152, v152, v255
    v_mul_f32 v153, v153, v255
    v_mul_f32 v154, v154, v255
    v_mul_f32 v155, v155, v255
    v_mul_f32 v156, v156, v255
    v_mul_f32 v157, v157, v255
    v_mul_f32 v158, v158, v255
    v_mul_f32 v159, v159, v255
    v_mul_f32 v160, v160, v255
    v_mul_f32 v161, v161, v255
    v_mul_f32 v162, v162, v255
    v_mul_f32 v163, v163, v255
    v_mul_f32 v164, v164, v255
    v_mul_f32 v165, v165, v255
    v_mul_f32 v166, v166, v255
    v_mul_f32 v167, v167, v255
    v_mul_f32 v168, v168, v255
    v_mul_f32 v169, v169, v255
    v_mul_f32 v170, v170, v255
    v_mul_f32 v171, v171, v255
    v_mul_f32 v172, v172, v255
    v_mul_f32 v173, v173, v255
    v_mul_f32 v174, v174, v255
    v_mul_f32 v175, v175, v255
    v_accvgpr_read_b32 v254, a208
    v_mul_f32 v254, v254, v255
    v_accvgpr_write_b32 a208, v254
    v_accvgpr_read_b32 v254, a209
    v_mul_f32 v254, v254, v255
    v_accvgpr_write_b32 a209, v254
    v_accvgpr_read_b32 v254, a210
    v_mul_f32 v254, v254, v255
    v_accvgpr_write_b32 a210, v254
    v_accvgpr_read_b32 v254, a211
    v_mul_f32 v254, v254, v255
    v_accvgpr_write_b32 a211, v254
    v_accvgpr_read_b32 v254, a212
    v_mul_f32 v254, v254, v255
    v_accvgpr_write_b32 a212, v254
    v_accvgpr_read_b32 v254, a213
    v_mul_f32 v254, v254, v255
    v_accvgpr_write_b32 a213, v254
    v_accvgpr_read_b32 v254, a214
    v_mul_f32 v254, v254, v255
    v_accvgpr_write_b32 a214, v254
    v_accvgpr_read_b32 v254, a215
    v_mul_f32 v254, v254, v255
    v_accvgpr_write_b32 a215, v254
    v_accvgpr_read_b32 v254, a216
    v_mul_f32 v254, v254, v255
    v_accvgpr_write_b32 a216, v254
    v_accvgpr_read_b32 v254, a217
    v_mul_f32 v254, v254, v255
    v_accvgpr_write_b32 a217, v254
    v_accvgpr_read_b32 v254, a218
    v_mul_f32 v254, v254, v255
    v_accvgpr_write_b32 a218, v254
    v_accvgpr_read_b32 v254, a219
    v_mul_f32 v254, v254, v255
    v_accvgpr_write_b32 a219, v254
    v_accvgpr_read_b32 v254, a220
    v_mul_f32 v254, v254, v255
    v_accvgpr_write_b32 a220, v254
    v_accvgpr_read_b32 v254, a221
    v_mul_f32 v254, v254, v255
    v_accvgpr_write_b32 a221, v254
    v_accvgpr_read_b32 v254, a222
    v_mul_f32 v254, v254, v255
    v_accvgpr_write_b32 a222, v254
    v_accvgpr_read_b32 v254, a223
    v_mul_f32 v254, v254, v255
    v_accvgpr_write_b32 a223, v254
    v_accvgpr_read_b32 v254, a240
    v_mul_f32 v254, v254, v255
    v_accvgpr_write_b32 a240, v254
    v_accvgpr_read_b32 v254, a241
    v_mul_f32 v254, v254, v255
    v_accvgpr_write_b32 a241, v254
    v_accvgpr_read_b32 v254, a242
    v_mul_f32 v254, v254, v255
    v_accvgpr_write_b32 a242, v254
    v_accvgpr_read_b32 v254, a243
    v_mul_f32 v254, v254, v255
    v_accvgpr_write_b32 a243, v254
    v_accvgpr_read_b32 v254, a244
    v_mul_f32 v254, v254, v255
    v_accvgpr_write_b32 a244, v254
    v_accvgpr_read_b32 v254, a245
    v_mul_f32 v254, v254, v255
    v_accvgpr_write_b32 a245, v254
    v_accvgpr_read_b32 v254, a246
    v_mul_f32 v254, v254, v255
    v_accvgpr_write_b32 a246, v254
    v_accvgpr_read_b32 v254, a247
    v_mul_f32 v254, v254, v255
    v_accvgpr_write_b32 a247, v254
    v_accvgpr_read_b32 v254, a248
    v_mul_f32 v254, v254, v255
    v_accvgpr_write_b32 a248, v254
    v_accvgpr_read_b32 v254, a249
    v_mul_f32 v254, v254, v255
    v_accvgpr_write_b32 a249, v254
    v_accvgpr_read_b32 v254, a250
    v_mul_f32 v254, v254, v255
    v_accvgpr_write_b32 a250, v254
    v_accvgpr_read_b32 v254, a251
    v_mul_f32 v254, v254, v255
    v_accvgpr_write_b32 a251, v254
    v_accvgpr_read_b32 v254, a252
    v_mul_f32 v254, v254, v255
    v_accvgpr_write_b32 a252, v254
    v_accvgpr_read_b32 v254, a253
    v_mul_f32 v254, v254, v255
    v_accvgpr_write_b32 a253, v254
    v_accvgpr_read_b32 v254, a254
    v_mul_f32 v254, v254, v255
    v_accvgpr_write_b32 a254, v254
    v_accvgpr_read_b32 v254, a255
    v_mul_f32 v254, v254, v255
    v_accvgpr_write_b32 a255, v254
    v_accvgpr_read_b32 v254, a224
    v_mul_f32 v254, v254, v255
    v_accvgpr_write_b32 a224, v254
    v_accvgpr_read_b32 v254, a225
    v_mul_f32 v254, v254, v255
    v_accvgpr_write_b32 a225, v254
    v_accvgpr_read_b32 v254, a226
    v_mul_f32 v254, v254, v255
    v_accvgpr_write_b32 a226, v254
    v_accvgpr_read_b32 v254, a227
    v_mul_f32 v254, v254, v255
    v_accvgpr_write_b32 a227, v254
    v_accvgpr_read_b32 v254, a228
    v_mul_f32 v254, v254, v255
    v_accvgpr_write_b32 a228, v254
    v_accvgpr_read_b32 v254, a229
    v_mul_f32 v254, v254, v255
    v_accvgpr_write_b32 a229, v254
    v_accvgpr_read_b32 v254, a230
    v_mul_f32 v254, v254, v255
    v_accvgpr_write_b32 a230, v254
    v_accvgpr_read_b32 v254, a231
    v_mul_f32 v254, v254, v255
    v_accvgpr_write_b32 a231, v254
    v_accvgpr_read_b32 v254, a232
    v_mul_f32 v254, v254, v255
    v_accvgpr_write_b32 a232, v254
    v_accvgpr_read_b32 v254, a233
    v_mul_f32 v254, v254, v255
    v_accvgpr_write_b32 a233, v254
    v_accvgpr_read_b32 v254, a234
    v_mul_f32 v254, v254, v255
    v_accvgpr_write_b32 a234, v254
    v_accvgpr_read_b32 v254, a235
    v_mul_f32 v254, v254, v255
    v_accvgpr_write_b32 a235, v254
    v_accvgpr_read_b32 v254, a236
    v_mul_f32 v254, v254, v255
    v_accvgpr_write_b32 a236, v254
    v_accvgpr_read_b32 v254, a237
    v_mul_f32 v254, v254, v255
    v_accvgpr_write_b32 a237, v254
    v_accvgpr_read_b32 v254, a238
    v_mul_f32 v254, v254, v255
    v_accvgpr_write_b32 a238, v254
    v_accvgpr_read_b32 v254, a239
    v_mul_f32 v254, v254, v255
    v_accvgpr_write_b32 a239, v254
    s_nop 1
    s_branch L_ret10
L_slow12:
    s_nop 1
    v_mov_b32 v255, v254
    s_nop 1
    v_permlane32_swap_b32 v254, v255
    v_max_f32 v254, v254, v255
    v_mul_f32 v254, s29, v254
    v_max_f32 v254, v254, v248
    v_sub_f32 v255, v248, v254
    v_exp_f32 v255, v255
    v_mov_b32 v248, v254
    v_mul_f32 v251, v251, v255
    v_mul_f32 v0, v0, v255
    v_mul_f32 v1, v1, v255
    v_mul_f32 v2, v2, v255
    v_mul_f32 v3, v3, v255
    v_mul_f32 v4, v4, v255
    v_mul_f32 v5, v5, v255
    v_mul_f32 v6, v6, v255
    v_mul_f32 v7, v7, v255
    v_mul_f32 v8, v8, v255
    v_mul_f32 v9, v9, v255
    v_mul_f32 v10, v10, v255
    v_mul_f32 v11, v11, v255
    v_mul_f32 v12, v12, v255
    v_mul_f32 v13, v13, v255
    v_mul_f32 v14, v14, v255
    v_mul_f32 v15, v15, v255
    v_mul_f32 v16, v16, v255
    v_mul_f32 v17, v17, v255
    v_mul_f32 v18, v18, v255
    v_mul_f32 v19, v19, v255
    v_mul_f32 v20, v20, v255
    v_mul_f32 v21, v21, v255
    v_mul_f32 v22, v22, v255
    v_mul_f32 v23, v23, v255
    v_mul_f32 v24, v24, v255
    v_mul_f32 v25, v25, v255
    v_mul_f32 v26, v26, v255
    v_mul_f32 v27, v27, v255
    v_mul_f32 v28, v28, v255
    v_mul_f32 v29, v29, v255
    v_mul_f32 v30, v30, v255
    v_mul_f32 v31, v31, v255
    v_mul_f32 v32, v32, v255
    v_mul_f32 v33, v33, v255
    v_mul_f32 v34, v34, v255
    v_mul_f32 v35, v35, v255
    v_mul_f32 v36, v36, v255
    v_mul_f32 v37, v37, v255
    v_mul_f32 v38, v38, v255
    v_mul_f32 v39, v39, v255
    v_mul_f32 v40, v40, v255
    v_mul_f32 v41, v41, v255
    v_mul_f32 v42, v42, v255
    v_mul_f32 v43, v43, v255
    v_mul_f32 v44, v44, v255
    v_mul_f32 v45, v45, v255
    v_mul_f32 v46, v46, v255
    v_mul_f32 v47, v47, v255
    v_accvgpr_read_b32 v254, a144
    v_mul_f32 v254, v254, v255
    v_accvgpr_write_b32 a144, v254
    v_accvgpr_read_b32 v254, a145
    v_mul_f32 v254, v254, v255
    v_accvgpr_write_b32 a145, v254
    v_accvgpr_read_b32 v254, a146
    v_mul_f32 v254, v254, v255
    v_accvgpr_write_b32 a146, v254
    v_accvgpr_read_b32 v254, a147
    v_mul_f32 v254, v254, v255
    v_accvgpr_write_b32 a147, v254
    v_accvgpr_read_b32 v254, a148
    v_mul_f32 v254, v254, v255
    v_accvgpr_write_b32 a148, v254
    v_accvgpr_read_b32 v254, a149
    v_mul_f32 v254, v254, v255
    v_accvgpr_write_b32 a149, v254
    v_accvgpr_read_b32 v254, a150
    v_mul_f32 v254, v254, v255
    v_accvgpr_write_b32 a150, v254
    v_accvgpr_read_b32 v254, a151
    v_mul_f32 v254, v254, v255
    v_accvgpr_write_b32 a151, v254
    v_accvgpr_read_b32 v254, a152
    v_mul_f32 v254, v254, v255
    v_accvgpr_write_b32 a152, v254
    v_accvgpr_read_b32 v254, a153
    v_mul_f32 v254, v254, v255
    v_accvgpr_write_b32 a153, v254
    v_accvgpr_read_b32 v254, a154
    v_mul_f32 v254, v254, v255
    v_accvgpr_write_b32 a154, v254
    v_accvgpr_read_b32 v254, a155
    v_mul_f32 v254, v254, v255
    v_accvgpr_write_b32 a155, v254
    v_accvgpr_read_b32 v254, a156
    v_mul_f32 v254, v254, v255
    v_accvgpr_write_b32 a156, v254
    v_accvgpr_read_b32 v254, a157
    v_mul_f32 v254, v254, v255
    v_accvgpr_write_b32 a157, v254
    v_accvgpr_read_b32 v254, a158
    v_mul_f32 v254, v254, v255
    v_accvgpr_write_b32 a158, v254
    v_accvgpr_read_b32 v254, a159
    v_mul_f32 v254, v254, v255
    v_accvgpr_write_b32 a159, v254
    v_mul_f32 v48, v48, v255
    v_mul_f32 v49, v49, v255
    v_mul_f32 v50, v50, v255
    v_mul_f32 v51, v51, v255
    v_mul_f32 v52, v52, v255
    v_mul_f32 v53, v53, v255
    v_mul_f32 v54, v54, v255
    v_mul_f32 v55, v55, v255
    v_mul_f32 v56, v56, v255
    v_mul_f32 v57, v57, v255
    v_mul_f32 v58, v58, v255
    v_mul_f32 v59, v59, v255
    v_mul_f32 v60, v60, v255
    v_mul_f32 v61, v61, v255
    v_mul_f32 v62, v62, v255
    v_mul_f32 v63, v63, v255
    v_accvgpr_read_b32 v254, a160
    v_mul_f32 v254, v254, v255
    v_accvgpr_write_b32 a160, v254
    v_accvgpr_read_b32 v254, a161
    v_mul_f32 v254, v254, v255
    v_accvgpr_write_b32 a161, v254
    v_accvgpr_read_b32 v254, a162
    v_mul_f32 v254, v254, v255
    v_accvgpr_write_b32 a162, v254
    v_accvgpr_read_b32 v254, a163
    v_mul_f32 v254, v254, v255
    v_accvgpr_write_b32 a163, v254
    v_accvgpr_read_b32 v254, a164
    v_mul_f32 v254, v254, v255
    v_accvgpr_write_b32 a164, v254
    v_accvgpr_read_b32 v254, a165
    v_mul_f32 v254, v254, v255
    v_accvgpr_write_b32 a165, v254
    v_accvgpr_read_b32 v254, a166
    v_mul_f32 v254, v254, v255
    v_accvgpr_write_b32 a166, v254
    v_accvgpr_read_b32 v254, a167
    v_mul_f32 v254, v254, v255
    v_accvgpr_write_b32 a167, v254
    v_accvgpr_read_b32 v254, a168
    v_mul_f32 v254, v254, v255
    v_accvgpr_write_b32 a168, v254
    v_accvgpr_read_b32 v254, a169
    v_mul_f32 v254, v254, v255
    v_accvgpr_write_b32 a169, v254
    v_accvgpr_read_b32 v254, a170
    v_mul_f32 v254, v254, v255
    v_accvgpr_write_b32 a170, v254
    v_accvgpr_read_b32 v254, a171
    v_mul_f32 v254, v254, v255
    v_accvgpr_write_b32 a171, v254
    v_accvgpr_read_b32 v254, a172
    v_mul_f32 v254, v254, v255
    v_accvgpr_write_b32 a172, v254
    v_accvgpr_read_b32 v254, a173
    v_mul_f32 v254, v254, v255
    v_accvgpr_write_b32 a173, v254
    v_accvgpr_read_b32 v254, a174
    v_mul_f32 v254, v254, v255
    v_accvgpr_write_b32 a174, v254
    v_accvgpr_read_b32 v254, a175
    v_mul_f32 v254, v254, v255
    v_accvgpr_write_b32 a175, v254
    s_nop 1
    s_branch L_ret12
L_slow14:
    s_nop 1
    v_mov_b32 v255, v254
    s_nop 1
    v_permlane32_swap_b32 v254, v255
    v_max_f32 v254, v254, v255
    v_mul_f32 v254, s29, v254
    v_max_f32 v254, v254, v249
    v_sub_f32 v255, v249, v254
    v_exp_f32 v255, v255
    v_mov_b32 v249, v254
    v_mul_f32 v252, v252, v255
    v_mul_f32 v64, v64, v255
    v_mul_f32 v65, v65, v255
    v_mul_f32 v66, v66, v255
    v_mul_f32 v67, v67, v255
    v_mul_f32 v68, v68, v255
    v_mul_f32 v69, v69, v255
    v_mul_f32 v70, v70, v255
    v_mul_f32 v71, v71, v255
    v_mul_f32 v72, v72, v255
    v_mul_f32 v73, v73, v255
    v_mul_f32 v74, v74, v255
    v_mul_f32 v75, v75, v255
    v_mul_f32 v76, v76, v255
    v_mul_f32 v77, v77, v255
    v_mul_f32 v78, v78, v255
    v_mul_f32 v79, v79, v255
    v_mul_f32 v80, v80, v255
    v_mul_f32 v81, v81, v255
    v_mul_f32 v82, v82, v255
    v_mul_f32 v83, v83, v255
    v_mul_f32 v84, v84, v255
    v_mul_f32 v85, v85, v255
    v_mul_f32 v86, v86, v255
    v_mul_f32 v87, v87, v255
    v_mul_f32 v88, v88, v255
    v_mul_f32 v89, v89, v255
    v_mul_f32 v90, v90, v255
    v_mul_f32 v91, v91, v255
    v_mul_f32 v92, v92, v255
    v_mul_f32 v93, v93, v255
    v_mul_f32 v94, v94, v255
    v_mul_f32 v95, v95, v255
    v_mul_f32 v96, v96, v255
    v_mul_f32 v97, v97, v255
    v_mul_f32 v98, v98, v255
    v_mul_f32 v99, v99, v255
    v_mul_f32 v100, v100, v255
    v_mul_f32 v101, v101, v255
    v_mul_f32 v102, v102, v255
    v_mul_f32 v103, v103, v255
    v_mul_f32 v104, v104, v255
    v_mul_f32 v105, v105, v255
    v_mul_f32 v106, v106, v255
    v_mul_f32 v107, v107, v255
    v_mul_f32 v108, v108, v255
    v_mul_f32 v109, v109, v255
    v_mul_f32 v110, v110, v255
    v_mul_f32 v111, v111, v255
    v_accvgpr_read_b32 v254, a176
    v_mul_f32 v254, v254, v255
    v_accvgpr_write_b32 a176, v254
    v_accvgpr_read_b32 v254, a177
    v_mul_f32 v254, v254, v255
    v_accvgpr_write_b32 a177, v254
    v_accvgpr_read_b32 v254, a178
    v_mul_f32 v254, v254, v255
    v_accvgpr_write_b32 a178, v254
    v_accvgpr_read_b32 v254, a179
    v_mul_f32 v254, v254, v255
    v_accvgpr_write_b32 a179, v254
    v_accvgpr_read_b32 v254, a180
    v_mul_f32 v254, v254, v255
    v_accvgpr_write_b32 a180, v254
    v_accvgpr_read_b32 v254, a181
    v_mul_f32 v254, v254, v255
    v_accvgpr_write_b32 a181, v254
    v_accvgpr_read_b32 v254, a182
    v_mul_f32 v254, v254, v255
    v_accvgpr_write_b32 a182, v254
    v_accvgpr_read_b32 v254, a183
    v_mul_f32 v254, v254, v255
    v_accvgpr_write_b32 a183, v254
    v_accvgpr_read_b32 v254, a184
    v_mul_f32 v254, v254, v255
    v_accvgpr_write_b32 a184, v254
    v_accvgpr_read_b32 v254, a185
    v_mul_f32 v254, v254, v255
    v_accvgpr_write_b32 a185, v254
    v_accvgpr_read_b32 v254, a186
    v_mul_f32 v254, v254, v255
    v_accvgpr_write_b32 a186, v254
    v_accvgpr_read_b32 v254, a187
    v_mul_f32 v254, v254, v255
    v_accvgpr_write_b32 a187, v254
    v_accvgpr_read_b32 v254, a188
    v_mul_f32 v254, v254, v255
    v_accvgpr_write_b32 a188, v254
    v_accvgpr_read_b32 v254, a189
    v_mul_f32 v254, v254, v255
    v_accvgpr_write_b32 a189, v254
    v_accvgpr_read_b32 v254, a190
    v_mul_f32 v254, v254, v255
    v_accvgpr_write_b32 a190, v254
    v_accvgpr_read_b32 v254, a191
    v_mul_f32 v254, v254, v255
    v_accvgpr_write_b32 a191, v254
    v_mul_f32 v112, v112, v255
    v_mul_f32 v113, v113, v255
    v_mul_f32 v114, v114, v255
    v_mul_f32 v115, v115, v255
    v_mul_f32 v116, v116, v255
    v_mul_f32 v117, v117, v255
    v_mul_f32 v118, v118, v255
    v_mul_f32 v119, v119, v255
    v_mul_f32 v120, v120, v255
    v_mul_f32 v121, v121, v255
    v_mul_f32 v122, v122, v255
    v_mul_f32 v123, v123, v255
    v_mul_f32 v124, v124, v255
    v_mul_f32 v125, v125, v255
    v_mul_f32 v126, v126, v255
    v_mul_f32 v127, v127, v255
    v_accvgpr_read_b32 v254, a192
    v_mul_f32 v254, v254, v255
    v_accvgpr_write_b32 a192, v254
    v_accvgpr_read_b32 v254, a193
    v_mul_f32 v254, v254, v255
    v_accvgpr_write_b32 a193, v254
    v_accvgpr_read_b32 v254, a194
    v_mul_f32 v254, v254, v255
    v_accvgpr_write_b32 a194, v254
    v_accvgpr_read_b32 v254, a195
    v_mul_f32 v254, v254, v255
    v_accvgpr_write_b32 a195, v254
    v_accvgpr_read_b32 v254, a196
    v_mul_f32 v254, v254, v255
    v_accvgpr_write_b32 a196, v254
    v_accvgpr_read_b32 v254, a197
    v_mul_f32 v254, v254, v255
    v_accvgpr_write_b32 a197, v254
    v_accvgpr_read_b32 v254, a198
    v_mul_f32 v254, v254, v255
    v_accvgpr_write_b32 a198, v254
    v_accvgpr_read_b32 v254, a199
    v_mul_f32 v254, v254, v255
    v_accvgpr_write_b32 a199, v254
    v_accvgpr_read_b32 v254, a200
    v_mul_f32 v254, v254, v255
    v_accvgpr_write_b32 a200, v254
    v_accvgpr_read_b32 v254, a201
    v_mul_f32 v254, v254, v255
    v_accvgpr_write_b32 a201, v254
    v_accvgpr_read_b32 v254, a202
    v_mul_f32 v254, v254, v255
    v_accvgpr_write_b32 a202, v254
    v_accvgpr_read_b32 v254, a203
    v_mul_f32 v254, v254, v255
    v_accvgpr_write_b32 a203, v254
    v_accvgpr_read_b32 v254, a204
    v_mul_f32 v254, v254, v255
    v_accvgpr_write_b32 a204, v254
    v_accvgpr_read_b32 v254, a205
    v_mul_f32 v254, v254, v255
    v_accvgpr_write_b32 a205, v254
    v_accvgpr_read_b32 v254, a206
    v_mul_f32 v254, v254, v255
    v_accvgpr_write_b32 a206, v254
    v_accvgpr_read_b32 v254, a207
    v_mul_f32 v254, v254, v255
    v_accvgpr_write_b32 a207, v254
    s_nop 1
    s_branch L_ret14
L_slow16:
    s_nop 1
    v_mov_b32 v255, v254
    s_nop 1
    v_permlane32_swap_b32 v254, v255
    v_max_f32 v254, v254, v255
    v_mul_f32 v254, s29, v254
    v_max_f32 v254, v254, v250
    v_sub_f32 v255, v250, v254
    v_exp_f32 v255, v255
    v_mov_b32 v250, v254
    v_mul_f32 v253, v253, v255
    v_mul_f32 v128, v128, v255
    v_mul_f32 v129, v129, v255
    v_mul_f32 v130, v130, v255
    v_mul_f32 v131, v131, v255
    v_mul_f32 v132, v132, v255
    v_mul_f32 v133, v133, v255
    v_mul_f32 v134, v134, v255
    v_mul_f32 v135, v135, v255
    v_mul_f32 v136, v136, v255
    v_mul_f32 v137, v137, v255
    v_mul_f32 v138, v138, v255
    v_mul_f32 v139, v139, v255
    v_mul_f32 v140, v140, v255
    v_mul_f32 v141, v141, v255
    v_mul_f32 v142, v142, v255
    v_mul_f32 v143, v143, v255
    v_mul_f32 v144, v144, v255
    v_mul_f32 v145, v145, v255
    v_mul_f32 v146, v146, v255
    v_mul_f32 v147, v147, v255
    v_mul_f32 v148, v148, v255
    v_mul_f32 v149, v149, v255
    v_mul_f32 v150, v150, v255
    v_mul_f32 v151, v151, v255
    v_mul_f32 v152, v152, v255
    v_mul_f32 v153, v153, v255
    v_mul_f32 v154, v154, v255
    v_mul_f32 v155, v155, v255
    v_mul_f32 v156, v156, v255
    v_mul_f32 v157, v157, v255
    v_mul_f32 v158, v158, v255
    v_mul_f32 v159, v159, v255
    v_mul_f32 v160, v160, v255
    v_mul_f32 v161, v161, v255
    v_mul_f32 v162, v162, v255
    v_mul_f32 v163, v163, v255
    v_mul_f32 v164, v164, v255
    v_mul_f32 v165, v165, v255
    v_mul_f32 v166, v166, v255
    v_mul_f32 v167, v167, v255
    v_mul_f32 v168, v168, v255
    v_mul_f32 v169, v169, v255
    v_mul_f32 v170, v170, v255
    v_mul_f32 v171, v171, v255
    v_mul_f32 v172, v172, v255
    v_mul_f32 v173, v173, v255
    v_mul_f32 v174, v174, v255
    v_mul_f32 v175, v175, v255
    v_accvgpr_read_b32 v254, a208
    v_mul_f32 v254, v254, v255
    v_accvgpr_write_b32 a208, v254
    v_accvgpr_read_b32 v254, a209
    v_mul_f32 v254, v254, v255
    v_accvgpr_write_b32 a209, v254
    v_accvgpr_read_b32 v254, a210
    v_mul_f32 v254, v254, v255
    v_accvgpr_write_b32 a210, v254
    v_accvgpr_read_b32 v254, a211
    v_mul_f32 v254, v254, v255
    v_accvgpr_write_b32 a211, v254
    v_accvgpr_read_b32 v254, a212
    v_mul_f32 v254, v254, v255
    v_accvgpr_write_b32 a212, v254
    v_accvgpr_read_b32 v254, a213
    v_mul_f32 v254, v254, v255
    v_accvgpr_write_b32 a213, v254
    v_accvgpr_read_b32 v254, a214
    v_mul_f32 v254, v254, v255
    v_accvgpr_write_b32 a214, v254
    v_accvgpr_read_b32 v254, a215
    v_mul_f32 v254, v254, v255
    v_accvgpr_write_b32 a215, v254
    v_accvgpr_read_b32 v254, a216
    v_mul_f32 v254, v254, v255
    v_accvgpr_write_b32 a216, v254
    v_accvgpr_read_b32 v254, a217
    v_mul_f32 v254, v254, v255
    v_accvgpr_write_b32 a217, v254
    v_accvgpr_read_b32 v254, a218
    v_mul_f32 v254, v254, v255
    v_accvgpr_write_b32 a218, v254
    v_accvgpr_read_b32 v254, a219
    v_mul_f32 v254, v254, v255
    v_accvgpr_write_b32 a219, v254
    v_accvgpr_read_b32 v254, a220
    v_mul_f32 v254, v254, v255
    v_accvgpr_write_b32 a220, v254
    v_accvgpr_read_b32 v254, a221
    v_mul_f32 v254, v254, v255
    v_accvgpr_write_b32 a221, v254
    v_accvgpr_read_b32 v254, a222
    v_mul_f32 v254, v254, v255
    v_accvgpr_write_b32 a222, v254
    v_accvgpr_read_b32 v254, a223
    v_mul_f32 v254, v254, v255
    v_accvgpr_write_b32 a223, v254
    v_accvgpr_read_b32 v254, a240
    v_mul_f32 v254, v254, v255
    v_accvgpr_write_b32 a240, v254
    v_accvgpr_read_b32 v254, a241
    v_mul_f32 v254, v254, v255
    v_accvgpr_write_b32 a241, v254
    v_accvgpr_read_b32 v254, a242
    v_mul_f32 v254, v254, v255
    v_accvgpr_write_b32 a242, v254
    v_accvgpr_read_b32 v254, a243
    v_mul_f32 v254, v254, v255
    v_accvgpr_write_b32 a243, v254
    v_accvgpr_read_b32 v254, a244
    v_mul_f32 v254, v254, v255
    v_accvgpr_write_b32 a244, v254
    v_accvgpr_read_b32 v254, a245
    v_mul_f32 v254, v254, v255
    v_accvgpr_write_b32 a245, v254
    v_accvgpr_read_b32 v254, a246
    v_mul_f32 v254, v254, v255
    v_accvgpr_write_b32 a246, v254
    v_accvgpr_read_b32 v254, a247
    v_mul_f32 v254, v254, v255
    v_accvgpr_write_b32 a247, v254
    v_accvgpr_read_b32 v254, a248
    v_mul_f32 v254, v254, v255
    v_accvgpr_write_b32 a248, v254
    v_accvgpr_read_b32 v254, a249
    v_mul_f32 v254, v254, v255
    v_accvgpr_write_b32 a249, v254
    v_accvgpr_read_b32 v254, a250
    v_mul_f32 v254, v254, v255
    v_accvgpr_write_b32 a250, v254
    v_accvgpr_read_b32 v254, a251
    v_mul_f32 v254, v254, v255
    v_accvgpr_write_b32 a251, v254
    v_accvgpr_read_b32 v254, a252
    v_mul_f32 v254, v254, v255
    v_accvgpr_write_b32 a252, v254
    v_accvgpr_read_b32 v254, a253
    v_mul_f32 v254, v254, v255
    v_accvgpr_write_b32 a253, v254
    v_accvgpr_read_b32 v254, a254
    v_mul_f32 v254, v254, v255
    v_accvgpr_write_b32 a254, v254
    v_accvgpr_read_b32 v254, a255
    v_mul_f32 v254, v254, v255
    v_accvgpr_write_b32 a255, v254
    v_accvgpr_read_b32 v254, a224
    v_mul_f32 v254, v254, v255
    v_accvgpr_write_b32 a224, v254
    v_accvgpr_read_b32 v254, a225
    v_mul_f32 v254, v254, v255
    v_accvgpr_write_b32 a225, v254
    v_accvgpr_read_b32 v254, a226
    v_mul_f32 v254, v254, v255
    v_accvgpr_write_b32 a226, v254
    v_accvgpr_read_b32 v254, a227
    v_mul_f32 v254, v254, v255
    v_accvgpr_write_b32 a227, v254
    v_accvgpr_read_b32 v254, a228
    v_mul_f32 v254, v254, v255
    v_accvgpr_write_b32 a228, v254
    v_accvgpr_read_b32 v254, a229
    v_mul_f32 v254, v254, v255
    v_accvgpr_write_b32 a229, v254
    v_accvgpr_read_b32 v254, a230
    v_mul_f32 v254, v254, v255
    v_accvgpr_write_b32 a230, v254
    v_accvgpr_read_b32 v254, a231
    v_mul_f32 v254, v254, v255
    v_accvgpr_write_b32 a231, v254
    v_accvgpr_read_b32 v254, a232
    v_mul_f32 v254, v254, v255
    v_accvgpr_write_b32 a232, v254
    v_accvgpr_read_b32 v254, a233
    v_mul_f32 v254, v254, v255
    v_accvgpr_write_b32 a233, v254
    v_accvgpr_read_b32 v254, a234
    v_mul_f32 v254, v254, v255
    v_accvgpr_write_b32 a234, v254
    v_accvgpr_read_b32 v254, a235
    v_mul_f32 v254, v254, v255
    v_accvgpr_write_b32 a235, v254
    v_accvgpr_read_b32 v254, a236
    v_mul_f32 v254, v254, v255
    v_accvgpr_write_b32 a236, v254
    v_accvgpr_read_b32 v254, a237
    v_mul_f32 v254, v254, v255
    v_accvgpr_write_b32 a237, v254
    v_accvgpr_read_b32 v254, a238
    v_mul_f32 v254, v254, v255
    v_accvgpr_write_b32 a238, v254
    v_accvgpr_read_b32 v254, a239
    v_mul_f32 v254, v254, v255
    v_accvgpr_write_b32 a239, v254
    s_nop 1
    s_branch L_ret16
L_slow18:
    s_nop 1
    v_mov_b32 v255, v254
    s_nop 1
    v_permlane32_swap_b32 v254, v255
    v_max_f32 v254, v254, v255
    v_mul_f32 v254, s29, v254
    v_max_f32 v254, v254, v248
    v_sub_f32 v255, v248, v254
    v_exp_f32 v255, v255
    v_mov_b32 v248, v254
    v_mul_f32 v251, v251, v255
    v_mul_f32 v0, v0, v255
    v_mul_f32 v1, v1, v255
    v_mul_f32 v2, v2, v255
    v_mul_f32 v3, v3, v255
    v_mul_f32 v4, v4, v255
    v_mul_f32 v5, v5, v255
    v_mul_f32 v6, v6, v255
    v_mul_f32 v7, v7, v255
    v_mul_f32 v8, v8, v255
    v_mul_f32 v9, v9, v255
    v_mul_f32 v10, v10, v255
    v_mul_f32 v11, v11, v255
    v_mul_f32 v12, v12, v255
    v_mul_f32 v13, v13, v255
    v_mul_f32 v14, v14, v255
    v_mul_f32 v15, v15, v255
    v_mul_f32 v16, v16, v255
    v_mul_f32 v17, v17, v255
    v_mul_f32 v18, v18, v255
    v_mul_f32 v19, v19, v255
    v_mul_f32 v20, v20, v255
    v_mul_f32 v21, v21, v255
    v_mul_f32 v22, v22, v255
    v_mul_f32 v23, v23, v255
    v_mul_f32 v24, v24, v255
    v_mul_f32 v25, v25, v255
    v_mul_f32 v26, v26, v255
    v_mul_f32 v27, v27, v255
    v_mul_f32 v28, v28, v255
    v_mul_f32 v29, v29, v255
    v_mul_f32 v30, v30, v255
    v_mul_f32 v31, v31, v255
    v_mul_f32 v32, v32, v255
    v_mul_f32 v33, v33, v255
    v_mul_f32 v34, v34, v255
    v_mul_f32 v35, v35, v255
    v_mul_f32 v36, v36, v255
    v_mul_f32 v37, v37, v255
    v_mul_f32 v38, v38, v255
    v_mul_f32 v39, v39, v255
    v_mul_f32 v40, v40, v255
    v_mul_f32 v41, v41, v255
    v_mul_f32 v42, v42, v255
    v_mul_f32 v43, v43, v255
    v_mul_f32 v44, v44, v255
    v_mul_f32 v45, v45, v255
    v_mul_f32 v46, v46, v255
    v_mul_f32 v47, v47, v255
    v_accvgpr_read_b32 v254, a144
    v_mul_f32 v254, v254, v255
    v_accvgpr_write_b32 a144, v254
    v_accvgpr_read_b32 v254, a145
    v_mul_f32 v254, v254, v255
    v_accvgpr_write_b32 a145, v254
    v_accvgpr_read_b32 v254, a146
    v_mul_f32 v254, v254, v255
    v_accvgpr_write_b32 a146, v254
    v_accvgpr_read_b32 v254, a147
    v_mul_f32 v254, v254, v255
    v_accvgpr_write_b32 a147, v254
    v_accvgpr_read_b32 v254, a148
    v_mul_f32 v254, v254, v255
    v_accvgpr_write_b32 a148, v254
    v_accvgpr_read_b32 v254, a149
    v_mul_f32 v254, v254, v255
    v_accvgpr_write_b32 a149, v254
    v_accvgpr_read_b32 v254, a150
    v_mul_f32 v254, v254, v255
    v_accvgpr_write_b32 a150, v254
    v_accvgpr_read_b32 v254, a151
    v_mul_f32 v254, v254, v255
    v_accvgpr_write_b32 a151, v254
    v_accvgpr_read_b32 v254, a152
    v_mul_f32 v254, v254, v255
    v_accvgpr_write_b32 a152, v254
    v_accvgpr_read_b32 v254, a153
    v_mul_f32 v254, v254, v255
    v_accvgpr_write_b32 a153, v254
    v_accvgpr_read_b32 v254, a154
    v_mul_f32 v254, v254, v255
    v_accvgpr_write_b32 a154, v254
    v_accvgpr_read_b32 v254, a155
    v_mul_f32 v254, v254, v255
    v_accvgpr_write_b32 a155, v254
    v_accvgpr_read_b32 v254, a156
    v_mul_f32 v254, v254, v255
    v_accvgpr_write_b32 a156, v254
    v_accvgpr_read_b32 v254, a157
    v_mul_f32 v254, v254, v255
    v_accvgpr_write_b32 a157, v254
    v_accvgpr_read_b32 v254, a158
    v_mul_f32 v254, v254, v255
    v_accvgpr_write_b32 a158, v254
    v_accvgpr_read_b32 v254, a159
    v_mul_f32 v254, v254, v255
    v_accvgpr_write_b32 a159, v254
    v_mul_f32 v48, v48, v255
    v_mul_f32 v49, v49, v255
    v_mul_f32 v50, v50, v255
    v_mul_f32 v51, v51, v255
    v_mul_f32 v52, v52, v255
    v_mul_f32 v53, v53, v255
    v_mul_f32 v54, v54, v255
    v_mul_f32 v55, v55, v255
    v_mul_f32 v56, v56, v255
    v_mul_f32 v57, v57, v255
    v_mul_f32 v58, v58, v255
    v_mul_f32 v59, v59, v255
    v_mul_f32 v60, v60, v255
    v_mul_f32 v61, v61, v255
    v_mul_f32 v62, v62, v255
    v_mul_f32 v63, v63, v255
    v_accvgpr_read_b32 v254, a160
    v_mul_f32 v254, v254, v255
    v_accvgpr_write_b32 a160, v254
    v_accvgpr_read_b32 v254, a161
    v_mul_f32 v254, v254, v255
    v_accvgpr_write_b32 a161, v254
    v_accvgpr_read_b32 v254, a162
    v_mul_f32 v254, v254, v255
    v_accvgpr_write_b32 a162, v254
    v_accvgpr_read_b32 v254, a163
    v_mul_f32 v254, v254, v255
    v_accvgpr_write_b32 a163, v254
    v_accvgpr_read_b32 v254, a164
    v_mul_f32 v254, v254, v255
    v_accvgpr_write_b32 a164, v254
    v_accvgpr_read_b32 v254, a165
    v_mul_f32 v254, v254, v255
    v_accvgpr_write_b32 a165, v254
    v_accvgpr_read_b32 v254, a166
    v_mul_f32 v254, v254, v255
    v_accvgpr_write_b32 a166, v254
    v_accvgpr_read_b32 v254, a167
    v_mul_f32 v254, v254, v255
    v_accvgpr_write_b32 a167, v254
    v_accvgpr_read_b32 v254, a168
    v_mul_f32 v254, v254, v255
    v_accvgpr_write_b32 a168, v254
    v_accvgpr_read_b32 v254, a169
    v_mul_f32 v254, v254, v255
    v_accvgpr_write_b32 a169, v254
    v_accvgpr_read_b32 v254, a170
    v_mul_f32 v254, v254, v255
    v_accvgpr_write_b32 a170, v254
    v_accvgpr_read_b32 v254, a171
    v_mul_f32 v254, v254, v255
    v_accvgpr_write_b32 a171, v254
    v_accvgpr_read_b32 v254, a172
    v_mul_f32 v254, v254, v255
    v_accvgpr_write_b32 a172, v254
    v_accvgpr_read_b32 v254, a173
    v_mul_f32 v254, v254, v255
    v_accvgpr_write_b32 a173, v254
    v_accvgpr_read_b32 v254, a174
    v_mul_f32 v254, v254, v255
    v_accvgpr_write_b32 a174, v254
    v_accvgpr_read_b32 v254, a175
    v_mul_f32 v254, v254, v255
    v_accvgpr_write_b32 a175, v254
    s_nop 1
    s_branch L_ret18
L_slow20:
    s_nop 1
    v_mov_b32 v255, v254
    s_nop 1
    v_permlane32_swap_b32 v254, v255
    v_max_f32 v254, v254, v255
    v_mul_f32 v254, s29, v254
    v_max_f32 v254, v254, v249
    v_sub_f32 v255, v249, v254
    v_exp_f32 v255, v255
    v_mov_b32 v249, v254
    v_mul_f32 v252, v252, v255
    v_mul_f32 v64, v64, v255
    v_mul_f32 v65, v65, v255
    v_mul_f32 v66, v66, v255
    v_mul_f32 v67, v67, v255
    v_mul_f32 v68, v68, v255
    v_mul_f32 v69, v69, v255
    v_mul_f32 v70, v70, v255
    v_mul_f32 v71, v71, v255
    v_mul_f32 v72, v72, v255
    v_mul_f32 v73, v73, v255
    v_mul_f32 v74, v74, v255
    v_mul_f32 v75, v75, v255
    v_mul_f32 v76, v76, v255
    v_mul_f32 v77, v77, v255
    v_mul_f32 v78, v78, v255
    v_mul_f32 v79, v79, v255
    v_mul_f32 v80, v80, v255
    v_mul_f32 v81, v81, v255
    v_mul_f32 v82, v82, v255
    v_mul_f32 v83, v83, v255
    v_mul_f32 v84, v84, v255
    v_mul_f32 v85, v85, v255
    v_mul_f32 v86, v86, v255
    v_mul_f32 v87, v87, v255
    v_mul_f32 v88, v88, v255
    v_mul_f32 v89, v89, v255
    v_mul_f32 v90, v90, v255
    v_mul_f32 v91, v91, v255
    v_mul_f32 v92, v92, v255
    v_mul_f32 v93, v93, v255
    v_mul_f32 v94, v94, v255
    v_mul_f32 v95, v95, v255
    v_mul_f32 v96, v96, v255
    v_mul_f32 v97, v97, v255
    v_mul_f32 v98, v98, v255
    v_mul_f32 v99, v99, v255
    v_mul_f32 v100, v100, v255
    v_mul_f32 v101, v101, v255
    v_mul_f32 v102, v102, v255
    v_mul_f32 v103, v103, v255
    v_mul_f32 v104, v104, v255
    v_mul_f32 v105, v105, v255
    v_mul_f32 v106, v106, v255
    v_mul_f32 v107, v107, v255
    v_mul_f32 v108, v108, v255
    v_mul_f32 v109, v109, v255
    v_mul_f32 v110, v110, v255
    v_mul_f32 v111, v111, v255
    v_accvgpr_read_b32 v254, a176
    v_mul_f32 v254, v254, v255
    v_accvgpr_write_b32 a176, v254
    v_accvgpr_read_b32 v254, a177
    v_mul_f32 v254, v254, v255
    v_accvgpr_write_b32 a177, v254
    v_accvgpr_read_b32 v254, a178
    v_mul_f32 v254, v254, v255
    v_accvgpr_write_b32 a178, v254
    v_accvgpr_read_b32 v254, a179
    v_mul_f32 v254, v254, v255
    v_accvgpr_write_b32 a179, v254
    v_accvgpr_read_b32 v254, a180
    v_mul_f32 v254, v254, v255
    v_accvgpr_write_b32 a180, v254
    v_accvgpr_read_b32 v254, a181
    v_mul_f32 v254, v254, v255
    v_accvgpr_write_b32 a181, v254
    v_accvgpr_read_b32 v254, a182
    v_mul_f32 v254, v254, v255
    v_accvgpr_write_b32 a182, v254
    v_accvgpr_read_b32 v254, a183
    v_mul_f32 v254, v254, v255
    v_accvgpr_write_b32 a183, v254
    v_accvgpr_read_b32 v254, a184
    v_mul_f32 v254, v254, v255
    v_accvgpr_write_b32 a184, v254
    v_accvgpr_read_b32 v254, a185
    v_mul_f32 v254, v254, v255
    v_accvgpr_write_b32 a185, v254
    v_accvgpr_read_b32 v254, a186
    v_mul_f32 v254, v254, v255
    v_accvgpr_write_b32 a186, v254
    v_accvgpr_read_b32 v254, a187
    v_mul_f32 v254, v254, v255
    v_accvgpr_write_b32 a187, v254
    v_accvgpr_read_b32 v254, a188
    v_mul_f32 v254, v254, v255
    v_accvgpr_write_b32 a188, v254
    v_accvgpr_read_b32 v254, a189
    v_mul_f32 v254, v254, v255
    v_accvgpr_write_b32 a189, v254
    v_accvgpr_read_b32 v254, a190
    v_mul_f32 v254, v254, v255
    v_accvgpr_write_b32 a190, v254
    v_accvgpr_read_b32 v254, a191
    v_mul_f32 v254, v254, v255
    v_accvgpr_write_b32 a191, v254
    v_mul_f32 v112, v112, v255
    v_mul_f32 v113, v113, v255
    v_mul_f32 v114, v114, v255
    v_mul_f32 v115, v115, v255
    v_mul_f32 v116, v116, v255
    v_mul_f32 v117, v117, v255
    v_mul_f32 v118, v118, v255
    v_mul_f32 v119, v119, v255
    v_mul_f32 v120, v120, v255
    v_mul_f32 v121, v121, v255
    v_mul_f32 v122, v122, v255
    v_mul_f32 v123, v123, v255
    v_mul_f32 v124, v124, v255
    v_mul_f32 v125, v125, v255
    v_mul_f32 v126, v126, v255
    v_mul_f32 v127, v127, v255
    v_accvgpr_read_b32 v254, a192
    v_mul_f32 v254, v254, v255
    v_accvgpr_write_b32 a192, v254
    v_accvgpr_read_b32 v254, a193
    v_mul_f32 v254, v254, v255
    v_accvgpr_write_b32 a193, v254
    v_accvgpr_read_b32 v254, a194
    v_mul_f32 v254, v254, v255
    v_accvgpr_write_b32 a194, v254
    v_accvgpr_read_b32 v254, a195
    v_mul_f32 v254, v254, v255
    v_accvgpr_write_b32 a195, v254
    v_accvgpr_read_b32 v254, a196
    v_mul_f32 v254, v254, v255
    v_accvgpr_write_b32 a196, v254
    v_accvgpr_read_b32 v254, a197
    v_mul_f32 v254, v254, v255
    v_accvgpr_write_b32 a197, v254
    v_accvgpr_read_b32 v254, a198
    v_mul_f32 v254, v254, v255
    v_accvgpr_write_b32 a198, v254
    v_accvgpr_read_b32 v254, a199
    v_mul_f32 v254, v254, v255
    v_accvgpr_write_b32 a199, v254
    v_accvgpr_read_b32 v254, a200
    v_mul_f32 v254, v254, v255
    v_accvgpr_write_b32 a200, v254
    v_accvgpr_read_b32 v254, a201
    v_mul_f32 v254, v254, v255
    v_accvgpr_write_b32 a201, v254
    v_accvgpr_read_b32 v254, a202
    v_mul_f32 v254, v254, v255
    v_accvgpr_write_b32 a202, v254
    v_accvgpr_read_b32 v254, a203
    v_mul_f32 v254, v254, v255
    v_accvgpr_write_b32 a203, v254
    v_accvgpr_read_b32 v254, a204
    v_mul_f32 v254, v254, v255
    v_accvgpr_write_b32 a204, v254
    v_accvgpr_read_b32 v254, a205
    v_mul_f32 v254, v254, v255
    v_accvgpr_write_b32 a205, v254
    v_accvgpr_read_b32 v254, a206
    v_mul_f32 v254, v254, v255
    v_accvgpr_write_b32 a206, v254
    v_accvgpr_read_b32 v254, a207
    v_mul_f32 v254, v254, v255
    v_accvgpr_write_b32 a207, v254
    s_nop 1
    s_branch L_ret20
L_slow22:
    s_nop 1
    v_mov_b32 v255, v254
    s_nop 1
    v_permlane32_swap_b32 v254, v255
    v_max_f32 v254, v254, v255
    v_mul_f32 v254, s29, v254
    v_max_f32 v254, v254, v250
    v_sub_f32 v255, v250, v254
    v_exp_f32 v255, v255
    v_mov_b32 v250, v254
    v_mul_f32 v253, v253, v255
    v_mul_f32 v128, v128, v255
    v_mul_f32 v129, v129, v255
    v_mul_f32 v130, v130, v255
    v_mul_f32 v131, v131, v255
    v_mul_f32 v132, v132, v255
    v_mul_f32 v133, v133, v255
    v_mul_f32 v134, v134, v255
    v_mul_f32 v135, v135, v255
    v_mul_f32 v136, v136, v255
    v_mul_f32 v137, v137, v255
    v_mul_f32 v138, v138, v255
    v_mul_f32 v139, v139, v255
    v_mul_f32 v140, v140, v255
    v_mul_f32 v141, v141, v255
    v_mul_f32 v142, v142, v255
    v_mul_f32 v143, v143, v255
    v_mul_f32 v144, v144, v255
    v_mul_f32 v145, v145, v255
    v_mul_f32 v146, v146, v255
    v_mul_f32 v147, v147, v255
    v_mul_f32 v148, v148, v255
    v_mul_f32 v149, v149, v255
    v_mul_f32 v150, v150, v255
    v_mul_f32 v151, v151, v255
    v_mul_f32 v152, v152, v255
    v_mul_f32 v153, v153, v255
    v_mul_f32 v154, v154, v255
    v_mul_f32 v155, v155, v255
    v_mul_f32 v156, v156, v255
    v_mul_f32 v157, v157, v255
    v_mul_f32 v158, v158, v255
    v_mul_f32 v159, v159, v255
    v_mul_f32 v160, v160, v255
    v_mul_f32 v161, v161, v255
    v_mul_f32 v162, v162, v255
    v_mul_f32 v163, v163, v255
    v_mul_f32 v164, v164, v255
    v_mul_f32 v165, v165, v255
    v_mul_f32 v166, v166, v255
    v_mul_f32 v167, v167, v255
    v_mul_f32 v168, v168, v255
    v_mul_f32 v169, v169, v255
    v_mul_f32 v170, v170, v255
    v_mul_f32 v171, v171, v255
    v_mul_f32 v172, v172, v255
    v_mul_f32 v173, v173, v255
    v_mul_f32 v174, v174, v255
    v_mul_f32 v175, v175, v255
    v_accvgpr_read_b32 v254, a208
    v_mul_f32 v254, v254, v255
    v_accvgpr_write_b32 a208, v254
    v_accvgpr_read_b32 v254, a209
    v_mul_f32 v254, v254, v255
    v_accvgpr_write_b32 a209, v254
    v_accvgpr_read_b32 v254, a210
    v_mul_f32 v254, v254, v255
    v_accvgpr_write_b32 a210, v254
    v_accvgpr_read_b32 v254, a211
    v_mul_f32 v254, v254, v255
    v_accvgpr_write_b32 a211, v254
    v_accvgpr_read_b32 v254, a212
    v_mul_f32 v254, v254, v255
    v_accvgpr_write_b32 a212, v254
    v_accvgpr_read_b32 v254, a213
    v_mul_f32 v254, v254, v255
    v_accvgpr_write_b32 a213, v254
    v_accvgpr_read_b32 v254, a214
    v_mul_f32 v254, v254, v255
    v_accvgpr_write_b32 a214, v254
    v_accvgpr_read_b32 v254, a215
    v_mul_f32 v254, v254, v255
    v_accvgpr_write_b32 a215, v254
    v_accvgpr_read_b32 v254, a216
    v_mul_f32 v254, v254, v255
    v_accvgpr_write_b32 a216, v254
    v_accvgpr_read_b32 v254, a217
    v_mul_f32 v254, v254, v255
    v_accvgpr_write_b32 a217, v254
    v_accvgpr_read_b32 v254, a218
    v_mul_f32 v254, v254, v255
    v_accvgpr_write_b32 a218, v254
    v_accvgpr_read_b32 v254, a219
    v_mul_f32 v254, v254, v255
    v_accvgpr_write_b32 a219, v254
    v_accvgpr_read_b32 v254, a220
    v_mul_f32 v254, v254, v255
    v_accvgpr_write_b32 a220, v254
    v_accvgpr_read_b32 v254, a221
    v_mul_f32 v254, v254, v255
    v_accvgpr_write_b32 a221, v254
    v_accvgpr_read_b32 v254, a222
    v_mul_f32 v254, v254, v255
    v_accvgpr_write_b32 a222, v254
    v_accvgpr_read_b32 v254, a223
    v_mul_f32 v254, v254, v255
    v_accvgpr_write_b32 a223, v254
    v_accvgpr_read_b32 v254, a240
    v_mul_f32 v254, v254, v255
    v_accvgpr_write_b32 a240, v254
    v_accvgpr_read_b32 v254, a241
    v_mul_f32 v254, v254, v255
    v_accvgpr_write_b32 a241, v254
    v_accvgpr_read_b32 v254, a242
    v_mul_f32 v254, v254, v255
    v_accvgpr_write_b32 a242, v254
    v_accvgpr_read_b32 v254, a243
    v_mul_f32 v254, v254, v255
    v_accvgpr_write_b32 a243, v254
    v_accvgpr_read_b32 v254, a244
    v_mul_f32 v254, v254, v255
    v_accvgpr_write_b32 a244, v254
    v_accvgpr_read_b32 v254, a245
    v_mul_f32 v254, v254, v255
    v_accvgpr_write_b32 a245, v254
    v_accvgpr_read_b32 v254, a246
    v_mul_f32 v254, v254, v255
    v_accvgpr_write_b32 a246, v254
    v_accvgpr_read_b32 v254, a247
    v_mul_f32 v254, v254, v255
    v_accvgpr_write_b32 a247, v254
    v_accvgpr_read_b32 v254, a248
    v_mul_f32 v254, v254, v255
    v_accvgpr_write_b32 a248, v254
    v_accvgpr_read_b32 v254, a249
    v_mul_f32 v254, v254, v255
    v_accvgpr_write_b32 a249, v254
    v_accvgpr_read_b32 v254, a250
    v_mul_f32 v254, v254, v255
    v_accvgpr_write_b32 a250, v254
    v_accvgpr_read_b32 v254, a251
    v_mul_f32 v254, v254, v255
    v_accvgpr_write_b32 a251, v254
    v_accvgpr_read_b32 v254, a252
    v_mul_f32 v254, v254, v255
    v_accvgpr_write_b32 a252, v254
    v_accvgpr_read_b32 v254, a253
    v_mul_f32 v254, v254, v255
    v_accvgpr_write_b32 a253, v254
    v_accvgpr_read_b32 v254, a254
    v_mul_f32 v254, v254, v255
    v_accvgpr_write_b32 a254, v254
    v_accvgpr_read_b32 v254, a255
    v_mul_f32 v254, v254, v255
    v_accvgpr_write_b32 a255, v254
    v_accvgpr_read_b32 v254, a224
    v_mul_f32 v254, v254, v255
    v_accvgpr_write_b32 a224, v254
    v_accvgpr_read_b32 v254, a225
    v_mul_f32 v254, v254, v255
    v_accvgpr_write_b32 a225, v254
    v_accvgpr_read_b32 v254, a226
    v_mul_f32 v254, v254, v255
    v_accvgpr_write_b32 a226, v254
    v_accvgpr_read_b32 v254, a227
    v_mul_f32 v254, v254, v255
    v_accvgpr_write_b32 a227, v254
    v_accvgpr_read_b32 v254, a228
    v_mul_f32 v254, v254, v255
    v_accvgpr_write_b32 a228, v254
    v_accvgpr_read_b32 v254, a229
    v_mul_f32 v254, v254, v255
    v_accvgpr_write_b32 a229, v254
    v_accvgpr_read_b32 v254, a230
    v_mul_f32 v254, v254, v255
    v_accvgpr_write_b32 a230, v254
    v_accvgpr_read_b32 v254, a231
    v_mul_f32 v254, v254, v255
    v_accvgpr_write_b32 a231, v254
    v_accvgpr_read_b32 v254, a232
    v_mul_f32 v254, v254, v255
    v_accvgpr_write_b32 a232, v254
    v_accvgpr_read_b32 v254, a233
    v_mul_f32 v254, v254, v255
    v_accvgpr_write_b32 a233, v254
    v_accvgpr_read_b32 v254, a234
    v_mul_f32 v254, v254, v255
    v_accvgpr_write_b32 a234, v254
    v_accvgpr_read_b32 v254, a235
    v_mul_f32 v254, v254, v255
    v_accvgpr_write_b32 a235, v254
    v_accvgpr_read_b32 v254, a236
    v_mul_f32 v254, v254, v255
    v_accvgpr_write_b32 a236, v254
    v_accvgpr_read_b32 v254, a237
    v_mul_f32 v254, v254, v255
    v_accvgpr_write_b32 a237, v254
    v_accvgpr_read_b32 v254, a238
    v_mul_f32 v254, v254, v255
    v_accvgpr_write_b32 a238, v254
    v_accvgpr_read_b32 v254, a239
    v_mul_f32 v254, v254, v255
    v_accvgpr_write_b32 a239, v254
    s_nop 1
    s_branch L_ret22
L_slow24:
    s_nop 1
    v_mov_b32 v255, v254
    s_nop 1
    v_permlane32_swap_b32 v254, v255
    v_max_f32 v254, v254, v255
    v_mul_f32 v254, s29, v254
    v_max_f32 v254, v254, v248
    v_sub_f32 v255, v248, v254
    v_exp_f32 v255, v255
    v_mov_b32 v248, v254
    v_mul_f32 v251, v251, v255
    v_mul_f32 v0, v0, v255
    v_mul_f32 v1, v1, v255
    v_mul_f32 v2, v2, v255
    v_mul_f32 v3, v3, v255
    v_mul_f32 v4, v4, v255
    v_mul_f32 v5, v5, v255
    v_mul_f32 v6, v6, v255
    v_mul_f32 v7, v7, v255
    v_mul_f32 v8, v8, v255
    v_mul_f32 v9, v9, v255
    v_mul_f32 v10, v10, v255
    v_mul_f32 v11, v11, v255
    v_mul_f32 v12, v12, v255
    v_mul_f32 v13, v13, v255
    v_mul_f32 v14, v14, v255
    v_mul_f32 v15, v15, v255
    v_mul_f32 v16, v16, v255
    v_mul_f32 v17, v17, v255
    v_mul_f32 v18, v18, v255
    v_mul_f32 v19, v19, v255
    v_mul_f32 v20, v20, v255
    v_mul_f32 v21, v21, v255
    v_mul_f32 v22, v22, v255
    v_mul_f32 v23, v23, v255
    v_mul_f32 v24, v24, v255
    v_mul_f32 v25, v25, v255
    v_mul_f32 v26, v26, v255
    v_mul_f32 v27, v27, v255
    v_mul_f32 v28, v28, v255
    v_mul_f32 v29, v29, v255
    v_mul_f32 v30, v30, v255
    v_mul_f32 v31, v31, v255
    v_mul_f32 v32, v32, v255
    v_mul_f32 v33, v33, v255
    v_mul_f32 v34, v34, v255
    v_mul_f32 v35, v35, v255
    v_mul_f32 v36, v36, v255
    v_mul_f32 v37, v37, v255
    v_mul_f32 v38, v38, v255
    v_mul_f32 v39, v39, v255
    v_mul_f32 v40, v40, v255
    v_mul_f32 v41, v41, v255
    v_mul_f32 v42, v42, v255
    v_mul_f32 v43, v43, v255
    v_mul_f32 v44, v44, v255
    v_mul_f32 v45, v45, v255
    v_mul_f32 v46, v46, v255
    v_mul_f32 v47, v47, v255
    v_accvgpr_read_b32 v254, a144
    v_mul_f32 v254, v254, v255
    v_accvgpr_write_b32 a144, v254
    v_accvgpr_read_b32 v254, a145
    v_mul_f32 v254, v254, v255
    v_accvgpr_write_b32 a145, v254
    v_accvgpr_read_b32 v254, a146
    v_mul_f32 v254, v254, v255
    v_accvgpr_write_b32 a146, v254
    v_accvgpr_read_b32 v254, a147
    v_mul_f32 v254, v254, v255
    v_accvgpr_write_b32 a147, v254
    v_accvgpr_read_b32 v254, a148
    v_mul_f32 v254, v254, v255
    v_accvgpr_write_b32 a148, v254
    v_accvgpr_read_b32 v254, a149
    v_mul_f32 v254, v254, v255
    v_accvgpr_write_b32 a149, v254
    v_accvgpr_read_b32 v254, a150
    v_mul_f32 v254, v254, v255
    v_accvgpr_write_b32 a150, v254
    v_accvgpr_read_b32 v254, a151
    v_mul_f32 v254, v254, v255
    v_accvgpr_write_b32 a151, v254
    v_accvgpr_read_b32 v254, a152
    v_mul_f32 v254, v254, v255
    v_accvgpr_write_b32 a152, v254
    v_accvgpr_read_b32 v254, a153
    v_mul_f32 v254, v254, v255
    v_accvgpr_write_b32 a153, v254
    v_accvgpr_read_b32 v254, a154
    v_mul_f32 v254, v254, v255
    v_accvgpr_write_b32 a154, v254
    v_accvgpr_read_b32 v254, a155
    v_mul_f32 v254, v254, v255
    v_accvgpr_write_b32 a155, v254
    v_accvgpr_read_b32 v254, a156
    v_mul_f32 v254, v254, v255
    v_accvgpr_write_b32 a156, v254
    v_accvgpr_read_b32 v254, a157
    v_mul_f32 v254, v254, v255
    v_accvgpr_write_b32 a157, v254
    v_accvgpr_read_b32 v254, a158
    v_mul_f32 v254, v254, v255
    v_accvgpr_write_b32 a158, v254
    v_accvgpr_read_b32 v254, a159
    v_mul_f32 v254, v254, v255
    v_accvgpr_write_b32 a159, v254
    v_mul_f32 v48, v48, v255
    v_mul_f32 v49, v49, v255
    v_mul_f32 v50, v50, v255
    v_mul_f32 v51, v51, v255
    v_mul_f32 v52, v52, v255
    v_mul_f32 v53, v53, v255
    v_mul_f32 v54, v54, v255
    v_mul_f32 v55, v55, v255
    v_mul_f32 v56, v56, v255
    v_mul_f32 v57, v57, v255
    v_mul_f32 v58, v58, v255
    v_mul_f32 v59, v59, v255
    v_mul_f32 v60, v60, v255
    v_mul_f32 v61, v61, v255
    v_mul_f32 v62, v62, v255
    v_mul_f32 v63, v63, v255
    v_accvgpr_read_b32 v254, a160
    v_mul_f32 v254, v254, v255
    v_accvgpr_write_b32 a160, v254
    v_accvgpr_read_b32 v254, a161
    v_mul_f32 v254, v254, v255
    v_accvgpr_write_b32 a161, v254
    v_accvgpr_read_b32 v254, a162
    v_mul_f32 v254, v254, v255
    v_accvgpr_write_b32 a162, v254
    v_accvgpr_read_b32 v254, a163
    v_mul_f32 v254, v254, v255
    v_accvgpr_write_b32 a163, v254
    v_accvgpr_read_b32 v254, a164
    v_mul_f32 v254, v254, v255
    v_accvgpr_write_b32 a164, v254
    v_accvgpr_read_b32 v254, a165
    v_mul_f32 v254, v254, v255
    v_accvgpr_write_b32 a165, v254
    v_accvgpr_read_b32 v254, a166
    v_mul_f32 v254, v254, v255
    v_accvgpr_write_b32 a166, v254
    v_accvgpr_read_b32 v254, a167
    v_mul_f32 v254, v254, v255
    v_accvgpr_write_b32 a167, v254
    v_accvgpr_read_b32 v254, a168
    v_mul_f32 v254, v254, v255
    v_accvgpr_write_b32 a168, v254
    v_accvgpr_read_b32 v254, a169
    v_mul_f32 v254, v254, v255
    v_accvgpr_write_b32 a169, v254
    v_accvgpr_read_b32 v254, a170
    v_mul_f32 v254, v254, v255
    v_accvgpr_write_b32 a170, v254
    v_accvgpr_read_b32 v254, a171
    v_mul_f32 v254, v254, v255
    v_accvgpr_write_b32 a171, v254
    v_accvgpr_read_b32 v254, a172
    v_mul_f32 v254, v254, v255
    v_accvgpr_write_b32 a172, v254
    v_accvgpr_read_b32 v254, a173
    v_mul_f32 v254, v254, v255
    v_accvgpr_write_b32 a173, v254
    v_accvgpr_read_b32 v254, a174
    v_mul_f32 v254, v254, v255
    v_accvgpr_write_b32 a174, v254
    v_accvgpr_read_b32 v254, a175
    v_mul_f32 v254, v254, v255
    v_accvgpr_write_b32 a175, v254
    s_nop 1
    s_branch L_ret24
L_slow26:
    s_nop 1
    v_mov_b32 v255, v254
    s_nop 1
    v_permlane32_swap_b32 v254, v255
    v_max_f32 v254, v254, v255
    v_mul_f32 v254, s29, v254
    v_max_f32 v254, v254, v249
    v_sub_f32 v255, v249, v254
    v_exp_f32 v255, v255
    v_mov_b32 v249, v254
    v_mul_f32 v252, v252, v255
    v_mul_f32 v64, v64, v255
    v_mul_f32 v65, v65, v255
    v_mul_f32 v66, v66, v255
    v_mul_f32 v67, v67, v255
    v_mul_f32 v68, v68, v255
    v_mul_f32 v69, v69, v255
    v_mul_f32 v70, v70, v255
    v_mul_f32 v71, v71, v255
    v_mul_f32 v72, v72, v255
    v_mul_f32 v73, v73, v255
    v_mul_f32 v74, v74, v255
    v_mul_f32 v75, v75, v255
    v_mul_f32 v76, v76, v255
    v_mul_f32 v77, v77, v255
    v_mul_f32 v78, v78, v255
    v_mul_f32 v79, v79, v255
    v_mul_f32 v80, v80, v255
    v_mul_f32 v81, v81, v255
    v_mul_f32 v82, v82, v255
    v_mul_f32 v83, v83, v255
    v_mul_f32 v84, v84, v255
    v_mul_f32 v85, v85, v255
    v_mul_f32 v86, v86, v255
    v_mul_f32 v87, v87, v255
    v_mul_f32 v88, v88, v255
    v_mul_f32 v89, v89, v255
    v_mul_f32 v90, v90, v255
    v_mul_f32 v91, v91, v255
    v_mul_f32 v92, v92, v255
    v_mul_f32 v93, v93, v255
    v_mul_f32 v94, v94, v255
    v_mul_f32 v95, v95, v255
    v_mul_f32 v96, v96, v255
    v_mul_f32 v97, v97, v255
    v_mul_f32 v98, v98, v255
    v_mul_f32 v99, v99, v255
    v_mul_f32 v100, v100, v255
    v_mul_f32 v101, v101, v255
    v_mul_f32 v102, v102, v255
    v_mul_f32 v103, v103, v255
    v_mul_f32 v104, v104, v255
    v_mul_f32 v105, v105, v255
    v_mul_f32 v106, v106, v255
    v_mul_f32 v107, v107, v255
    v_mul_f32 v108, v108, v255
    v_mul_f32 v109, v109, v255
    v_mul_f32 v110, v110, v255
    v_mul_f32 v111, v111, v255
    v_accvgpr_read_b32 v254, a176
    v_mul_f32 v254, v254, v255
    v_accvgpr_write_b32 a176, v254
    v_accvgpr_read_b32 v254, a177
    v_mul_f32 v254, v254, v255
    v_accvgpr_write_b32 a177, v254
    v_accvgpr_read_b32 v254, a178
    v_mul_f32 v254, v254, v255
    v_accvgpr_write_b32 a178, v254
    v_accvgpr_read_b32 v254, a179
    v_mul_f32 v254, v254, v255
    v_accvgpr_write_b32 a179, v254
    v_accvgpr_read_b32 v254, a180
    v_mul_f32 v254, v254, v255
    v_accvgpr_write_b32 a180, v254
    v_accvgpr_read_b32 v254, a181
    v_mul_f32 v254, v254, v255
    v_accvgpr_write_b32 a181, v254
    v_accvgpr_read_b32 v254, a182
    v_mul_f32 v254, v254, v255
    v_accvgpr_write_b32 a182, v254
    v_accvgpr_read_b32 v254, a183
    v_mul_f32 v254, v254, v255
    v_accvgpr_write_b32 a183, v254
    v_accvgpr_read_b32 v254, a184
    v_mul_f32 v254, v254, v255
    v_accvgpr_write_b32 a184, v254
    v_accvgpr_read_b32 v254, a185
    v_mul_f32 v254, v254, v255
    v_accvgpr_write_b32 a185, v254
    v_accvgpr_read_b32 v254, a186
    v_mul_f32 v254, v254, v255
    v_accvgpr_write_b32 a186, v254
    v_accvgpr_read_b32 v254, a187
    v_mul_f32 v254, v254, v255
    v_accvgpr_write_b32 a187, v254
    v_accvgpr_read_b32 v254, a188
    v_mul_f32 v254, v254, v255
    v_accvgpr_write_b32 a188, v254
    v_accvgpr_read_b32 v254, a189
    v_mul_f32 v254, v254, v255
    v_accvgpr_write_b32 a189, v254
    v_accvgpr_read_b32 v254, a190
    v_mul_f32 v254, v254, v255
    v_accvgpr_write_b32 a190, v254
    v_accvgpr_read_b32 v254, a191
    v_mul_f32 v254, v254, v255
    v_accvgpr_write_b32 a191, v254
    v_mul_f32 v112, v112, v255
    v_mul_f32 v113, v113, v255
    v_mul_f32 v114, v114, v255
    v_mul_f32 v115, v115, v255
    v_mul_f32 v116, v116, v255
    v_mul_f32 v117, v117, v255
    v_mul_f32 v118, v118, v255
    v_mul_f32 v119, v119, v255
    v_mul_f32 v120, v120, v255
    v_mul_f32 v121, v121, v255
    v_mul_f32 v122, v122, v255
    v_mul_f32 v123, v123, v255
    v_mul_f32 v124, v124, v255
    v_mul_f32 v125, v125, v255
    v_mul_f32 v126, v126, v255
    v_mul_f32 v127, v127, v255
    v_accvgpr_read_b32 v254, a192
    v_mul_f32 v254, v254, v255
    v_accvgpr_write_b32 a192, v254
    v_accvgpr_read_b32 v254, a193
    v_mul_f32 v254, v254, v255
    v_accvgpr_write_b32 a193, v254
    v_accvgpr_read_b32 v254, a194
    v_mul_f32 v254, v254, v255
    v_accvgpr_write_b32 a194, v254
    v_accvgpr_read_b32 v254, a195
    v_mul_f32 v254, v254, v255
    v_accvgpr_write_b32 a195, v254
    v_accvgpr_read_b32 v254, a196
    v_mul_f32 v254, v254, v255
    v_accvgpr_write_b32 a196, v254
    v_accvgpr_read_b32 v254, a197
    v_mul_f32 v254, v254, v255
    v_accvgpr_write_b32 a197, v254
    v_accvgpr_read_b32 v254, a198
    v_mul_f32 v254, v254, v255
    v_accvgpr_write_b32 a198, v254
    v_accvgpr_read_b32 v254, a199
    v_mul_f32 v254, v254, v255
    v_accvgpr_write_b32 a199, v254
    v_accvgpr_read_b32 v254, a200
    v_mul_f32 v254, v254, v255
    v_accvgpr_write_b32 a200, v254
    v_accvgpr_read_b32 v254, a201
    v_mul_f32 v254, v254, v255
    v_accvgpr_write_b32 a201, v254
    v_accvgpr_read_b32 v254, a202
    v_mul_f32 v254, v254, v255
    v_accvgpr_write_b32 a202, v254
    v_accvgpr_read_b32 v254, a203
    v_mul_f32 v254, v254, v255
    v_accvgpr_write_b32 a203, v254
    v_accvgpr_read_b32 v254, a204
    v_mul_f32 v254, v254, v255
    v_accvgpr_write_b32 a204, v254
    v_accvgpr_read_b32 v254, a205
    v_mul_f32 v254, v254, v255
    v_accvgpr_write_b32 a205, v254
    v_accvgpr_read_b32 v254, a206
    v_mul_f32 v254, v254, v255
    v_accvgpr_write_b32 a206, v254
    v_accvgpr_read_b32 v254, a207
    v_mul_f32 v254, v254, v255
    v_accvgpr_write_b32 a207, v254
    s_nop 1
    s_branch L_ret26
L_slow28:
    s_nop 1
    v_mov_b32 v255, v254
    s_nop 1
    v_permlane32_swap_b32 v254, v255
    v_max_f32 v254, v254, v255
    v_mul_f32 v254, s29, v254
    v_max_f32 v254, v254, v250
    v_sub_f32 v255, v250, v254
    v_exp_f32 v255, v255
    v_mov_b32 v250, v254
    v_mul_f32 v253, v253, v255
    v_mul_f32 v128, v128, v255
    v_mul_f32 v129, v129, v255
    v_mul_f32 v130, v130, v255
    v_mul_f32 v131, v131, v255
    v_mul_f32 v132, v132, v255
    v_mul_f32 v133, v133, v255
    v_mul_f32 v134, v134, v255
    v_mul_f32 v135, v135, v255
    v_mul_f32 v136, v136, v255
    v_mul_f32 v137, v137, v255
    v_mul_f32 v138, v138, v255
    v_mul_f32 v139, v139, v255
    v_mul_f32 v140, v140, v255
    v_mul_f32 v141, v141, v255
    v_mul_f32 v142, v142, v255
    v_mul_f32 v143, v143, v255
    v_mul_f32 v144, v144, v255
    v_mul_f32 v145, v145, v255
    v_mul_f32 v146, v146, v255
    v_mul_f32 v147, v147, v255
    v_mul_f32 v148, v148, v255
    v_mul_f32 v149, v149, v255
    v_mul_f32 v150, v150, v255
    v_mul_f32 v151, v151, v255
    v_mul_f32 v152, v152, v255
    v_mul_f32 v153, v153, v255
    v_mul_f32 v154, v154, v255
    v_mul_f32 v155, v155, v255
    v_mul_f32 v156, v156, v255
    v_mul_f32 v157, v157, v255
    v_mul_f32 v158, v158, v255
    v_mul_f32 v159, v159, v255
    v_mul_f32 v160, v160, v255
    v_mul_f32 v161, v161, v255
    v_mul_f32 v162, v162, v255
    v_mul_f32 v163, v163, v255
    v_mul_f32 v164, v164, v255
    v_mul_f32 v165, v165, v255
    v_mul_f32 v166, v166, v255
    v_mul_f32 v167, v167, v255
    v_mul_f32 v168, v168, v255
    v_mul_f32 v169, v169, v255
    v_mul_f32 v170, v170, v255
    v_mul_f32 v171, v171, v255
    v_mul_f32 v172, v172, v255
    v_mul_f32 v173, v173, v255
    v_mul_f32 v174, v174, v255
    v_mul_f32 v175, v175, v255
    v_accvgpr_read_b32 v254, a208
    v_mul_f32 v254, v254, v255
    v_accvgpr_write_b32 a208, v254
    v_accvgpr_read_b32 v254, a209
    v_mul_f32 v254, v254, v255
    v_accvgpr_write_b32 a209, v254
    v_accvgpr_read_b32 v254, a210
    v_mul_f32 v254, v254, v255
    v_accvgpr_write_b32 a210, v254
    v_accvgpr_read_b32 v254, a211
    v_mul_f32 v254, v254, v255
    v_accvgpr_write_b32 a211, v254
    v_accvgpr_read_b32 v254, a212
    v_mul_f32 v254, v254, v255
    v_accvgpr_write_b32 a212, v254
    v_accvgpr_read_b32 v254, a213
    v_mul_f32 v254, v254, v255
    v_accvgpr_write_b32 a213, v254
    v_accvgpr_read_b32 v254, a214
    v_mul_f32 v254, v254, v255
    v_accvgpr_write_b32 a214, v254
    v_accvgpr_read_b32 v254, a215
    v_mul_f32 v254, v254, v255
    v_accvgpr_write_b32 a215, v254
    v_accvgpr_read_b32 v254, a216
    v_mul_f32 v254, v254, v255
    v_accvgpr_write_b32 a216, v254
    v_accvgpr_read_b32 v254, a217
    v_mul_f32 v254, v254, v255
    v_accvgpr_write_b32 a217, v254
    v_accvgpr_read_b32 v254, a218
    v_mul_f32 v254, v254, v255
    v_accvgpr_write_b32 a218, v254
    v_accvgpr_read_b32 v254, a219
    v_mul_f32 v254, v254, v255
    v_accvgpr_write_b32 a219, v254
    v_accvgpr_read_b32 v254, a220
    v_mul_f32 v254, v254, v255
    v_accvgpr_write_b32 a220, v254
    v_accvgpr_read_b32 v254, a221
    v_mul_f32 v254, v254, v255
    v_accvgpr_write_b32 a221, v254
    v_accvgpr_read_b32 v254, a222
    v_mul_f32 v254, v254, v255
    v_accvgpr_write_b32 a222, v254
    v_accvgpr_read_b32 v254, a223
    v_mul_f32 v254, v254, v255
    v_accvgpr_write_b32 a223, v254
    v_accvgpr_read_b32 v254, a240
    v_mul_f32 v254, v254, v255
    v_accvgpr_write_b32 a240, v254
    v_accvgpr_read_b32 v254, a241
    v_mul_f32 v254, v254, v255
    v_accvgpr_write_b32 a241, v254
    v_accvgpr_read_b32 v254, a242
    v_mul_f32 v254, v254, v255
    v_accvgpr_write_b32 a242, v254
    v_accvgpr_read_b32 v254, a243
    v_mul_f32 v254, v254, v255
    v_accvgpr_write_b32 a243, v254
    v_accvgpr_read_b32 v254, a244
    v_mul_f32 v254, v254, v255
    v_accvgpr_write_b32 a244, v254
    v_accvgpr_read_b32 v254, a245
    v_mul_f32 v254, v254, v255
    v_accvgpr_write_b32 a245, v254
    v_accvgpr_read_b32 v254, a246
    v_mul_f32 v254, v254, v255
    v_accvgpr_write_b32 a246, v254
    v_accvgpr_read_b32 v254, a247
    v_mul_f32 v254, v254, v255
    v_accvgpr_write_b32 a247, v254
    v_accvgpr_read_b32 v254, a248
    v_mul_f32 v254, v254, v255
    v_accvgpr_write_b32 a248, v254
    v_accvgpr_read_b32 v254, a249
    v_mul_f32 v254, v254, v255
    v_accvgpr_write_b32 a249, v254
    v_accvgpr_read_b32 v254, a250
    v_mul_f32 v254, v254, v255
    v_accvgpr_write_b32 a250, v254
    v_accvgpr_read_b32 v254, a251
    v_mul_f32 v254, v254, v255
    v_accvgpr_write_b32 a251, v254
    v_accvgpr_read_b32 v254, a252
    v_mul_f32 v254, v254, v255
    v_accvgpr_write_b32 a252, v254
    v_accvgpr_read_b32 v254, a253
    v_mul_f32 v254, v254, v255
    v_accvgpr_write_b32 a253, v254
    v_accvgpr_read_b32 v254, a254
    v_mul_f32 v254, v254, v255
    v_accvgpr_write_b32 a254, v254
    v_accvgpr_read_b32 v254, a255
    v_mul_f32 v254, v254, v255
    v_accvgpr_write_b32 a255, v254
    v_accvgpr_read_b32 v254, a224
    v_mul_f32 v254, v254, v255
    v_accvgpr_write_b32 a224, v254
    v_accvgpr_read_b32 v254, a225
    v_mul_f32 v254, v254, v255
    v_accvgpr_write_b32 a225, v254
    v_accvgpr_read_b32 v254, a226
    v_mul_f32 v254, v254, v255
    v_accvgpr_write_b32 a226, v254
    v_accvgpr_read_b32 v254, a227
    v_mul_f32 v254, v254, v255
    v_accvgpr_write_b32 a227, v254
    v_accvgpr_read_b32 v254, a228
    v_mul_f32 v254, v254, v255
    v_accvgpr_write_b32 a228, v254
    v_accvgpr_read_b32 v254, a229
    v_mul_f32 v254, v254, v255
    v_accvgpr_write_b32 a229, v254
    v_accvgpr_read_b32 v254, a230
    v_mul_f32 v254, v254, v255
    v_accvgpr_write_b32 a230, v254
    v_accvgpr_read_b32 v254, a231
    v_mul_f32 v254, v254, v255
    v_accvgpr_write_b32 a231, v254
    v_accvgpr_read_b32 v254, a232
    v_mul_f32 v254, v254, v255
    v_accvgpr_write_b32 a232, v254
    v_accvgpr_read_b32 v254, a233
    v_mul_f32 v254, v254, v255
    v_accvgpr_write_b32 a233, v254
    v_accvgpr_read_b32 v254, a234
    v_mul_f32 v254, v254, v255
    v_accvgpr_write_b32 a234, v254
    v_accvgpr_read_b32 v254, a235
    v_mul_f32 v254, v254, v255
    v_accvgpr_write_b32 a235, v254
    v_accvgpr_read_b32 v254, a236
    v_mul_f32 v254, v254, v255
    v_accvgpr_write_b32 a236, v254
    v_accvgpr_read_b32 v254, a237
    v_mul_f32 v254, v254, v255
    v_accvgpr_write_b32 a237, v254
    v_accvgpr_read_b32 v254, a238
    v_mul_f32 v254, v254, v255
    v_accvgpr_write_b32 a238, v254
    v_accvgpr_read_b32 v254, a239
    v_mul_f32 v254, v254, v255
    v_accvgpr_write_b32 a239, v254
    s_nop 1
    s_branch L_ret28
L_slow30:
    s_nop 1
    v_mov_b32 v255, v254
    s_nop 1
    v_permlane32_swap_b32 v254, v255
    v_max_f32 v254, v254, v255
    v_mul_f32 v254, s29, v254
    v_max_f32 v254, v254, v248
    v_sub_f32 v255, v248, v254
    v_exp_f32 v255, v255
    v_mov_b32 v248, v254
    v_mul_f32 v251, v251, v255
    v_mul_f32 v0, v0, v255
    v_mul_f32 v1, v1, v255
    v_mul_f32 v2, v2, v255
    v_mul_f32 v3, v3, v255
    v_mul_f32 v4, v4, v255
    v_mul_f32 v5, v5, v255
    v_mul_f32 v6, v6, v255
    v_mul_f32 v7, v7, v255
    v_mul_f32 v8, v8, v255
    v_mul_f32 v9, v9, v255
    v_mul_f32 v10, v10, v255
    v_mul_f32 v11, v11, v255
    v_mul_f32 v12, v12, v255
    v_mul_f32 v13, v13, v255
    v_mul_f32 v14, v14, v255
    v_mul_f32 v15, v15, v255
    v_mul_f32 v16, v16, v255
    v_mul_f32 v17, v17, v255
    v_mul_f32 v18, v18, v255
    v_mul_f32 v19, v19, v255
    v_mul_f32 v20, v20, v255
    v_mul_f32 v21, v21, v255
    v_mul_f32 v22, v22, v255
    v_mul_f32 v23, v23, v255
    v_mul_f32 v24, v24, v255
    v_mul_f32 v25, v25, v255
    v_mul_f32 v26, v26, v255
    v_mul_f32 v27, v27, v255
    v_mul_f32 v28, v28, v255
    v_mul_f32 v29, v29, v255
    v_mul_f32 v30, v30, v255
    v_mul_f32 v31, v31, v255
    v_mul_f32 v32, v32, v255
    v_mul_f32 v33, v33, v255
    v_mul_f32 v34, v34, v255
    v_mul_f32 v35, v35, v255
    v_mul_f32 v36, v36, v255
    v_mul_f32 v37, v37, v255
    v_mul_f32 v38, v38, v255
    v_mul_f32 v39, v39, v255
    v_mul_f32 v40, v40, v255
    v_mul_f32 v41, v41, v255
    v_mul_f32 v42, v42, v255
    v_mul_f32 v43, v43, v255
    v_mul_f32 v44, v44, v255
    v_mul_f32 v45, v45, v255
    v_mul_f32 v46, v46, v255
    v_mul_f32 v47, v47, v255
    v_accvgpr_read_b32 v254, a144
    v_mul_f32 v254, v254, v255
    v_accvgpr_write_b32 a144, v254
    v_accvgpr_read_b32 v254, a145
    v_mul_f32 v254, v254, v255
    v_accvgpr_write_b32 a145, v254
    v_accvgpr_read_b32 v254, a146
    v_mul_f32 v254, v254, v255
    v_accvgpr_write_b32 a146, v254
    v_accvgpr_read_b32 v254, a147
    v_mul_f32 v254, v254, v255
    v_accvgpr_write_b32 a147, v254
    v_accvgpr_read_b32 v254, a148
    v_mul_f32 v254, v254, v255
    v_accvgpr_write_b32 a148, v254
    v_accvgpr_read_b32 v254, a149
    v_mul_f32 v254, v254, v255
    v_accvgpr_write_b32 a149, v254
    v_accvgpr_read_b32 v254, a150
    v_mul_f32 v254, v254, v255
    v_accvgpr_write_b32 a150, v254
    v_accvgpr_read_b32 v254, a151
    v_mul_f32 v254, v254, v255
    v_accvgpr_write_b32 a151, v254
    v_accvgpr_read_b32 v254, a152
    v_mul_f32 v254, v254, v255
    v_accvgpr_write_b32 a152, v254
    v_accvgpr_read_b32 v254, a153
    v_mul_f32 v254, v254, v255
    v_accvgpr_write_b32 a153, v254
    v_accvgpr_read_b32 v254, a154
    v_mul_f32 v254, v254, v255
    v_accvgpr_write_b32 a154, v254
    v_accvgpr_read_b32 v254, a155
    v_mul_f32 v254, v254, v255
    v_accvgpr_write_b32 a155, v254
    v_accvgpr_read_b32 v254, a156
    v_mul_f32 v254, v254, v255
    v_accvgpr_write_b32 a156, v254
    v_accvgpr_read_b32 v254, a157
    v_mul_f32 v254, v254, v255
    v_accvgpr_write_b32 a157, v254
    v_accvgpr_read_b32 v254, a158
    v_mul_f32 v254, v254, v255
    v_accvgpr_write_b32 a158, v254
    v_accvgpr_read_b32 v254, a159
    v_mul_f32 v254, v254, v255
    v_accvgpr_write_b32 a159, v254
    v_mul_f32 v48, v48, v255
    v_mul_f32 v49, v49, v255
    v_mul_f32 v50, v50, v255
    v_mul_f32 v51, v51, v255
    v_mul_f32 v52, v52, v255
    v_mul_f32 v53, v53, v255
    v_mul_f32 v54, v54, v255
    v_mul_f32 v55, v55, v255
    v_mul_f32 v56, v56, v255
    v_mul_f32 v57, v57, v255
    v_mul_f32 v58, v58, v255
    v_mul_f32 v59, v59, v255
    v_mul_f32 v60, v60, v255
    v_mul_f32 v61, v61, v255
    v_mul_f32 v62, v62, v255
    v_mul_f32 v63, v63, v255
    v_accvgpr_read_b32 v254, a160
    v_mul_f32 v254, v254, v255
    v_accvgpr_write_b32 a160, v254
    v_accvgpr_read_b32 v254, a161
    v_mul_f32 v254, v254, v255
    v_accvgpr_write_b32 a161, v254
    v_accvgpr_read_b32 v254, a162
    v_mul_f32 v254, v254, v255
    v_accvgpr_write_b32 a162, v254
    v_accvgpr_read_b32 v254, a163
    v_mul_f32 v254, v254, v255
    v_accvgpr_write_b32 a163, v254
    v_accvgpr_read_b32 v254, a164
    v_mul_f32 v254, v254, v255
    v_accvgpr_write_b32 a164, v254
    v_accvgpr_read_b32 v254, a165
    v_mul_f32 v254, v254, v255
    v_accvgpr_write_b32 a165, v254
    v_accvgpr_read_b32 v254, a166
    v_mul_f32 v254, v254, v255
    v_accvgpr_write_b32 a166, v254
    v_accvgpr_read_b32 v254, a167
    v_mul_f32 v254, v254, v255
    v_accvgpr_write_b32 a167, v254
    v_accvgpr_read_b32 v254, a168
    v_mul_f32 v254, v254, v255
    v_accvgpr_write_b32 a168, v254
    v_accvgpr_read_b32 v254, a169
    v_mul_f32 v254, v254, v255
    v_accvgpr_write_b32 a169, v254
    v_accvgpr_read_b32 v254, a170
    v_mul_f32 v254, v254, v255
    v_accvgpr_write_b32 a170, v254
    v_accvgpr_read_b32 v254, a171
    v_mul_f32 v254, v254, v255
    v_accvgpr_write_b32 a171, v254
    v_accvgpr_read_b32 v254, a172
    v_mul_f32 v254, v254, v255
    v_accvgpr_write_b32 a172, v254
    v_accvgpr_read_b32 v254, a173
    v_mul_f32 v254, v254, v255
    v_accvgpr_write_b32 a173, v254
    v_accvgpr_read_b32 v254, a174
    v_mul_f32 v254, v254, v255
    v_accvgpr_write_b32 a174, v254
    v_accvgpr_read_b32 v254, a175
    v_mul_f32 v254, v254, v255
    v_accvgpr_write_b32 a175, v254
    s_nop 1
    s_branch L_ret30
L_slow32:
    s_nop 1
    v_mov_b32 v255, v254
    s_nop 1
    v_permlane32_swap_b32 v254, v255
    v_max_f32 v254, v254, v255
    v_mul_f32 v254, s29, v254
    v_max_f32 v254, v254, v249
    v_sub_f32 v255, v249, v254
    v_exp_f32 v255, v255
    v_mov_b32 v249, v254
    v_mul_f32 v252, v252, v255
    v_mul_f32 v64, v64, v255
    v_mul_f32 v65, v65, v255
    v_mul_f32 v66, v66, v255
    v_mul_f32 v67, v67, v255
    v_mul_f32 v68, v68, v255
    v_mul_f32 v69, v69, v255
    v_mul_f32 v70, v70, v255
    v_mul_f32 v71, v71, v255
    v_mul_f32 v72, v72, v255
    v_mul_f32 v73, v73, v255
    v_mul_f32 v74, v74, v255
    v_mul_f32 v75, v75, v255
    v_mul_f32 v76, v76, v255
    v_mul_f32 v77, v77, v255
    v_mul_f32 v78, v78, v255
    v_mul_f32 v79, v79, v255
    v_mul_f32 v80, v80, v255
    v_mul_f32 v81, v81, v255
    v_mul_f32 v82, v82, v255
    v_mul_f32 v83, v83, v255
    v_mul_f32 v84, v84, v255
    v_mul_f32 v85, v85, v255
    v_mul_f32 v86, v86, v255
    v_mul_f32 v87, v87, v255
    v_mul_f32 v88, v88, v255
    v_mul_f32 v89, v89, v255
    v_mul_f32 v90, v90, v255
    v_mul_f32 v91, v91, v255
    v_mul_f32 v92, v92, v255
    v_mul_f32 v93, v93, v255
    v_mul_f32 v94, v94, v255
    v_mul_f32 v95, v95, v255
    v_mul_f32 v96, v96, v255
    v_mul_f32 v97, v97, v255
    v_mul_f32 v98, v98, v255
    v_mul_f32 v99, v99, v255
    v_mul_f32 v100, v100, v255
    v_mul_f32 v101, v101, v255
    v_mul_f32 v102, v102, v255
    v_mul_f32 v103, v103, v255
    v_mul_f32 v104, v104, v255
    v_mul_f32 v105, v105, v255
    v_mul_f32 v106, v106, v255
    v_mul_f32 v107, v107, v255
    v_mul_f32 v108, v108, v255
    v_mul_f32 v109, v109, v255
    v_mul_f32 v110, v110, v255
    v_mul_f32 v111, v111, v255
    v_accvgpr_read_b32 v254, a176
    v_mul_f32 v254, v254, v255
    v_accvgpr_write_b32 a176, v254
    v_accvgpr_read_b32 v254, a177
    v_mul_f32 v254, v254, v255
    v_accvgpr_write_b32 a177, v254
    v_accvgpr_read_b32 v254, a178
    v_mul_f32 v254, v254, v255
    v_accvgpr_write_b32 a178, v254
    v_accvgpr_read_b32 v254, a179
    v_mul_f32 v254, v254, v255
    v_accvgpr_write_b32 a179, v254
    v_accvgpr_read_b32 v254, a180
    v_mul_f32 v254, v254, v255
    v_accvgpr_write_b32 a180, v254
    v_accvgpr_read_b32 v254, a181
    v_mul_f32 v254, v254, v255
    v_accvgpr_write_b32 a181, v254
    v_accvgpr_read_b32 v254, a182
    v_mul_f32 v254, v254, v255
    v_accvgpr_write_b32 a182, v254
    v_accvgpr_read_b32 v254, a183
    v_mul_f32 v254, v254, v255
    v_accvgpr_write_b32 a183, v254
    v_accvgpr_read_b32 v254, a184
    v_mul_f32 v254, v254, v255
    v_accvgpr_write_b32 a184, v254
    v_accvgpr_read_b32 v254, a185
    v_mul_f32 v254, v254, v255
    v_accvgpr_write_b32 a185, v254
    v_accvgpr_read_b32 v254, a186
    v_mul_f32 v254, v254, v255
    v_accvgpr_write_b32 a186, v254
    v_accvgpr_read_b32 v254, a187
    v_mul_f32 v254, v254, v255
    v_accvgpr_write_b32 a187, v254
    v_accvgpr_read_b32 v254, a188
    v_mul_f32 v254, v254, v255
    v_accvgpr_write_b32 a188, v254
    v_accvgpr_read_b32 v254, a189
    v_mul_f32 v254, v254, v255
    v_accvgpr_write_b32 a189, v254
    v_accvgpr_read_b32 v254, a190
    v_mul_f32 v254, v254, v255
    v_accvgpr_write_b32 a190, v254
    v_accvgpr_read_b32 v254, a191
    v_mul_f32 v254, v254, v255
    v_accvgpr_write_b32 a191, v254
    v_mul_f32 v112, v112, v255
    v_mul_f32 v113, v113, v255
    v_mul_f32 v114, v114, v255
    v_mul_f32 v115, v115, v255
    v_mul_f32 v116, v116, v255
    v_mul_f32 v117, v117, v255
    v_mul_f32 v118, v118, v255
    v_mul_f32 v119, v119, v255
    v_mul_f32 v120, v120, v255
    v_mul_f32 v121, v121, v255
    v_mul_f32 v122, v122, v255
    v_mul_f32 v123, v123, v255
    v_mul_f32 v124, v124, v255
    v_mul_f32 v125, v125, v255
    v_mul_f32 v126, v126, v255
    v_mul_f32 v127, v127, v255
    v_accvgpr_read_b32 v254, a192
    v_mul_f32 v254, v254, v255
    v_accvgpr_write_b32 a192, v254
    v_accvgpr_read_b32 v254, a193
    v_mul_f32 v254, v254, v255
    v_accvgpr_write_b32 a193, v254
    v_accvgpr_read_b32 v254, a194
    v_mul_f32 v254, v254, v255
    v_accvgpr_write_b32 a194, v254
    v_accvgpr_read_b32 v254, a195
    v_mul_f32 v254, v254, v255
    v_accvgpr_write_b32 a195, v254
    v_accvgpr_read_b32 v254, a196
    v_mul_f32 v254, v254, v255
    v_accvgpr_write_b32 a196, v254
    v_accvgpr_read_b32 v254, a197
    v_mul_f32 v254, v254, v255
    v_accvgpr_write_b32 a197, v254
    v_accvgpr_read_b32 v254, a198
    v_mul_f32 v254, v254, v255
    v_accvgpr_write_b32 a198, v254
    v_accvgpr_read_b32 v254, a199
    v_mul_f32 v254, v254, v255
    v_accvgpr_write_b32 a199, v254
    v_accvgpr_read_b32 v254, a200
    v_mul_f32 v254, v254, v255
    v_accvgpr_write_b32 a200, v254
    v_accvgpr_read_b32 v254, a201
    v_mul_f32 v254, v254, v255
    v_accvgpr_write_b32 a201, v254
    v_accvgpr_read_b32 v254, a202
    v_mul_f32 v254, v254, v255
    v_accvgpr_write_b32 a202, v254
    v_accvgpr_read_b32 v254, a203
    v_mul_f32 v254, v254, v255
    v_accvgpr_write_b32 a203, v254
    v_accvgpr_read_b32 v254, a204
    v_mul_f32 v254, v254, v255
    v_accvgpr_write_b32 a204, v254
    v_accvgpr_read_b32 v254, a205
    v_mul_f32 v254, v254, v255
    v_accvgpr_write_b32 a205, v254
    v_accvgpr_read_b32 v254, a206
    v_mul_f32 v254, v254, v255
    v_accvgpr_write_b32 a206, v254
    v_accvgpr_read_b32 v254, a207
    v_mul_f32 v254, v254, v255
    v_accvgpr_write_b32 a207, v254
    s_nop 1
    s_branch L_ret32
L_slow34:
    s_nop 1
    v_mov_b32 v255, v254
    s_nop 1
    v_permlane32_swap_b32 v254, v255
    v_max_f32 v254, v254, v255
    v_mul_f32 v254, s29, v254
    v_max_f32 v254, v254, v250
    v_sub_f32 v255, v250, v254
    v_exp_f32 v255, v255
    v_mov_b32 v250, v254
    v_mul_f32 v253, v253, v255
    v_mul_f32 v128, v128, v255
    v_mul_f32 v129, v129, v255
    v_mul_f32 v130, v130, v255
    v_mul_f32 v131, v131, v255
    v_mul_f32 v132, v132, v255
    v_mul_f32 v133, v133, v255
    v_mul_f32 v134, v134, v255
    v_mul_f32 v135, v135, v255
    v_mul_f32 v136, v136, v255
    v_mul_f32 v137, v137, v255
    v_mul_f32 v138, v138, v255
    v_mul_f32 v139, v139, v255
    v_mul_f32 v140, v140, v255
    v_mul_f32 v141, v141, v255
    v_mul_f32 v142, v142, v255
    v_mul_f32 v143, v143, v255
    v_mul_f32 v144, v144, v255
    v_mul_f32 v145, v145, v255
    v_mul_f32 v146, v146, v255
    v_mul_f32 v147, v147, v255
    v_mul_f32 v148, v148, v255
    v_mul_f32 v149, v149, v255
    v_mul_f32 v150, v150, v255
    v_mul_f32 v151, v151, v255
    v_mul_f32 v152, v152, v255
    v_mul_f32 v153, v153, v255
    v_mul_f32 v154, v154, v255
    v_mul_f32 v155, v155, v255
    v_mul_f32 v156, v156, v255
    v_mul_f32 v157, v157, v255
    v_mul_f32 v158, v158, v255
    v_mul_f32 v159, v159, v255
    v_mul_f32 v160, v160, v255
    v_mul_f32 v161, v161, v255
    v_mul_f32 v162, v162, v255
    v_mul_f32 v163, v163, v255
    v_mul_f32 v164, v164, v255
    v_mul_f32 v165, v165, v255
    v_mul_f32 v166, v166, v255
    v_mul_f32 v167, v167, v255
    v_mul_f32 v168, v168, v255
    v_mul_f32 v169, v169, v255
    v_mul_f32 v170, v170, v255
    v_mul_f32 v171, v171, v255
    v_mul_f32 v172, v172, v255
    v_mul_f32 v173, v173, v255
    v_mul_f32 v174, v174, v255
    v_mul_f32 v175, v175, v255
    v_accvgpr_read_b32 v254, a208
    v_mul_f32 v254, v254, v255
    v_accvgpr_write_b32 a208, v254
    v_accvgpr_read_b32 v254, a209
    v_mul_f32 v254, v254, v255
    v_accvgpr_write_b32 a209, v254
    v_accvgpr_read_b32 v254, a210
    v_mul_f32 v254, v254, v255
    v_accvgpr_write_b32 a210, v254
    v_accvgpr_read_b32 v254, a211
    v_mul_f32 v254, v254, v255
    v_accvgpr_write_b32 a211, v254
    v_accvgpr_read_b32 v254, a212
    v_mul_f32 v254, v254, v255
    v_accvgpr_write_b32 a212, v254
    v_accvgpr_read_b32 v254, a213
    v_mul_f32 v254, v254, v255
    v_accvgpr_write_b32 a213, v254
    v_accvgpr_read_b32 v254, a214
    v_mul_f32 v254, v254, v255
    v_accvgpr_write_b32 a214, v254
    v_accvgpr_read_b32 v254, a215
    v_mul_f32 v254, v254, v255
    v_accvgpr_write_b32 a215, v254
    v_accvgpr_read_b32 v254, a216
    v_mul_f32 v254, v254, v255
    v_accvgpr_write_b32 a216, v254
    v_accvgpr_read_b32 v254, a217
    v_mul_f32 v254, v254, v255
    v_accvgpr_write_b32 a217, v254
    v_accvgpr_read_b32 v254, a218
    v_mul_f32 v254, v254, v255
    v_accvgpr_write_b32 a218, v254
    v_accvgpr_read_b32 v254, a219
    v_mul_f32 v254, v254, v255
    v_accvgpr_write_b32 a219, v254
    v_accvgpr_read_b32 v254, a220
    v_mul_f32 v254, v254, v255
    v_accvgpr_write_b32 a220, v254
    v_accvgpr_read_b32 v254, a221
    v_mul_f32 v254, v254, v255
    v_accvgpr_write_b32 a221, v254
    v_accvgpr_read_b32 v254, a222
    v_mul_f32 v254, v254, v255
    v_accvgpr_write_b32 a222, v254
    v_accvgpr_read_b32 v254, a223
    v_mul_f32 v254, v254, v255
    v_accvgpr_write_b32 a223, v254
    v_accvgpr_read_b32 v254, a240
    v_mul_f32 v254, v254, v255
    v_accvgpr_write_b32 a240, v254
    v_accvgpr_read_b32 v254, a241
    v_mul_f32 v254, v254, v255
    v_accvgpr_write_b32 a241, v254
    v_accvgpr_read_b32 v254, a242
    v_mul_f32 v254, v254, v255
    v_accvgpr_write_b32 a242, v254
    v_accvgpr_read_b32 v254, a243
    v_mul_f32 v254, v254, v255
    v_accvgpr_write_b32 a243, v254
    v_accvgpr_read_b32 v254, a244
    v_mul_f32 v254, v254, v255
    v_accvgpr_write_b32 a244, v254
    v_accvgpr_read_b32 v254, a245
    v_mul_f32 v254, v254, v255
    v_accvgpr_write_b32 a245, v254
    v_accvgpr_read_b32 v254, a246
    v_mul_f32 v254, v254, v255
    v_accvgpr_write_b32 a246, v254
    v_accvgpr_read_b32 v254, a247
    v_mul_f32 v254, v254, v255
    v_accvgpr_write_b32 a247, v254
    v_accvgpr_read_b32 v254, a248
    v_mul_f32 v254, v254, v255
    v_accvgpr_write_b32 a248, v254
    v_accvgpr_read_b32 v254, a249
    v_mul_f32 v254, v254, v255
    v_accvgpr_write_b32 a249, v254
    v_accvgpr_read_b32 v254, a250
    v_mul_f32 v254, v254, v255
    v_accvgpr_write_b32 a250, v254
    v_accvgpr_read_b32 v254, a251
    v_mul_f32 v254, v254, v255
    v_accvgpr_write_b32 a251, v254
    v_accvgpr_read_b32 v254, a252
    v_mul_f32 v254, v254, v255
    v_accvgpr_write_b32 a252, v254
    v_accvgpr_read_b32 v254, a253
    v_mul_f32 v254, v254, v255
    v_accvgpr_write_b32 a253, v254
    v_accvgpr_read_b32 v254, a254
    v_mul_f32 v254, v254, v255
    v_accvgpr_write_b32 a254, v254
    v_accvgpr_read_b32 v254, a255
    v_mul_f32 v254, v254, v255
    v_accvgpr_write_b32 a255, v254
    v_accvgpr_read_b32 v254, a224
    v_mul_f32 v254, v254, v255
    v_accvgpr_write_b32 a224, v254
    v_accvgpr_read_b32 v254, a225
    v_mul_f32 v254, v254, v255
    v_accvgpr_write_b32 a225, v254
    v_accvgpr_read_b32 v254, a226
    v_mul_f32 v254, v254, v255
    v_accvgpr_write_b32 a226, v254
    v_accvgpr_read_b32 v254, a227
    v_mul_f32 v254, v254, v255
    v_accvgpr_write_b32 a227, v254
    v_accvgpr_read_b32 v254, a228
    v_mul_f32 v254, v254, v255
    v_accvgpr_write_b32 a228, v254
    v_accvgpr_read_b32 v254, a229
    v_mul_f32 v254, v254, v255
    v_accvgpr_write_b32 a229, v254
    v_accvgpr_read_b32 v254, a230
    v_mul_f32 v254, v254, v255
    v_accvgpr_write_b32 a230, v254
    v_accvgpr_read_b32 v254, a231
    v_mul_f32 v254, v254, v255
    v_accvgpr_write_b32 a231, v254
    v_accvgpr_read_b32 v254, a232
    v_mul_f32 v254, v254, v255
    v_accvgpr_write_b32 a232, v254
    v_accvgpr_read_b32 v254, a233
    v_mul_f32 v254, v254, v255
    v_accvgpr_write_b32 a233, v254
    v_accvgpr_read_b32 v254, a234
    v_mul_f32 v254, v254, v255
    v_accvgpr_write_b32 a234, v254
    v_accvgpr_read_b32 v254, a235
    v_mul_f32 v254, v254, v255
    v_accvgpr_write_b32 a235, v254
    v_accvgpr_read_b32 v254, a236
    v_mul_f32 v254, v254, v255
    v_accvgpr_write_b32 a236, v254
    v_accvgpr_read_b32 v254, a237
    v_mul_f32 v254, v254, v255
    v_accvgpr_write_b32 a237, v254
    v_accvgpr_read_b32 v254, a238
    v_mul_f32 v254, v254, v255
    v_accvgpr_write_b32 a238, v254
    v_accvgpr_read_b32 v254, a239
    v_mul_f32 v254, v254, v255
    v_accvgpr_write_b32 a239, v254
    s_nop 1
    s_branch L_ret34
L_slow36:
    s_nop 1
    v_mov_b32 v255, v254
    s_nop 1
    v_permlane32_swap_b32 v254, v255
    v_max_f32 v254, v254, v255
    v_mul_f32 v254, s29, v254
    v_max_f32 v254, v254, v248
    v_sub_f32 v255, v248, v254
    v_exp_f32 v255, v255
    v_mov_b32 v248, v254
    v_mul_f32 v251, v251, v255
    v_mul_f32 v0, v0, v255
    v_mul_f32 v1, v1, v255
    v_mul_f32 v2, v2, v255
    v_mul_f32 v3, v3, v255
    v_mul_f32 v4, v4, v255
    v_mul_f32 v5, v5, v255
    v_mul_f32 v6, v6, v255
    v_mul_f32 v7, v7, v255
    v_mul_f32 v8, v8, v255
    v_mul_f32 v9, v9, v255
    v_mul_f32 v10, v10, v255
    v_mul_f32 v11, v11, v255
    v_mul_f32 v12, v12, v255
    v_mul_f32 v13, v13, v255
    v_mul_f32 v14, v14, v255
    v_mul_f32 v15, v15, v255
    v_mul_f32 v16, v16, v255
    v_mul_f32 v17, v17, v255
    v_mul_f32 v18, v18, v255
    v_mul_f32 v19, v19, v255
    v_mul_f32 v20, v20, v255
    v_mul_f32 v21, v21, v255
    v_mul_f32 v22, v22, v255
    v_mul_f32 v23, v23, v255
    v_mul_f32 v24, v24, v255
    v_mul_f32 v25, v25, v255
    v_mul_f32 v26, v26, v255
    v_mul_f32 v27, v27, v255
    v_mul_f32 v28, v28, v255
    v_mul_f32 v29, v29, v255
    v_mul_f32 v30, v30, v255
    v_mul_f32 v31, v31, v255
    v_mul_f32 v32, v32, v255
    v_mul_f32 v33, v33, v255
    v_mul_f32 v34, v34, v255
    v_mul_f32 v35, v35, v255
    v_mul_f32 v36, v36, v255
    v_mul_f32 v37, v37, v255
    v_mul_f32 v38, v38, v255
    v_mul_f32 v39, v39, v255
    v_mul_f32 v40, v40, v255
    v_mul_f32 v41, v41, v255
    v_mul_f32 v42, v42, v255
    v_mul_f32 v43, v43, v255
    v_mul_f32 v44, v44, v255
    v_mul_f32 v45, v45, v255
    v_mul_f32 v46, v46, v255
    v_mul_f32 v47, v47, v255
    v_accvgpr_read_b32 v254, a144
    v_mul_f32 v254, v254, v255
    v_accvgpr_write_b32 a144, v254
    v_accvgpr_read_b32 v254, a145
    v_mul_f32 v254, v254, v255
    v_accvgpr_write_b32 a145, v254
    v_accvgpr_read_b32 v254, a146
    v_mul_f32 v254, v254, v255
    v_accvgpr_write_b32 a146, v254
    v_accvgpr_read_b32 v254, a147
    v_mul_f32 v254, v254, v255
    v_accvgpr_write_b32 a147, v254
    v_accvgpr_read_b32 v254, a148
    v_mul_f32 v254, v254, v255
    v_accvgpr_write_b32 a148, v254
    v_accvgpr_read_b32 v254, a149
    v_mul_f32 v254, v254, v255
    v_accvgpr_write_b32 a149, v254
    v_accvgpr_read_b32 v254, a150
    v_mul_f32 v254, v254, v255
    v_accvgpr_write_b32 a150, v254
    v_accvgpr_read_b32 v254, a151
    v_mul_f32 v254, v254, v255
    v_accvgpr_write_b32 a151, v254
    v_accvgpr_read_b32 v254, a152
    v_mul_f32 v254, v254, v255
    v_accvgpr_write_b32 a152, v254
    v_accvgpr_read_b32 v254, a153
    v_mul_f32 v254, v254, v255
    v_accvgpr_write_b32 a153, v254
    v_accvgpr_read_b32 v254, a154
    v_mul_f32 v254, v254, v255
    v_accvgpr_write_b32 a154, v254
    v_accvgpr_read_b32 v254, a155
    v_mul_f32 v254, v254, v255
    v_accvgpr_write_b32 a155, v254
    v_accvgpr_read_b32 v254, a156
    v_mul_f32 v254, v254, v255
    v_accvgpr_write_b32 a156, v254
    v_accvgpr_read_b32 v254, a157
    v_mul_f32 v254, v254, v255
    v_accvgpr_write_b32 a157, v254
    v_accvgpr_read_b32 v254, a158
    v_mul_f32 v254, v254, v255
    v_accvgpr_write_b32 a158, v254
    v_accvgpr_read_b32 v254, a159
    v_mul_f32 v254, v254, v255
    v_accvgpr_write_b32 a159, v254
    v_mul_f32 v48, v48, v255
    v_mul_f32 v49, v49, v255
    v_mul_f32 v50, v50, v255
    v_mul_f32 v51, v51, v255
    v_mul_f32 v52, v52, v255
    v_mul_f32 v53, v53, v255
    v_mul_f32 v54, v54, v255
    v_mul_f32 v55, v55, v255
    v_mul_f32 v56, v56, v255
    v_mul_f32 v57, v57, v255
    v_mul_f32 v58, v58, v255
    v_mul_f32 v59, v59, v255
    v_mul_f32 v60, v60, v255
    v_mul_f32 v61, v61, v255
    v_mul_f32 v62, v62, v255
    v_mul_f32 v63, v63, v255
    v_accvgpr_read_b32 v254, a160
    v_mul_f32 v254, v254, v255
    v_accvgpr_write_b32 a160, v254
    v_accvgpr_read_b32 v254, a161
    v_mul_f32 v254, v254, v255
    v_accvgpr_write_b32 a161, v254
    v_accvgpr_read_b32 v254, a162
    v_mul_f32 v254, v254, v255
    v_accvgpr_write_b32 a162, v254
    v_accvgpr_read_b32 v254, a163
    v_mul_f32 v254, v254, v255
    v_accvgpr_write_b32 a163, v254
    v_accvgpr_read_b32 v254, a164
    v_mul_f32 v254, v254, v255
    v_accvgpr_write_b32 a164, v254
    v_accvgpr_read_b32 v254, a165
    v_mul_f32 v254, v254, v255
    v_accvgpr_write_b32 a165, v254
    v_accvgpr_read_b32 v254, a166
    v_mul_f32 v254, v254, v255
    v_accvgpr_write_b32 a166, v254
    v_accvgpr_read_b32 v254, a167
    v_mul_f32 v254, v254, v255
    v_accvgpr_write_b32 a167, v254
    v_accvgpr_read_b32 v254, a168
    v_mul_f32 v254, v254, v255
    v_accvgpr_write_b32 a168, v254
    v_accvgpr_read_b32 v254, a169
    v_mul_f32 v254, v254, v255
    v_accvgpr_write_b32 a169, v254
    v_accvgpr_read_b32 v254, a170
    v_mul_f32 v254, v254, v255
    v_accvgpr_write_b32 a170, v254
    v_accvgpr_read_b32 v254, a171
    v_mul_f32 v254, v254, v255
    v_accvgpr_write_b32 a171, v254
    v_accvgpr_read_b32 v254, a172
    v_mul_f32 v254, v254, v255
    v_accvgpr_write_b32 a172, v254
    v_accvgpr_read_b32 v254, a173
    v_mul_f32 v254, v254, v255
    v_accvgpr_write_b32 a173, v254
    v_accvgpr_read_b32 v254, a174
    v_mul_f32 v254, v254, v255
    v_accvgpr_write_b32 a174, v254
    v_accvgpr_read_b32 v254, a175
    v_mul_f32 v254, v254, v255
    v_accvgpr_write_b32 a175, v254
    s_nop 1
    s_branch L_ret36
L_slow38:
    s_nop 1
    v_mov_b32 v255, v254
    s_nop 1
    v_permlane32_swap_b32 v254, v255
    v_max_f32 v254, v254, v255
    v_mul_f32 v254, s29, v254
    v_max_f32 v254, v254, v249
    v_sub_f32 v255, v249, v254
    v_exp_f32 v255, v255
    v_mov_b32 v249, v254
    v_mul_f32 v252, v252, v255
    v_mul_f32 v64, v64, v255
    v_mul_f32 v65, v65, v255
    v_mul_f32 v66, v66, v255
    v_mul_f32 v67, v67, v255
    v_mul_f32 v68, v68, v255
    v_mul_f32 v69, v69, v255
    v_mul_f32 v70, v70, v255
    v_mul_f32 v71, v71, v255
    v_mul_f32 v72, v72, v255
    v_mul_f32 v73, v73, v255
    v_mul_f32 v74, v74, v255
    v_mul_f32 v75, v75, v255
    v_mul_f32 v76, v76, v255
    v_mul_f32 v77, v77, v255
    v_mul_f32 v78, v78, v255
    v_mul_f32 v79, v79, v255
    v_mul_f32 v80, v80, v255
    v_mul_f32 v81, v81, v255
    v_mul_f32 v82, v82, v255
    v_mul_f32 v83, v83, v255
    v_mul_f32 v84, v84, v255
    v_mul_f32 v85, v85, v255
    v_mul_f32 v86, v86, v255
    v_mul_f32 v87, v87, v255
    v_mul_f32 v88, v88, v255
    v_mul_f32 v89, v89, v255
    v_mul_f32 v90, v90, v255
    v_mul_f32 v91, v91, v255
    v_mul_f32 v92, v92, v255
    v_mul_f32 v93, v93, v255
    v_mul_f32 v94, v94, v255
    v_mul_f32 v95, v95, v255
    v_mul_f32 v96, v96, v255
    v_mul_f32 v97, v97, v255
    v_mul_f32 v98, v98, v255
    v_mul_f32 v99, v99, v255
    v_mul_f32 v100, v100, v255
    v_mul_f32 v101, v101, v255
    v_mul_f32 v102, v102, v255
    v_mul_f32 v103, v103, v255
    v_mul_f32 v104, v104, v255
    v_mul_f32 v105, v105, v255
    v_mul_f32 v106, v106, v255
    v_mul_f32 v107, v107, v255
    v_mul_f32 v108, v108, v255
    v_mul_f32 v109, v109, v255
    v_mul_f32 v110, v110, v255
    v_mul_f32 v111, v111, v255
    v_accvgpr_read_b32 v254, a176
    v_mul_f32 v254, v254, v255
    v_accvgpr_write_b32 a176, v254
    v_accvgpr_read_b32 v254, a177
    v_mul_f32 v254, v254, v255
    v_accvgpr_write_b32 a177, v254
    v_accvgpr_read_b32 v254, a178
    v_mul_f32 v254, v254, v255
    v_accvgpr_write_b32 a178, v254
    v_accvgpr_read_b32 v254, a179
    v_mul_f32 v254, v254, v255
    v_accvgpr_write_b32 a179, v254
    v_accvgpr_read_b32 v254, a180
    v_mul_f32 v254, v254, v255
    v_accvgpr_write_b32 a180, v254
    v_accvgpr_read_b32 v254, a181
    v_mul_f32 v254, v254, v255
    v_accvgpr_write_b32 a181, v254
    v_accvgpr_read_b32 v254, a182
    v_mul_f32 v254, v254, v255
    v_accvgpr_write_b32 a182, v254
    v_accvgpr_read_b32 v254, a183
    v_mul_f32 v254, v254, v255
    v_accvgpr_write_b32 a183, v254
    v_accvgpr_read_b32 v254, a184
    v_mul_f32 v254, v254, v255
    v_accvgpr_write_b32 a184, v254
    v_accvgpr_read_b32 v254, a185
    v_mul_f32 v254, v254, v255
    v_accvgpr_write_b32 a185, v254
    v_accvgpr_read_b32 v254, a186
    v_mul_f32 v254, v254, v255
    v_accvgpr_write_b32 a186, v254
    v_accvgpr_read_b32 v254, a187
    v_mul_f32 v254, v254, v255
    v_accvgpr_write_b32 a187, v254
    v_accvgpr_read_b32 v254, a188
    v_mul_f32 v254, v254, v255
    v_accvgpr_write_b32 a188, v254
    v_accvgpr_read_b32 v254, a189
    v_mul_f32 v254, v254, v255
    v_accvgpr_write_b32 a189, v254
    v_accvgpr_read_b32 v254, a190
    v_mul_f32 v254, v254, v255
    v_accvgpr_write_b32 a190, v254
    v_accvgpr_read_b32 v254, a191
    v_mul_f32 v254, v254, v255
    v_accvgpr_write_b32 a191, v254
    v_mul_f32 v112, v112, v255
    v_mul_f32 v113, v113, v255
    v_mul_f32 v114, v114, v255
    v_mul_f32 v115, v115, v255
    v_mul_f32 v116, v116, v255
    v_mul_f32 v117, v117, v255
    v_mul_f32 v118, v118, v255
    v_mul_f32 v119, v119, v255
    v_mul_f32 v120, v120, v255
    v_mul_f32 v121, v121, v255
    v_mul_f32 v122, v122, v255
    v_mul_f32 v123, v123, v255
    v_mul_f32 v124, v124, v255
    v_mul_f32 v125, v125, v255
    v_mul_f32 v126, v126, v255
    v_mul_f32 v127, v127, v255
    v_accvgpr_read_b32 v254, a192
    v_mul_f32 v254, v254, v255
    v_accvgpr_write_b32 a192, v254
    v_accvgpr_read_b32 v254, a193
    v_mul_f32 v254, v254, v255
    v_accvgpr_write_b32 a193, v254
    v_accvgpr_read_b32 v254, a194
    v_mul_f32 v254, v254, v255
    v_accvgpr_write_b32 a194, v254
    v_accvgpr_read_b32 v254, a195
    v_mul_f32 v254, v254, v255
    v_accvgpr_write_b32 a195, v254
    v_accvgpr_read_b32 v254, a196
    v_mul_f32 v254, v254, v255
    v_accvgpr_write_b32 a196, v254
    v_accvgpr_read_b32 v254, a197
    v_mul_f32 v254, v254, v255
    v_accvgpr_write_b32 a197, v254
    v_accvgpr_read_b32 v254, a198
    v_mul_f32 v254, v254, v255
    v_accvgpr_write_b32 a198, v254
    v_accvgpr_read_b32 v254, a199
    v_mul_f32 v254, v254, v255
    v_accvgpr_write_b32 a199, v254
    v_accvgpr_read_b32 v254, a200
    v_mul_f32 v254, v254, v255
    v_accvgpr_write_b32 a200, v254
    v_accvgpr_read_b32 v254, a201
    v_mul_f32 v254, v254, v255
    v_accvgpr_write_b32 a201, v254
    v_accvgpr_read_b32 v254, a202
    v_mul_f32 v254, v254, v255
    v_accvgpr_write_b32 a202, v254
    v_accvgpr_read_b32 v254, a203
    v_mul_f32 v254, v254, v255
    v_accvgpr_write_b32 a203, v254
    v_accvgpr_read_b32 v254, a204
    v_mul_f32 v254, v254, v255
    v_accvgpr_write_b32 a204, v254
    v_accvgpr_read_b32 v254, a205
    v_mul_f32 v254, v254, v255
    v_accvgpr_write_b32 a205, v254
    v_accvgpr_read_b32 v254, a206
    v_mul_f32 v254, v254, v255
    v_accvgpr_write_b32 a206, v254
    v_accvgpr_read_b32 v254, a207
    v_mul_f32 v254, v254, v255
    v_accvgpr_write_b32 a207, v254
    s_nop 1
    s_branch L_ret38
L_slow40:
    s_nop 1
    v_mov_b32 v255, v254
    s_nop 1
    v_permlane32_swap_b32 v254, v255
    v_max_f32 v254, v254, v255
    v_mul_f32 v254, s29, v254
    v_max_f32 v254, v254, v250
    v_sub_f32 v255, v250, v254
    v_exp_f32 v255, v255
    v_mov_b32 v250, v254
    v_mul_f32 v253, v253, v255
    v_mul_f32 v128, v128, v255
    v_mul_f32 v129, v129, v255
    v_mul_f32 v130, v130, v255
    v_mul_f32 v131, v131, v255
    v_mul_f32 v132, v132, v255
    v_mul_f32 v133, v133, v255
    v_mul_f32 v134, v134, v255
    v_mul_f32 v135, v135, v255
    v_mul_f32 v136, v136, v255
    v_mul_f32 v137, v137, v255
    v_mul_f32 v138, v138, v255
    v_mul_f32 v139, v139, v255
    v_mul_f32 v140, v140, v255
    v_mul_f32 v141, v141, v255
    v_mul_f32 v142, v142, v255
    v_mul_f32 v143, v143, v255
    v_mul_f32 v144, v144, v255
    v_mul_f32 v145, v145, v255
    v_mul_f32 v146, v146, v255
    v_mul_f32 v147, v147, v255
    v_mul_f32 v148, v148, v255
    v_mul_f32 v149, v149, v255
    v_mul_f32 v150, v150, v255
    v_mul_f32 v151, v151, v255
    v_mul_f32 v152, v152, v255
    v_mul_f32 v153, v153, v255
    v_mul_f32 v154, v154, v255
    v_mul_f32 v155, v155, v255
    v_mul_f32 v156, v156, v255
    v_mul_f32 v157, v157, v255
    v_mul_f32 v158, v158, v255
    v_mul_f32 v159, v159, v255
    v_mul_f32 v160, v160, v255
    v_mul_f32 v161, v161, v255
    v_mul_f32 v162, v162, v255
    v_mul_f32 v163, v163, v255
    v_mul_f32 v164, v164, v255
    v_mul_f32 v165, v165, v255
    v_mul_f32 v166, v166, v255
    v_mul_f32 v167, v167, v255
    v_mul_f32 v168, v168, v255
    v_mul_f32 v169, v169, v255
    v_mul_f32 v170, v170, v255
    v_mul_f32 v171, v171, v255
    v_mul_f32 v172, v172, v255
    v_mul_f32 v173, v173, v255
    v_mul_f32 v174, v174, v255
    v_mul_f32 v175, v175, v255
    v_accvgpr_read_b32 v254, a208
    v_mul_f32 v254, v254, v255
    v_accvgpr_write_b32 a208, v254
    v_accvgpr_read_b32 v254, a209
    v_mul_f32 v254, v254, v255
    v_accvgpr_write_b32 a209, v254
    v_accvgpr_read_b32 v254, a210
    v_mul_f32 v254, v254, v255
    v_accvgpr_write_b32 a210, v254
    v_accvgpr_read_b32 v254, a211
    v_mul_f32 v254, v254, v255
    v_accvgpr_write_b32 a211, v254
    v_accvgpr_read_b32 v254, a212
    v_mul_f32 v254, v254, v255
    v_accvgpr_write_b32 a212, v254
    v_accvgpr_read_b32 v254, a213
    v_mul_f32 v254, v254, v255
    v_accvgpr_write_b32 a213, v254
    v_accvgpr_read_b32 v254, a214
    v_mul_f32 v254, v254, v255
    v_accvgpr_write_b32 a214, v254
    v_accvgpr_read_b32 v254, a215
    v_mul_f32 v254, v254, v255
    v_accvgpr_write_b32 a215, v254
    v_accvgpr_read_b32 v254, a216
    v_mul_f32 v254, v254, v255
    v_accvgpr_write_b32 a216, v254
    v_accvgpr_read_b32 v254, a217
    v_mul_f32 v254, v254, v255
    v_accvgpr_write_b32 a217, v254
    v_accvgpr_read_b32 v254, a218
    v_mul_f32 v254, v254, v255
    v_accvgpr_write_b32 a218, v254
    v_accvgpr_read_b32 v254, a219
    v_mul_f32 v254, v254, v255
    v_accvgpr_write_b32 a219, v254
    v_accvgpr_read_b32 v254, a220
    v_mul_f32 v254, v254, v255
    v_accvgpr_write_b32 a220, v254
    v_accvgpr_read_b32 v254, a221
    v_mul_f32 v254, v254, v255
    v_accvgpr_write_b32 a221, v254
    v_accvgpr_read_b32 v254, a222
    v_mul_f32 v254, v254, v255
    v_accvgpr_write_b32 a222, v254
    v_accvgpr_read_b32 v254, a223
    v_mul_f32 v254, v254, v255
    v_accvgpr_write_b32 a223, v254
    v_accvgpr_read_b32 v254, a240
    v_mul_f32 v254, v254, v255
    v_accvgpr_write_b32 a240, v254
    v_accvgpr_read_b32 v254, a241
    v_mul_f32 v254, v254, v255
    v_accvgpr_write_b32 a241, v254
    v_accvgpr_read_b32 v254, a242
    v_mul_f32 v254, v254, v255
    v_accvgpr_write_b32 a242, v254
    v_accvgpr_read_b32 v254, a243
    v_mul_f32 v254, v254, v255
    v_accvgpr_write_b32 a243, v254
    v_accvgpr_read_b32 v254, a244
    v_mul_f32 v254, v254, v255
    v_accvgpr_write_b32 a244, v254
    v_accvgpr_read_b32 v254, a245
    v_mul_f32 v254, v254, v255
    v_accvgpr_write_b32 a245, v254
    v_accvgpr_read_b32 v254, a246
    v_mul_f32 v254, v254, v255
    v_accvgpr_write_b32 a246, v254
    v_accvgpr_read_b32 v254, a247
    v_mul_f32 v254, v254, v255
    v_accvgpr_write_b32 a247, v254
    v_accvgpr_read_b32 v254, a248
    v_mul_f32 v254, v254, v255
    v_accvgpr_write_b32 a248, v254
    v_accvgpr_read_b32 v254, a249
    v_mul_f32 v254, v254, v255
    v_accvgpr_write_b32 a249, v254
    v_accvgpr_read_b32 v254, a250
    v_mul_f32 v254, v254, v255
    v_accvgpr_write_b32 a250, v254
    v_accvgpr_read_b32 v254, a251
    v_mul_f32 v254, v254, v255
    v_accvgpr_write_b32 a251, v254
    v_accvgpr_read_b32 v254, a252
    v_mul_f32 v254, v254, v255
    v_accvgpr_write_b32 a252, v254
    v_accvgpr_read_b32 v254, a253
    v_mul_f32 v254, v254, v255
    v_accvgpr_write_b32 a253, v254
    v_accvgpr_read_b32 v254, a254
    v_mul_f32 v254, v254, v255
    v_accvgpr_write_b32 a254, v254
    v_accvgpr_read_b32 v254, a255
    v_mul_f32 v254, v254, v255
    v_accvgpr_write_b32 a255, v254
    v_accvgpr_read_b32 v254, a224
    v_mul_f32 v254, v254, v255
    v_accvgpr_write_b32 a224, v254
    v_accvgpr_read_b32 v254, a225
    v_mul_f32 v254, v254, v255
    v_accvgpr_write_b32 a225, v254
    v_accvgpr_read_b32 v254, a226
    v_mul_f32 v254, v254, v255
    v_accvgpr_write_b32 a226, v254
    v_accvgpr_read_b32 v254, a227
    v_mul_f32 v254, v254, v255
    v_accvgpr_write_b32 a227, v254
    v_accvgpr_read_b32 v254, a228
    v_mul_f32 v254, v254, v255
    v_accvgpr_write_b32 a228, v254
    v_accvgpr_read_b32 v254, a229
    v_mul_f32 v254, v254, v255
    v_accvgpr_write_b32 a229, v254
    v_accvgpr_read_b32 v254, a230
    v_mul_f32 v254, v254, v255
    v_accvgpr_write_b32 a230, v254
    v_accvgpr_read_b32 v254, a231
    v_mul_f32 v254, v254, v255
    v_accvgpr_write_b32 a231, v254
    v_accvgpr_read_b32 v254, a232
    v_mul_f32 v254, v254, v255
    v_accvgpr_write_b32 a232, v254
    v_accvgpr_read_b32 v254, a233
    v_mul_f32 v254, v254, v255
    v_accvgpr_write_b32 a233, v254
    v_accvgpr_read_b32 v254, a234
    v_mul_f32 v254, v254, v255
    v_accvgpr_write_b32 a234, v254
    v_accvgpr_read_b32 v254, a235
    v_mul_f32 v254, v254, v255
    v_accvgpr_write_b32 a235, v254
    v_accvgpr_read_b32 v254, a236
    v_mul_f32 v254, v254, v255
    v_accvgpr_write_b32 a236, v254
    v_accvgpr_read_b32 v254, a237
    v_mul_f32 v254, v254, v255
    v_accvgpr_write_b32 a237, v254
    v_accvgpr_read_b32 v254, a238
    v_mul_f32 v254, v254, v255
    v_accvgpr_write_b32 a238, v254
    v_accvgpr_read_b32 v254, a239
    v_mul_f32 v254, v254, v255
    v_accvgpr_write_b32 a239, v254
    s_nop 1
    s_branch L_ret40
L_slow42:
    s_nop 1
    v_mov_b32 v255, v254
    s_nop 1
    v_permlane32_swap_b32 v254, v255
    v_max_f32 v254, v254, v255
    v_mul_f32 v254, s29, v254
    v_max_f32 v254, v254, v248
    v_sub_f32 v255, v248, v254
    v_exp_f32 v255, v255
    v_mov_b32 v248, v254
    v_mul_f32 v251, v251, v255
    v_mul_f32 v0, v0, v255
    v_mul_f32 v1, v1, v255
    v_mul_f32 v2, v2, v255
    v_mul_f32 v3, v3, v255
    v_mul_f32 v4, v4, v255
    v_mul_f32 v5, v5, v255
    v_mul_f32 v6, v6, v255
    v_mul_f32 v7, v7, v255
    v_mul_f32 v8, v8, v255
    v_mul_f32 v9, v9, v255
    v_mul_f32 v10, v10, v255
    v_mul_f32 v11, v11, v255
    v_mul_f32 v12, v12, v255
    v_mul_f32 v13, v13, v255
    v_mul_f32 v14, v14, v255
    v_mul_f32 v15, v15, v255
    v_mul_f32 v16, v16, v255
    v_mul_f32 v17, v17, v255
    v_mul_f32 v18, v18, v255
    v_mul_f32 v19, v19, v255
    v_mul_f32 v20, v20, v255
    v_mul_f32 v21, v21, v255
    v_mul_f32 v22, v22, v255
    v_mul_f32 v23, v23, v255
    v_mul_f32 v24, v24, v255
    v_mul_f32 v25, v25, v255
    v_mul_f32 v26, v26, v255
    v_mul_f32 v27, v27, v255
    v_mul_f32 v28, v28, v255
    v_mul_f32 v29, v29, v255
    v_mul_f32 v30, v30, v255
    v_mul_f32 v31, v31, v255
    v_mul_f32 v32, v32, v255
    v_mul_f32 v33, v33, v255
    v_mul_f32 v34, v34, v255
    v_mul_f32 v35, v35, v255
    v_mul_f32 v36, v36, v255
    v_mul_f32 v37, v37, v255
    v_mul_f32 v38, v38, v255
    v_mul_f32 v39, v39, v255
    v_mul_f32 v40, v40, v255
    v_mul_f32 v41, v41, v255
    v_mul_f32 v42, v42, v255
    v_mul_f32 v43, v43, v255
    v_mul_f32 v44, v44, v255
    v_mul_f32 v45, v45, v255
    v_mul_f32 v46, v46, v255
    v_mul_f32 v47, v47, v255
    v_accvgpr_read_b32 v254, a144
    v_mul_f32 v254, v254, v255
    v_accvgpr_write_b32 a144, v254
    v_accvgpr_read_b32 v254, a145
    v_mul_f32 v254, v254, v255
    v_accvgpr_write_b32 a145, v254
    v_accvgpr_read_b32 v254, a146
    v_mul_f32 v254, v254, v255
    v_accvgpr_write_b32 a146, v254
    v_accvgpr_read_b32 v254, a147
    v_mul_f32 v254, v254, v255
    v_accvgpr_write_b32 a147, v254
    v_accvgpr_read_b32 v254, a148
    v_mul_f32 v254, v254, v255
    v_accvgpr_write_b32 a148, v254
    v_accvgpr_read_b32 v254, a149
    v_mul_f32 v254, v254, v255
    v_accvgpr_write_b32 a149, v254
    v_accvgpr_read_b32 v254, a150
    v_mul_f32 v254, v254, v255
    v_accvgpr_write_b32 a150, v254
    v_accvgpr_read_b32 v254, a151
    v_mul_f32 v254, v254, v255
    v_accvgpr_write_b32 a151, v254
    v_accvgpr_read_b32 v254, a152
    v_mul_f32 v254, v254, v255
    v_accvgpr_write_b32 a152, v254
    v_accvgpr_read_b32 v254, a153
    v_mul_f32 v254, v254, v255
    v_accvgpr_write_b32 a153, v254
    v_accvgpr_read_b32 v254, a154
    v_mul_f32 v254, v254, v255
    v_accvgpr_write_b32 a154, v254
    v_accvgpr_read_b32 v254, a155
    v_mul_f32 v254, v254, v255
    v_accvgpr_write_b32 a155, v254
    v_accvgpr_read_b32 v254, a156
    v_mul_f32 v254, v254, v255
    v_accvgpr_write_b32 a156, v254
    v_accvgpr_read_b32 v254, a157
    v_mul_f32 v254, v254, v255
    v_accvgpr_write_b32 a157, v254
    v_accvgpr_read_b32 v254, a158
    v_mul_f32 v254, v254, v255
    v_accvgpr_write_b32 a158, v254
    v_accvgpr_read_b32 v254, a159
    v_mul_f32 v254, v254, v255
    v_accvgpr_write_b32 a159, v254
    v_mul_f32 v48, v48, v255
    v_mul_f32 v49, v49, v255
    v_mul_f32 v50, v50, v255
    v_mul_f32 v51, v51, v255
    v_mul_f32 v52, v52, v255
    v_mul_f32 v53, v53, v255
    v_mul_f32 v54, v54, v255
    v_mul_f32 v55, v55, v255
    v_mul_f32 v56, v56, v255
    v_mul_f32 v57, v57, v255
    v_mul_f32 v58, v58, v255
    v_mul_f32 v59, v59, v255
    v_mul_f32 v60, v60, v255
    v_mul_f32 v61, v61, v255
    v_mul_f32 v62, v62, v255
    v_mul_f32 v63, v63, v255
    v_accvgpr_read_b32 v254, a160
    v_mul_f32 v254, v254, v255
    v_accvgpr_write_b32 a160, v254
    v_accvgpr_read_b32 v254, a161
    v_mul_f32 v254, v254, v255
    v_accvgpr_write_b32 a161, v254
    v_accvgpr_read_b32 v254, a162
    v_mul_f32 v254, v254, v255
    v_accvgpr_write_b32 a162, v254
    v_accvgpr_read_b32 v254, a163
    v_mul_f32 v254, v254, v255
    v_accvgpr_write_b32 a163, v254
    v_accvgpr_read_b32 v254, a164
    v_mul_f32 v254, v254, v255
    v_accvgpr_write_b32 a164, v254
    v_accvgpr_read_b32 v254, a165
    v_mul_f32 v254, v254, v255
    v_accvgpr_write_b32 a165, v254
    v_accvgpr_read_b32 v254, a166
    v_mul_f32 v254, v254, v255
    v_accvgpr_write_b32 a166, v254
    v_accvgpr_read_b32 v254, a167
    v_mul_f32 v254, v254, v255
    v_accvgpr_write_b32 a167, v254
    v_accvgpr_read_b32 v254, a168
    v_mul_f32 v254, v254, v255
    v_accvgpr_write_b32 a168, v254
    v_accvgpr_read_b32 v254, a169
    v_mul_f32 v254, v254, v255
    v_accvgpr_write_b32 a169, v254
    v_accvgpr_read_b32 v254, a170
    v_mul_f32 v254, v254, v255
    v_accvgpr_write_b32 a170, v254
    v_accvgpr_read_b32 v254, a171
    v_mul_f32 v254, v254, v255
    v_accvgpr_write_b32 a171, v254
    v_accvgpr_read_b32 v254, a172
    v_mul_f32 v254, v254, v255
    v_accvgpr_write_b32 a172, v254
    v_accvgpr_read_b32 v254, a173
    v_mul_f32 v254, v254, v255
    v_accvgpr_write_b32 a173, v254
    v_accvgpr_read_b32 v254, a174
    v_mul_f32 v254, v254, v255
    v_accvgpr_write_b32 a174, v254
    v_accvgpr_read_b32 v254, a175
    v_mul_f32 v254, v254, v255
    v_accvgpr_write_b32 a175, v254
    s_nop 1
    s_branch L_ret42
L_slow44:
    s_nop 1
    v_mov_b32 v255, v254
    s_nop 1
    v_permlane32_swap_b32 v254, v255
    v_max_f32 v254, v254, v255
    v_mul_f32 v254, s29, v254
    v_max_f32 v254, v254, v249
    v_sub_f32 v255, v249, v254
    v_exp_f32 v255, v255
    v_mov_b32 v249, v254
    v_mul_f32 v252, v252, v255
    v_mul_f32 v64, v64, v255
    v_mul_f32 v65, v65, v255
    v_mul_f32 v66, v66, v255
    v_mul_f32 v67, v67, v255
    v_mul_f32 v68, v68, v255
    v_mul_f32 v69, v69, v255
    v_mul_f32 v70, v70, v255
    v_mul_f32 v71, v71, v255
    v_mul_f32 v72, v72, v255
    v_mul_f32 v73, v73, v255
    v_mul_f32 v74, v74, v255
    v_mul_f32 v75, v75, v255
    v_mul_f32 v76, v76, v255
    v_mul_f32 v77, v77, v255
    v_mul_f32 v78, v78, v255
    v_mul_f32 v79, v79, v255
    v_mul_f32 v80, v80, v255
    v_mul_f32 v81, v81, v255
    v_mul_f32 v82, v82, v255
    v_mul_f32 v83, v83, v255
    v_mul_f32 v84, v84, v255
    v_mul_f32 v85, v85, v255
    v_mul_f32 v86, v86, v255
    v_mul_f32 v87, v87, v255
    v_mul_f32 v88, v88, v255
    v_mul_f32 v89, v89, v255
    v_mul_f32 v90, v90, v255
    v_mul_f32 v91, v91, v255
    v_mul_f32 v92, v92, v255
    v_mul_f32 v93, v93, v255
    v_mul_f32 v94, v94, v255
    v_mul_f32 v95, v95, v255
    v_mul_f32 v96, v96, v255
    v_mul_f32 v97, v97, v255
    v_mul_f32 v98, v98, v255
    v_mul_f32 v99, v99, v255
    v_mul_f32 v100, v100, v255
    v_mul_f32 v101, v101, v255
    v_mul_f32 v102, v102, v255
    v_mul_f32 v103, v103, v255
    v_mul_f32 v104, v104, v255
    v_mul_f32 v105, v105, v255
    v_mul_f32 v106, v106, v255
    v_mul_f32 v107, v107, v255
    v_mul_f32 v108, v108, v255
    v_mul_f32 v109, v109, v255
    v_mul_f32 v110, v110, v255
    v_mul_f32 v111, v111, v255
    v_accvgpr_read_b32 v254, a176
    v_mul_f32 v254, v254, v255
    v_accvgpr_write_b32 a176, v254
    v_accvgpr_read_b32 v254, a177
    v_mul_f32 v254, v254, v255
    v_accvgpr_write_b32 a177, v254
    v_accvgpr_read_b32 v254, a178
    v_mul_f32 v254, v254, v255
    v_accvgpr_write_b32 a178, v254
    v_accvgpr_read_b32 v254, a179
    v_mul_f32 v254, v254, v255
    v_accvgpr_write_b32 a179, v254
    v_accvgpr_read_b32 v254, a180
    v_mul_f32 v254, v254, v255
    v_accvgpr_write_b32 a180, v254
    v_accvgpr_read_b32 v254, a181
    v_mul_f32 v254, v254, v255
    v_accvgpr_write_b32 a181, v254
    v_accvgpr_read_b32 v254, a182
    v_mul_f32 v254, v254, v255
    v_accvgpr_write_b32 a182, v254
    v_accvgpr_read_b32 v254, a183
    v_mul_f32 v254, v254, v255
    v_accvgpr_write_b32 a183, v254
    v_accvgpr_read_b32 v254, a184
    v_mul_f32 v254, v254, v255
    v_accvgpr_write_b32 a184, v254
    v_accvgpr_read_b32 v254, a185
    v_mul_f32 v254, v254, v255
    v_accvgpr_write_b32 a185, v254
    v_accvgpr_read_b32 v254, a186
    v_mul_f32 v254, v254, v255
    v_accvgpr_write_b32 a186, v254
    v_accvgpr_read_b32 v254, a187
    v_mul_f32 v254, v254, v255
    v_accvgpr_write_b32 a187, v254
    v_accvgpr_read_b32 v254, a188
    v_mul_f32 v254, v254, v255
    v_accvgpr_write_b32 a188, v254
    v_accvgpr_read_b32 v254, a189
    v_mul_f32 v254, v254, v255
    v_accvgpr_write_b32 a189, v254
    v_accvgpr_read_b32 v254, a190
    v_mul_f32 v254, v254, v255
    v_accvgpr_write_b32 a190, v254
    v_accvgpr_read_b32 v254, a191
    v_mul_f32 v254, v254, v255
    v_accvgpr_write_b32 a191, v254
    v_mul_f32 v112, v112, v255
    v_mul_f32 v113, v113, v255
    v_mul_f32 v114, v114, v255
    v_mul_f32 v115, v115, v255
    v_mul_f32 v116, v116, v255
    v_mul_f32 v117, v117, v255
    v_mul_f32 v118, v118, v255
    v_mul_f32 v119, v119, v255
    v_mul_f32 v120, v120, v255
    v_mul_f32 v121, v121, v255
    v_mul_f32 v122, v122, v255
    v_mul_f32 v123, v123, v255
    v_mul_f32 v124, v124, v255
    v_mul_f32 v125, v125, v255
    v_mul_f32 v126, v126, v255
    v_mul_f32 v127, v127, v255
    v_accvgpr_read_b32 v254, a192
    v_mul_f32 v254, v254, v255
    v_accvgpr_write_b32 a192, v254
    v_accvgpr_read_b32 v254, a193
    v_mul_f32 v254, v254, v255
    v_accvgpr_write_b32 a193, v254
    v_accvgpr_read_b32 v254, a194
    v_mul_f32 v254, v254, v255
    v_accvgpr_write_b32 a194, v254
    v_accvgpr_read_b32 v254, a195
    v_mul_f32 v254, v254, v255
    v_accvgpr_write_b32 a195, v254
    v_accvgpr_read_b32 v254, a196
    v_mul_f32 v254, v254, v255
    v_accvgpr_write_b32 a196, v254
    v_accvgpr_read_b32 v254, a197
    v_mul_f32 v254, v254, v255
    v_accvgpr_write_b32 a197, v254
    v_accvgpr_read_b32 v254, a198
    v_mul_f32 v254, v254, v255
    v_accvgpr_write_b32 a198, v254
    v_accvgpr_read_b32 v254, a199
    v_mul_f32 v254, v254, v255
    v_accvgpr_write_b32 a199, v254
    v_accvgpr_read_b32 v254, a200
    v_mul_f32 v254, v254, v255
    v_accvgpr_write_b32 a200, v254
    v_accvgpr_read_b32 v254, a201
    v_mul_f32 v254, v254, v255
    v_accvgpr_write_b32 a201, v254
    v_accvgpr_read_b32 v254, a202
    v_mul_f32 v254, v254, v255
    v_accvgpr_write_b32 a202, v254
    v_accvgpr_read_b32 v254, a203
    v_mul_f32 v254, v254, v255
    v_accvgpr_write_b32 a203, v254
    v_accvgpr_read_b32 v254, a204
    v_mul_f32 v254, v254, v255
    v_accvgpr_write_b32 a204, v254
    v_accvgpr_read_b32 v254, a205
    v_mul_f32 v254, v254, v255
    v_accvgpr_write_b32 a205, v254
    v_accvgpr_read_b32 v254, a206
    v_mul_f32 v254, v254, v255
    v_accvgpr_write_b32 a206, v254
    v_accvgpr_read_b32 v254, a207
    v_mul_f32 v254, v254, v255
    v_accvgpr_write_b32 a207, v254
    s_nop 1
    s_branch L_ret44
L_slow46:
    s_nop 1
    v_mov_b32 v255, v254
    s_nop 1
    v_permlane32_swap_b32 v254, v255
    v_max_f32 v254, v254, v255
    v_mul_f32 v254, s29, v254
    v_max_f32 v254, v254, v250
    v_sub_f32 v255, v250, v254
    v_exp_f32 v255, v255
    v_mov_b32 v250, v254
    v_mul_f32 v253, v253, v255
    v_mul_f32 v128, v128, v255
    v_mul_f32 v129, v129, v255
    v_mul_f32 v130, v130, v255
    v_mul_f32 v131, v131, v255
    v_mul_f32 v132, v132, v255
    v_mul_f32 v133, v133, v255
    v_mul_f32 v134, v134, v255
    v_mul_f32 v135, v135, v255
    v_mul_f32 v136, v136, v255
    v_mul_f32 v137, v137, v255
    v_mul_f32 v138, v138, v255
    v_mul_f32 v139, v139, v255
    v_mul_f32 v140, v140, v255
    v_mul_f32 v141, v141, v255
    v_mul_f32 v142, v142, v255
    v_mul_f32 v143, v143, v255
    v_mul_f32 v144, v144, v255
    v_mul_f32 v145, v145, v255
    v_mul_f32 v146, v146, v255
    v_mul_f32 v147, v147, v255
    v_mul_f32 v148, v148, v255
    v_mul_f32 v149, v149, v255
    v_mul_f32 v150, v150, v255
    v_mul_f32 v151, v151, v255
    v_mul_f32 v152, v152, v255
    v_mul_f32 v153, v153, v255
    v_mul_f32 v154, v154, v255
    v_mul_f32 v155, v155, v255
    v_mul_f32 v156, v156, v255
    v_mul_f32 v157, v157, v255
    v_mul_f32 v158, v158, v255
    v_mul_f32 v159, v159, v255
    v_mul_f32 v160, v160, v255
    v_mul_f32 v161, v161, v255
    v_mul_f32 v162, v162, v255
    v_mul_f32 v163, v163, v255
    v_mul_f32 v164, v164, v255
    v_mul_f32 v165, v165, v255
    v_mul_f32 v166, v166, v255
    v_mul_f32 v167, v167, v255
    v_mul_f32 v168, v168, v255
    v_mul_f32 v169, v169, v255
    v_mul_f32 v170, v170, v255
    v_mul_f32 v171, v171, v255
    v_mul_f32 v172, v172, v255
    v_mul_f32 v173, v173, v255
    v_mul_f32 v174, v174, v255
    v_mul_f32 v175, v175, v255
    v_accvgpr_read_b32 v254, a208
    v_mul_f32 v254, v254, v255
    v_accvgpr_write_b32 a208, v254
    v_accvgpr_read_b32 v254, a209
    v_mul_f32 v254, v254, v255
    v_accvgpr_write_b32 a209, v254
    v_accvgpr_read_b32 v254, a210
    v_mul_f32 v254, v254, v255
    v_accvgpr_write_b32 a210, v254
    v_accvgpr_read_b32 v254, a211
    v_mul_f32 v254, v254, v255
    v_accvgpr_write_b32 a211, v254
    v_accvgpr_read_b32 v254, a212
    v_mul_f32 v254, v254, v255
    v_accvgpr_write_b32 a212, v254
    v_accvgpr_read_b32 v254, a213
    v_mul_f32 v254, v254, v255
    v_accvgpr_write_b32 a213, v254
    v_accvgpr_read_b32 v254, a214
    v_mul_f32 v254, v254, v255
    v_accvgpr_write_b32 a214, v254
    v_accvgpr_read_b32 v254, a215
    v_mul_f32 v254, v254, v255
    v_accvgpr_write_b32 a215, v254
    v_accvgpr_read_b32 v254, a216
    v_mul_f32 v254, v254, v255
    v_accvgpr_write_b32 a216, v254
    v_accvgpr_read_b32 v254, a217
    v_mul_f32 v254, v254, v255
    v_accvgpr_write_b32 a217, v254
    v_accvgpr_read_b32 v254, a218
    v_mul_f32 v254, v254, v255
    v_accvgpr_write_b32 a218, v254
    v_accvgpr_read_b32 v254, a219
    v_mul_f32 v254, v254, v255
    v_accvgpr_write_b32 a219, v254
    v_accvgpr_read_b32 v254, a220
    v_mul_f32 v254, v254, v255
    v_accvgpr_write_b32 a220, v254
    v_accvgpr_read_b32 v254, a221
    v_mul_f32 v254, v254, v255
    v_accvgpr_write_b32 a221, v254
    v_accvgpr_read_b32 v254, a222
    v_mul_f32 v254, v254, v255
    v_accvgpr_write_b32 a222, v254
    v_accvgpr_read_b32 v254, a223
    v_mul_f32 v254, v254, v255
    v_accvgpr_write_b32 a223, v254
    v_accvgpr_read_b32 v254, a240
    v_mul_f32 v254, v254, v255
    v_accvgpr_write_b32 a240, v254
    v_accvgpr_read_b32 v254, a241
    v_mul_f32 v254, v254, v255
    v_accvgpr_write_b32 a241, v254
    v_accvgpr_read_b32 v254, a242
    v_mul_f32 v254, v254, v255
    v_accvgpr_write_b32 a242, v254
    v_accvgpr_read_b32 v254, a243
    v_mul_f32 v254, v254, v255
    v_accvgpr_write_b32 a243, v254
    v_accvgpr_read_b32 v254, a244
    v_mul_f32 v254, v254, v255
    v_accvgpr_write_b32 a244, v254
    v_accvgpr_read_b32 v254, a245
    v_mul_f32 v254, v254, v255
    v_accvgpr_write_b32 a245, v254
    v_accvgpr_read_b32 v254, a246
    v_mul_f32 v254, v254, v255
    v_accvgpr_write_b32 a246, v254
    v_accvgpr_read_b32 v254, a247
    v_mul_f32 v254, v254, v255
    v_accvgpr_write_b32 a247, v254
    v_accvgpr_read_b32 v254, a248
    v_mul_f32 v254, v254, v255
    v_accvgpr_write_b32 a248, v254
    v_accvgpr_read_b32 v254, a249
    v_mul_f32 v254, v254, v255
    v_accvgpr_write_b32 a249, v254
    v_accvgpr_read_b32 v254, a250
    v_mul_f32 v254, v254, v255
    v_accvgpr_write_b32 a250, v254
    v_accvgpr_read_b32 v254, a251
    v_mul_f32 v254, v254, v255
    v_accvgpr_write_b32 a251, v254
    v_accvgpr_read_b32 v254, a252
    v_mul_f32 v254, v254, v255
    v_accvgpr_write_b32 a252, v254
    v_accvgpr_read_b32 v254, a253
    v_mul_f32 v254, v254, v255
    v_accvgpr_write_b32 a253, v254
    v_accvgpr_read_b32 v254, a254
    v_mul_f32 v254, v254, v255
    v_accvgpr_write_b32 a254, v254
    v_accvgpr_read_b32 v254, a255
    v_mul_f32 v254, v254, v255
    v_accvgpr_write_b32 a255, v254
    v_accvgpr_read_b32 v254, a224
    v_mul_f32 v254, v254, v255
    v_accvgpr_write_b32 a224, v254
    v_accvgpr_read_b32 v254, a225
    v_mul_f32 v254, v254, v255
    v_accvgpr_write_b32 a225, v254
    v_accvgpr_read_b32 v254, a226
    v_mul_f32 v254, v254, v255
    v_accvgpr_write_b32 a226, v254
    v_accvgpr_read_b32 v254, a227
    v_mul_f32 v254, v254, v255
    v_accvgpr_write_b32 a227, v254
    v_accvgpr_read_b32 v254, a228
    v_mul_f32 v254, v254, v255
    v_accvgpr_write_b32 a228, v254
    v_accvgpr_read_b32 v254, a229
    v_mul_f32 v254, v254, v255
    v_accvgpr_write_b32 a229, v254
    v_accvgpr_read_b32 v254, a230
    v_mul_f32 v254, v254, v255
    v_accvgpr_write_b32 a230, v254
    v_accvgpr_read_b32 v254, a231
    v_mul_f32 v254, v254, v255
    v_accvgpr_write_b32 a231, v254
    v_accvgpr_read_b32 v254, a232
    v_mul_f32 v254, v254, v255
    v_accvgpr_write_b32 a232, v254
    v_accvgpr_read_b32 v254, a233
    v_mul_f32 v254, v254, v255
    v_accvgpr_write_b32 a233, v254
    v_accvgpr_read_b32 v254, a234
    v_mul_f32 v254, v254, v255
    v_accvgpr_write_b32 a234, v254
    v_accvgpr_read_b32 v254, a235
    v_mul_f32 v254, v254, v255
    v_accvgpr_write_b32 a235, v254
    v_accvgpr_read_b32 v254, a236
    v_mul_f32 v254, v254, v255
    v_accvgpr_write_b32 a236, v254
    v_accvgpr_read_b32 v254, a237
    v_mul_f32 v254, v254, v255
    v_accvgpr_write_b32 a237, v254
    v_accvgpr_read_b32 v254, a238
    v_mul_f32 v254, v254, v255
    v_accvgpr_write_b32 a238, v254
    v_accvgpr_read_b32 v254, a239
    v_mul_f32 v254, v254, v255
    v_accvgpr_write_b32 a239, v254
    s_nop 1
    s_branch L_ret46
L_slow48:
    s_nop 1
    v_mov_b32 v255, v254
    s_nop 1
    v_permlane32_swap_b32 v254, v255
    v_max_f32 v254, v254, v255
    v_mul_f32 v254, s29, v254
    v_max_f32 v254, v254, v248
    v_sub_f32 v255, v248, v254
    v_exp_f32 v255, v255
    v_mov_b32 v248, v254
    v_mul_f32 v251, v251, v255
    v_mul_f32 v0, v0, v255
    v_mul_f32 v1, v1, v255
    v_mul_f32 v2, v2, v255
    v_mul_f32 v3, v3, v255
    v_mul_f32 v4, v4, v255
    v_mul_f32 v5, v5, v255
    v_mul_f32 v6, v6, v255
    v_mul_f32 v7, v7, v255
    v_mul_f32 v8, v8, v255
    v_mul_f32 v9, v9, v255
    v_mul_f32 v10, v10, v255
    v_mul_f32 v11, v11, v255
    v_mul_f32 v12, v12, v255
    v_mul_f32 v13, v13, v255
    v_mul_f32 v14, v14, v255
    v_mul_f32 v15, v15, v255
    v_mul_f32 v16, v16, v255
    v_mul_f32 v17, v17, v255
    v_mul_f32 v18, v18, v255
    v_mul_f32 v19, v19, v255
    v_mul_f32 v20, v20, v255
    v_mul_f32 v21, v21, v255
    v_mul_f32 v22, v22, v255
    v_mul_f32 v23, v23, v255
    v_mul_f32 v24, v24, v255
    v_mul_f32 v25, v25, v255
    v_mul_f32 v26, v26, v255
    v_mul_f32 v27, v27, v255
    v_mul_f32 v28, v28, v255
    v_mul_f32 v29, v29, v255
    v_mul_f32 v30, v30, v255
    v_mul_f32 v31, v31, v255
    v_mul_f32 v32, v32, v255
    v_mul_f32 v33, v33, v255
    v_mul_f32 v34, v34, v255
    v_mul_f32 v35, v35, v255
    v_mul_f32 v36, v36, v255
    v_mul_f32 v37, v37, v255
    v_mul_f32 v38, v38, v255
    v_mul_f32 v39, v39, v255
    v_mul_f32 v40, v40, v255
    v_mul_f32 v41, v41, v255
    v_mul_f32 v42, v42, v255
    v_mul_f32 v43, v43, v255
    v_mul_f32 v44, v44, v255
    v_mul_f32 v45, v45, v255
    v_mul_f32 v46, v46, v255
    v_mul_f32 v47, v47, v255
    v_accvgpr_read_b32 v254, a144
    v_mul_f32 v254, v254, v255
    v_accvgpr_write_b32 a144, v254
    v_accvgpr_read_b32 v254, a145
    v_mul_f32 v254, v254, v255
    v_accvgpr_write_b32 a145, v254
    v_accvgpr_read_b32 v254, a146
    v_mul_f32 v254, v254, v255
    v_accvgpr_write_b32 a146, v254
    v_accvgpr_read_b32 v254, a147
    v_mul_f32 v254, v254, v255
    v_accvgpr_write_b32 a147, v254
    v_accvgpr_read_b32 v254, a148
    v_mul_f32 v254, v254, v255
    v_accvgpr_write_b32 a148, v254
    v_accvgpr_read_b32 v254, a149
    v_mul_f32 v254, v254, v255
    v_accvgpr_write_b32 a149, v254
    v_accvgpr_read_b32 v254, a150
    v_mul_f32 v254, v254, v255
    v_accvgpr_write_b32 a150, v254
    v_accvgpr_read_b32 v254, a151
    v_mul_f32 v254, v254, v255
    v_accvgpr_write_b32 a151, v254
    v_accvgpr_read_b32 v254, a152
    v_mul_f32 v254, v254, v255
    v_accvgpr_write_b32 a152, v254
    v_accvgpr_read_b32 v254, a153
    v_mul_f32 v254, v254, v255
    v_accvgpr_write_b32 a153, v254
    v_accvgpr_read_b32 v254, a154
    v_mul_f32 v254, v254, v255
    v_accvgpr_write_b32 a154, v254
    v_accvgpr_read_b32 v254, a155
    v_mul_f32 v254, v254, v255
    v_accvgpr_write_b32 a155, v254
    v_accvgpr_read_b32 v254, a156
    v_mul_f32 v254, v254, v255
    v_accvgpr_write_b32 a156, v254
    v_accvgpr_read_b32 v254, a157
    v_mul_f32 v254, v254, v255
    v_accvgpr_write_b32 a157, v254
    v_accvgpr_read_b32 v254, a158
    v_mul_f32 v254, v254, v255
    v_accvgpr_write_b32 a158, v254
    v_accvgpr_read_b32 v254, a159
    v_mul_f32 v254, v254, v255
    v_accvgpr_write_b32 a159, v254
    v_mul_f32 v48, v48, v255
    v_mul_f32 v49, v49, v255
    v_mul_f32 v50, v50, v255
    v_mul_f32 v51, v51, v255
    v_mul_f32 v52, v52, v255
    v_mul_f32 v53, v53, v255
    v_mul_f32 v54, v54, v255
    v_mul_f32 v55, v55, v255
    v_mul_f32 v56, v56, v255
    v_mul_f32 v57, v57, v255
    v_mul_f32 v58, v58, v255
    v_mul_f32 v59, v59, v255
    v_mul_f32 v60, v60, v255
    v_mul_f32 v61, v61, v255
    v_mul_f32 v62, v62, v255
    v_mul_f32 v63, v63, v255
    v_accvgpr_read_b32 v254, a160
    v_mul_f32 v254, v254, v255
    v_accvgpr_write_b32 a160, v254
    v_accvgpr_read_b32 v254, a161
    v_mul_f32 v254, v254, v255
    v_accvgpr_write_b32 a161, v254
    v_accvgpr_read_b32 v254, a162
    v_mul_f32 v254, v254, v255
    v_accvgpr_write_b32 a162, v254
    v_accvgpr_read_b32 v254, a163
    v_mul_f32 v254, v254, v255
    v_accvgpr_write_b32 a163, v254
    v_accvgpr_read_b32 v254, a164
    v_mul_f32 v254, v254, v255
    v_accvgpr_write_b32 a164, v254
    v_accvgpr_read_b32 v254, a165
    v_mul_f32 v254, v254, v255
    v_accvgpr_write_b32 a165, v254
    v_accvgpr_read_b32 v254, a166
    v_mul_f32 v254, v254, v255
    v_accvgpr_write_b32 a166, v254
    v_accvgpr_read_b32 v254, a167
    v_mul_f32 v254, v254, v255
    v_accvgpr_write_b32 a167, v254
    v_accvgpr_read_b32 v254, a168
    v_mul_f32 v254, v254, v255
    v_accvgpr_write_b32 a168, v254
    v_accvgpr_read_b32 v254, a169
    v_mul_f32 v254, v254, v255
    v_accvgpr_write_b32 a169, v254
    v_accvgpr_read_b32 v254, a170
    v_mul_f32 v254, v254, v255
    v_accvgpr_write_b32 a170, v254
    v_accvgpr_read_b32 v254, a171
    v_mul_f32 v254, v254, v255
    v_accvgpr_write_b32 a171, v254
    v_accvgpr_read_b32 v254, a172
    v_mul_f32 v254, v254, v255
    v_accvgpr_write_b32 a172, v254
    v_accvgpr_read_b32 v254, a173
    v_mul_f32 v254, v254, v255
    v_accvgpr_write_b32 a173, v254
    v_accvgpr_read_b32 v254, a174
    v_mul_f32 v254, v254, v255
    v_accvgpr_write_b32 a174, v254
    v_accvgpr_read_b32 v254, a175
    v_mul_f32 v254, v254, v255
    v_accvgpr_write_b32 a175, v254
    s_nop 1
    s_branch L_ret48
L_slow50:
    s_nop 1
    v_mov_b32 v255, v254
    s_nop 1
    v_permlane32_swap_b32 v254, v255
    v_max_f32 v254, v254, v255
    v_mul_f32 v254, s29, v254
    v_max_f32 v254, v254, v249
    v_sub_f32 v255, v249, v254
    v_exp_f32 v255, v255
    v_mov_b32 v249, v254
    v_mul_f32 v252, v252, v255
    v_mul_f32 v64, v64, v255
    v_mul_f32 v65, v65, v255
    v_mul_f32 v66, v66, v255
    v_mul_f32 v67, v67, v255
    v_mul_f32 v68, v68, v255
    v_mul_f32 v69, v69, v255
    v_mul_f32 v70, v70, v255
    v_mul_f32 v71, v71, v255
    v_mul_f32 v72, v72, v255
    v_mul_f32 v73, v73, v255
    v_mul_f32 v74, v74, v255
    v_mul_f32 v75, v75, v255
    v_mul_f32 v76, v76, v255
    v_mul_f32 v77, v77, v255
    v_mul_f32 v78, v78, v255
    v_mul_f32 v79, v79, v255
    v_mul_f32 v80, v80, v255
    v_mul_f32 v81, v81, v255
    v_mul_f32 v82, v82, v255
    v_mul_f32 v83, v83, v255
    v_mul_f32 v84, v84, v255
    v_mul_f32 v85, v85, v255
    v_mul_f32 v86, v86, v255
    v_mul_f32 v87, v87, v255
    v_mul_f32 v88, v88, v255
    v_mul_f32 v89, v89, v255
    v_mul_f32 v90, v90, v255
    v_mul_f32 v91, v91, v255
    v_mul_f32 v92, v92, v255
    v_mul_f32 v93, v93, v255
    v_mul_f32 v94, v94, v255
    v_mul_f32 v95, v95, v255
    v_mul_f32 v96, v96, v255
    v_mul_f32 v97, v97, v255
    v_mul_f32 v98, v98, v255
    v_mul_f32 v99, v99, v255
    v_mul_f32 v100, v100, v255
    v_mul_f32 v101, v101, v255
    v_mul_f32 v102, v102, v255
    v_mul_f32 v103, v103, v255
    v_mul_f32 v104, v104, v255
    v_mul_f32 v105, v105, v255
    v_mul_f32 v106, v106, v255
    v_mul_f32 v107, v107, v255
    v_mul_f32 v108, v108, v255
    v_mul_f32 v109, v109, v255
    v_mul_f32 v110, v110, v255
    v_mul_f32 v111, v111, v255
    v_accvgpr_read_b32 v254, a176
    v_mul_f32 v254, v254, v255
    v_accvgpr_write_b32 a176, v254
    v_accvgpr_read_b32 v254, a177
    v_mul_f32 v254, v254, v255
    v_accvgpr_write_b32 a177, v254
    v_accvgpr_read_b32 v254, a178
    v_mul_f32 v254, v254, v255
    v_accvgpr_write_b32 a178, v254
    v_accvgpr_read_b32 v254, a179
    v_mul_f32 v254, v254, v255
    v_accvgpr_write_b32 a179, v254
    v_accvgpr_read_b32 v254, a180
    v_mul_f32 v254, v254, v255
    v_accvgpr_write_b32 a180, v254
    v_accvgpr_read_b32 v254, a181
    v_mul_f32 v254, v254, v255
    v_accvgpr_write_b32 a181, v254
    v_accvgpr_read_b32 v254, a182
    v_mul_f32 v254, v254, v255
    v_accvgpr_write_b32 a182, v254
    v_accvgpr_read_b32 v254, a183
    v_mul_f32 v254, v254, v255
    v_accvgpr_write_b32 a183, v254
    v_accvgpr_read_b32 v254, a184
    v_mul_f32 v254, v254, v255
    v_accvgpr_write_b32 a184, v254
    v_accvgpr_read_b32 v254, a185
    v_mul_f32 v254, v254, v255
    v_accvgpr_write_b32 a185, v254
    v_accvgpr_read_b32 v254, a186
    v_mul_f32 v254, v254, v255
    v_accvgpr_write_b32 a186, v254
    v_accvgpr_read_b32 v254, a187
    v_mul_f32 v254, v254, v255
    v_accvgpr_write_b32 a187, v254
    v_accvgpr_read_b32 v254, a188
    v_mul_f32 v254, v254, v255
    v_accvgpr_write_b32 a188, v254
    v_accvgpr_read_b32 v254, a189
    v_mul_f32 v254, v254, v255
    v_accvgpr_write_b32 a189, v254
    v_accvgpr_read_b32 v254, a190
    v_mul_f32 v254, v254, v255
    v_accvgpr_write_b32 a190, v254
    v_accvgpr_read_b32 v254, a191
    v_mul_f32 v254, v254, v255
    v_accvgpr_write_b32 a191, v254
    v_mul_f32 v112, v112, v255
    v_mul_f32 v113, v113, v255
    v_mul_f32 v114, v114, v255
    v_mul_f32 v115, v115, v255
    v_mul_f32 v116, v116, v255
    v_mul_f32 v117, v117, v255
    v_mul_f32 v118, v118, v255
    v_mul_f32 v119, v119, v255
    v_mul_f32 v120, v120, v255
    v_mul_f32 v121, v121, v255
    v_mul_f32 v122, v122, v255
    v_mul_f32 v123, v123, v255
    v_mul_f32 v124, v124, v255
    v_mul_f32 v125, v125, v255
    v_mul_f32 v126, v126, v255
    v_mul_f32 v127, v127, v255
    v_accvgpr_read_b32 v254, a192
    v_mul_f32 v254, v254, v255
    v_accvgpr_write_b32 a192, v254
    v_accvgpr_read_b32 v254, a193
    v_mul_f32 v254, v254, v255
    v_accvgpr_write_b32 a193, v254
    v_accvgpr_read_b32 v254, a194
    v_mul_f32 v254, v254, v255
    v_accvgpr_write_b32 a194, v254
    v_accvgpr_read_b32 v254, a195
    v_mul_f32 v254, v254, v255
    v_accvgpr_write_b32 a195, v254
    v_accvgpr_read_b32 v254, a196
    v_mul_f32 v254, v254, v255
    v_accvgpr_write_b32 a196, v254
    v_accvgpr_read_b32 v254, a197
    v_mul_f32 v254, v254, v255
    v_accvgpr_write_b32 a197, v254
    v_accvgpr_read_b32 v254, a198
    v_mul_f32 v254, v254, v255
    v_accvgpr_write_b32 a198, v254
    v_accvgpr_read_b32 v254, a199
    v_mul_f32 v254, v254, v255
    v_accvgpr_write_b32 a199, v254
    v_accvgpr_read_b32 v254, a200
    v_mul_f32 v254, v254, v255
    v_accvgpr_write_b32 a200, v254
    v_accvgpr_read_b32 v254, a201
    v_mul_f32 v254, v254, v255
    v_accvgpr_write_b32 a201, v254
    v_accvgpr_read_b32 v254, a202
    v_mul_f32 v254, v254, v255
    v_accvgpr_write_b32 a202, v254
    v_accvgpr_read_b32 v254, a203
    v_mul_f32 v254, v254, v255
    v_accvgpr_write_b32 a203, v254
    v_accvgpr_read_b32 v254, a204
    v_mul_f32 v254, v254, v255
    v_accvgpr_write_b32 a204, v254
    v_accvgpr_read_b32 v254, a205
    v_mul_f32 v254, v254, v255
    v_accvgpr_write_b32 a205, v254
    v_accvgpr_read_b32 v254, a206
    v_mul_f32 v254, v254, v255
    v_accvgpr_write_b32 a206, v254
    v_accvgpr_read_b32 v254, a207
    v_mul_f32 v254, v254, v255
    v_accvgpr_write_b32 a207, v254
    s_nop 1
    s_branch L_ret50
L_slow52:
    s_nop 1
    v_mov_b32 v255, v254
    s_nop 1
    v_permlane32_swap_b32 v254, v255
    v_max_f32 v254, v254, v255
    v_mul_f32 v254, s29, v254
    v_max_f32 v254, v254, v250
    v_sub_f32 v255, v250, v254
    v_exp_f32 v255, v255
    v_mov_b32 v250, v254
    v_mul_f32 v253, v253, v255
    v_mul_f32 v128, v128, v255
    v_mul_f32 v129, v129, v255
    v_mul_f32 v130, v130, v255
    v_mul_f32 v131, v131, v255
    v_mul_f32 v132, v132, v255
    v_mul_f32 v133, v133, v255
    v_mul_f32 v134, v134, v255
    v_mul_f32 v135, v135, v255
    v_mul_f32 v136, v136, v255
    v_mul_f32 v137, v137, v255
    v_mul_f32 v138, v138, v255
    v_mul_f32 v139, v139, v255
    v_mul_f32 v140, v140, v255
    v_mul_f32 v141, v141, v255
    v_mul_f32 v142, v142, v255
    v_mul_f32 v143, v143, v255
    v_mul_f32 v144, v144, v255
    v_mul_f32 v145, v145, v255
    v_mul_f32 v146, v146, v255
    v_mul_f32 v147, v147, v255
    v_mul_f32 v148, v148, v255
    v_mul_f32 v149, v149, v255
    v_mul_f32 v150, v150, v255
    v_mul_f32 v151, v151, v255
    v_mul_f32 v152, v152, v255
    v_mul_f32 v153, v153, v255
    v_mul_f32 v154, v154, v255
    v_mul_f32 v155, v155, v255
    v_mul_f32 v156, v156, v255
    v_mul_f32 v157, v157, v255
    v_mul_f32 v158, v158, v255
    v_mul_f32 v159, v159, v255
    v_mul_f32 v160, v160, v255
    v_mul_f32 v161, v161, v255
    v_mul_f32 v162, v162, v255
    v_mul_f32 v163, v163, v255
    v_mul_f32 v164, v164, v255
    v_mul_f32 v165, v165, v255
    v_mul_f32 v166, v166, v255
    v_mul_f32 v167, v167, v255
    v_mul_f32 v168, v168, v255
    v_mul_f32 v169, v169, v255
    v_mul_f32 v170, v170, v255
    v_mul_f32 v171, v171, v255
    v_mul_f32 v172, v172, v255
    v_mul_f32 v173, v173, v255
    v_mul_f32 v174, v174, v255
    v_mul_f32 v175, v175, v255
    v_accvgpr_read_b32 v254, a208
    v_mul_f32 v254, v254, v255
    v_accvgpr_write_b32 a208, v254
    v_accvgpr_read_b32 v254, a209
    v_mul_f32 v254, v254, v255
    v_accvgpr_write_b32 a209, v254
    v_accvgpr_read_b32 v254, a210
    v_mul_f32 v254, v254, v255
    v_accvgpr_write_b32 a210, v254
    v_accvgpr_read_b32 v254, a211
    v_mul_f32 v254, v254, v255
    v_accvgpr_write_b32 a211, v254
    v_accvgpr_read_b32 v254, a212
    v_mul_f32 v254, v254, v255
    v_accvgpr_write_b32 a212, v254
    v_accvgpr_read_b32 v254, a213
    v_mul_f32 v254, v254, v255
    v_accvgpr_write_b32 a213, v254
    v_accvgpr_read_b32 v254, a214
    v_mul_f32 v254, v254, v255
    v_accvgpr_write_b32 a214, v254
    v_accvgpr_read_b32 v254, a215
    v_mul_f32 v254, v254, v255
    v_accvgpr_write_b32 a215, v254
    v_accvgpr_read_b32 v254, a216
    v_mul_f32 v254, v254, v255
    v_accvgpr_write_b32 a216, v254
    v_accvgpr_read_b32 v254, a217
    v_mul_f32 v254, v254, v255
    v_accvgpr_write_b32 a217, v254
    v_accvgpr_read_b32 v254, a218
    v_mul_f32 v254, v254, v255
    v_accvgpr_write_b32 a218, v254
    v_accvgpr_read_b32 v254, a219
    v_mul_f32 v254, v254, v255
    v_accvgpr_write_b32 a219, v254
    v_accvgpr_read_b32 v254, a220
    v_mul_f32 v254, v254, v255
    v_accvgpr_write_b32 a220, v254
    v_accvgpr_read_b32 v254, a221
    v_mul_f32 v254, v254, v255
    v_accvgpr_write_b32 a221, v254
    v_accvgpr_read_b32 v254, a222
    v_mul_f32 v254, v254, v255
    v_accvgpr_write_b32 a222, v254
    v_accvgpr_read_b32 v254, a223
    v_mul_f32 v254, v254, v255
    v_accvgpr_write_b32 a223, v254
    v_accvgpr_read_b32 v254, a240
    v_mul_f32 v254, v254, v255
    v_accvgpr_write_b32 a240, v254
    v_accvgpr_read_b32 v254, a241
    v_mul_f32 v254, v254, v255
    v_accvgpr_write_b32 a241, v254
    v_accvgpr_read_b32 v254, a242
    v_mul_f32 v254, v254, v255
    v_accvgpr_write_b32 a242, v254
    v_accvgpr_read_b32 v254, a243
    v_mul_f32 v254, v254, v255
    v_accvgpr_write_b32 a243, v254
    v_accvgpr_read_b32 v254, a244
    v_mul_f32 v254, v254, v255
    v_accvgpr_write_b32 a244, v254
    v_accvgpr_read_b32 v254, a245
    v_mul_f32 v254, v254, v255
    v_accvgpr_write_b32 a245, v254
    v_accvgpr_read_b32 v254, a246
    v_mul_f32 v254, v254, v255
    v_accvgpr_write_b32 a246, v254
    v_accvgpr_read_b32 v254, a247
    v_mul_f32 v254, v254, v255
    v_accvgpr_write_b32 a247, v254
    v_accvgpr_read_b32 v254, a248
    v_mul_f32 v254, v254, v255
    v_accvgpr_write_b32 a248, v254
    v_accvgpr_read_b32 v254, a249
    v_mul_f32 v254, v254, v255
    v_accvgpr_write_b32 a249, v254
    v_accvgpr_read_b32 v254, a250
    v_mul_f32 v254, v254, v255
    v_accvgpr_write_b32 a250, v254
    v_accvgpr_read_b32 v254, a251
    v_mul_f32 v254, v254, v255
    v_accvgpr_write_b32 a251, v254
    v_accvgpr_read_b32 v254, a252
    v_mul_f32 v254, v254, v255
    v_accvgpr_write_b32 a252, v254
    v_accvgpr_read_b32 v254, a253
    v_mul_f32 v254, v254, v255
    v_accvgpr_write_b32 a253, v254
    v_accvgpr_read_b32 v254, a254
    v_mul_f32 v254, v254, v255
    v_accvgpr_write_b32 a254, v254
    v_accvgpr_read_b32 v254, a255
    v_mul_f32 v254, v254, v255
    v_accvgpr_write_b32 a255, v254
    v_accvgpr_read_b32 v254, a224
    v_mul_f32 v254, v254, v255
    v_accvgpr_write_b32 a224, v254
    v_accvgpr_read_b32 v254, a225
    v_mul_f32 v254, v254, v255
    v_accvgpr_write_b32 a225, v254
    v_accvgpr_read_b32 v254, a226
    v_mul_f32 v254, v254, v255
    v_accvgpr_write_b32 a226, v254
    v_accvgpr_read_b32 v254, a227
    v_mul_f32 v254, v254, v255
    v_accvgpr_write_b32 a227, v254
    v_accvgpr_read_b32 v254, a228
    v_mul_f32 v254, v254, v255
    v_accvgpr_write_b32 a228, v254
    v_accvgpr_read_b32 v254, a229
    v_mul_f32 v254, v254, v255
    v_accvgpr_write_b32 a229, v254
    v_accvgpr_read_b32 v254, a230
    v_mul_f32 v254, v254, v255
    v_accvgpr_write_b32 a230, v254
    v_accvgpr_read_b32 v254, a231
    v_mul_f32 v254, v254, v255
    v_accvgpr_write_b32 a231, v254
    v_accvgpr_read_b32 v254, a232
    v_mul_f32 v254, v254, v255
    v_accvgpr_write_b32 a232, v254
    v_accvgpr_read_b32 v254, a233
    v_mul_f32 v254, v254, v255
    v_accvgpr_write_b32 a233, v254
    v_accvgpr_read_b32 v254, a234
    v_mul_f32 v254, v254, v255
    v_accvgpr_write_b32 a234, v254
    v_accvgpr_read_b32 v254, a235
    v_mul_f32 v254, v254, v255
    v_accvgpr_write_b32 a235, v254
    v_accvgpr_read_b32 v254, a236
    v_mul_f32 v254, v254, v255
    v_accvgpr_write_b32 a236, v254
    v_accvgpr_read_b32 v254, a237
    v_mul_f32 v254, v254, v255
    v_accvgpr_write_b32 a237, v254
    v_accvgpr_read_b32 v254, a238
    v_mul_f32 v254, v254, v255
    v_accvgpr_write_b32 a238, v254
    v_accvgpr_read_b32 v254, a239
    v_mul_f32 v254, v254, v255
    v_accvgpr_write_b32 a239, v254
    s_nop 1
    s_branch L_ret52
L_slow54:
    s_nop 1
    v_mov_b32 v255, v254
    s_nop 1
    v_permlane32_swap_b32 v254, v255
    v_max_f32 v254, v254, v255
    v_mul_f32 v254, s29, v254
    v_max_f32 v254, v254, v248
    v_sub_f32 v255, v248, v254
    v_exp_f32 v255, v255
    v_mov_b32 v248, v254
    v_mul_f32 v251, v251, v255
    v_mul_f32 v0, v0, v255
    v_mul_f32 v1, v1, v255
    v_mul_f32 v2, v2, v255
    v_mul_f32 v3, v3, v255
    v_mul_f32 v4, v4, v255
    v_mul_f32 v5, v5, v255
    v_mul_f32 v6, v6, v255
    v_mul_f32 v7, v7, v255
    v_mul_f32 v8, v8, v255
    v_mul_f32 v9, v9, v255
    v_mul_f32 v10, v10, v255
    v_mul_f32 v11, v11, v255
    v_mul_f32 v12, v12, v255
    v_mul_f32 v13, v13, v255
    v_mul_f32 v14, v14, v255
    v_mul_f32 v15, v15, v255
    v_mul_f32 v16, v16, v255
    v_mul_f32 v17, v17, v255
    v_mul_f32 v18, v18, v255
    v_mul_f32 v19, v19, v255
    v_mul_f32 v20, v20, v255
    v_mul_f32 v21, v21, v255
    v_mul_f32 v22, v22, v255
    v_mul_f32 v23, v23, v255
    v_mul_f32 v24, v24, v255
    v_mul_f32 v25, v25, v255
    v_mul_f32 v26, v26, v255
    v_mul_f32 v27, v27, v255
    v_mul_f32 v28, v28, v255
    v_mul_f32 v29, v29, v255
    v_mul_f32 v30, v30, v255
    v_mul_f32 v31, v31, v255
    v_mul_f32 v32, v32, v255
    v_mul_f32 v33, v33, v255
    v_mul_f32 v34, v34, v255
    v_mul_f32 v35, v35, v255
    v_mul_f32 v36, v36, v255
    v_mul_f32 v37, v37, v255
    v_mul_f32 v38, v38, v255
    v_mul_f32 v39, v39, v255
    v_mul_f32 v40, v40, v255
    v_mul_f32 v41, v41, v255
    v_mul_f32 v42, v42, v255
    v_mul_f32 v43, v43, v255
    v_mul_f32 v44, v44, v255
    v_mul_f32 v45, v45, v255
    v_mul_f32 v46, v46, v255
    v_mul_f32 v47, v47, v255
    v_accvgpr_read_b32 v254, a144
    v_mul_f32 v254, v254, v255
    v_accvgpr_write_b32 a144, v254
    v_accvgpr_read_b32 v254, a145
    v_mul_f32 v254, v254, v255
    v_accvgpr_write_b32 a145, v254
    v_accvgpr_read_b32 v254, a146
    v_mul_f32 v254, v254, v255
    v_accvgpr_write_b32 a146, v254
    v_accvgpr_read_b32 v254, a147
    v_mul_f32 v254, v254, v255
    v_accvgpr_write_b32 a147, v254
    v_accvgpr_read_b32 v254, a148
    v_mul_f32 v254, v254, v255
    v_accvgpr_write_b32 a148, v254
    v_accvgpr_read_b32 v254, a149
    v_mul_f32 v254, v254, v255
    v_accvgpr_write_b32 a149, v254
    v_accvgpr_read_b32 v254, a150
    v_mul_f32 v254, v254, v255
    v_accvgpr_write_b32 a150, v254
    v_accvgpr_read_b32 v254, a151
    v_mul_f32 v254, v254, v255
    v_accvgpr_write_b32 a151, v254
    v_accvgpr_read_b32 v254, a152
    v_mul_f32 v254, v254, v255
    v_accvgpr_write_b32 a152, v254
    v_accvgpr_read_b32 v254, a153
    v_mul_f32 v254, v254, v255
    v_accvgpr_write_b32 a153, v254
    v_accvgpr_read_b32 v254, a154
    v_mul_f32 v254, v254, v255
    v_accvgpr_write_b32 a154, v254
    v_accvgpr_read_b32 v254, a155
    v_mul_f32 v254, v254, v255
    v_accvgpr_write_b32 a155, v254
    v_accvgpr_read_b32 v254, a156
    v_mul_f32 v254, v254, v255
    v_accvgpr_write_b32 a156, v254
    v_accvgpr_read_b32 v254, a157
    v_mul_f32 v254, v254, v255
    v_accvgpr_write_b32 a157, v254
    v_accvgpr_read_b32 v254, a158
    v_mul_f32 v254, v254, v255
    v_accvgpr_write_b32 a158, v254
    v_accvgpr_read_b32 v254, a159
    v_mul_f32 v254, v254, v255
    v_accvgpr_write_b32 a159, v254
    v_mul_f32 v48, v48, v255
    v_mul_f32 v49, v49, v255
    v_mul_f32 v50, v50, v255
    v_mul_f32 v51, v51, v255
    v_mul_f32 v52, v52, v255
    v_mul_f32 v53, v53, v255
    v_mul_f32 v54, v54, v255
    v_mul_f32 v55, v55, v255
    v_mul_f32 v56, v56, v255
    v_mul_f32 v57, v57, v255
    v_mul_f32 v58, v58, v255
    v_mul_f32 v59, v59, v255
    v_mul_f32 v60, v60, v255
    v_mul_f32 v61, v61, v255
    v_mul_f32 v62, v62, v255
    v_mul_f32 v63, v63, v255
    v_accvgpr_read_b32 v254, a160
    v_mul_f32 v254, v254, v255
    v_accvgpr_write_b32 a160, v254
    v_accvgpr_read_b32 v254, a161
    v_mul_f32 v254, v254, v255
    v_accvgpr_write_b32 a161, v254
    v_accvgpr_read_b32 v254, a162
    v_mul_f32 v254, v254, v255
    v_accvgpr_write_b32 a162, v254
    v_accvgpr_read_b32 v254, a163
    v_mul_f32 v254, v254, v255
    v_accvgpr_write_b32 a163, v254
    v_accvgpr_read_b32 v254, a164
    v_mul_f32 v254, v254, v255
    v_accvgpr_write_b32 a164, v254
    v_accvgpr_read_b32 v254, a165
    v_mul_f32 v254, v254, v255
    v_accvgpr_write_b32 a165, v254
    v_accvgpr_read_b32 v254, a166
    v_mul_f32 v254, v254, v255
    v_accvgpr_write_b32 a166, v254
    v_accvgpr_read_b32 v254, a167
    v_mul_f32 v254, v254, v255
    v_accvgpr_write_b32 a167, v254
    v_accvgpr_read_b32 v254, a168
    v_mul_f32 v254, v254, v255
    v_accvgpr_write_b32 a168, v254
    v_accvgpr_read_b32 v254, a169
    v_mul_f32 v254, v254, v255
    v_accvgpr_write_b32 a169, v254
    v_accvgpr_read_b32 v254, a170
    v_mul_f32 v254, v254, v255
    v_accvgpr_write_b32 a170, v254
    v_accvgpr_read_b32 v254, a171
    v_mul_f32 v254, v254, v255
    v_accvgpr_write_b32 a171, v254
    v_accvgpr_read_b32 v254, a172
    v_mul_f32 v254, v254, v255
    v_accvgpr_write_b32 a172, v254
    v_accvgpr_read_b32 v254, a173
    v_mul_f32 v254, v254, v255
    v_accvgpr_write_b32 a173, v254
    v_accvgpr_read_b32 v254, a174
    v_mul_f32 v254, v254, v255
    v_accvgpr_write_b32 a174, v254
    v_accvgpr_read_b32 v254, a175
    v_mul_f32 v254, v254, v255
    v_accvgpr_write_b32 a175, v254
    s_nop 1
    s_branch L_ret54
L_slow56:
    s_nop 1
    v_mov_b32 v255, v254
    s_nop 1
    v_permlane32_swap_b32 v254, v255
    v_max_f32 v254, v254, v255
    v_mul_f32 v254, s29, v254
    v_max_f32 v254, v254, v249
    v_sub_f32 v255, v249, v254
    v_exp_f32 v255, v255
    v_mov_b32 v249, v254
    v_mul_f32 v252, v252, v255
    v_mul_f32 v64, v64, v255
    v_mul_f32 v65, v65, v255
    v_mul_f32 v66, v66, v255
    v_mul_f32 v67, v67, v255
    v_mul_f32 v68, v68, v255
    v_mul_f32 v69, v69, v255
    v_mul_f32 v70, v70, v255
    v_mul_f32 v71, v71, v255
    v_mul_f32 v72, v72, v255
    v_mul_f32 v73, v73, v255
    v_mul_f32 v74, v74, v255
    v_mul_f32 v75, v75, v255
    v_mul_f32 v76, v76, v255
    v_mul_f32 v77, v77, v255
    v_mul_f32 v78, v78, v255
    v_mul_f32 v79, v79, v255
    v_mul_f32 v80, v80, v255
    v_mul_f32 v81, v81, v255
    v_mul_f32 v82, v82, v255
    v_mul_f32 v83, v83, v255
    v_mul_f32 v84, v84, v255
    v_mul_f32 v85, v85, v255
    v_mul_f32 v86, v86, v255
    v_mul_f32 v87, v87, v255
    v_mul_f32 v88, v88, v255
    v_mul_f32 v89, v89, v255
    v_mul_f32 v90, v90, v255
    v_mul_f32 v91, v91, v255
    v_mul_f32 v92, v92, v255
    v_mul_f32 v93, v93, v255
    v_mul_f32 v94, v94, v255
    v_mul_f32 v95, v95, v255
    v_mul_f32 v96, v96, v255
    v_mul_f32 v97, v97, v255
    v_mul_f32 v98, v98, v255
    v_mul_f32 v99, v99, v255
    v_mul_f32 v100, v100, v255
    v_mul_f32 v101, v101, v255
    v_mul_f32 v102, v102, v255
    v_mul_f32 v103, v103, v255
    v_mul_f32 v104, v104, v255
    v_mul_f32 v105, v105, v255
    v_mul_f32 v106, v106, v255
    v_mul_f32 v107, v107, v255
    v_mul_f32 v108, v108, v255
    v_mul_f32 v109, v109, v255
    v_mul_f32 v110, v110, v255
    v_mul_f32 v111, v111, v255
    v_accvgpr_read_b32 v254, a176
    v_mul_f32 v254, v254, v255
    v_accvgpr_write_b32 a176, v254
    v_accvgpr_read_b32 v254, a177
    v_mul_f32 v254, v254, v255
    v_accvgpr_write_b32 a177, v254
    v_accvgpr_read_b32 v254, a178
    v_mul_f32 v254, v254, v255
    v_accvgpr_write_b32 a178, v254
    v_accvgpr_read_b32 v254, a179
    v_mul_f32 v254, v254, v255
    v_accvgpr_write_b32 a179, v254
    v_accvgpr_read_b32 v254, a180
    v_mul_f32 v254, v254, v255
    v_accvgpr_write_b32 a180, v254
    v_accvgpr_read_b32 v254, a181
    v_mul_f32 v254, v254, v255
    v_accvgpr_write_b32 a181, v254
    v_accvgpr_read_b32 v254, a182
    v_mul_f32 v254, v254, v255
    v_accvgpr_write_b32 a182, v254
    v_accvgpr_read_b32 v254, a183
    v_mul_f32 v254, v254, v255
    v_accvgpr_write_b32 a183, v254
    v_accvgpr_read_b32 v254, a184
    v_mul_f32 v254, v254, v255
    v_accvgpr_write_b32 a184, v254
    v_accvgpr_read_b32 v254, a185
    v_mul_f32 v254, v254, v255
    v_accvgpr_write_b32 a185, v254
    v_accvgpr_read_b32 v254, a186
    v_mul_f32 v254, v254, v255
    v_accvgpr_write_b32 a186, v254
    v_accvgpr_read_b32 v254, a187
    v_mul_f32 v254, v254, v255
    v_accvgpr_write_b32 a187, v254
    v_accvgpr_read_b32 v254, a188
    v_mul_f32 v254, v254, v255
    v_accvgpr_write_b32 a188, v254
    v_accvgpr_read_b32 v254, a189
    v_mul_f32 v254, v254, v255
    v_accvgpr_write_b32 a189, v254
    v_accvgpr_read_b32 v254, a190
    v_mul_f32 v254, v254, v255
    v_accvgpr_write_b32 a190, v254
    v_accvgpr_read_b32 v254, a191
    v_mul_f32 v254, v254, v255
    v_accvgpr_write_b32 a191, v254
    v_mul_f32 v112, v112, v255
    v_mul_f32 v113, v113, v255
    v_mul_f32 v114, v114, v255
    v_mul_f32 v115, v115, v255
    v_mul_f32 v116, v116, v255
    v_mul_f32 v117, v117, v255
    v_mul_f32 v118, v118, v255
    v_mul_f32 v119, v119, v255
    v_mul_f32 v120, v120, v255
    v_mul_f32 v121, v121, v255
    v_mul_f32 v122, v122, v255
    v_mul_f32 v123, v123, v255
    v_mul_f32 v124, v124, v255
    v_mul_f32 v125, v125, v255
    v_mul_f32 v126, v126, v255
    v_mul_f32 v127, v127, v255
    v_accvgpr_read_b32 v254, a192
    v_mul_f32 v254, v254, v255
    v_accvgpr_write_b32 a192, v254
    v_accvgpr_read_b32 v254, a193
    v_mul_f32 v254, v254, v255
    v_accvgpr_write_b32 a193, v254
    v_accvgpr_read_b32 v254, a194
    v_mul_f32 v254, v254, v255
    v_accvgpr_write_b32 a194, v254
    v_accvgpr_read_b32 v254, a195
    v_mul_f32 v254, v254, v255
    v_accvgpr_write_b32 a195, v254
    v_accvgpr_read_b32 v254, a196
    v_mul_f32 v254, v254, v255
    v_accvgpr_write_b32 a196, v254
    v_accvgpr_read_b32 v254, a197
    v_mul_f32 v254, v254, v255
    v_accvgpr_write_b32 a197, v254
    v_accvgpr_read_b32 v254, a198
    v_mul_f32 v254, v254, v255
    v_accvgpr_write_b32 a198, v254
    v_accvgpr_read_b32 v254, a199
    v_mul_f32 v254, v254, v255
    v_accvgpr_write_b32 a199, v254
    v_accvgpr_read_b32 v254, a200
    v_mul_f32 v254, v254, v255
    v_accvgpr_write_b32 a200, v254
    v_accvgpr_read_b32 v254, a201
    v_mul_f32 v254, v254, v255
    v_accvgpr_write_b32 a201, v254
    v_accvgpr_read_b32 v254, a202
    v_mul_f32 v254, v254, v255
    v_accvgpr_write_b32 a202, v254
    v_accvgpr_read_b32 v254, a203
    v_mul_f32 v254, v254, v255
    v_accvgpr_write_b32 a203, v254
    v_accvgpr_read_b32 v254, a204
    v_mul_f32 v254, v254, v255
    v_accvgpr_write_b32 a204, v254
    v_accvgpr_read_b32 v254, a205
    v_mul_f32 v254, v254, v255
    v_accvgpr_write_b32 a205, v254
    v_accvgpr_read_b32 v254, a206
    v_mul_f32 v254, v254, v255
    v_accvgpr_write_b32 a206, v254
    v_accvgpr_read_b32 v254, a207
    v_mul_f32 v254, v254, v255
    v_accvgpr_write_b32 a207, v254
    s_nop 1
    s_branch L_ret56
L_slow58:
    s_nop 1
    v_mov_b32 v255, v254
    s_nop 1
    v_permlane32_swap_b32 v254, v255
    v_max_f32 v254, v254, v255
    v_mul_f32 v254, s29, v254
    v_max_f32 v254, v254, v250
    v_sub_f32 v255, v250, v254
    v_exp_f32 v255, v255
    v_mov_b32 v250, v254
    v_mul_f32 v253, v253, v255
    v_mul_f32 v128, v128, v255
    v_mul_f32 v129, v129, v255
    v_mul_f32 v130, v130, v255
    v_mul_f32 v131, v131, v255
    v_mul_f32 v132, v132, v255
    v_mul_f32 v133, v133, v255
    v_mul_f32 v134, v134, v255
    v_mul_f32 v135, v135, v255
    v_mul_f32 v136, v136, v255
    v_mul_f32 v137, v137, v255
    v_mul_f32 v138, v138, v255
    v_mul_f32 v139, v139, v255
    v_mul_f32 v140, v140, v255
    v_mul_f32 v141, v141, v255
    v_mul_f32 v142, v142, v255
    v_mul_f32 v143, v143, v255
    v_mul_f32 v144, v144, v255
    v_mul_f32 v145, v145, v255
    v_mul_f32 v146, v146, v255
    v_mul_f32 v147, v147, v255
    v_mul_f32 v148, v148, v255
    v_mul_f32 v149, v149, v255
    v_mul_f32 v150, v150, v255
    v_mul_f32 v151, v151, v255
    v_mul_f32 v152, v152, v255
    v_mul_f32 v153, v153, v255
    v_mul_f32 v154, v154, v255
    v_mul_f32 v155, v155, v255
    v_mul_f32 v156, v156, v255
    v_mul_f32 v157, v157, v255
    v_mul_f32 v158, v158, v255
    v_mul_f32 v159, v159, v255
    v_mul_f32 v160, v160, v255
    v_mul_f32 v161, v161, v255
    v_mul_f32 v162, v162, v255
    v_mul_f32 v163, v163, v255
    v_mul_f32 v164, v164, v255
    v_mul_f32 v165, v165, v255
    v_mul_f32 v166, v166, v255
    v_mul_f32 v167, v167, v255
    v_mul_f32 v168, v168, v255
    v_mul_f32 v169, v169, v255
    v_mul_f32 v170, v170, v255
    v_mul_f32 v171, v171, v255
    v_mul_f32 v172, v172, v255
    v_mul_f32 v173, v173, v255
    v_mul_f32 v174, v174, v255
    v_mul_f32 v175, v175, v255
    v_accvgpr_read_b32 v254, a208
    v_mul_f32 v254, v254, v255
    v_accvgpr_write_b32 a208, v254
    v_accvgpr_read_b32 v254, a209
    v_mul_f32 v254, v254, v255
    v_accvgpr_write_b32 a209, v254
    v_accvgpr_read_b32 v254, a210
    v_mul_f32 v254, v254, v255
    v_accvgpr_write_b32 a210, v254
    v_accvgpr_read_b32 v254, a211
    v_mul_f32 v254, v254, v255
    v_accvgpr_write_b32 a211, v254
    v_accvgpr_read_b32 v254, a212
    v_mul_f32 v254, v254, v255
    v_accvgpr_write_b32 a212, v254
    v_accvgpr_read_b32 v254, a213
    v_mul_f32 v254, v254, v255
    v_accvgpr_write_b32 a213, v254
    v_accvgpr_read_b32 v254, a214
    v_mul_f32 v254, v254, v255
    v_accvgpr_write_b32 a214, v254
    v_accvgpr_read_b32 v254, a215
    v_mul_f32 v254, v254, v255
    v_accvgpr_write_b32 a215, v254
    v_accvgpr_read_b32 v254, a216
    v_mul_f32 v254, v254, v255
    v_accvgpr_write_b32 a216, v254
    v_accvgpr_read_b32 v254, a217
    v_mul_f32 v254, v254, v255
    v_accvgpr_write_b32 a217, v254
    v_accvgpr_read_b32 v254, a218
    v_mul_f32 v254, v254, v255
    v_accvgpr_write_b32 a218, v254
    v_accvgpr_read_b32 v254, a219
    v_mul_f32 v254, v254, v255
    v_accvgpr_write_b32 a219, v254
    v_accvgpr_read_b32 v254, a220
    v_mul_f32 v254, v254, v255
    v_accvgpr_write_b32 a220, v254
    v_accvgpr_read_b32 v254, a221
    v_mul_f32 v254, v254, v255
    v_accvgpr_write_b32 a221, v254
    v_accvgpr_read_b32 v254, a222
    v_mul_f32 v254, v254, v255
    v_accvgpr_write_b32 a222, v254
    v_accvgpr_read_b32 v254, a223
    v_mul_f32 v254, v254, v255
    v_accvgpr_write_b32 a223, v254
    v_accvgpr_read_b32 v254, a240
    v_mul_f32 v254, v254, v255
    v_accvgpr_write_b32 a240, v254
    v_accvgpr_read_b32 v254, a241
    v_mul_f32 v254, v254, v255
    v_accvgpr_write_b32 a241, v254
    v_accvgpr_read_b32 v254, a242
    v_mul_f32 v254, v254, v255
    v_accvgpr_write_b32 a242, v254
    v_accvgpr_read_b32 v254, a243
    v_mul_f32 v254, v254, v255
    v_accvgpr_write_b32 a243, v254
    v_accvgpr_read_b32 v254, a244
    v_mul_f32 v254, v254, v255
    v_accvgpr_write_b32 a244, v254
    v_accvgpr_read_b32 v254, a245
    v_mul_f32 v254, v254, v255
    v_accvgpr_write_b32 a245, v254
    v_accvgpr_read_b32 v254, a246
    v_mul_f32 v254, v254, v255
    v_accvgpr_write_b32 a246, v254
    v_accvgpr_read_b32 v254, a247
    v_mul_f32 v254, v254, v255
    v_accvgpr_write_b32 a247, v254
    v_accvgpr_read_b32 v254, a248
    v_mul_f32 v254, v254, v255
    v_accvgpr_write_b32 a248, v254
    v_accvgpr_read_b32 v254, a249
    v_mul_f32 v254, v254, v255
    v_accvgpr_write_b32 a249, v254
    v_accvgpr_read_b32 v254, a250
    v_mul_f32 v254, v254, v255
    v_accvgpr_write_b32 a250, v254
    v_accvgpr_read_b32 v254, a251
    v_mul_f32 v254, v254, v255
    v_accvgpr_write_b32 a251, v254
    v_accvgpr_read_b32 v254, a252
    v_mul_f32 v254, v254, v255
    v_accvgpr_write_b32 a252, v254
    v_accvgpr_read_b32 v254, a253
    v_mul_f32 v254, v254, v255
    v_accvgpr_write_b32 a253, v254
    v_accvgpr_read_b32 v254, a254
    v_mul_f32 v254, v254, v255
    v_accvgpr_write_b32 a254, v254
    v_accvgpr_read_b32 v254, a255
    v_mul_f32 v254, v254, v255
    v_accvgpr_write_b32 a255, v254
    v_accvgpr_read_b32 v254, a224
    v_mul_f32 v254, v254, v255
    v_accvgpr_write_b32 a224, v254
    v_accvgpr_read_b32 v254, a225
    v_mul_f32 v254, v254, v255
    v_accvgpr_write_b32 a225, v254
    v_accvgpr_read_b32 v254, a226
    v_mul_f32 v254, v254, v255
    v_accvgpr_write_b32 a226, v254
    v_accvgpr_read_b32 v254, a227
    v_mul_f32 v254, v254, v255
    v_accvgpr_write_b32 a227, v254
    v_accvgpr_read_b32 v254, a228
    v_mul_f32 v254, v254, v255
    v_accvgpr_write_b32 a228, v254
    v_accvgpr_read_b32 v254, a229
    v_mul_f32 v254, v254, v255
    v_accvgpr_write_b32 a229, v254
    v_accvgpr_read_b32 v254, a230
    v_mul_f32 v254, v254, v255
    v_accvgpr_write_b32 a230, v254
    v_accvgpr_read_b32 v254, a231
    v_mul_f32 v254, v254, v255
    v_accvgpr_write_b32 a231, v254
    v_accvgpr_read_b32 v254, a232
    v_mul_f32 v254, v254, v255
    v_accvgpr_write_b32 a232, v254
    v_accvgpr_read_b32 v254, a233
    v_mul_f32 v254, v254, v255
    v_accvgpr_write_b32 a233, v254
    v_accvgpr_read_b32 v254, a234
    v_mul_f32 v254, v254, v255
    v_accvgpr_write_b32 a234, v254
    v_accvgpr_read_b32 v254, a235
    v_mul_f32 v254, v254, v255
    v_accvgpr_write_b32 a235, v254
    v_accvgpr_read_b32 v254, a236
    v_mul_f32 v254, v254, v255
    v_accvgpr_write_b32 a236, v254
    v_accvgpr_read_b32 v254, a237
    v_mul_f32 v254, v254, v255
    v_accvgpr_write_b32 a237, v254
    v_accvgpr_read_b32 v254, a238
    v_mul_f32 v254, v254, v255
    v_accvgpr_write_b32 a238, v254
    v_accvgpr_read_b32 v254, a239
    v_mul_f32 v254, v254, v255
    v_accvgpr_write_b32 a239, v254
    s_nop 1
    s_branch L_ret58
L_slow60:
    s_nop 1
    v_mov_b32 v255, v254
    s_nop 1
    v_permlane32_swap_b32 v254, v255
    v_max_f32 v254, v254, v255
    v_mul_f32 v254, s29, v254
    v_max_f32 v254, v254, v248
    v_sub_f32 v255, v248, v254
    v_exp_f32 v255, v255
    v_mov_b32 v248, v254
    v_mul_f32 v251, v251, v255
    v_mul_f32 v0, v0, v255
    v_mul_f32 v1, v1, v255
    v_mul_f32 v2, v2, v255
    v_mul_f32 v3, v3, v255
    v_mul_f32 v4, v4, v255
    v_mul_f32 v5, v5, v255
    v_mul_f32 v6, v6, v255
    v_mul_f32 v7, v7, v255
    v_mul_f32 v8, v8, v255
    v_mul_f32 v9, v9, v255
    v_mul_f32 v10, v10, v255
    v_mul_f32 v11, v11, v255
    v_mul_f32 v12, v12, v255
    v_mul_f32 v13, v13, v255
    v_mul_f32 v14, v14, v255
    v_mul_f32 v15, v15, v255
    v_mul_f32 v16, v16, v255
    v_mul_f32 v17, v17, v255
    v_mul_f32 v18, v18, v255
    v_mul_f32 v19, v19, v255
    v_mul_f32 v20, v20, v255
    v_mul_f32 v21, v21, v255
    v_mul_f32 v22, v22, v255
    v_mul_f32 v23, v23, v255
    v_mul_f32 v24, v24, v255
    v_mul_f32 v25, v25, v255
    v_mul_f32 v26, v26, v255
    v_mul_f32 v27, v27, v255
    v_mul_f32 v28, v28, v255
    v_mul_f32 v29, v29, v255
    v_mul_f32 v30, v30, v255
    v_mul_f32 v31, v31, v255
    v_mul_f32 v32, v32, v255
    v_mul_f32 v33, v33, v255
    v_mul_f32 v34, v34, v255
    v_mul_f32 v35, v35, v255
    v_mul_f32 v36, v36, v255
    v_mul_f32 v37, v37, v255
    v_mul_f32 v38, v38, v255
    v_mul_f32 v39, v39, v255
    v_mul_f32 v40, v40, v255
    v_mul_f32 v41, v41, v255
    v_mul_f32 v42, v42, v255
    v_mul_f32 v43, v43, v255
    v_mul_f32 v44, v44, v255
    v_mul_f32 v45, v45, v255
    v_mul_f32 v46, v46, v255
    v_mul_f32 v47, v47, v255
    v_accvgpr_read_b32 v254, a144
    v_mul_f32 v254, v254, v255
    v_accvgpr_write_b32 a144, v254
    v_accvgpr_read_b32 v254, a145
    v_mul_f32 v254, v254, v255
    v_accvgpr_write_b32 a145, v254
    v_accvgpr_read_b32 v254, a146
    v_mul_f32 v254, v254, v255
    v_accvgpr_write_b32 a146, v254
    v_accvgpr_read_b32 v254, a147
    v_mul_f32 v254, v254, v255
    v_accvgpr_write_b32 a147, v254
    v_accvgpr_read_b32 v254, a148
    v_mul_f32 v254, v254, v255
    v_accvgpr_write_b32 a148, v254
    v_accvgpr_read_b32 v254, a149
    v_mul_f32 v254, v254, v255
    v_accvgpr_write_b32 a149, v254
    v_accvgpr_read_b32 v254, a150
    v_mul_f32 v254, v254, v255
    v_accvgpr_write_b32 a150, v254
    v_accvgpr_read_b32 v254, a151
    v_mul_f32 v254, v254, v255
    v_accvgpr_write_b32 a151, v254
    v_accvgpr_read_b32 v254, a152
    v_mul_f32 v254, v254, v255
    v_accvgpr_write_b32 a152, v254
    v_accvgpr_read_b32 v254, a153
    v_mul_f32 v254, v254, v255
    v_accvgpr_write_b32 a153, v254
    v_accvgpr_read_b32 v254, a154
    v_mul_f32 v254, v254, v255
    v_accvgpr_write_b32 a154, v254
    v_accvgpr_read_b32 v254, a155
    v_mul_f32 v254, v254, v255
    v_accvgpr_write_b32 a155, v254
    v_accvgpr_read_b32 v254, a156
    v_mul_f32 v254, v254, v255
    v_accvgpr_write_b32 a156, v254
    v_accvgpr_read_b32 v254, a157
    v_mul_f32 v254, v254, v255
    v_accvgpr_write_b32 a157, v254
    v_accvgpr_read_b32 v254, a158
    v_mul_f32 v254, v254, v255
    v_accvgpr_write_b32 a158, v254
    v_accvgpr_read_b32 v254, a159
    v_mul_f32 v254, v254, v255
    v_accvgpr_write_b32 a159, v254
    v_mul_f32 v48, v48, v255
    v_mul_f32 v49, v49, v255
    v_mul_f32 v50, v50, v255
    v_mul_f32 v51, v51, v255
    v_mul_f32 v52, v52, v255
    v_mul_f32 v53, v53, v255
    v_mul_f32 v54, v54, v255
    v_mul_f32 v55, v55, v255
    v_mul_f32 v56, v56, v255
    v_mul_f32 v57, v57, v255
    v_mul_f32 v58, v58, v255
    v_mul_f32 v59, v59, v255
    v_mul_f32 v60, v60, v255
    v_mul_f32 v61, v61, v255
    v_mul_f32 v62, v62, v255
    v_mul_f32 v63, v63, v255
    v_accvgpr_read_b32 v254, a160
    v_mul_f32 v254, v254, v255
    v_accvgpr_write_b32 a160, v254
    v_accvgpr_read_b32 v254, a161
    v_mul_f32 v254, v254, v255
    v_accvgpr_write_b32 a161, v254
    v_accvgpr_read_b32 v254, a162
    v_mul_f32 v254, v254, v255
    v_accvgpr_write_b32 a162, v254
    v_accvgpr_read_b32 v254, a163
    v_mul_f32 v254, v254, v255
    v_accvgpr_write_b32 a163, v254
    v_accvgpr_read_b32 v254, a164
    v_mul_f32 v254, v254, v255
    v_accvgpr_write_b32 a164, v254
    v_accvgpr_read_b32 v254, a165
    v_mul_f32 v254, v254, v255
    v_accvgpr_write_b32 a165, v254
    v_accvgpr_read_b32 v254, a166
    v_mul_f32 v254, v254, v255
    v_accvgpr_write_b32 a166, v254
    v_accvgpr_read_b32 v254, a167
    v_mul_f32 v254, v254, v255
    v_accvgpr_write_b32 a167, v254
    v_accvgpr_read_b32 v254, a168
    v_mul_f32 v254, v254, v255
    v_accvgpr_write_b32 a168, v254
    v_accvgpr_read_b32 v254, a169
    v_mul_f32 v254, v254, v255
    v_accvgpr_write_b32 a169, v254
    v_accvgpr_read_b32 v254, a170
    v_mul_f32 v254, v254, v255
    v_accvgpr_write_b32 a170, v254
    v_accvgpr_read_b32 v254, a171
    v_mul_f32 v254, v254, v255
    v_accvgpr_write_b32 a171, v254
    v_accvgpr_read_b32 v254, a172
    v_mul_f32 v254, v254, v255
    v_accvgpr_write_b32 a172, v254
    v_accvgpr_read_b32 v254, a173
    v_mul_f32 v254, v254, v255
    v_accvgpr_write_b32 a173, v254
    v_accvgpr_read_b32 v254, a174
    v_mul_f32 v254, v254, v255
    v_accvgpr_write_b32 a174, v254
    v_accvgpr_read_b32 v254, a175
    v_mul_f32 v254, v254, v255
    v_accvgpr_write_b32 a175, v254
    s_nop 1
    s_branch L_ret60
L_slow62:
    s_nop 1
    v_mov_b32 v255, v254
    s_nop 1
    v_permlane32_swap_b32 v254, v255
    v_max_f32 v254, v254, v255
    v_mul_f32 v254, s29, v254
    v_max_f32 v254, v254, v249
    v_sub_f32 v255, v249, v254
    v_exp_f32 v255, v255
    v_mov_b32 v249, v254
    v_mul_f32 v252, v252, v255
    v_mul_f32 v64, v64, v255
    v_mul_f32 v65, v65, v255
    v_mul_f32 v66, v66, v255
    v_mul_f32 v67, v67, v255
    v_mul_f32 v68, v68, v255
    v_mul_f32 v69, v69, v255
    v_mul_f32 v70, v70, v255
    v_mul_f32 v71, v71, v255
    v_mul_f32 v72, v72, v255
    v_mul_f32 v73, v73, v255
    v_mul_f32 v74, v74, v255
    v_mul_f32 v75, v75, v255
    v_mul_f32 v76, v76, v255
    v_mul_f32 v77, v77, v255
    v_mul_f32 v78, v78, v255
    v_mul_f32 v79, v79, v255
    v_mul_f32 v80, v80, v255
    v_mul_f32 v81, v81, v255
    v_mul_f32 v82, v82, v255
    v_mul_f32 v83, v83, v255
    v_mul_f32 v84, v84, v255
    v_mul_f32 v85, v85, v255
    v_mul_f32 v86, v86, v255
    v_mul_f32 v87, v87, v255
    v_mul_f32 v88, v88, v255
    v_mul_f32 v89, v89, v255
    v_mul_f32 v90, v90, v255
    v_mul_f32 v91, v91, v255
    v_mul_f32 v92, v92, v255
    v_mul_f32 v93, v93, v255
    v_mul_f32 v94, v94, v255
    v_mul_f32 v95, v95, v255
    v_mul_f32 v96, v96, v255
    v_mul_f32 v97, v97, v255
    v_mul_f32 v98, v98, v255
    v_mul_f32 v99, v99, v255
    v_mul_f32 v100, v100, v255
    v_mul_f32 v101, v101, v255
    v_mul_f32 v102, v102, v255
    v_mul_f32 v103, v103, v255
    v_mul_f32 v104, v104, v255
    v_mul_f32 v105, v105, v255
    v_mul_f32 v106, v106, v255
    v_mul_f32 v107, v107, v255
    v_mul_f32 v108, v108, v255
    v_mul_f32 v109, v109, v255
    v_mul_f32 v110, v110, v255
    v_mul_f32 v111, v111, v255
    v_accvgpr_read_b32 v254, a176
    v_mul_f32 v254, v254, v255
    v_accvgpr_write_b32 a176, v254
    v_accvgpr_read_b32 v254, a177
    v_mul_f32 v254, v254, v255
    v_accvgpr_write_b32 a177, v254
    v_accvgpr_read_b32 v254, a178
    v_mul_f32 v254, v254, v255
    v_accvgpr_write_b32 a178, v254
    v_accvgpr_read_b32 v254, a179
    v_mul_f32 v254, v254, v255
    v_accvgpr_write_b32 a179, v254
    v_accvgpr_read_b32 v254, a180
    v_mul_f32 v254, v254, v255
    v_accvgpr_write_b32 a180, v254
    v_accvgpr_read_b32 v254, a181
    v_mul_f32 v254, v254, v255
    v_accvgpr_write_b32 a181, v254
    v_accvgpr_read_b32 v254, a182
    v_mul_f32 v254, v254, v255
    v_accvgpr_write_b32 a182, v254
    v_accvgpr_read_b32 v254, a183
    v_mul_f32 v254, v254, v255
    v_accvgpr_write_b32 a183, v254
    v_accvgpr_read_b32 v254, a184
    v_mul_f32 v254, v254, v255
    v_accvgpr_write_b32 a184, v254
    v_accvgpr_read_b32 v254, a185
    v_mul_f32 v254, v254, v255
    v_accvgpr_write_b32 a185, v254
    v_accvgpr_read_b32 v254, a186
    v_mul_f32 v254, v254, v255
    v_accvgpr_write_b32 a186, v254
    v_accvgpr_read_b32 v254, a187
    v_mul_f32 v254, v254, v255
    v_accvgpr_write_b32 a187, v254
    v_accvgpr_read_b32 v254, a188
    v_mul_f32 v254, v254, v255
    v_accvgpr_write_b32 a188, v254
    v_accvgpr_read_b32 v254, a189
    v_mul_f32 v254, v254, v255
    v_accvgpr_write_b32 a189, v254
    v_accvgpr_read_b32 v254, a190
    v_mul_f32 v254, v254, v255
    v_accvgpr_write_b32 a190, v254
    v_accvgpr_read_b32 v254, a191
    v_mul_f32 v254, v254, v255
    v_accvgpr_write_b32 a191, v254
    v_mul_f32 v112, v112, v255
    v_mul_f32 v113, v113, v255
    v_mul_f32 v114, v114, v255
    v_mul_f32 v115, v115, v255
    v_mul_f32 v116, v116, v255
    v_mul_f32 v117, v117, v255
    v_mul_f32 v118, v118, v255
    v_mul_f32 v119, v119, v255
    v_mul_f32 v120, v120, v255
    v_mul_f32 v121, v121, v255
    v_mul_f32 v122, v122, v255
    v_mul_f32 v123, v123, v255
    v_mul_f32 v124, v124, v255
    v_mul_f32 v125, v125, v255
    v_mul_f32 v126, v126, v255
    v_mul_f32 v127, v127, v255
    v_accvgpr_read_b32 v254, a192
    v_mul_f32 v254, v254, v255
    v_accvgpr_write_b32 a192, v254
    v_accvgpr_read_b32 v254, a193
    v_mul_f32 v254, v254, v255
    v_accvgpr_write_b32 a193, v254
    v_accvgpr_read_b32 v254, a194
    v_mul_f32 v254, v254, v255
    v_accvgpr_write_b32 a194, v254
    v_accvgpr_read_b32 v254, a195
    v_mul_f32 v254, v254, v255
    v_accvgpr_write_b32 a195, v254
    v_accvgpr_read_b32 v254, a196
    v_mul_f32 v254, v254, v255
    v_accvgpr_write_b32 a196, v254
    v_accvgpr_read_b32 v254, a197
    v_mul_f32 v254, v254, v255
    v_accvgpr_write_b32 a197, v254
    v_accvgpr_read_b32 v254, a198
    v_mul_f32 v254, v254, v255
    v_accvgpr_write_b32 a198, v254
    v_accvgpr_read_b32 v254, a199
    v_mul_f32 v254, v254, v255
    v_accvgpr_write_b32 a199, v254
    v_accvgpr_read_b32 v254, a200
    v_mul_f32 v254, v254, v255
    v_accvgpr_write_b32 a200, v254
    v_accvgpr_read_b32 v254, a201
    v_mul_f32 v254, v254, v255
    v_accvgpr_write_b32 a201, v254
    v_accvgpr_read_b32 v254, a202
    v_mul_f32 v254, v254, v255
    v_accvgpr_write_b32 a202, v254
    v_accvgpr_read_b32 v254, a203
    v_mul_f32 v254, v254, v255
    v_accvgpr_write_b32 a203, v254
    v_accvgpr_read_b32 v254, a204
    v_mul_f32 v254, v254, v255
    v_accvgpr_write_b32 a204, v254
    v_accvgpr_read_b32 v254, a205
    v_mul_f32 v254, v254, v255
    v_accvgpr_write_b32 a205, v254
    v_accvgpr_read_b32 v254, a206
    v_mul_f32 v254, v254, v255
    v_accvgpr_write_b32 a206, v254
    v_accvgpr_read_b32 v254, a207
    v_mul_f32 v254, v254, v255
    v_accvgpr_write_b32 a207, v254
    s_nop 1
    s_branch L_ret62
L_slow64:
    s_nop 1
    v_mov_b32 v255, v254
    s_nop 1
    v_permlane32_swap_b32 v254, v255
    v_max_f32 v254, v254, v255
    v_mul_f32 v254, s29, v254
    v_max_f32 v254, v254, v250
    v_sub_f32 v255, v250, v254
    v_exp_f32 v255, v255
    v_mov_b32 v250, v254
    v_mul_f32 v253, v253, v255
    v_mul_f32 v128, v128, v255
    v_mul_f32 v129, v129, v255
    v_mul_f32 v130, v130, v255
    v_mul_f32 v131, v131, v255
    v_mul_f32 v132, v132, v255
    v_mul_f32 v133, v133, v255
    v_mul_f32 v134, v134, v255
    v_mul_f32 v135, v135, v255
    v_mul_f32 v136, v136, v255
    v_mul_f32 v137, v137, v255
    v_mul_f32 v138, v138, v255
    v_mul_f32 v139, v139, v255
    v_mul_f32 v140, v140, v255
    v_mul_f32 v141, v141, v255
    v_mul_f32 v142, v142, v255
    v_mul_f32 v143, v143, v255
    v_mul_f32 v144, v144, v255
    v_mul_f32 v145, v145, v255
    v_mul_f32 v146, v146, v255
    v_mul_f32 v147, v147, v255
    v_mul_f32 v148, v148, v255
    v_mul_f32 v149, v149, v255
    v_mul_f32 v150, v150, v255
    v_mul_f32 v151, v151, v255
    v_mul_f32 v152, v152, v255
    v_mul_f32 v153, v153, v255
    v_mul_f32 v154, v154, v255
    v_mul_f32 v155, v155, v255
    v_mul_f32 v156, v156, v255
    v_mul_f32 v157, v157, v255
    v_mul_f32 v158, v158, v255
    v_mul_f32 v159, v159, v255
    v_mul_f32 v160, v160, v255
    v_mul_f32 v161, v161, v255
    v_mul_f32 v162, v162, v255
    v_mul_f32 v163, v163, v255
    v_mul_f32 v164, v164, v255
    v_mul_f32 v165, v165, v255
    v_mul_f32 v166, v166, v255
    v_mul_f32 v167, v167, v255
    v_mul_f32 v168, v168, v255
    v_mul_f32 v169, v169, v255
    v_mul_f32 v170, v170, v255
    v_mul_f32 v171, v171, v255
    v_mul_f32 v172, v172, v255
    v_mul_f32 v173, v173, v255
    v_mul_f32 v174, v174, v255
    v_mul_f32 v175, v175, v255
    v_accvgpr_read_b32 v254, a208
    v_mul_f32 v254, v254, v255
    v_accvgpr_write_b32 a208, v254
    v_accvgpr_read_b32 v254, a209
    v_mul_f32 v254, v254, v255
    v_accvgpr_write_b32 a209, v254
    v_accvgpr_read_b32 v254, a210
    v_mul_f32 v254, v254, v255
    v_accvgpr_write_b32 a210, v254
    v_accvgpr_read_b32 v254, a211
    v_mul_f32 v254, v254, v255
    v_accvgpr_write_b32 a211, v254
    v_accvgpr_read_b32 v254, a212
    v_mul_f32 v254, v254, v255
    v_accvgpr_write_b32 a212, v254
    v_accvgpr_read_b32 v254, a213
    v_mul_f32 v254, v254, v255
    v_accvgpr_write_b32 a213, v254
    v_accvgpr_read_b32 v254, a214
    v_mul_f32 v254, v254, v255
    v_accvgpr_write_b32 a214, v254
    v_accvgpr_read_b32 v254, a215
    v_mul_f32 v254, v254, v255
    v_accvgpr_write_b32 a215, v254
    v_accvgpr_read_b32 v254, a216
    v_mul_f32 v254, v254, v255
    v_accvgpr_write_b32 a216, v254
    v_accvgpr_read_b32 v254, a217
    v_mul_f32 v254, v254, v255
    v_accvgpr_write_b32 a217, v254
    v_accvgpr_read_b32 v254, a218
    v_mul_f32 v254, v254, v255
    v_accvgpr_write_b32 a218, v254
    v_accvgpr_read_b32 v254, a219
    v_mul_f32 v254, v254, v255
    v_accvgpr_write_b32 a219, v254
    v_accvgpr_read_b32 v254, a220
    v_mul_f32 v254, v254, v255
    v_accvgpr_write_b32 a220, v254
    v_accvgpr_read_b32 v254, a221
    v_mul_f32 v254, v254, v255
    v_accvgpr_write_b32 a221, v254
    v_accvgpr_read_b32 v254, a222
    v_mul_f32 v254, v254, v255
    v_accvgpr_write_b32 a222, v254
    v_accvgpr_read_b32 v254, a223
    v_mul_f32 v254, v254, v255
    v_accvgpr_write_b32 a223, v254
    v_accvgpr_read_b32 v254, a240
    v_mul_f32 v254, v254, v255
    v_accvgpr_write_b32 a240, v254
    v_accvgpr_read_b32 v254, a241
    v_mul_f32 v254, v254, v255
    v_accvgpr_write_b32 a241, v254
    v_accvgpr_read_b32 v254, a242
    v_mul_f32 v254, v254, v255
    v_accvgpr_write_b32 a242, v254
    v_accvgpr_read_b32 v254, a243
    v_mul_f32 v254, v254, v255
    v_accvgpr_write_b32 a243, v254
    v_accvgpr_read_b32 v254, a244
    v_mul_f32 v254, v254, v255
    v_accvgpr_write_b32 a244, v254
    v_accvgpr_read_b32 v254, a245
    v_mul_f32 v254, v254, v255
    v_accvgpr_write_b32 a245, v254
    v_accvgpr_read_b32 v254, a246
    v_mul_f32 v254, v254, v255
    v_accvgpr_write_b32 a246, v254
    v_accvgpr_read_b32 v254, a247
    v_mul_f32 v254, v254, v255
    v_accvgpr_write_b32 a247, v254
    v_accvgpr_read_b32 v254, a248
    v_mul_f32 v254, v254, v255
    v_accvgpr_write_b32 a248, v254
    v_accvgpr_read_b32 v254, a249
    v_mul_f32 v254, v254, v255
    v_accvgpr_write_b32 a249, v254
    v_accvgpr_read_b32 v254, a250
    v_mul_f32 v254, v254, v255
    v_accvgpr_write_b32 a250, v254
    v_accvgpr_read_b32 v254, a251
    v_mul_f32 v254, v254, v255
    v_accvgpr_write_b32 a251, v254
    v_accvgpr_read_b32 v254, a252
    v_mul_f32 v254, v254, v255
    v_accvgpr_write_b32 a252, v254
    v_accvgpr_read_b32 v254, a253
    v_mul_f32 v254, v254, v255
    v_accvgpr_write_b32 a253, v254
    v_accvgpr_read_b32 v254, a254
    v_mul_f32 v254, v254, v255
    v_accvgpr_write_b32 a254, v254
    v_accvgpr_read_b32 v254, a255
    v_mul_f32 v254, v254, v255
    v_accvgpr_write_b32 a255, v254
    v_accvgpr_read_b32 v254, a224
    v_mul_f32 v254, v254, v255
    v_accvgpr_write_b32 a224, v254
    v_accvgpr_read_b32 v254, a225
    v_mul_f32 v254, v254, v255
    v_accvgpr_write_b32 a225, v254
    v_accvgpr_read_b32 v254, a226
    v_mul_f32 v254, v254, v255
    v_accvgpr_write_b32 a226, v254
    v_accvgpr_read_b32 v254, a227
    v_mul_f32 v254, v254, v255
    v_accvgpr_write_b32 a227, v254
    v_accvgpr_read_b32 v254, a228
    v_mul_f32 v254, v254, v255
    v_accvgpr_write_b32 a228, v254
    v_accvgpr_read_b32 v254, a229
    v_mul_f32 v254, v254, v255
    v_accvgpr_write_b32 a229, v254
    v_accvgpr_read_b32 v254, a230
    v_mul_f32 v254, v254, v255
    v_accvgpr_write_b32 a230, v254
    v_accvgpr_read_b32 v254, a231
    v_mul_f32 v254, v254, v255
    v_accvgpr_write_b32 a231, v254
    v_accvgpr_read_b32 v254, a232
    v_mul_f32 v254, v254, v255
    v_accvgpr_write_b32 a232, v254
    v_accvgpr_read_b32 v254, a233
    v_mul_f32 v254, v254, v255
    v_accvgpr_write_b32 a233, v254
    v_accvgpr_read_b32 v254, a234
    v_mul_f32 v254, v254, v255
    v_accvgpr_write_b32 a234, v254
    v_accvgpr_read_b32 v254, a235
    v_mul_f32 v254, v254, v255
    v_accvgpr_write_b32 a235, v254
    v_accvgpr_read_b32 v254, a236
    v_mul_f32 v254, v254, v255
    v_accvgpr_write_b32 a236, v254
    v_accvgpr_read_b32 v254, a237
    v_mul_f32 v254, v254, v255
    v_accvgpr_write_b32 a237, v254
    v_accvgpr_read_b32 v254, a238
    v_mul_f32 v254, v254, v255
    v_accvgpr_write_b32 a238, v254
    v_accvgpr_read_b32 v254, a239
    v_mul_f32 v254, v254, v255
    v_accvgpr_write_b32 a239, v254
    s_nop 1
    s_branch L_ret64
L_slow66:
    s_nop 1
    v_mov_b32 v255, v254
    s_nop 1
    v_permlane32_swap_b32 v254, v255
    v_max_f32 v254, v254, v255
    v_mul_f32 v254, s29, v254
    v_max_f32 v254, v254, v248
    v_sub_f32 v255, v248, v254
    v_exp_f32 v255, v255
    v_mov_b32 v248, v254
    v_mul_f32 v251, v251, v255
    v_mul_f32 v0, v0, v255
    v_mul_f32 v1, v1, v255
    v_mul_f32 v2, v2, v255
    v_mul_f32 v3, v3, v255
    v_mul_f32 v4, v4, v255
    v_mul_f32 v5, v5, v255
    v_mul_f32 v6, v6, v255
    v_mul_f32 v7, v7, v255
    v_mul_f32 v8, v8, v255
    v_mul_f32 v9, v9, v255
    v_mul_f32 v10, v10, v255
    v_mul_f32 v11, v11, v255
    v_mul_f32 v12, v12, v255
    v_mul_f32 v13, v13, v255
    v_mul_f32 v14, v14, v255
    v_mul_f32 v15, v15, v255
    v_mul_f32 v16, v16, v255
    v_mul_f32 v17, v17, v255
    v_mul_f32 v18, v18, v255
    v_mul_f32 v19, v19, v255
    v_mul_f32 v20, v20, v255
    v_mul_f32 v21, v21, v255
    v_mul_f32 v22, v22, v255
    v_mul_f32 v23, v23, v255
    v_mul_f32 v24, v24, v255
    v_mul_f32 v25, v25, v255
    v_mul_f32 v26, v26, v255
    v_mul_f32 v27, v27, v255
    v_mul_f32 v28, v28, v255
    v_mul_f32 v29, v29, v255
    v_mul_f32 v30, v30, v255
    v_mul_f32 v31, v31, v255
    v_mul_f32 v32, v32, v255
    v_mul_f32 v33, v33, v255
    v_mul_f32 v34, v34, v255
    v_mul_f32 v35, v35, v255
    v_mul_f32 v36, v36, v255
    v_mul_f32 v37, v37, v255
    v_mul_f32 v38, v38, v255
    v_mul_f32 v39, v39, v255
    v_mul_f32 v40, v40, v255
    v_mul_f32 v41, v41, v255
    v_mul_f32 v42, v42, v255
    v_mul_f32 v43, v43, v255
    v_mul_f32 v44, v44, v255
    v_mul_f32 v45, v45, v255
    v_mul_f32 v46, v46, v255
    v_mul_f32 v47, v47, v255
    v_accvgpr_read_b32 v254, a144
    v_mul_f32 v254, v254, v255
    v_accvgpr_write_b32 a144, v254
    v_accvgpr_read_b32 v254, a145
    v_mul_f32 v254, v254, v255
    v_accvgpr_write_b32 a145, v254
    v_accvgpr_read_b32 v254, a146
    v_mul_f32 v254, v254, v255
    v_accvgpr_write_b32 a146, v254
    v_accvgpr_read_b32 v254, a147
    v_mul_f32 v254, v254, v255
    v_accvgpr_write_b32 a147, v254
    v_accvgpr_read_b32 v254, a148
    v_mul_f32 v254, v254, v255
    v_accvgpr_write_b32 a148, v254
    v_accvgpr_read_b32 v254, a149
    v_mul_f32 v254, v254, v255
    v_accvgpr_write_b32 a149, v254
    v_accvgpr_read_b32 v254, a150
    v_mul_f32 v254, v254, v255
    v_accvgpr_write_b32 a150, v254
    v_accvgpr_read_b32 v254, a151
    v_mul_f32 v254, v254, v255
    v_accvgpr_write_b32 a151, v254
    v_accvgpr_read_b32 v254, a152
    v_mul_f32 v254, v254, v255
    v_accvgpr_write_b32 a152, v254
    v_accvgpr_read_b32 v254, a153
    v_mul_f32 v254, v254, v255
    v_accvgpr_write_b32 a153, v254
    v_accvgpr_read_b32 v254, a154
    v_mul_f32 v254, v254, v255
    v_accvgpr_write_b32 a154, v254
    v_accvgpr_read_b32 v254, a155
    v_mul_f32 v254, v254, v255
    v_accvgpr_write_b32 a155, v254
    v_accvgpr_read_b32 v254, a156
    v_mul_f32 v254, v254, v255
    v_accvgpr_write_b32 a156, v254
    v_accvgpr_read_b32 v254, a157
    v_mul_f32 v254, v254, v255
    v_accvgpr_write_b32 a157, v254
    v_accvgpr_read_b32 v254, a158
    v_mul_f32 v254, v254, v255
    v_accvgpr_write_b32 a158, v254
    v_accvgpr_read_b32 v254, a159
    v_mul_f32 v254, v254, v255
    v_accvgpr_write_b32 a159, v254
    v_mul_f32 v48, v48, v255
    v_mul_f32 v49, v49, v255
    v_mul_f32 v50, v50, v255
    v_mul_f32 v51, v51, v255
    v_mul_f32 v52, v52, v255
    v_mul_f32 v53, v53, v255
    v_mul_f32 v54, v54, v255
    v_mul_f32 v55, v55, v255
    v_mul_f32 v56, v56, v255
    v_mul_f32 v57, v57, v255
    v_mul_f32 v58, v58, v255
    v_mul_f32 v59, v59, v255
    v_mul_f32 v60, v60, v255
    v_mul_f32 v61, v61, v255
    v_mul_f32 v62, v62, v255
    v_mul_f32 v63, v63, v255
    v_accvgpr_read_b32 v254, a160
    v_mul_f32 v254, v254, v255
    v_accvgpr_write_b32 a160, v254
    v_accvgpr_read_b32 v254, a161
    v_mul_f32 v254, v254, v255
    v_accvgpr_write_b32 a161, v254
    v_accvgpr_read_b32 v254, a162
    v_mul_f32 v254, v254, v255
    v_accvgpr_write_b32 a162, v254
    v_accvgpr_read_b32 v254, a163
    v_mul_f32 v254, v254, v255
    v_accvgpr_write_b32 a163, v254
    v_accvgpr_read_b32 v254, a164
    v_mul_f32 v254, v254, v255
    v_accvgpr_write_b32 a164, v254
    v_accvgpr_read_b32 v254, a165
    v_mul_f32 v254, v254, v255
    v_accvgpr_write_b32 a165, v254
    v_accvgpr_read_b32 v254, a166
    v_mul_f32 v254, v254, v255
    v_accvgpr_write_b32 a166, v254
    v_accvgpr_read_b32 v254, a167
    v_mul_f32 v254, v254, v255
    v_accvgpr_write_b32 a167, v254
    v_accvgpr_read_b32 v254, a168
    v_mul_f32 v254, v254, v255
    v_accvgpr_write_b32 a168, v254
    v_accvgpr_read_b32 v254, a169
    v_mul_f32 v254, v254, v255
    v_accvgpr_write_b32 a169, v254
    v_accvgpr_read_b32 v254, a170
    v_mul_f32 v254, v254, v255
    v_accvgpr_write_b32 a170, v254
    v_accvgpr_read_b32 v254, a171
    v_mul_f32 v254, v254, v255
    v_accvgpr_write_b32 a171, v254
    v_accvgpr_read_b32 v254, a172
    v_mul_f32 v254, v254, v255
    v_accvgpr_write_b32 a172, v254
    v_accvgpr_read_b32 v254, a173
    v_mul_f32 v254, v254, v255
    v_accvgpr_write_b32 a173, v254
    v_accvgpr_read_b32 v254, a174
    v_mul_f32 v254, v254, v255
    v_accvgpr_write_b32 a174, v254
    v_accvgpr_read_b32 v254, a175
    v_mul_f32 v254, v254, v255
    v_accvgpr_write_b32 a175, v254
    s_nop 1
    s_branch L_ret66
L_slow68:
    s_nop 1
    v_mov_b32 v255, v254
    s_nop 1
    v_permlane32_swap_b32 v254, v255
    v_max_f32 v254, v254, v255
    v_mul_f32 v254, s29, v254
    v_max_f32 v254, v254, v249
    v_sub_f32 v255, v249, v254
    v_exp_f32 v255, v255
    v_mov_b32 v249, v254
    v_mul_f32 v252, v252, v255
    v_mul_f32 v64, v64, v255
    v_mul_f32 v65, v65, v255
    v_mul_f32 v66, v66, v255
    v_mul_f32 v67, v67, v255
    v_mul_f32 v68, v68, v255
    v_mul_f32 v69, v69, v255
    v_mul_f32 v70, v70, v255
    v_mul_f32 v71, v71, v255
    v_mul_f32 v72, v72, v255
    v_mul_f32 v73, v73, v255
    v_mul_f32 v74, v74, v255
    v_mul_f32 v75, v75, v255
    v_mul_f32 v76, v76, v255
    v_mul_f32 v77, v77, v255
    v_mul_f32 v78, v78, v255
    v_mul_f32 v79, v79, v255
    v_mul_f32 v80, v80, v255
    v_mul_f32 v81, v81, v255
    v_mul_f32 v82, v82, v255
    v_mul_f32 v83, v83, v255
    v_mul_f32 v84, v84, v255
    v_mul_f32 v85, v85, v255
    v_mul_f32 v86, v86, v255
    v_mul_f32 v87, v87, v255
    v_mul_f32 v88, v88, v255
    v_mul_f32 v89, v89, v255
    v_mul_f32 v90, v90, v255
    v_mul_f32 v91, v91, v255
    v_mul_f32 v92, v92, v255
    v_mul_f32 v93, v93, v255
    v_mul_f32 v94, v94, v255
    v_mul_f32 v95, v95, v255
    v_mul_f32 v96, v96, v255
    v_mul_f32 v97, v97, v255
    v_mul_f32 v98, v98, v255
    v_mul_f32 v99, v99, v255
    v_mul_f32 v100, v100, v255
    v_mul_f32 v101, v101, v255
    v_mul_f32 v102, v102, v255
    v_mul_f32 v103, v103, v255
    v_mul_f32 v104, v104, v255
    v_mul_f32 v105, v105, v255
    v_mul_f32 v106, v106, v255
    v_mul_f32 v107, v107, v255
    v_mul_f32 v108, v108, v255
    v_mul_f32 v109, v109, v255
    v_mul_f32 v110, v110, v255
    v_mul_f32 v111, v111, v255
    v_accvgpr_read_b32 v254, a176
    v_mul_f32 v254, v254, v255
    v_accvgpr_write_b32 a176, v254
    v_accvgpr_read_b32 v254, a177
    v_mul_f32 v254, v254, v255
    v_accvgpr_write_b32 a177, v254
    v_accvgpr_read_b32 v254, a178
    v_mul_f32 v254, v254, v255
    v_accvgpr_write_b32 a178, v254
    v_accvgpr_read_b32 v254, a179
    v_mul_f32 v254, v254, v255
    v_accvgpr_write_b32 a179, v254
    v_accvgpr_read_b32 v254, a180
    v_mul_f32 v254, v254, v255
    v_accvgpr_write_b32 a180, v254
    v_accvgpr_read_b32 v254, a181
    v_mul_f32 v254, v254, v255
    v_accvgpr_write_b32 a181, v254
    v_accvgpr_read_b32 v254, a182
    v_mul_f32 v254, v254, v255
    v_accvgpr_write_b32 a182, v254
    v_accvgpr_read_b32 v254, a183
    v_mul_f32 v254, v254, v255
    v_accvgpr_write_b32 a183, v254
    v_accvgpr_read_b32 v254, a184
    v_mul_f32 v254, v254, v255
    v_accvgpr_write_b32 a184, v254
    v_accvgpr_read_b32 v254, a185
    v_mul_f32 v254, v254, v255
    v_accvgpr_write_b32 a185, v254
    v_accvgpr_read_b32 v254, a186
    v_mul_f32 v254, v254, v255
    v_accvgpr_write_b32 a186, v254
    v_accvgpr_read_b32 v254, a187
    v_mul_f32 v254, v254, v255
    v_accvgpr_write_b32 a187, v254
    v_accvgpr_read_b32 v254, a188
    v_mul_f32 v254, v254, v255
    v_accvgpr_write_b32 a188, v254
    v_accvgpr_read_b32 v254, a189
    v_mul_f32 v254, v254, v255
    v_accvgpr_write_b32 a189, v254
    v_accvgpr_read_b32 v254, a190
    v_mul_f32 v254, v254, v255
    v_accvgpr_write_b32 a190, v254
    v_accvgpr_read_b32 v254, a191
    v_mul_f32 v254, v254, v255
    v_accvgpr_write_b32 a191, v254
    v_mul_f32 v112, v112, v255
    v_mul_f32 v113, v113, v255
    v_mul_f32 v114, v114, v255
    v_mul_f32 v115, v115, v255
    v_mul_f32 v116, v116, v255
    v_mul_f32 v117, v117, v255
    v_mul_f32 v118, v118, v255
    v_mul_f32 v119, v119, v255
    v_mul_f32 v120, v120, v255
    v_mul_f32 v121, v121, v255
    v_mul_f32 v122, v122, v255
    v_mul_f32 v123, v123, v255
    v_mul_f32 v124, v124, v255
    v_mul_f32 v125, v125, v255
    v_mul_f32 v126, v126, v255
    v_mul_f32 v127, v127, v255
    v_accvgpr_read_b32 v254, a192
    v_mul_f32 v254, v254, v255
    v_accvgpr_write_b32 a192, v254
    v_accvgpr_read_b32 v254, a193
    v_mul_f32 v254, v254, v255
    v_accvgpr_write_b32 a193, v254
    v_accvgpr_read_b32 v254, a194
    v_mul_f32 v254, v254, v255
    v_accvgpr_write_b32 a194, v254
    v_accvgpr_read_b32 v254, a195
    v_mul_f32 v254, v254, v255
    v_accvgpr_write_b32 a195, v254
    v_accvgpr_read_b32 v254, a196
    v_mul_f32 v254, v254, v255
    v_accvgpr_write_b32 a196, v254
    v_accvgpr_read_b32 v254, a197
    v_mul_f32 v254, v254, v255
    v_accvgpr_write_b32 a197, v254
    v_accvgpr_read_b32 v254, a198
    v_mul_f32 v254, v254, v255
    v_accvgpr_write_b32 a198, v254
    v_accvgpr_read_b32 v254, a199
    v_mul_f32 v254, v254, v255
    v_accvgpr_write_b32 a199, v254
    v_accvgpr_read_b32 v254, a200
    v_mul_f32 v254, v254, v255
    v_accvgpr_write_b32 a200, v254
    v_accvgpr_read_b32 v254, a201
    v_mul_f32 v254, v254, v255
    v_accvgpr_write_b32 a201, v254
    v_accvgpr_read_b32 v254, a202
    v_mul_f32 v254, v254, v255
    v_accvgpr_write_b32 a202, v254
    v_accvgpr_read_b32 v254, a203
    v_mul_f32 v254, v254, v255
    v_accvgpr_write_b32 a203, v254
    v_accvgpr_read_b32 v254, a204
    v_mul_f32 v254, v254, v255
    v_accvgpr_write_b32 a204, v254
    v_accvgpr_read_b32 v254, a205
    v_mul_f32 v254, v254, v255
    v_accvgpr_write_b32 a205, v254
    v_accvgpr_read_b32 v254, a206
    v_mul_f32 v254, v254, v255
    v_accvgpr_write_b32 a206, v254
    v_accvgpr_read_b32 v254, a207
    v_mul_f32 v254, v254, v255
    v_accvgpr_write_b32 a207, v254
    s_nop 1
    s_branch L_ret68
L_slow70:
    s_nop 1
    v_mov_b32 v255, v254
    s_nop 1
    v_permlane32_swap_b32 v254, v255
    v_max_f32 v254, v254, v255
    v_mul_f32 v254, s29, v254
    v_max_f32 v254, v254, v250
    v_sub_f32 v255, v250, v254
    v_exp_f32 v255, v255
    v_mov_b32 v250, v254
    v_mul_f32 v253, v253, v255
    v_mul_f32 v128, v128, v255
    v_mul_f32 v129, v129, v255
    v_mul_f32 v130, v130, v255
    v_mul_f32 v131, v131, v255
    v_mul_f32 v132, v132, v255
    v_mul_f32 v133, v133, v255
    v_mul_f32 v134, v134, v255
    v_mul_f32 v135, v135, v255
    v_mul_f32 v136, v136, v255
    v_mul_f32 v137, v137, v255
    v_mul_f32 v138, v138, v255
    v_mul_f32 v139, v139, v255
    v_mul_f32 v140, v140, v255
    v_mul_f32 v141, v141, v255
    v_mul_f32 v142, v142, v255
    v_mul_f32 v143, v143, v255
    v_mul_f32 v144, v144, v255
    v_mul_f32 v145, v145, v255
    v_mul_f32 v146, v146, v255
    v_mul_f32 v147, v147, v255
    v_mul_f32 v148, v148, v255
    v_mul_f32 v149, v149, v255
    v_mul_f32 v150, v150, v255
    v_mul_f32 v151, v151, v255
    v_mul_f32 v152, v152, v255
    v_mul_f32 v153, v153, v255
    v_mul_f32 v154, v154, v255
    v_mul_f32 v155, v155, v255
    v_mul_f32 v156, v156, v255
    v_mul_f32 v157, v157, v255
    v_mul_f32 v158, v158, v255
    v_mul_f32 v159, v159, v255
    v_mul_f32 v160, v160, v255
    v_mul_f32 v161, v161, v255
    v_mul_f32 v162, v162, v255
    v_mul_f32 v163, v163, v255
    v_mul_f32 v164, v164, v255
    v_mul_f32 v165, v165, v255
    v_mul_f32 v166, v166, v255
    v_mul_f32 v167, v167, v255
    v_mul_f32 v168, v168, v255
    v_mul_f32 v169, v169, v255
    v_mul_f32 v170, v170, v255
    v_mul_f32 v171, v171, v255
    v_mul_f32 v172, v172, v255
    v_mul_f32 v173, v173, v255
    v_mul_f32 v174, v174, v255
    v_mul_f32 v175, v175, v255
    v_accvgpr_read_b32 v254, a208
    v_mul_f32 v254, v254, v255
    v_accvgpr_write_b32 a208, v254
    v_accvgpr_read_b32 v254, a209
    v_mul_f32 v254, v254, v255
    v_accvgpr_write_b32 a209, v254
    v_accvgpr_read_b32 v254, a210
    v_mul_f32 v254, v254, v255
    v_accvgpr_write_b32 a210, v254
    v_accvgpr_read_b32 v254, a211
    v_mul_f32 v254, v254, v255
    v_accvgpr_write_b32 a211, v254
    v_accvgpr_read_b32 v254, a212
    v_mul_f32 v254, v254, v255
    v_accvgpr_write_b32 a212, v254
    v_accvgpr_read_b32 v254, a213
    v_mul_f32 v254, v254, v255
    v_accvgpr_write_b32 a213, v254
    v_accvgpr_read_b32 v254, a214
    v_mul_f32 v254, v254, v255
    v_accvgpr_write_b32 a214, v254
    v_accvgpr_read_b32 v254, a215
    v_mul_f32 v254, v254, v255
    v_accvgpr_write_b32 a215, v254
    v_accvgpr_read_b32 v254, a216
    v_mul_f32 v254, v254, v255
    v_accvgpr_write_b32 a216, v254
    v_accvgpr_read_b32 v254, a217
    v_mul_f32 v254, v254, v255
    v_accvgpr_write_b32 a217, v254
    v_accvgpr_read_b32 v254, a218
    v_mul_f32 v254, v254, v255
    v_accvgpr_write_b32 a218, v254
    v_accvgpr_read_b32 v254, a219
    v_mul_f32 v254, v254, v255
    v_accvgpr_write_b32 a219, v254
    v_accvgpr_read_b32 v254, a220
    v_mul_f32 v254, v254, v255
    v_accvgpr_write_b32 a220, v254
    v_accvgpr_read_b32 v254, a221
    v_mul_f32 v254, v254, v255
    v_accvgpr_write_b32 a221, v254
    v_accvgpr_read_b32 v254, a222
    v_mul_f32 v254, v254, v255
    v_accvgpr_write_b32 a222, v254
    v_accvgpr_read_b32 v254, a223
    v_mul_f32 v254, v254, v255
    v_accvgpr_write_b32 a223, v254
    v_accvgpr_read_b32 v254, a240
    v_mul_f32 v254, v254, v255
    v_accvgpr_write_b32 a240, v254
    v_accvgpr_read_b32 v254, a241
    v_mul_f32 v254, v254, v255
    v_accvgpr_write_b32 a241, v254
    v_accvgpr_read_b32 v254, a242
    v_mul_f32 v254, v254, v255
    v_accvgpr_write_b32 a242, v254
    v_accvgpr_read_b32 v254, a243
    v_mul_f32 v254, v254, v255
    v_accvgpr_write_b32 a243, v254
    v_accvgpr_read_b32 v254, a244
    v_mul_f32 v254, v254, v255
    v_accvgpr_write_b32 a244, v254
    v_accvgpr_read_b32 v254, a245
    v_mul_f32 v254, v254, v255
    v_accvgpr_write_b32 a245, v254
    v_accvgpr_read_b32 v254, a246
    v_mul_f32 v254, v254, v255
    v_accvgpr_write_b32 a246, v254
    v_accvgpr_read_b32 v254, a247
    v_mul_f32 v254, v254, v255
    v_accvgpr_write_b32 a247, v254
    v_accvgpr_read_b32 v254, a248
    v_mul_f32 v254, v254, v255
    v_accvgpr_write_b32 a248, v254
    v_accvgpr_read_b32 v254, a249
    v_mul_f32 v254, v254, v255
    v_accvgpr_write_b32 a249, v254
    v_accvgpr_read_b32 v254, a250
    v_mul_f32 v254, v254, v255
    v_accvgpr_write_b32 a250, v254
    v_accvgpr_read_b32 v254, a251
    v_mul_f32 v254, v254, v255
    v_accvgpr_write_b32 a251, v254
    v_accvgpr_read_b32 v254, a252
    v_mul_f32 v254, v254, v255
    v_accvgpr_write_b32 a252, v254
    v_accvgpr_read_b32 v254, a253
    v_mul_f32 v254, v254, v255
    v_accvgpr_write_b32 a253, v254
    v_accvgpr_read_b32 v254, a254
    v_mul_f32 v254, v254, v255
    v_accvgpr_write_b32 a254, v254
    v_accvgpr_read_b32 v254, a255
    v_mul_f32 v254, v254, v255
    v_accvgpr_write_b32 a255, v254
    v_accvgpr_read_b32 v254, a224
    v_mul_f32 v254, v254, v255
    v_accvgpr_write_b32 a224, v254
    v_accvgpr_read_b32 v254, a225
    v_mul_f32 v254, v254, v255
    v_accvgpr_write_b32 a225, v254
    v_accvgpr_read_b32 v254, a226
    v_mul_f32 v254, v254, v255
    v_accvgpr_write_b32 a226, v254
    v_accvgpr_read_b32 v254, a227
    v_mul_f32 v254, v254, v255
    v_accvgpr_write_b32 a227, v254
    v_accvgpr_read_b32 v254, a228
    v_mul_f32 v254, v254, v255
    v_accvgpr_write_b32 a228, v254
    v_accvgpr_read_b32 v254, a229
    v_mul_f32 v254, v254, v255
    v_accvgpr_write_b32 a229, v254
    v_accvgpr_read_b32 v254, a230
    v_mul_f32 v254, v254, v255
    v_accvgpr_write_b32 a230, v254
    v_accvgpr_read_b32 v254, a231
    v_mul_f32 v254, v254, v255
    v_accvgpr_write_b32 a231, v254
    v_accvgpr_read_b32 v254, a232
    v_mul_f32 v254, v254, v255
    v_accvgpr_write_b32 a232, v254
    v_accvgpr_read_b32 v254, a233
    v_mul_f32 v254, v254, v255
    v_accvgpr_write_b32 a233, v254
    v_accvgpr_read_b32 v254, a234
    v_mul_f32 v254, v254, v255
    v_accvgpr_write_b32 a234, v254
    v_accvgpr_read_b32 v254, a235
    v_mul_f32 v254, v254, v255
    v_accvgpr_write_b32 a235, v254
    v_accvgpr_read_b32 v254, a236
    v_mul_f32 v254, v254, v255
    v_accvgpr_write_b32 a236, v254
    v_accvgpr_read_b32 v254, a237
    v_mul_f32 v254, v254, v255
    v_accvgpr_write_b32 a237, v254
    v_accvgpr_read_b32 v254, a238
    v_mul_f32 v254, v254, v255
    v_accvgpr_write_b32 a238, v254
    v_accvgpr_read_b32 v254, a239
    v_mul_f32 v254, v254, v255
    v_accvgpr_write_b32 a239, v254
    s_nop 1
    s_branch L_ret70
.section .rodata,"a"
.p2align 6
.amdhsa_kernel standalone__mha_softmax__near_ridge_kernel
  .amdhsa_next_free_vgpr 512
  .amdhsa_next_free_sgpr 96
  .amdhsa_accum_offset 256
  .amdhsa_group_segment_fixed_size 0
  .amdhsa_kernarg_size 48
  .amdhsa_user_sgpr_count 2
  .amdhsa_user_sgpr_kernarg_segment_ptr 1
  .amdhsa_system_sgpr_workgroup_id_x 1
.end_amdhsa_kernel
```
